```python
import torch

def _softmax(x, axis=-1):
    return torch.softmax(x, dim=axis)
def _gelu(x):
    return torch.nn.functional.gelu(x, approximate="tanh")
def _silu(x):
    return torch.nn.functional.silu(x)
def _sigmoid(x):
    return torch.sigmoid(x)
def _layernorm(x, axis=-1, eps=1e-5):
    m = x.mean(dim=axis, keepdim=True)
    v = x.var(dim=axis, keepdim=True, unbiased=False)
    return (x - m) / torch.sqrt(v + eps)
def _scatter_add(tgt, idx, src, axis=0):
    return tgt.clone().index_add_(axis, idx, src)
def _segment_sum(src, seg, n):
    out = torch.zeros((n,) + src.shape[1:], dtype=src.dtype)
    return out.index_add_(0, seg, src)
def _pad(x, pw):
    flat = tuple(v for pair in reversed(pw) for v in pair)
    return torch.nn.functional.pad(x, flat)

kernel_name = 'recurrent_scan__compressed_kv_cla__geglu_ffn__prompt'

def setup_inputs():

    _w = (lambda a: (lambda t: t.to(torch.bfloat16) if t.is_floating_point() else t)(torch.as_tensor(a)))
    def _A_setup():
        B, H, Sq, Sk, D, M = 1, 32, 2048, 2048, 128, 512
        Dc = 4 * D
        return {
            "x": _w((lambda *s: torch.randn(*s, dtype=torch.bfloat16) * 0.05)(B, Sq, M)),
            "c_kv": _w((lambda *s: torch.randn(*s, dtype=torch.bfloat16) * 0.2)(B, Sk, Dc)),
            "w_q": _w((lambda *s: torch.randn(*s, dtype=torch.bfloat16) * 3.2)(M, H, D) * (M ** -0.5)),
            "w_uk": _w((lambda *s: torch.randn(*s, dtype=torch.bfloat16) * 3.2)(Dc, H, D) * (Dc ** -0.5)),
            "w_uv": _w((lambda *s: torch.randn(*s, dtype=torch.bfloat16) * 0.2)(Dc, H, D) * (Dc ** -0.5)),
            "w_o": _w((lambda *s: torch.randn(*s, dtype=torch.bfloat16) * 0.2)(H, D, M) * ((H * D) ** -0.5)),
        }
    _A_in = _A_setup()

    def _B_setup():
        B, S, D, F = 1, 2048, 512, 1792
        return {
            "x": _w((lambda *s: torch.randn(*s, dtype=torch.bfloat16) * 0.05)(B, S, D)),
            "w_gate": _w((lambda *s: torch.randn(*s, dtype=torch.bfloat16) * 0.1)(D, F)),
            "w_up": _w((lambda *s: torch.randn(*s, dtype=torch.bfloat16) * 0.1)(D, F)),
            "w_down": _w((lambda *s: torch.randn(*s, dtype=torch.bfloat16) * 0.1)(F, D)),
        }
    _B_in = _B_setup()

    return {
        "A_x": _A_in["x"],
        "A_c_kv": _A_in["c_kv"],
        "A_w_q": _A_in["w_q"],
        "A_w_uk": _A_in["w_uk"],
        "A_w_uv": _A_in["w_uv"],
        "A_w_o": _A_in["w_o"],
        "B_x": _B_in["x"],
        "B_w_gate": _B_in["w_gate"],
        "B_w_up": _B_in["w_up"],
        "B_w_down": _B_in["w_down"],
    }

def reference(A_x, A_c_kv, A_w_q, A_w_uk, A_w_uv, A_w_o, B_x, B_w_gate, B_w_up, B_w_down):
    def _A_ref(x, c_kv, w_q, w_uk, w_uv, w_o):
        B, Sq, M = x.shape[0], x.shape[1], x.shape[2]
        Sk = c_kv.shape[1]
        H, D = w_q.shape[1], w_q.shape[2]
        q = torch.einsum("bqm,mhd->bhqd", x, w_q)
        k = torch.einsum("bkc,chd->bhkd", c_kv, w_uk)
        v = torch.einsum("bkc,chd->bhkd", c_kv, w_uv)
        scores = torch.einsum("bhqd,bhkd->bhqk", q, k) * (D ** -0.5)
        off = Sk - Sq
        qi = torch.arange(Sq)[:, None]
        kj = torch.arange(Sk)[None, :]
        cmask = kj <= (qi + off)
        scores = torch.where(cmask[None, None], scores, -1e9)
        p = _softmax(scores, axis=-1)
        ctx = torch.einsum("bhqk,bhkd->bhqd", p, v)
        return torch.einsum("bhqd,hdm->bqm", ctx, w_o)

    def _B_ref(x, w_gate, w_up, w_down):
        return (_gelu(x @ w_gate) * (x @ w_up)) @ w_down

    x = A_x
    xn = _layernorm(x, axis=-1)
    s = _A_ref(xn, A_c_kv, A_w_q, A_w_uk, A_w_uv, A_w_o)
    g = _silu(_B_ref(xn, B_w_gate, B_w_up, B_w_down))
    return x + s * g
```

```asm
; @launch grid=(256,1,1) block=(256,1,1) lds=163840
.amdgcn_target "amdgcn-amd-amdhsa--gfx950"
.text
.globl recurrent_scan__compressed_kv_cla__geglu_ffn__prompt_kernel
.p2align 8
.type recurrent_scan__compressed_kv_cla__geglu_ffn__prompt_kernel,@function
recurrent_scan__compressed_kv_cla__geglu_ffn__prompt_kernel:
    s_cmp_lt_u32 s2, 0x100
    s_cbranch_scc1 GO_K2_END
    s_endpgm
GO_K2_END:
    s_load_dwordx16 s[4:19], s[0:1], 0
    s_load_dwordx8 s[20:27], s[0:1], 64
    s_load_dwordx2 s[28:29], s[0:1], 0x60
    s_getpc_b64 s[30:31]
L_pc_ka:
    s_add_u32 s30, s30, recurrent_scan__compressed_kv_cla__geglu_ffn__prompt_kernel-L_pc_ka
    s_addc_u32 s31, s31, -1
    s_lshr_b32 s3, s2, 3
    s_lshl_b32 s3, s3, 12
    v_lshlrev_b32 v3, 4, v0
    v_add_u32 v3, s3, v3
    v_min_u32 v3, TEXT_END-recurrent_scan__compressed_kv_cla__geglu_ffn__prompt_kernel-16, v3
    global_load_dwordx4 v[28:31], v3, s[30:31]
    v_and_b32 v1, 63, v0
    v_lshrrev_b32 v3, 6, v0
    v_lshlrev_b32 v2, 4, v1
    v_readfirstlane_b32 s56, v3
    s_and_b32 s79, s2, 7
    s_lshl_b32 s79, s79, 2
    s_bfe_u32 s80, s2, 0x20003
    s_add_u32 s57, s79, s80
    s_lshr_b32 s58, s2, 5
    v_lshrrev_b32 v3, 3, v1
    v_lshlrev_b32 v4, 10, v3
    v_lshrrev_b32 v3, 1, v3
    v_xor_b32 v3, v3, v1
    v_and_b32 v3, 7, v3
    v_lshlrev_b32 v5, 4, v3
    v_add_u32 v17, v4, v5
    v_xor_b32 v5, 64, v5
    v_add_u32 v18, v4, v5
    s_lshl_b32 s79, s58, 18
    s_lshl_b32 s80, s56, 16
    s_add_u32 s79, s79, s80
    s_add_u32 s71, s79, 0
    s_add_u32 s72, s79, 0x1c00
    s_add_u32 s73, s79, 0x3800
    s_add_u32 s74, s79, 0x5400
    s_add_u32 s75, s79, 0x8000
    s_add_u32 s76, s79, 0x9c00
    s_add_u32 s77, s79, 0xb800
    s_add_u32 s78, s79, 0xd400
    s_mul_i32 s67, s56, 0x6000
    s_waitcnt lgkmcnt(0)
    s_mov_b32 s36, s6
    s_mov_b32 s37, s7
    s_mov_b32 s38, 0x200000
    s_mov_b32 s39, 0x20000
    s_cmp_ge_u32 s57, 28
    s_cbranch_scc1 K2_NOGU
    s_add_u32 m0, s67, 0
    s_nop 0
    buffer_load_dwordx4 v17, s[36:39], s71 offen offset:0 lds
    buffer_load_dwordx4 v18, s[36:39], s72 offen offset:1024 lds
    buffer_load_dwordx4 v17, s[36:39], s73 offen offset:2048 lds
    buffer_load_dwordx4 v18, s[36:39], s74 offen offset:3072 lds
    s_add_u32 m0, s67, 0x1000
    s_nop 0
    buffer_load_dwordx4 v17, s[36:39], s75 offen offset:0 lds
    buffer_load_dwordx4 v18, s[36:39], s76 offen offset:1024 lds
    buffer_load_dwordx4 v17, s[36:39], s77 offen offset:2048 lds
    buffer_load_dwordx4 v18, s[36:39], s78 offen offset:3072 lds
    v_add_u32 v17, 0x80, v17
    v_add_u32 v18, 0x80, v18
    v_lshrrev_b32 v3, 3, v1
    v_mul_u32_u24 v3, 0x2000, v3
    v_bfe_u32 v4, v1, 4, 1
    v_lshlrev_b32 v4, 2, v4
    v_xor_b32 v4, v4, v1
    v_and_b32 v4, 7, v4
    v_lshlrev_b32 v4, 4, v4
    v_add_u32 v12, v3, v4
    v_add_u32 v13, 0xfc00, v12
    v_add_u32 v14, 0xfc00, v13
    v_add_u32 v15, 0xfc00, v14
    s_and_b32 s79, s56, 1
    s_lshl_b32 s79, s79, 18
    s_lshr_b32 s80, s56, 1
    s_lshl_b32 s80, s80, 7
    s_lshl_b32 s3, s57, 8
    s_add_u32 s68, s3, s79
    s_add_u32 s68, s68, s80
    s_lshl_b32 s79, s56, 18
    s_add_u32 s69, s3, s79
    s_add_u32 s70, s69, 0x80
    s_lshl_b32 s59, s56, 12
    s_add_u32 s59, s59, 0x18000
    s_mov_b32 s40, s10
    s_mov_b32 s41, s11
    s_mov_b32 s42, 0x400000
    s_mov_b32 s43, 0x20000
    s_add_u32 m0, s59, 0
    s_add_u32 s60, s68, 0
    buffer_load_dwordx4 v12, s[40:43], s60 offen offset:0 lds
    buffer_load_dwordx4 v13, s[40:43], s60 offen offset:1024 lds
    buffer_load_dwordx4 v14, s[40:43], s60 offen offset:2048 lds
    buffer_load_dwordx4 v15, s[40:43], s60 offen offset:3072 lds
    s_add_u32 m0, s67, 0x2000
    s_nop 0
    buffer_load_dwordx4 v17, s[36:39], s71 offen offset:0 lds
    buffer_load_dwordx4 v18, s[36:39], s72 offen offset:1024 lds
    buffer_load_dwordx4 v17, s[36:39], s73 offen offset:2048 lds
    buffer_load_dwordx4 v18, s[36:39], s74 offen offset:3072 lds
    s_add_u32 m0, s67, 0x3000
    s_nop 0
    buffer_load_dwordx4 v17, s[36:39], s75 offen offset:0 lds
    buffer_load_dwordx4 v18, s[36:39], s76 offen offset:1024 lds
    buffer_load_dwordx4 v17, s[36:39], s77 offen offset:2048 lds
    buffer_load_dwordx4 v18, s[36:39], s78 offen offset:3072 lds
    v_add_u32 v17, 0x80, v17
    v_add_u32 v18, 0x80, v18
    s_add_u32 m0, s59, 0x4000
    s_add_u32 s60, s68, 0x80000
    buffer_load_dwordx4 v12, s[40:43], s60 offen offset:0 lds
    buffer_load_dwordx4 v13, s[40:43], s60 offen offset:1024 lds
    buffer_load_dwordx4 v14, s[40:43], s60 offen offset:2048 lds
    buffer_load_dwordx4 v15, s[40:43], s60 offen offset:3072 lds
    s_add_u32 m0, s67, 0x4000
    s_nop 0
    buffer_load_dwordx4 v17, s[36:39], s71 offen offset:0 lds
    buffer_load_dwordx4 v18, s[36:39], s72 offen offset:1024 lds
    buffer_load_dwordx4 v17, s[36:39], s73 offen offset:2048 lds
    buffer_load_dwordx4 v18, s[36:39], s74 offen offset:3072 lds
    s_add_u32 m0, s67, 0x5000
    s_nop 0
    buffer_load_dwordx4 v17, s[36:39], s75 offen offset:0 lds
    buffer_load_dwordx4 v18, s[36:39], s76 offen offset:1024 lds
    buffer_load_dwordx4 v17, s[36:39], s77 offen offset:2048 lds
    buffer_load_dwordx4 v18, s[36:39], s78 offen offset:3072 lds
    v_add_u32 v17, 0x80, v17
    v_add_u32 v18, 0x80, v18
    v_and_b32 v3, 31, v1
    v_lshlrev_b32 v4, 7, v3
    v_add_u32 v4, s67, v4
    v_bfe_u32 v3, v1, 1, 3
    v_lshrrev_b32 v5, 5, v1
    v_xor_b32 v3, v3, v5
    v_xor_b32 v5, 0, v3
    v_lshlrev_b32 v5, 4, v5
    v_add_u32 v19, v4, v5
    v_xor_b32 v5, 2, v3
    v_lshlrev_b32 v5, 4, v5
    v_add_u32 v20, v4, v5
    v_xor_b32 v5, 4, v3
    v_lshlrev_b32 v5, 4, v5
    v_add_u32 v21, v4, v5
    v_xor_b32 v5, 6, v3
    v_lshlrev_b32 v5, 4, v5
    v_add_u32 v22, v4, v5
    v_lshrrev_b32 v3, 5, v1
    v_lshlrev_b32 v3, 10, v3
    v_bfe_u32 v4, v1, 2, 2
    v_lshlrev_b32 v4, 7, v4
    v_add_u32 v3, v3, v4
    v_bfe_u32 v4, v1, 4, 1
    v_lshlrev_b32 v4, 5, v4
    v_add_u32 v3, v3, v4
    v_and_b32 v4, 3, v1
    v_lshlrev_b32 v4, 3, v4
    v_add_u32 v3, v3, v4
    v_add_u32 v3, 0x18000, v3
    v_bfe_u32 v5, v1, 3, 1
    v_lshlrev_b32 v5, 6, v5
    v_add_u32 v6, v3, v5
    v_xor_b32 v5, 64, v5
    v_add_u32 v7, v3, v5
    s_waitcnt vmcnt(24)
    ds_read_b128 a[0:3], v19 offset:0
    ds_read_b128 a[128:131], v19 offset:4096
    ds_read_b128 a[4:7], v20 offset:0
    ds_read_b128 a[132:135], v20 offset:4096
    ds_read_b128 a[8:11], v21 offset:0
    ds_read_b128 a[136:139], v21 offset:4096
    ds_read_b128 a[12:15], v22 offset:0
    ds_read_b128 a[140:143], v22 offset:4096
    s_waitcnt vmcnt(20)
    s_barrier
    ds_read_b64_tr_b16 v[32:33], v6 offset:0
    ds_read_b64_tr_b16 v[34:35], v6 offset:512
    ds_read_b64_tr_b16 v[36:37], v7 offset:0
    ds_read_b64_tr_b16 v[38:39], v7 offset:512
    ds_read_b64_tr_b16 v[40:41], v6 offset:8192
    ds_read_b64_tr_b16 v[42:43], v6 offset:8704
    ds_read_b64_tr_b16 v[44:45], v7 offset:8192
    s_waitcnt lgkmcnt(8)
    ds_read_b64_tr_b16 v[46:47], v7 offset:8704
    s_waitcnt lgkmcnt(6)
    v_mfma_f32_32x32x16_bf16 v[64:79], v[32:35], a[0:3], 0
    s_add_u32 m0, s59, 0x8000
    s_add_u32 s60, s68, 0x100000
    buffer_load_dwordx4 v12, s[40:43], s60 offen offset:0 lds
    ds_read_b64_tr_b16 v[48:49], v6 offset:2048
    s_waitcnt lgkmcnt(0)
    s_mov_b32 s48, s4
    s_mov_b32 s49, s5
    v_mfma_f32_32x32x16_bf16 v[128:143], v[32:35], a[128:131], 0
    buffer_load_dwordx4 v13, s[40:43], s60 offen offset:1024 lds
    ds_read_b64_tr_b16 v[50:51], v6 offset:2560
    s_mov_b32 s50, 0x200000
    s_mov_b32 s51, 0x20000
    v_lshrrev_b32 v3, 5, v0
    v_mfma_f32_32x32x16_bf16 v[80:95], v[36:39], a[0:3], 0
    buffer_load_dwordx4 v14, s[40:43], s60 offen offset:2048 lds
    ds_read_b64_tr_b16 v[52:53], v7 offset:2048
    v_lshlrev_b32 v4, 10, v3
    v_and_b32 v5, 31, v1
    v_lshlrev_b32 v23, 4, v5
    v_mfma_f32_32x32x16_bf16 v[144:159], v[36:39], a[128:131], 0
    buffer_load_dwordx4 v15, s[40:43], s60 offen offset:3072 lds
    ds_read_b64_tr_b16 v[54:55], v7 offset:2560
    v_add_u32 v23, v23, v4
    s_lshl_b32 s79, s2, 13
    buffer_load_dwordx4 v[192:195], v23, s[48:51], s79 offen
    v_mfma_f32_32x32x16_bf16 v[96:111], v[40:43], a[0:3], 0
    s_add_u32 m0, s67, 0
    s_nop 0
    buffer_load_dwordx4 v17, s[36:39], s71 offen offset:0 lds
    ds_read_b64_tr_b16 v[56:57], v6 offset:10240
    buffer_load_dwordx4 v[196:199], v23, s[48:51], s79 offen offset:512
    v_lshrrev_b32 v4, 1, v5
    v_mfma_f32_32x32x16_bf16 v[160:175], v[40:43], a[128:131], 0
    buffer_load_dwordx4 v18, s[36:39], s72 offen offset:1024 lds
    v_lshlrev_b32 v4, 10, v4
    ds_read_b64_tr_b16 v[58:59], v6 offset:10752
    v_and_b32 v5, 1, v5
    v_lshlrev_b32 v5, 9, v5
    v_mfma_f32_32x32x16_bf16 v[112:127], v[44:47], a[0:3], 0
    buffer_load_dwordx4 v17, s[36:39], s73 offen offset:2048 lds
    v_add_u32 v4, v4, v5
    ds_read_b64_tr_b16 v[60:61], v7 offset:10240
    v_lshlrev_b32 v3, 4, v3
    v_add_u32 v24, v4, v3
    v_mfma_f32_32x32x16_bf16 v[176:191], v[44:47], a[128:131], 0
    buffer_load_dwordx4 v18, s[36:39], s74 offen offset:3072 lds
    s_mov_b32 s44, s12
    ds_read_b64_tr_b16 v[62:63], v7 offset:10752
    s_mov_b32 s45, s13
    s_mov_b32 s46, 0x400000
    s_waitcnt lgkmcnt(6)
    v_mfma_f32_32x32x16_bf16 v[64:79], v[48:51], a[4:7], v[64:79]
    s_add_u32 m0, s67, 0x1000
    s_nop 0
    buffer_load_dwordx4 v17, s[36:39], s75 offen offset:0 lds
    ds_read_b64_tr_b16 v[32:33], v6 offset:4096
    s_waitcnt vmcnt(23)
    ds_read_b128 a[16:19], v19 offset:8192
    ds_read_b128 a[144:147], v19 offset:12288
    ds_read_b128 a[20:23], v20 offset:8192
    v_mfma_f32_32x32x16_bf16 v[128:143], v[48:51], a[132:135], v[128:143]
    buffer_load_dwordx4 v18, s[36:39], s76 offen offset:1024 lds
    ds_read_b64_tr_b16 v[34:35], v6 offset:4608
    ds_read_b128 a[148:151], v20 offset:12288
    ds_read_b128 a[24:27], v21 offset:8192
    ds_read_b128 a[152:155], v21 offset:12288
    ds_read_b128 a[28:31], v22 offset:8192
    s_waitcnt lgkmcnt(13)
    v_mfma_f32_32x32x16_bf16 v[80:95], v[52:55], a[4:7], v[80:95]
    buffer_load_dwordx4 v17, s[36:39], s77 offen offset:2048 lds
    ds_read_b64_tr_b16 v[36:37], v7 offset:4096
    ds_read_b128 a[156:159], v22 offset:12288
    s_mov_b32 s47, 0x20000
    s_mov_b32 s32, s28
    s_mov_b32 s33, s29
    v_mfma_f32_32x32x16_bf16 v[144:159], v[52:55], a[132:135], v[144:159]
    buffer_load_dwordx4 v18, s[36:39], s78 offen offset:3072 lds
    v_add_u32 v17, 0x80, v17
    v_add_u32 v18, 0x80, v18
    s_waitcnt lgkmcnt(8)
    ds_read_b64_tr_b16 v[38:39], v7 offset:4608
    s_mov_b32 s34, 0x10000000
    s_mov_b32 s35, 0x20000
    s_mov_b32 s96, s26
    s_mov_b32 s97, s27
    v_mfma_f32_32x32x16_bf16 v[96:111], v[56:59], a[4:7], v[96:111]
    ds_read_b64_tr_b16 v[40:41], v6 offset:12288
    s_mov_b32 s98, 0x100
    s_mov_b32 s99, 0x20000
    s_lshr_b32 s64, s2, 2
    v_mfma_f32_32x32x16_bf16 v[160:175], v[56:59], a[132:135], v[160:175]
    s_lshl_b32 s64, s64, 15
    ds_read_b64_tr_b16 v[42:43], v6 offset:12800
    s_and_b32 s65, s2, 3
    s_lshl_b32 s65, s65, 7
    s_add_u32 s64, s64, s65
    v_mfma_f32_32x32x16_bf16 v[112:127], v[60:63], a[4:7], v[112:127]
    s_add_u32 s65, s64, 0x4000
    ds_read_b64_tr_b16 v[44:45], v7 offset:12288
    s_lshl_b32 s79, s57, 6
    s_lshl_b32 s80, s58, 3
    s_add_u32 s79, s79, s80
    v_mfma_f32_32x32x16_bf16 v[176:191], v[60:63], a[132:135], v[176:191]
    s_lshl_b32 s80, s56, 1
    ds_read_b64_tr_b16 v[46:47], v7 offset:12800
    s_add_u32 s79, s79, s80
    s_lshl_b32 s79, s79, 13
    s_add_u32 s100, s79, 0x200000
    s_waitcnt lgkmcnt(0)
    v_mfma_f32_32x32x16_bf16 v[64:79], v[32:35], a[8:11], v[64:79]
    s_add_u32 m0, s67, 0x2000
    s_nop 0
    buffer_load_dwordx4 v17, s[36:39], s71 offen offset:0 lds
    ds_read_b64_tr_b16 v[48:49], v6 offset:6144
    s_add_u32 s101, s79, 0x1200000
    v_mfma_f32_32x32x16_bf16 v[128:143], v[32:35], a[136:139], v[128:143]
    buffer_load_dwordx4 v18, s[36:39], s72 offen offset:1024 lds
    ds_read_b64_tr_b16 v[50:51], v6 offset:6656
    v_mfma_f32_32x32x16_bf16 v[80:95], v[36:39], a[8:11], v[80:95]
    buffer_load_dwordx4 v17, s[36:39], s73 offen offset:2048 lds
    ds_read_b64_tr_b16 v[52:53], v7 offset:6144
    v_mfma_f32_32x32x16_bf16 v[144:159], v[36:39], a[136:139], v[144:159]
    buffer_load_dwordx4 v18, s[36:39], s74 offen offset:3072 lds
    ds_read_b64_tr_b16 v[54:55], v7 offset:6656
    v_mfma_f32_32x32x16_bf16 v[96:111], v[40:43], a[8:11], v[96:111]
    s_add_u32 m0, s67, 0x3000
    s_nop 0
    buffer_load_dwordx4 v17, s[36:39], s75 offen offset:0 lds
    ds_read_b64_tr_b16 v[56:57], v6 offset:14336
    v_mfma_f32_32x32x16_bf16 v[160:175], v[40:43], a[136:139], v[160:175]
    buffer_load_dwordx4 v18, s[36:39], s76 offen offset:1024 lds
    ds_read_b64_tr_b16 v[58:59], v6 offset:14848
    v_mfma_f32_32x32x16_bf16 v[112:127], v[44:47], a[8:11], v[112:127]
    buffer_load_dwordx4 v17, s[36:39], s77 offen offset:2048 lds
    ds_read_b64_tr_b16 v[60:61], v7 offset:14336
    v_mfma_f32_32x32x16_bf16 v[176:191], v[44:47], a[136:139], v[176:191]
    buffer_load_dwordx4 v18, s[36:39], s78 offen offset:3072 lds
    v_add_u32 v17, 0x80, v17
    v_add_u32 v18, 0x80, v18
    ds_read_b64_tr_b16 v[62:63], v7 offset:14848
    s_waitcnt lgkmcnt(0)
    s_waitcnt vmcnt(30)
    s_barrier
    v_mfma_f32_32x32x16_bf16 v[64:79], v[48:51], a[12:15], v[64:79]
    s_add_u32 m0, s59, 0xc000
    s_add_u32 s60, s68, 0x180000
    buffer_load_dwordx4 v12, s[40:43], s60 offen offset:0 lds
    ds_read_b64_tr_b16 v[32:33], v6 offset:16384
    s_waitcnt vmcnt(23)
    ds_read_b128 a[32:35], v19 offset:16384
    ds_read_b128 a[160:163], v19 offset:20480
    ds_read_b128 a[36:39], v20 offset:16384
    v_mfma_f32_32x32x16_bf16 v[128:143], v[48:51], a[140:143], v[128:143]
    buffer_load_dwordx4 v13, s[40:43], s60 offen offset:1024 lds
    ds_read_b64_tr_b16 v[34:35], v6 offset:16896
    ds_read_b128 a[164:167], v20 offset:20480
    ds_read_b128 a[40:43], v21 offset:16384
    ds_read_b128 a[168:171], v21 offset:20480
    ds_read_b128 a[44:47], v22 offset:16384
    v_mfma_f32_32x32x16_bf16 v[80:95], v[52:55], a[12:15], v[80:95]
    buffer_load_dwordx4 v14, s[40:43], s60 offen offset:2048 lds
    ds_read_b64_tr_b16 v[36:37], v7 offset:16384
    ds_read_b128 a[172:175], v22 offset:20480
    v_mfma_f32_32x32x16_bf16 v[144:159], v[52:55], a[140:143], v[144:159]
    buffer_load_dwordx4 v15, s[40:43], s60 offen offset:3072 lds
    ds_read_b64_tr_b16 v[38:39], v7 offset:16896
    v_mfma_f32_32x32x16_bf16 v[96:111], v[56:59], a[12:15], v[96:111]
    ds_read_b64_tr_b16 v[40:41], v6 offset:24576
    v_mfma_f32_32x32x16_bf16 v[160:175], v[56:59], a[140:143], v[160:175]
    ds_read_b64_tr_b16 v[42:43], v6 offset:25088
    v_mfma_f32_32x32x16_bf16 v[112:127], v[60:63], a[12:15], v[112:127]
    ds_read_b64_tr_b16 v[44:45], v7 offset:24576
    v_mfma_f32_32x32x16_bf16 v[176:191], v[60:63], a[140:143], v[176:191]
    s_waitcnt lgkmcnt(8)
    ds_read_b64_tr_b16 v[46:47], v7 offset:25088
    s_waitcnt lgkmcnt(0)
    v_mfma_f32_32x32x16_bf16 v[64:79], v[32:35], a[16:19], v[64:79]
    s_add_u32 m0, s67, 0x4000
    s_nop 0
    buffer_load_dwordx4 v17, s[36:39], s71 offen offset:0 lds
    ds_read_b64_tr_b16 v[48:49], v6 offset:18432
    v_mfma_f32_32x32x16_bf16 v[128:143], v[32:35], a[144:147], v[128:143]
    buffer_load_dwordx4 v18, s[36:39], s72 offen offset:1024 lds
    ds_read_b64_tr_b16 v[50:51], v6 offset:18944
    v_mfma_f32_32x32x16_bf16 v[80:95], v[36:39], a[16:19], v[80:95]
    buffer_load_dwordx4 v17, s[36:39], s73 offen offset:2048 lds
    ds_read_b64_tr_b16 v[52:53], v7 offset:18432
    v_mfma_f32_32x32x16_bf16 v[144:159], v[36:39], a[144:147], v[144:159]
    buffer_load_dwordx4 v18, s[36:39], s74 offen offset:3072 lds
    ds_read_b64_tr_b16 v[54:55], v7 offset:18944
    v_mfma_f32_32x32x16_bf16 v[96:111], v[40:43], a[16:19], v[96:111]
    s_add_u32 m0, s67, 0x5000
    s_nop 0
    buffer_load_dwordx4 v17, s[36:39], s75 offen offset:0 lds
    ds_read_b64_tr_b16 v[56:57], v6 offset:26624
    v_mfma_f32_32x32x16_bf16 v[160:175], v[40:43], a[144:147], v[160:175]
    buffer_load_dwordx4 v18, s[36:39], s76 offen offset:1024 lds
    ds_read_b64_tr_b16 v[58:59], v6 offset:27136
    v_mfma_f32_32x32x16_bf16 v[112:127], v[44:47], a[16:19], v[112:127]
    buffer_load_dwordx4 v17, s[36:39], s77 offen offset:2048 lds
    ds_read_b64_tr_b16 v[60:61], v7 offset:26624
    v_mfma_f32_32x32x16_bf16 v[176:191], v[44:47], a[144:147], v[176:191]
    buffer_load_dwordx4 v18, s[36:39], s78 offen offset:3072 lds
    v_add_u32 v17, 0x80, v17
    v_add_u32 v18, 0x80, v18
    ds_read_b64_tr_b16 v[62:63], v7 offset:27136
    s_waitcnt lgkmcnt(6)
    v_mfma_f32_32x32x16_bf16 v[64:79], v[48:51], a[20:23], v[64:79]
    ds_read_b64_tr_b16 v[32:33], v6 offset:20480
    s_waitcnt vmcnt(29)
    v_lshlrev_b32 v200, 16, v192
    v_and_b32 v201, 0xffff0000, v192
    v_mfma_f32_32x32x16_bf16 v[128:143], v[48:51], a[148:151], v[128:143]
    ds_read_b64_tr_b16 v[34:35], v6 offset:20992
    s_waitcnt vmcnt(27)
    v_lshlrev_b32 v208, 16, v196
    v_and_b32 v209, 0xffff0000, v196
    v_lshlrev_b32 v202, 16, v193
    s_waitcnt lgkmcnt(6)
    v_mfma_f32_32x32x16_bf16 v[80:95], v[52:55], a[20:23], v[80:95]
    ds_read_b64_tr_b16 v[36:37], v7 offset:20480
    v_and_b32 v203, 0xffff0000, v193
    v_lshlrev_b32 v210, 16, v197
    v_mfma_f32_32x32x16_bf16 v[144:159], v[52:55], a[148:151], v[144:159]
    v_and_b32 v211, 0xffff0000, v197
    ds_read_b64_tr_b16 v[38:39], v7 offset:20992
    v_lshlrev_b32 v204, 16, v194
    v_and_b32 v205, 0xffff0000, v194
    s_waitcnt lgkmcnt(6)
    v_mfma_f32_32x32x16_bf16 v[96:111], v[56:59], a[20:23], v[96:111]
    ds_read_b64_tr_b16 v[40:41], v6 offset:28672
    v_lshlrev_b32 v212, 16, v198
    v_and_b32 v213, 0xffff0000, v198
    v_lshlrev_b32 v206, 16, v195
    v_mfma_f32_32x32x16_bf16 v[160:175], v[56:59], a[148:151], v[160:175]
    ds_read_b64_tr_b16 v[42:43], v6 offset:29184
    v_and_b32 v207, 0xffff0000, v195
    v_lshlrev_b32 v214, 16, v199
    v_and_b32 v215, 0xffff0000, v199
    s_waitcnt lgkmcnt(6)
    v_mfma_f32_32x32x16_bf16 v[112:127], v[60:63], a[20:23], v[112:127]
    ds_read_b64_tr_b16 v[44:45], v7 offset:28672
    v_add_f32 v232, v200, v201
    v_add_f32 v232, v232, v202
    v_mfma_f32_32x32x16_bf16 v[176:191], v[60:63], a[148:151], v[176:191]
    v_add_f32 v232, v232, v203
    ds_read_b64_tr_b16 v[46:47], v7 offset:29184
    v_add_f32 v232, v232, v204
    v_add_f32 v232, v232, v205
    s_waitcnt lgkmcnt(6)
    v_mfma_f32_32x32x16_bf16 v[64:79], v[32:35], a[24:27], v[64:79]
    ds_read_b64_tr_b16 v[48:49], v6 offset:22528
    s_waitcnt vmcnt(20)
    ds_read_b128 a[48:51], v19 offset:0
    ds_read_b128 a[176:179], v19 offset:4096
    ds_read_b128 a[52:55], v20 offset:0
    v_mfma_f32_32x32x16_bf16 v[128:143], v[32:35], a[152:155], v[128:143]
    ds_read_b64_tr_b16 v[50:51], v6 offset:23040
    ds_read_b128 a[180:183], v20 offset:4096
    ds_read_b128 a[56:59], v21 offset:0
    ds_read_b128 a[184:187], v21 offset:4096
    ds_read_b128 a[60:63], v22 offset:0
    s_waitcnt lgkmcnt(13)
    v_mfma_f32_32x32x16_bf16 v[80:95], v[36:39], a[24:27], v[80:95]
    ds_read_b64_tr_b16 v[52:53], v7 offset:22528
    ds_read_b128 a[188:191], v22 offset:4096
    v_add_f32 v232, v232, v206
    v_add_f32 v232, v232, v207
    v_add_f32 v232, v232, v208
    v_mfma_f32_32x32x16_bf16 v[144:159], v[36:39], a[152:155], v[144:159]
    s_waitcnt lgkmcnt(8)
    ds_read_b64_tr_b16 v[54:55], v7 offset:23040
    v_add_f32 v232, v232, v209
    v_add_f32 v232, v232, v210
    v_add_f32 v232, v232, v211
    v_add_f32 v232, v232, v212
    v_mfma_f32_32x32x16_bf16 v[96:111], v[40:43], a[24:27], v[96:111]
    ds_read_b64_tr_b16 v[56:57], v6 offset:30720
    v_add_f32 v232, v232, v213
    v_add_f32 v232, v232, v214
    v_add_f32 v232, v232, v215
    v_mfma_f32_32x32x16_bf16 v[160:175], v[40:43], a[152:155], v[160:175]
    ds_swizzle_b32 v233, v232 offset:0x041f
    ds_read_b64_tr_b16 v[58:59], v6 offset:31232
    s_waitcnt lgkmcnt(1)
    v_add_f32 v232, v232, v233
    ds_swizzle_b32 v233, v232 offset:0x081f
    s_waitcnt lgkmcnt(0)
    v_add_f32 v232, v232, v233
    v_mfma_f32_32x32x16_bf16 v[112:127], v[44:47], a[24:27], v[112:127]
    ds_swizzle_b32 v233, v232 offset:0x101f
    ds_read_b64_tr_b16 v[60:61], v7 offset:30720
    s_waitcnt lgkmcnt(1)
    v_add_f32 v232, v232, v233
    ds_swizzle_b32 v233, v232 offset:0x201f
    s_waitcnt lgkmcnt(0)
    v_add_f32 v232, v232, v233
    v_mfma_f32_32x32x16_bf16 v[176:191], v[44:47], a[152:155], v[176:191]
    ds_swizzle_b32 v233, v232 offset:0x401f
    ds_read_b64_tr_b16 v[62:63], v7 offset:31232
    s_waitcnt lgkmcnt(1)
    v_add_f32 v232, v232, v233
    v_mul_f32 v234, 0x3b000000, v232
    v_sub_f32 v216, v200, v234
    s_waitcnt lgkmcnt(0)
    s_barrier
    v_mfma_f32_32x32x16_bf16 v[64:79], v[48:51], a[28:31], v[64:79]
    s_add_u32 m0, s67, 0
    s_nop 0
    buffer_load_dwordx4 v17, s[36:39], s71 offen offset:0 lds
    ds_read_b64_tr_b16 v[32:33], v6 offset:32768
    v_sub_f32 v217, v201, v234
    v_sub_f32 v218, v202, v234
    v_sub_f32 v219, v203, v234
    v_mfma_f32_32x32x16_bf16 v[128:143], v[48:51], a[156:159], v[128:143]
    buffer_load_dwordx4 v18, s[36:39], s72 offen offset:1024 lds
    ds_read_b64_tr_b16 v[34:35], v6 offset:33280
    v_sub_f32 v220, v204, v234
    v_sub_f32 v221, v205, v234
    v_sub_f32 v222, v206, v234
    v_mfma_f32_32x32x16_bf16 v[80:95], v[52:55], a[28:31], v[80:95]
    buffer_load_dwordx4 v17, s[36:39], s73 offen offset:2048 lds
    ds_read_b64_tr_b16 v[36:37], v7 offset:32768
    v_sub_f32 v223, v207, v234
    v_sub_f32 v224, v208, v234
    v_mfma_f32_32x32x16_bf16 v[144:159], v[52:55], a[156:159], v[144:159]
    buffer_load_dwordx4 v18, s[36:39], s74 offen offset:3072 lds
    v_sub_f32 v225, v209, v234
    ds_read_b64_tr_b16 v[38:39], v7 offset:33280
    v_sub_f32 v226, v210, v234
    v_sub_f32 v227, v211, v234
    v_mfma_f32_32x32x16_bf16 v[96:111], v[56:59], a[28:31], v[96:111]
    s_add_u32 m0, s67, 0x1000
    s_nop 0
    buffer_load_dwordx4 v17, s[36:39], s75 offen offset:0 lds
    ds_read_b64_tr_b16 v[40:41], v6 offset:40960
    v_sub_f32 v228, v212, v234
    v_sub_f32 v229, v213, v234
    v_sub_f32 v230, v214, v234
    v_mfma_f32_32x32x16_bf16 v[160:175], v[56:59], a[156:159], v[160:175]
    buffer_load_dwordx4 v18, s[36:39], s76 offen offset:1024 lds
    ds_read_b64_tr_b16 v[42:43], v6 offset:41472
    v_sub_f32 v231, v215, v234
    v_mul_f32 v232, v216, v216
    v_fmac_f32 v232, v217, v217
    v_mfma_f32_32x32x16_bf16 v[112:127], v[60:63], a[28:31], v[112:127]
    buffer_load_dwordx4 v17, s[36:39], s77 offen offset:2048 lds
    ds_read_b64_tr_b16 v[44:45], v7 offset:40960
    v_fmac_f32 v232, v218, v218
    v_fmac_f32 v232, v219, v219
    v_mfma_f32_32x32x16_bf16 v[176:191], v[60:63], a[156:159], v[176:191]
    buffer_load_dwordx4 v18, s[36:39], s78 offen offset:3072 lds
    v_add_u32 v17, 0x80, v17
    v_add_u32 v18, 0x80, v18
    v_fmac_f32 v232, v220, v220
    ds_read_b64_tr_b16 v[46:47], v7 offset:41472
    v_fmac_f32 v232, v221, v221
    v_fmac_f32 v232, v222, v222
    s_waitcnt lgkmcnt(6)
    v_mfma_f32_32x32x16_bf16 v[64:79], v[32:35], a[32:35], v[64:79]
    s_add_u32 m0, s59, 0
    s_add_u32 s60, s68, 0x200000
    buffer_load_dwordx4 v12, s[40:43], s60 offen offset:0 lds
    ds_read_b64_tr_b16 v[48:49], v6 offset:34816
    v_fmac_f32 v232, v223, v223
    v_fmac_f32 v232, v224, v224
    v_fmac_f32 v232, v225, v225
    v_mfma_f32_32x32x16_bf16 v[128:143], v[32:35], a[160:163], v[128:143]
    buffer_load_dwordx4 v13, s[40:43], s60 offen offset:1024 lds
    ds_read_b64_tr_b16 v[50:51], v6 offset:35328
    v_fmac_f32 v232, v226, v226
    v_fmac_f32 v232, v227, v227
    v_fmac_f32 v232, v228, v228
    s_waitcnt lgkmcnt(6)
    v_mfma_f32_32x32x16_bf16 v[80:95], v[36:39], a[32:35], v[80:95]
    buffer_load_dwordx4 v14, s[40:43], s60 offen offset:2048 lds
    ds_read_b64_tr_b16 v[52:53], v7 offset:34816
    v_fmac_f32 v232, v229, v229
    v_fmac_f32 v232, v230, v230
    v_mfma_f32_32x32x16_bf16 v[144:159], v[36:39], a[160:163], v[144:159]
    buffer_load_dwordx4 v15, s[40:43], s60 offen offset:3072 lds
    v_fmac_f32 v232, v231, v231
    ds_read_b64_tr_b16 v[54:55], v7 offset:35328
    ds_swizzle_b32 v233, v232 offset:0x041f
    s_waitcnt lgkmcnt(0)
    v_add_f32 v232, v232, v233
    v_mfma_f32_32x32x16_bf16 v[96:111], v[40:43], a[32:35], v[96:111]
    ds_read_b64_tr_b16 v[56:57], v6 offset:43008
    ds_swizzle_b32 v233, v232 offset:0x081f
    s_waitcnt lgkmcnt(0)
    v_add_f32 v232, v232, v233
    ds_swizzle_b32 v233, v232 offset:0x101f
    v_mfma_f32_32x32x16_bf16 v[160:175], v[40:43], a[160:163], v[160:175]
    ds_read_b64_tr_b16 v[58:59], v6 offset:43520
    s_waitcnt lgkmcnt(1)
    v_add_f32 v232, v232, v233
    ds_swizzle_b32 v233, v232 offset:0x201f
    s_waitcnt lgkmcnt(0)
    v_add_f32 v232, v232, v233
    v_mfma_f32_32x32x16_bf16 v[112:127], v[44:47], a[32:35], v[112:127]
    ds_read_b64_tr_b16 v[60:61], v7 offset:43008
    ds_swizzle_b32 v233, v232 offset:0x401f
    s_waitcnt lgkmcnt(0)
    v_add_f32 v232, v232, v233
    v_mfma_f32_32x32x16_bf16 v[176:191], v[44:47], a[160:163], v[176:191]
    v_mul_f32 v235, 0x3b000000, v232
    ds_read_b64_tr_b16 v[62:63], v7 offset:43520
    v_cvt_pk_bf16_f32 v236, v234, v235
    v_lshlrev_b32 v237, 16, v236
    v_mfma_f32_32x32x16_bf16 v[64:79], v[48:51], a[36:39], v[64:79]
    ds_read_b64_tr_b16 v[32:33], v6 offset:36864
    s_waitcnt vmcnt(24)
    ds_read_b128 a[64:67], v19 offset:8192
    ds_read_b128 a[192:195], v19 offset:12288
    ds_read_b128 a[68:71], v20 offset:8192
    v_mfma_f32_32x32x16_bf16 v[128:143], v[48:51], a[164:167], v[128:143]
    ds_read_b64_tr_b16 v[34:35], v6 offset:37376
    ds_read_b128 a[196:199], v20 offset:12288
    ds_read_b128 a[72:75], v21 offset:8192
    ds_read_b128 a[200:203], v21 offset:12288
    ds_read_b128 a[76:79], v22 offset:8192
    v_mfma_f32_32x32x16_bf16 v[80:95], v[52:55], a[36:39], v[80:95]
    ds_read_b64_tr_b16 v[36:37], v7 offset:36864
    ds_read_b128 a[204:207], v22 offset:12288
    v_and_b32 v238, 0xffff0000, v236
    v_add_f32 v238, 0x3727c5ac, v238
    v_cvt_pk_bf16_f32 v236, v238, v238
    v_mfma_f32_32x32x16_bf16 v[144:159], v[52:55], a[164:167], v[144:159]
    ds_read_b64_tr_b16 v[38:39], v7 offset:37376
    v_lshlrev_b32 v238, 16, v236
    v_sqrt_f32 v238, v238
    s_nop 0
    v_cvt_pk_bf16_f32 v236, v238, v238
    v_lshlrev_b32 v239, 16, v236
    v_mfma_f32_32x32x16_bf16 v[96:111], v[56:59], a[36:39], v[96:111]
    ds_read_b64_tr_b16 v[40:41], v6 offset:45056
    v_rcp_f32 v240, v239
    v_sub_f32 v216, v200, v237
    v_sub_f32 v217, v201, v237
    v_mfma_f32_32x32x16_bf16 v[160:175], v[56:59], a[164:167], v[160:175]
    v_sub_f32 v218, v202, v237
    ds_read_b64_tr_b16 v[42:43], v6 offset:45568
    v_sub_f32 v219, v203, v237
    v_sub_f32 v220, v204, v237
    v_sub_f32 v221, v205, v237
    s_waitcnt lgkmcnt(14)
    v_mfma_f32_32x32x16_bf16 v[112:127], v[60:63], a[36:39], v[112:127]
    v_sub_f32 v222, v206, v237
    ds_read_b64_tr_b16 v[44:45], v7 offset:45056
    v_sub_f32 v223, v207, v237
    v_sub_f32 v224, v208, v237
    v_sub_f32 v225, v209, v237
    v_mfma_f32_32x32x16_bf16 v[176:191], v[60:63], a[164:167], v[176:191]
    v_sub_f32 v226, v210, v237
    s_waitcnt lgkmcnt(8)
    ds_read_b64_tr_b16 v[46:47], v7 offset:45568
    v_sub_f32 v227, v211, v237
    v_sub_f32 v228, v212, v237
    v_sub_f32 v229, v213, v237
    s_waitcnt lgkmcnt(0)
    v_mfma_f32_32x32x16_bf16 v[64:79], v[32:35], a[40:43], v[64:79]
    s_add_u32 m0, s67, 0x2000
    s_nop 0
    buffer_load_dwordx4 v17, s[36:39], s71 offen offset:0 lds
    ds_read_b64_tr_b16 v[48:49], v6 offset:38912
    v_sub_f32 v230, v214, v237
    v_sub_f32 v231, v215, v237
    v_cvt_pk_bf16_f32 v236, v216, v217
    v_mfma_f32_32x32x16_bf16 v[128:143], v[32:35], a[168:171], v[128:143]
    buffer_load_dwordx4 v18, s[36:39], s72 offen offset:1024 lds
    ds_read_b64_tr_b16 v[50:51], v6 offset:39424
    v_lshlrev_b32 v216, 16, v236
    v_and_b32 v217, 0xffff0000, v236
    v_cvt_pk_bf16_f32 v236, v218, v219
    v_mfma_f32_32x32x16_bf16 v[80:95], v[36:39], a[40:43], v[80:95]
    buffer_load_dwordx4 v17, s[36:39], s73 offen offset:2048 lds
    ds_read_b64_tr_b16 v[52:53], v7 offset:38912
    v_lshlrev_b32 v218, 16, v236
    v_and_b32 v219, 0xffff0000, v236
    v_mfma_f32_32x32x16_bf16 v[144:159], v[36:39], a[168:171], v[144:159]
    buffer_load_dwordx4 v18, s[36:39], s74 offen offset:3072 lds
    v_cvt_pk_bf16_f32 v236, v220, v221
    ds_read_b64_tr_b16 v[54:55], v7 offset:39424
    v_lshlrev_b32 v220, 16, v236
    v_and_b32 v221, 0xffff0000, v236
    v_mfma_f32_32x32x16_bf16 v[96:111], v[40:43], a[40:43], v[96:111]
    s_add_u32 m0, s67, 0x3000
    s_nop 0
    buffer_load_dwordx4 v17, s[36:39], s75 offen offset:0 lds
    ds_read_b64_tr_b16 v[56:57], v6 offset:47104
    v_cvt_pk_bf16_f32 v236, v222, v223
    v_lshlrev_b32 v222, 16, v236
    v_and_b32 v223, 0xffff0000, v236
    v_mfma_f32_32x32x16_bf16 v[160:175], v[40:43], a[168:171], v[160:175]
    buffer_load_dwordx4 v18, s[36:39], s76 offen offset:1024 lds
    ds_read_b64_tr_b16 v[58:59], v6 offset:47616
    v_cvt_pk_bf16_f32 v236, v224, v225
    v_lshlrev_b32 v224, 16, v236
    v_and_b32 v225, 0xffff0000, v236
    v_mfma_f32_32x32x16_bf16 v[112:127], v[44:47], a[40:43], v[112:127]
    buffer_load_dwordx4 v17, s[36:39], s77 offen offset:2048 lds
    ds_read_b64_tr_b16 v[60:61], v7 offset:47104
    v_cvt_pk_bf16_f32 v236, v226, v227
    v_lshlrev_b32 v226, 16, v236
    v_mfma_f32_32x32x16_bf16 v[176:191], v[44:47], a[168:171], v[176:191]
    buffer_load_dwordx4 v18, s[36:39], s78 offen offset:3072 lds
    v_add_u32 v17, 0x80, v17
    v_add_u32 v18, 0x80, v18
    v_and_b32 v227, 0xffff0000, v236
    ds_read_b64_tr_b16 v[62:63], v7 offset:47616
    v_cvt_pk_bf16_f32 v236, v228, v229
    v_lshlrev_b32 v228, 16, v236
    s_waitcnt lgkmcnt(0)
    s_waitcnt vmcnt(28)
    s_barrier
    v_mfma_f32_32x32x16_bf16 v[64:79], v[48:51], a[44:47], v[64:79]
    s_add_u32 m0, s59, 0x4000
    s_add_u32 s60, s68, 0x280000
    buffer_load_dwordx4 v12, s[40:43], s60 offen offset:0 lds
    ds_read_b64_tr_b16 v[32:33], v6 offset:49152
    v_and_b32 v229, 0xffff0000, v236
    v_cvt_pk_bf16_f32 v236, v230, v231
    v_lshlrev_b32 v230, 16, v236
    v_mfma_f32_32x32x16_bf16 v[128:143], v[48:51], a[172:175], v[128:143]
    buffer_load_dwordx4 v13, s[40:43], s60 offen offset:1024 lds
    ds_read_b64_tr_b16 v[34:35], v6 offset:49664
    v_and_b32 v231, 0xffff0000, v236
    v_mul_f32 v200, v216, v240
    v_fma_f32 v216, -v200, v239, v216
    v_mfma_f32_32x32x16_bf16 v[80:95], v[52:55], a[44:47], v[80:95]
    buffer_load_dwordx4 v14, s[40:43], s60 offen offset:2048 lds
    ds_read_b64_tr_b16 v[36:37], v7 offset:49152
    v_fmac_f32 v200, v216, v240
    v_mul_f32 v201, v217, v240
    v_mfma_f32_32x32x16_bf16 v[144:159], v[52:55], a[172:175], v[144:159]
    buffer_load_dwordx4 v15, s[40:43], s60 offen offset:3072 lds
    v_fma_f32 v217, -v201, v239, v217
    ds_read_b64_tr_b16 v[38:39], v7 offset:49664
    v_fmac_f32 v201, v217, v240
    v_mul_f32 v202, v218, v240
    v_mfma_f32_32x32x16_bf16 v[96:111], v[56:59], a[44:47], v[96:111]
    s_add_u32 m0, s59, 0x8000
    s_add_u32 s60, s68, 0x300000
    buffer_load_dwordx4 v12, s[40:43], s60 offen offset:0 lds
    ds_read_b64_tr_b16 v[40:41], v6 offset:57344
    v_fma_f32 v218, -v202, v239, v218
    v_fmac_f32 v202, v218, v240
    v_mul_f32 v203, v219, v240
    v_mfma_f32_32x32x16_bf16 v[160:175], v[56:59], a[172:175], v[160:175]
    buffer_load_dwordx4 v13, s[40:43], s60 offen offset:1024 lds
    ds_read_b64_tr_b16 v[42:43], v6 offset:57856
    v_fma_f32 v219, -v203, v239, v219
    v_fmac_f32 v203, v219, v240
    v_mul_f32 v204, v220, v240
    v_mfma_f32_32x32x16_bf16 v[112:127], v[60:63], a[44:47], v[112:127]
    buffer_load_dwordx4 v14, s[40:43], s60 offen offset:2048 lds
    ds_read_b64_tr_b16 v[44:45], v7 offset:57344
    v_fma_f32 v220, -v204, v239, v220
    v_fmac_f32 v204, v220, v240
    v_mfma_f32_32x32x16_bf16 v[176:191], v[60:63], a[172:175], v[176:191]
    buffer_load_dwordx4 v15, s[40:43], s60 offen offset:3072 lds
    v_mul_f32 v205, v221, v240
    ds_read_b64_tr_b16 v[46:47], v7 offset:57856
    v_fma_f32 v221, -v205, v239, v221
    v_fmac_f32 v205, v221, v240
    s_waitcnt lgkmcnt(6)
    v_mfma_f32_32x32x16_bf16 v[64:79], v[32:35], a[48:51], v[64:79]
    ds_read_b64_tr_b16 v[48:49], v6 offset:51200
    s_waitcnt vmcnt(28)
    ds_read_b128 a[80:83], v19 offset:16384
    ds_read_b128 a[208:211], v19 offset:20480
    ds_read_b128 a[84:87], v20 offset:16384
    v_mfma_f32_32x32x16_bf16 v[128:143], v[32:35], a[176:179], v[128:143]
    ds_read_b64_tr_b16 v[50:51], v6 offset:51712
    ds_read_b128 a[212:215], v20 offset:20480
    ds_read_b128 a[88:91], v21 offset:16384
    ds_read_b128 a[216:219], v21 offset:20480
    ds_read_b128 a[92:95], v22 offset:16384
    s_waitcnt lgkmcnt(13)
    v_mfma_f32_32x32x16_bf16 v[80:95], v[36:39], a[48:51], v[80:95]
    ds_read_b64_tr_b16 v[52:53], v7 offset:51200
    ds_read_b128 a[220:223], v22 offset:20480
    v_mul_f32 v206, v222, v240
    v_fma_f32 v222, -v206, v239, v222
    v_fmac_f32 v206, v222, v240
    v_mfma_f32_32x32x16_bf16 v[144:159], v[36:39], a[176:179], v[144:159]
    s_waitcnt lgkmcnt(8)
    ds_read_b64_tr_b16 v[54:55], v7 offset:51712
    v_mul_f32 v207, v223, v240
    v_fma_f32 v223, -v207, v239, v223
    v_fmac_f32 v207, v223, v240
    v_mul_f32 v208, v224, v240
    v_mfma_f32_32x32x16_bf16 v[96:111], v[40:43], a[48:51], v[96:111]
    ds_read_b64_tr_b16 v[56:57], v6 offset:59392
    v_fma_f32 v224, -v208, v239, v224
    v_fmac_f32 v208, v224, v240
    v_mul_f32 v209, v225, v240
    v_mfma_f32_32x32x16_bf16 v[160:175], v[40:43], a[176:179], v[160:175]
    v_fma_f32 v225, -v209, v239, v225
    ds_read_b64_tr_b16 v[58:59], v6 offset:59904
    v_fmac_f32 v209, v225, v240
    v_mul_f32 v210, v226, v240
    v_fma_f32 v226, -v210, v239, v226
    v_mfma_f32_32x32x16_bf16 v[112:127], v[44:47], a[48:51], v[112:127]
    v_fmac_f32 v210, v226, v240
    ds_read_b64_tr_b16 v[60:61], v7 offset:59392
    v_mul_f32 v211, v227, v240
    v_fma_f32 v227, -v211, v239, v227
    v_fmac_f32 v211, v227, v240
    v_mfma_f32_32x32x16_bf16 v[176:191], v[44:47], a[176:179], v[176:191]
    v_mul_f32 v212, v228, v240
    ds_read_b64_tr_b16 v[62:63], v7 offset:59904
    v_fma_f32 v228, -v212, v239, v228
    v_fmac_f32 v212, v228, v240
    v_mul_f32 v213, v229, v240
    s_waitcnt lgkmcnt(0)
    v_mfma_f32_32x32x16_bf16 v[64:79], v[48:51], a[52:55], v[64:79]
    ds_read_b64_tr_b16 v[32:33], v6 offset:53248
    v_fma_f32 v229, -v213, v239, v229
    v_fmac_f32 v213, v229, v240
    v_mul_f32 v214, v230, v240
    v_mfma_f32_32x32x16_bf16 v[128:143], v[48:51], a[180:183], v[128:143]
    ds_read_b64_tr_b16 v[34:35], v6 offset:53760
    v_fma_f32 v230, -v214, v239, v230
    v_fmac_f32 v214, v230, v240
    v_mul_f32 v215, v231, v240
    v_mfma_f32_32x32x16_bf16 v[80:95], v[52:55], a[52:55], v[80:95]
    ds_read_b64_tr_b16 v[36:37], v7 offset:53248
    v_fma_f32 v231, -v215, v239, v231
    v_fmac_f32 v215, v231, v240
    v_cvt_pk_bf16_f32 v192, v200, v201
    v_mfma_f32_32x32x16_bf16 v[144:159], v[52:55], a[180:183], v[144:159]
    ds_read_b64_tr_b16 v[38:39], v7 offset:53760
    v_cvt_pk_bf16_f32 v196, v208, v209
    v_cvt_pk_bf16_f32 v193, v202, v203
    ds_read_b64_tr_b16 v[40:41], v6 offset:61440
    v_mfma_f32_32x32x16_bf16 v[96:111], v[56:59], a[52:55], v[96:111]
    v_cvt_pk_bf16_f32 v197, v210, v211
    v_cvt_pk_bf16_f32 v194, v204, v205
    v_cvt_pk_bf16_f32 v198, v212, v213
    ds_read_b64_tr_b16 v[42:43], v6 offset:61952
    v_mfma_f32_32x32x16_bf16 v[160:175], v[56:59], a[180:183], v[160:175]
    v_cvt_pk_bf16_f32 v195, v206, v207
    v_cvt_pk_bf16_f32 v199, v214, v215
    v_mov_b32 v242, 0
    ds_read_b64_tr_b16 v[44:45], v7 offset:61440
    v_mfma_f32_32x32x16_bf16 v[112:127], v[60:63], a[52:55], v[112:127]
    v_mov_b32 v243, 0
    s_lshl_b32 s31, s2, 7
    s_add_u32 s31, s31, 0x4800000
    ds_read_b64_tr_b16 v[46:47], v7 offset:61952
    v_mfma_f32_32x32x16_bf16 v[176:191], v[60:63], a[180:183], v[176:191]
    buffer_store_dwordx2 v[242:243], off, s[32:35], s31 sc1
    buffer_store_dwordx4 v[192:195], v24, s[32:35], s64 offen sc1
    s_waitcnt lgkmcnt(6)
    v_mfma_f32_32x32x16_bf16 v[64:79], v[32:35], a[56:59], v[64:79]
    ds_read_b64_tr_b16 v[48:49], v6 offset:55296
    buffer_store_dwordx4 v[196:199], v24, s[32:35], s65 offen sc1
    v_mfma_f32_32x32x16_bf16 v[128:143], v[32:35], a[184:187], v[128:143]
    ds_read_b64_tr_b16 v[50:51], v6 offset:55808
    s_waitcnt lgkmcnt(6)
    v_mfma_f32_32x32x16_bf16 v[80:95], v[36:39], a[56:59], v[80:95]
    ds_read_b64_tr_b16 v[52:53], v7 offset:55296
    v_mfma_f32_32x32x16_bf16 v[144:159], v[36:39], a[184:187], v[144:159]
    ds_read_b64_tr_b16 v[54:55], v7 offset:55808
    s_waitcnt lgkmcnt(6)
    v_mfma_f32_32x32x16_bf16 v[96:111], v[40:43], a[56:59], v[96:111]
    ds_read_b64_tr_b16 v[56:57], v6 offset:63488
    v_mfma_f32_32x32x16_bf16 v[160:175], v[40:43], a[184:187], v[160:175]
    ds_read_b64_tr_b16 v[58:59], v6 offset:64000
    s_waitcnt lgkmcnt(6)
    v_mfma_f32_32x32x16_bf16 v[112:127], v[44:47], a[56:59], v[112:127]
    ds_read_b64_tr_b16 v[60:61], v7 offset:63488
    v_mfma_f32_32x32x16_bf16 v[176:191], v[44:47], a[184:187], v[176:191]
    ds_read_b64_tr_b16 v[62:63], v7 offset:64000
    s_waitcnt lgkmcnt(0)
    s_waitcnt vmcnt(19)
    s_barrier
    v_mfma_f32_32x32x16_bf16 v[64:79], v[48:51], a[60:63], v[64:79]
    s_add_u32 m0, s59, 0xc000
    s_add_u32 s60, s68, 0x380000
    buffer_load_dwordx4 v12, s[40:43], s60 offen offset:0 lds
    ds_read_b64_tr_b16 v[32:33], v6 offset:0
    v_mfma_f32_32x32x16_bf16 v[128:143], v[48:51], a[188:191], v[128:143]
    ds_read_b64_tr_b16 v[34:35], v6 offset:512
    v_mfma_f32_32x32x16_bf16 v[80:95], v[52:55], a[60:63], v[80:95]
    buffer_load_dwordx4 v13, s[40:43], s60 offen offset:1024 lds
    ds_read_b64_tr_b16 v[36:37], v7 offset:0
    v_mfma_f32_32x32x16_bf16 v[144:159], v[52:55], a[188:191], v[144:159]
    ds_read_b64_tr_b16 v[38:39], v7 offset:512
    v_mfma_f32_32x32x16_bf16 v[96:111], v[56:59], a[60:63], v[96:111]
    buffer_load_dwordx4 v14, s[40:43], s60 offen offset:2048 lds
    ds_read_b64_tr_b16 v[40:41], v6 offset:8192
    v_mfma_f32_32x32x16_bf16 v[160:175], v[56:59], a[188:191], v[160:175]
    ds_read_b64_tr_b16 v[42:43], v6 offset:8704
    v_mfma_f32_32x32x16_bf16 v[112:127], v[60:63], a[60:63], v[112:127]
    buffer_load_dwordx4 v15, s[40:43], s60 offen offset:3072 lds
    ds_read_b64_tr_b16 v[44:45], v7 offset:8192
    v_mfma_f32_32x32x16_bf16 v[176:191], v[60:63], a[188:191], v[176:191]
    ds_read_b64_tr_b16 v[46:47], v7 offset:8704
    s_waitcnt lgkmcnt(6)
    v_mfma_f32_32x32x16_bf16 v[64:79], v[32:35], a[64:67], v[64:79]
    ds_read_b64_tr_b16 v[48:49], v6 offset:2048
    ds_read_b128 a[96:99], v19 offset:0
    ds_read_b128 a[224:227], v19 offset:4096
    ds_read_b128 a[100:103], v20 offset:0
    v_mfma_f32_32x32x16_bf16 v[128:143], v[32:35], a[192:195], v[128:143]
    ds_read_b64_tr_b16 v[50:51], v6 offset:2560
    ds_read_b128 a[228:231], v20 offset:4096
    ds_read_b128 a[104:107], v21 offset:0
    ds_read_b128 a[232:235], v21 offset:4096
    ds_read_b128 a[108:111], v22 offset:0
    s_waitcnt lgkmcnt(13)
    v_mfma_f32_32x32x16_bf16 v[80:95], v[36:39], a[64:67], v[80:95]
    ds_read_b64_tr_b16 v[52:53], v7 offset:2048
    ds_read_b128 a[236:239], v22 offset:4096
    v_mfma_f32_32x32x16_bf16 v[144:159], v[36:39], a[192:195], v[144:159]
    s_waitcnt lgkmcnt(8)
    ds_read_b64_tr_b16 v[54:55], v7 offset:2560
    v_mfma_f32_32x32x16_bf16 v[96:111], v[40:43], a[64:67], v[96:111]
    ds_read_b64_tr_b16 v[56:57], v6 offset:10240
    v_mfma_f32_32x32x16_bf16 v[160:175], v[40:43], a[192:195], v[160:175]
    ds_read_b64_tr_b16 v[58:59], v6 offset:10752
    v_mfma_f32_32x32x16_bf16 v[112:127], v[44:47], a[64:67], v[112:127]
    ds_read_b64_tr_b16 v[60:61], v7 offset:10240
    v_mfma_f32_32x32x16_bf16 v[176:191], v[44:47], a[192:195], v[176:191]
    ds_read_b64_tr_b16 v[62:63], v7 offset:10752
    s_waitcnt lgkmcnt(0)
    v_mfma_f32_32x32x16_bf16 v[64:79], v[48:51], a[68:71], v[64:79]
    ds_read_b64_tr_b16 v[32:33], v6 offset:4096
    v_mfma_f32_32x32x16_bf16 v[128:143], v[48:51], a[196:199], v[128:143]
    ds_read_b64_tr_b16 v[34:35], v6 offset:4608
    v_mfma_f32_32x32x16_bf16 v[80:95], v[52:55], a[68:71], v[80:95]
    ds_read_b64_tr_b16 v[36:37], v7 offset:4096
    v_mfma_f32_32x32x16_bf16 v[144:159], v[52:55], a[196:199], v[144:159]
    ds_read_b64_tr_b16 v[38:39], v7 offset:4608
    v_mfma_f32_32x32x16_bf16 v[96:111], v[56:59], a[68:71], v[96:111]
    ds_read_b64_tr_b16 v[40:41], v6 offset:12288
    v_mfma_f32_32x32x16_bf16 v[160:175], v[56:59], a[196:199], v[160:175]
    ds_read_b64_tr_b16 v[42:43], v6 offset:12800
    v_mfma_f32_32x32x16_bf16 v[112:127], v[60:63], a[68:71], v[112:127]
    ds_read_b64_tr_b16 v[44:45], v7 offset:12288
    v_mfma_f32_32x32x16_bf16 v[176:191], v[60:63], a[196:199], v[176:191]
    ds_read_b64_tr_b16 v[46:47], v7 offset:12800
    s_waitcnt lgkmcnt(6)
    v_mfma_f32_32x32x16_bf16 v[64:79], v[32:35], a[72:75], v[64:79]
    ds_read_b64_tr_b16 v[48:49], v6 offset:6144
    v_mfma_f32_32x32x16_bf16 v[128:143], v[32:35], a[200:203], v[128:143]
    ds_read_b64_tr_b16 v[50:51], v6 offset:6656
    s_waitcnt lgkmcnt(6)
    v_mfma_f32_32x32x16_bf16 v[80:95], v[36:39], a[72:75], v[80:95]
    ds_read_b64_tr_b16 v[52:53], v7 offset:6144
    v_mfma_f32_32x32x16_bf16 v[144:159], v[36:39], a[200:203], v[144:159]
    ds_read_b64_tr_b16 v[54:55], v7 offset:6656
    s_waitcnt lgkmcnt(6)
    v_mfma_f32_32x32x16_bf16 v[96:111], v[40:43], a[72:75], v[96:111]
    ds_read_b64_tr_b16 v[56:57], v6 offset:14336
    v_mfma_f32_32x32x16_bf16 v[160:175], v[40:43], a[200:203], v[160:175]
    ds_read_b64_tr_b16 v[58:59], v6 offset:14848
    s_waitcnt lgkmcnt(6)
    v_mfma_f32_32x32x16_bf16 v[112:127], v[44:47], a[72:75], v[112:127]
    ds_read_b64_tr_b16 v[60:61], v7 offset:14336
    v_mfma_f32_32x32x16_bf16 v[176:191], v[44:47], a[200:203], v[176:191]
    ds_read_b64_tr_b16 v[62:63], v7 offset:14848
    s_waitcnt lgkmcnt(0)
    s_waitcnt vmcnt(11)
    s_barrier
    v_mfma_f32_32x32x16_bf16 v[64:79], v[48:51], a[76:79], v[64:79]
    s_add_u32 m0, s59, 0
    s_add_u32 s60, s69, 0
    buffer_load_dwordx4 v12, s[44:47], s60 offen offset:0 lds
    ds_read_b64_tr_b16 v[32:33], v6 offset:16384
    v_mfma_f32_32x32x16_bf16 v[128:143], v[48:51], a[204:207], v[128:143]
    ds_read_b64_tr_b16 v[34:35], v6 offset:16896
    v_mfma_f32_32x32x16_bf16 v[80:95], v[52:55], a[76:79], v[80:95]
    buffer_load_dwordx4 v13, s[44:47], s60 offen offset:1024 lds
    ds_read_b64_tr_b16 v[36:37], v7 offset:16384
    v_mfma_f32_32x32x16_bf16 v[144:159], v[52:55], a[204:207], v[144:159]
    ds_read_b64_tr_b16 v[38:39], v7 offset:16896
    v_mfma_f32_32x32x16_bf16 v[96:111], v[56:59], a[76:79], v[96:111]
    buffer_load_dwordx4 v14, s[44:47], s60 offen offset:2048 lds
    ds_read_b64_tr_b16 v[40:41], v6 offset:24576
    v_mfma_f32_32x32x16_bf16 v[160:175], v[56:59], a[204:207], v[160:175]
    ds_read_b64_tr_b16 v[42:43], v6 offset:25088
    v_mfma_f32_32x32x16_bf16 v[112:127], v[60:63], a[76:79], v[112:127]
    buffer_load_dwordx4 v15, s[44:47], s60 offen offset:3072 lds
    ds_read_b64_tr_b16 v[44:45], v7 offset:24576
    v_mfma_f32_32x32x16_bf16 v[176:191], v[60:63], a[204:207], v[176:191]
    ds_read_b64_tr_b16 v[46:47], v7 offset:25088
    s_waitcnt lgkmcnt(6)
    v_mfma_f32_32x32x16_bf16 v[64:79], v[32:35], a[80:83], v[64:79]
    ds_read_b64_tr_b16 v[48:49], v6 offset:18432
    ds_read_b128 a[112:115], v19 offset:8192
    ds_read_b128 a[240:243], v19 offset:12288
    ds_read_b128 a[116:119], v20 offset:8192
    v_mfma_f32_32x32x16_bf16 v[128:143], v[32:35], a[208:211], v[128:143]
    ds_read_b64_tr_b16 v[50:51], v6 offset:18944
    ds_read_b128 a[244:247], v20 offset:12288
    ds_read_b128 a[120:123], v21 offset:8192
    ds_read_b128 a[248:251], v21 offset:12288
    ds_read_b128 a[124:127], v22 offset:8192
    s_waitcnt lgkmcnt(13)
    v_mfma_f32_32x32x16_bf16 v[80:95], v[36:39], a[80:83], v[80:95]
    ds_read_b64_tr_b16 v[52:53], v7 offset:18432
    ds_read_b128 a[252:255], v22 offset:12288
    v_mfma_f32_32x32x16_bf16 v[144:159], v[36:39], a[208:211], v[144:159]
    s_waitcnt lgkmcnt(8)
    ds_read_b64_tr_b16 v[54:55], v7 offset:18944
    v_mfma_f32_32x32x16_bf16 v[96:111], v[40:43], a[80:83], v[96:111]
    ds_read_b64_tr_b16 v[56:57], v6 offset:26624
    v_mfma_f32_32x32x16_bf16 v[160:175], v[40:43], a[208:211], v[160:175]
    ds_read_b64_tr_b16 v[58:59], v6 offset:27136
    v_mfma_f32_32x32x16_bf16 v[112:127], v[44:47], a[80:83], v[112:127]
    ds_read_b64_tr_b16 v[60:61], v7 offset:26624
    v_mfma_f32_32x32x16_bf16 v[176:191], v[44:47], a[208:211], v[176:191]
    ds_read_b64_tr_b16 v[62:63], v7 offset:27136
    s_waitcnt lgkmcnt(0)
    v_mfma_f32_32x32x16_bf16 v[64:79], v[48:51], a[84:87], v[64:79]
    ds_read_b64_tr_b16 v[32:33], v6 offset:20480
    v_mfma_f32_32x32x16_bf16 v[128:143], v[48:51], a[212:215], v[128:143]
    ds_read_b64_tr_b16 v[34:35], v6 offset:20992
    v_mfma_f32_32x32x16_bf16 v[80:95], v[52:55], a[84:87], v[80:95]
    ds_read_b64_tr_b16 v[36:37], v7 offset:20480
    v_mfma_f32_32x32x16_bf16 v[144:159], v[52:55], a[212:215], v[144:159]
    ds_read_b64_tr_b16 v[38:39], v7 offset:20992
    v_mfma_f32_32x32x16_bf16 v[96:111], v[56:59], a[84:87], v[96:111]
    ds_read_b64_tr_b16 v[40:41], v6 offset:28672
    v_mfma_f32_32x32x16_bf16 v[160:175], v[56:59], a[212:215], v[160:175]
    ds_read_b64_tr_b16 v[42:43], v6 offset:29184
    v_mfma_f32_32x32x16_bf16 v[112:127], v[60:63], a[84:87], v[112:127]
    ds_read_b64_tr_b16 v[44:45], v7 offset:28672
    v_mfma_f32_32x32x16_bf16 v[176:191], v[60:63], a[212:215], v[176:191]
    ds_read_b64_tr_b16 v[46:47], v7 offset:29184
    s_waitcnt lgkmcnt(6)
    v_mfma_f32_32x32x16_bf16 v[64:79], v[32:35], a[88:91], v[64:79]
    ds_read_b64_tr_b16 v[48:49], v6 offset:22528
    v_mfma_f32_32x32x16_bf16 v[128:143], v[32:35], a[216:219], v[128:143]
    ds_read_b64_tr_b16 v[50:51], v6 offset:23040
    s_waitcnt lgkmcnt(6)
    v_mfma_f32_32x32x16_bf16 v[80:95], v[36:39], a[88:91], v[80:95]
    ds_read_b64_tr_b16 v[52:53], v7 offset:22528
    v_mfma_f32_32x32x16_bf16 v[144:159], v[36:39], a[216:219], v[144:159]
    ds_read_b64_tr_b16 v[54:55], v7 offset:23040
    s_waitcnt lgkmcnt(6)
    v_mfma_f32_32x32x16_bf16 v[96:111], v[40:43], a[88:91], v[96:111]
    ds_read_b64_tr_b16 v[56:57], v6 offset:30720
    v_mfma_f32_32x32x16_bf16 v[160:175], v[40:43], a[216:219], v[160:175]
    ds_read_b64_tr_b16 v[58:59], v6 offset:31232
    s_waitcnt lgkmcnt(6)
    v_mfma_f32_32x32x16_bf16 v[112:127], v[44:47], a[88:91], v[112:127]
    ds_read_b64_tr_b16 v[60:61], v7 offset:30720
    v_mfma_f32_32x32x16_bf16 v[176:191], v[44:47], a[216:219], v[176:191]
    ds_read_b64_tr_b16 v[62:63], v7 offset:31232
    s_waitcnt lgkmcnt(0)
    s_waitcnt vmcnt(11)
    s_waitcnt vmcnt(8)
    s_barrier
    s_cmp_lg_u32 s56, 0
    s_cbranch_scc1 L_sig_lna
    s_mov_b64 exec, 1
    v_mov_b32 v26, 1
    buffer_atomic_add v26, off, s[96:99], 0 offset:0
    s_mov_b64 exec, -1
L_sig_lna:
    v_mfma_f32_32x32x16_bf16 v[64:79], v[48:51], a[92:95], v[64:79]
    s_add_u32 m0, s59, 0x4000
    s_add_u32 s60, s69, 0x100000
    buffer_load_dwordx4 v12, s[44:47], s60 offen offset:0 lds
    ds_read_b64_tr_b16 v[32:33], v6 offset:32768
    v_mfma_f32_32x32x16_bf16 v[128:143], v[48:51], a[220:223], v[128:143]
    ds_read_b64_tr_b16 v[34:35], v6 offset:33280
    v_mfma_f32_32x32x16_bf16 v[80:95], v[52:55], a[92:95], v[80:95]
    buffer_load_dwordx4 v13, s[44:47], s60 offen offset:1024 lds
    ds_read_b64_tr_b16 v[36:37], v7 offset:32768
    v_mfma_f32_32x32x16_bf16 v[144:159], v[52:55], a[220:223], v[144:159]
    ds_read_b64_tr_b16 v[38:39], v7 offset:33280
    v_mfma_f32_32x32x16_bf16 v[96:111], v[56:59], a[92:95], v[96:111]
    buffer_load_dwordx4 v14, s[44:47], s60 offen offset:2048 lds
    ds_read_b64_tr_b16 v[40:41], v6 offset:40960
    v_mfma_f32_32x32x16_bf16 v[160:175], v[56:59], a[220:223], v[160:175]
    ds_read_b64_tr_b16 v[42:43], v6 offset:41472
    v_mfma_f32_32x32x16_bf16 v[112:127], v[60:63], a[92:95], v[112:127]
    buffer_load_dwordx4 v15, s[44:47], s60 offen offset:3072 lds
    ds_read_b64_tr_b16 v[44:45], v7 offset:40960
    v_mfma_f32_32x32x16_bf16 v[176:191], v[60:63], a[220:223], v[176:191]
    ds_read_b64_tr_b16 v[46:47], v7 offset:41472
    s_waitcnt lgkmcnt(6)
    v_mfma_f32_32x32x16_bf16 v[64:79], v[32:35], a[96:99], v[64:79]
    ds_read_b64_tr_b16 v[48:49], v6 offset:34816
    v_mfma_f32_32x32x16_bf16 v[128:143], v[32:35], a[224:227], v[128:143]
    ds_read_b64_tr_b16 v[50:51], v6 offset:35328
    s_waitcnt lgkmcnt(6)
    v_mfma_f32_32x32x16_bf16 v[80:95], v[36:39], a[96:99], v[80:95]
    ds_read_b64_tr_b16 v[52:53], v7 offset:34816
    v_mfma_f32_32x32x16_bf16 v[144:159], v[36:39], a[224:227], v[144:159]
    ds_read_b64_tr_b16 v[54:55], v7 offset:35328
    s_waitcnt lgkmcnt(6)
    v_mfma_f32_32x32x16_bf16 v[96:111], v[40:43], a[96:99], v[96:111]
    ds_read_b64_tr_b16 v[56:57], v6 offset:43008
    v_mfma_f32_32x32x16_bf16 v[160:175], v[40:43], a[224:227], v[160:175]
    ds_read_b64_tr_b16 v[58:59], v6 offset:43520
    s_waitcnt lgkmcnt(6)
    v_mfma_f32_32x32x16_bf16 v[112:127], v[44:47], a[96:99], v[112:127]
    ds_read_b64_tr_b16 v[60:61], v7 offset:43008
    v_mfma_f32_32x32x16_bf16 v[176:191], v[44:47], a[224:227], v[176:191]
    ds_read_b64_tr_b16 v[62:63], v7 offset:43520
    s_waitcnt lgkmcnt(6)
    v_mfma_f32_32x32x16_bf16 v[64:79], v[48:51], a[100:103], v[64:79]
    ds_read_b64_tr_b16 v[32:33], v6 offset:36864
    v_mfma_f32_32x32x16_bf16 v[128:143], v[48:51], a[228:231], v[128:143]
    ds_read_b64_tr_b16 v[34:35], v6 offset:37376
    s_waitcnt lgkmcnt(6)
    v_mfma_f32_32x32x16_bf16 v[80:95], v[52:55], a[100:103], v[80:95]
    ds_read_b64_tr_b16 v[36:37], v7 offset:36864
    v_mfma_f32_32x32x16_bf16 v[144:159], v[52:55], a[228:231], v[144:159]
    ds_read_b64_tr_b16 v[38:39], v7 offset:37376
    s_waitcnt lgkmcnt(6)
    v_mfma_f32_32x32x16_bf16 v[96:111], v[56:59], a[100:103], v[96:111]
    ds_read_b64_tr_b16 v[40:41], v6 offset:45056
    v_mfma_f32_32x32x16_bf16 v[160:175], v[56:59], a[228:231], v[160:175]
    ds_read_b64_tr_b16 v[42:43], v6 offset:45568
    s_waitcnt lgkmcnt(6)
    v_mfma_f32_32x32x16_bf16 v[112:127], v[60:63], a[100:103], v[112:127]
    ds_read_b64_tr_b16 v[44:45], v7 offset:45056
    v_mfma_f32_32x32x16_bf16 v[176:191], v[60:63], a[228:231], v[176:191]
    ds_read_b64_tr_b16 v[46:47], v7 offset:45568
    s_waitcnt lgkmcnt(6)
    v_mfma_f32_32x32x16_bf16 v[64:79], v[32:35], a[104:107], v[64:79]
    ds_read_b64_tr_b16 v[48:49], v6 offset:38912
    v_mfma_f32_32x32x16_bf16 v[128:143], v[32:35], a[232:235], v[128:143]
    ds_read_b64_tr_b16 v[50:51], v6 offset:39424
    s_waitcnt lgkmcnt(6)
    v_mfma_f32_32x32x16_bf16 v[80:95], v[36:39], a[104:107], v[80:95]
    ds_read_b64_tr_b16 v[52:53], v7 offset:38912
    v_mfma_f32_32x32x16_bf16 v[144:159], v[36:39], a[232:235], v[144:159]
    ds_read_b64_tr_b16 v[54:55], v7 offset:39424
    s_waitcnt lgkmcnt(6)
    v_mfma_f32_32x32x16_bf16 v[96:111], v[40:43], a[104:107], v[96:111]
    ds_read_b64_tr_b16 v[56:57], v6 offset:47104
    v_mfma_f32_32x32x16_bf16 v[160:175], v[40:43], a[232:235], v[160:175]
    ds_read_b64_tr_b16 v[58:59], v6 offset:47616
    s_waitcnt lgkmcnt(6)
    v_mfma_f32_32x32x16_bf16 v[112:127], v[44:47], a[104:107], v[112:127]
    ds_read_b64_tr_b16 v[60:61], v7 offset:47104
    v_mfma_f32_32x32x16_bf16 v[176:191], v[44:47], a[232:235], v[176:191]
    ds_read_b64_tr_b16 v[62:63], v7 offset:47616
    s_waitcnt lgkmcnt(0)
    s_waitcnt vmcnt(8)
    s_barrier
    v_mfma_f32_32x32x16_bf16 v[64:79], v[48:51], a[108:111], v[64:79]
    s_add_u32 m0, s59, 0x8000
    s_add_u32 s60, s69, 0x200000
    buffer_load_dwordx4 v12, s[44:47], s60 offen offset:0 lds
    ds_read_b64_tr_b16 v[32:33], v6 offset:49152
    v_mfma_f32_32x32x16_bf16 v[128:143], v[48:51], a[236:239], v[128:143]
    ds_read_b64_tr_b16 v[34:35], v6 offset:49664
    v_mfma_f32_32x32x16_bf16 v[80:95], v[52:55], a[108:111], v[80:95]
    buffer_load_dwordx4 v13, s[44:47], s60 offen offset:1024 lds
    ds_read_b64_tr_b16 v[36:37], v7 offset:49152
    v_mfma_f32_32x32x16_bf16 v[144:159], v[52:55], a[236:239], v[144:159]
    ds_read_b64_tr_b16 v[38:39], v7 offset:49664
    v_mfma_f32_32x32x16_bf16 v[96:111], v[56:59], a[108:111], v[96:111]
    buffer_load_dwordx4 v14, s[44:47], s60 offen offset:2048 lds
    ds_read_b64_tr_b16 v[40:41], v6 offset:57344
    v_mfma_f32_32x32x16_bf16 v[160:175], v[56:59], a[236:239], v[160:175]
    ds_read_b64_tr_b16 v[42:43], v6 offset:57856
    v_mfma_f32_32x32x16_bf16 v[112:127], v[60:63], a[108:111], v[112:127]
    buffer_load_dwordx4 v15, s[44:47], s60 offen offset:3072 lds
    ds_read_b64_tr_b16 v[44:45], v7 offset:57344
    v_mfma_f32_32x32x16_bf16 v[176:191], v[60:63], a[236:239], v[176:191]
    ds_read_b64_tr_b16 v[46:47], v7 offset:57856
    s_waitcnt lgkmcnt(6)
    v_mfma_f32_32x32x16_bf16 v[64:79], v[32:35], a[112:115], v[64:79]
    ds_read_b64_tr_b16 v[48:49], v6 offset:51200
    v_mfma_f32_32x32x16_bf16 v[128:143], v[32:35], a[240:243], v[128:143]
    ds_read_b64_tr_b16 v[50:51], v6 offset:51712
    s_waitcnt lgkmcnt(6)
    v_mfma_f32_32x32x16_bf16 v[80:95], v[36:39], a[112:115], v[80:95]
    ds_read_b64_tr_b16 v[52:53], v7 offset:51200
    v_mfma_f32_32x32x16_bf16 v[144:159], v[36:39], a[240:243], v[144:159]
    ds_read_b64_tr_b16 v[54:55], v7 offset:51712
    s_waitcnt lgkmcnt(6)
    v_mfma_f32_32x32x16_bf16 v[96:111], v[40:43], a[112:115], v[96:111]
    ds_read_b64_tr_b16 v[56:57], v6 offset:59392
    v_mfma_f32_32x32x16_bf16 v[160:175], v[40:43], a[240:243], v[160:175]
    ds_read_b64_tr_b16 v[58:59], v6 offset:59904
    s_waitcnt lgkmcnt(6)
    v_mfma_f32_32x32x16_bf16 v[112:127], v[44:47], a[112:115], v[112:127]
    ds_read_b64_tr_b16 v[60:61], v7 offset:59392
    v_mfma_f32_32x32x16_bf16 v[176:191], v[44:47], a[240:243], v[176:191]
    ds_read_b64_tr_b16 v[62:63], v7 offset:59904
    s_waitcnt lgkmcnt(6)
    v_mfma_f32_32x32x16_bf16 v[64:79], v[48:51], a[116:119], v[64:79]
    ds_read_b64_tr_b16 v[32:33], v6 offset:53248
    v_mfma_f32_32x32x16_bf16 v[128:143], v[48:51], a[244:247], v[128:143]
    ds_read_b64_tr_b16 v[34:35], v6 offset:53760
    s_waitcnt lgkmcnt(6)
    v_mfma_f32_32x32x16_bf16 v[80:95], v[52:55], a[116:119], v[80:95]
    ds_read_b64_tr_b16 v[36:37], v7 offset:53248
    v_mfma_f32_32x32x16_bf16 v[144:159], v[52:55], a[244:247], v[144:159]
    ds_read_b64_tr_b16 v[38:39], v7 offset:53760
    s_waitcnt lgkmcnt(6)
    v_mfma_f32_32x32x16_bf16 v[96:111], v[56:59], a[116:119], v[96:111]
    ds_read_b64_tr_b16 v[40:41], v6 offset:61440
    v_mfma_f32_32x32x16_bf16 v[160:175], v[56:59], a[244:247], v[160:175]
    ds_read_b64_tr_b16 v[42:43], v6 offset:61952
    s_waitcnt lgkmcnt(6)
    v_mfma_f32_32x32x16_bf16 v[112:127], v[60:63], a[116:119], v[112:127]
    ds_read_b64_tr_b16 v[44:45], v7 offset:61440
    v_mfma_f32_32x32x16_bf16 v[176:191], v[60:63], a[244:247], v[176:191]
    ds_read_b64_tr_b16 v[46:47], v7 offset:61952
    s_waitcnt lgkmcnt(6)
    v_mfma_f32_32x32x16_bf16 v[64:79], v[32:35], a[120:123], v[64:79]
    ds_read_b64_tr_b16 v[48:49], v6 offset:55296
    v_mfma_f32_32x32x16_bf16 v[128:143], v[32:35], a[248:251], v[128:143]
    ds_read_b64_tr_b16 v[50:51], v6 offset:55808
    s_waitcnt lgkmcnt(6)
    v_mfma_f32_32x32x16_bf16 v[80:95], v[36:39], a[120:123], v[80:95]
    ds_read_b64_tr_b16 v[52:53], v7 offset:55296
    v_mfma_f32_32x32x16_bf16 v[144:159], v[36:39], a[248:251], v[144:159]
    ds_read_b64_tr_b16 v[54:55], v7 offset:55808
    s_waitcnt lgkmcnt(6)
    v_mfma_f32_32x32x16_bf16 v[96:111], v[40:43], a[120:123], v[96:111]
    ds_read_b64_tr_b16 v[56:57], v6 offset:63488
    v_mfma_f32_32x32x16_bf16 v[160:175], v[40:43], a[248:251], v[160:175]
    ds_read_b64_tr_b16 v[58:59], v6 offset:64000
    s_waitcnt lgkmcnt(6)
    v_mfma_f32_32x32x16_bf16 v[112:127], v[44:47], a[120:123], v[112:127]
    ds_read_b64_tr_b16 v[60:61], v7 offset:63488
    v_mfma_f32_32x32x16_bf16 v[176:191], v[44:47], a[248:251], v[176:191]
    ds_read_b64_tr_b16 v[62:63], v7 offset:64000
    s_waitcnt lgkmcnt(0)
    s_waitcnt vmcnt(8)
    s_barrier
    v_mfma_f32_32x32x16_bf16 v[64:79], v[48:51], a[124:127], v[64:79]
    s_add_u32 m0, s59, 0xc000
    s_add_u32 s60, s69, 0x300000
    buffer_load_dwordx4 v12, s[44:47], s60 offen offset:0 lds
    ds_read_b64_tr_b16 v[32:33], v6 offset:0
    v_mfma_f32_32x32x16_bf16 v[128:143], v[48:51], a[252:255], v[128:143]
    v_mfma_f32_32x32x16_bf16 v[80:95], v[52:55], a[124:127], v[80:95]
    buffer_load_dwordx4 v13, s[44:47], s60 offen offset:1024 lds
    ds_read_b64_tr_b16 v[34:35], v6 offset:512
    v_mfma_f32_32x32x16_bf16 v[144:159], v[52:55], a[252:255], v[144:159]
    v_mfma_f32_32x32x16_bf16 v[96:111], v[56:59], a[124:127], v[96:111]
    buffer_load_dwordx4 v14, s[44:47], s60 offen offset:2048 lds
    ds_read_b64_tr_b16 v[36:37], v7 offset:0
    v_mfma_f32_32x32x16_bf16 v[160:175], v[56:59], a[252:255], v[160:175]
    v_mfma_f32_32x32x16_bf16 v[112:127], v[60:63], a[124:127], v[112:127]
    buffer_load_dwordx4 v15, s[44:47], s60 offen offset:3072 lds
    ds_read_b64_tr_b16 v[38:39], v7 offset:512
    v_mfma_f32_32x32x16_bf16 v[176:191], v[60:63], a[252:255], v[176:191]
    s_waitcnt lgkmcnt(2)
    v_mfma_f32_32x32x16_bf16 v[192:207], a[0:3], v[32:35], 0
    ds_read_b64_tr_b16 v[48:49], v6 offset:2048
    v_cvt_pk_bf16_f32 v64, v64, v65
    v_mfma_f32_32x32x16_bf16 v[224:239], a[128:131], v[32:35], 0
    ds_read_b64_tr_b16 v[50:51], v6 offset:2560
    s_lshl_b32 s79, s58, 2
    s_waitcnt lgkmcnt(2)
    v_mfma_f32_32x32x16_bf16 v[208:223], a[0:3], v[36:39], 0
    ds_read_b64_tr_b16 v[52:53], v7 offset:2048
    v_mfma_f32_32x32x16_bf16 v[240:255], a[128:131], v[36:39], 0
    v_cvt_pk_bf16_f32 v65, v66, v67
    ds_read_b64_tr_b16 v[54:55], v7 offset:2560
    s_waitcnt lgkmcnt(2)
    v_mfma_f32_32x32x16_bf16 v[192:207], a[4:7], v[48:51], v[192:207]
    ds_read_b64_tr_b16 v[32:33], v6 offset:4096
    s_lshl_b32 s74, s2, 2
    s_add_u32 s74, s74, s56
    s_lshl_b32 s74, s74, 13
    s_mov_b32 s48, s8
    s_mov_b32 s49, s9
    s_mov_b32 s50, 0x400000
    s_mov_b32 s51, 0x20000
    s_cmp_ge_u32 s74, s50
    s_cselect_b32 s76, s50, 0
    s_cselect_b32 s48, s18, s48
    s_cselect_b32 s49, s19, s49
    s_cselect_b32 s50, 0x1c0000, s50
    s_sub_u32 s74, s74, s76
    s_cmp_ge_u32 s74, s50
    s_cselect_b32 s76, s50, 0
    s_cselect_b32 s48, s20, s48
    s_cselect_b32 s49, s21, s49
    s_cselect_b32 s50, 0x1c0000, s50
    s_sub_u32 s74, s74, s76
    v_lshlrev_b32 v5, 7, v1
    buffer_load_dword v28, v5, s[48:51], s74 offen
    v_mfma_f32_32x32x16_bf16 v[224:239], a[132:135], v[48:51], v[224:239]
    s_add_u32 s30, s79, s56
    ds_read_b64_tr_b16 v[34:35], v6 offset:4608
    v_cvt_pk_bf16_f32 v66, v68, v69
    s_waitcnt lgkmcnt(2)
    v_mfma_f32_32x32x16_bf16 v[208:223], a[4:7], v[52:55], v[208:223]
    ds_read_b64_tr_b16 v[36:37], v7 offset:4096
    v_cvt_pk_bf16_f32 v67, v70, v71
    v_mfma_f32_32x32x16_bf16 v[240:255], a[132:135], v[52:55], v[240:255]
    ds_read_b64_tr_b16 v[38:39], v7 offset:4608
    s_sub_u32 s81, 60, s79
    s_waitcnt lgkmcnt(2)
    v_mfma_f32_32x32x16_bf16 v[192:207], a[8:11], v[32:35], v[192:207]
    ds_read_b64_tr_b16 v[48:49], v6 offset:6144
    s_add_u32 s3, s100, 0
    v_mfma_f32_32x32x16_bf16 v[224:239], a[136:139], v[32:35], v[224:239]
    ds_read_b64_tr_b16 v[50:51], v6 offset:6656
    buffer_store_dwordx4 v[64:67], v2, s[32:35], s3 offen offset:0 sc1
    s_waitcnt lgkmcnt(2)
    v_mfma_f32_32x32x16_bf16 v[208:223], a[8:11], v[36:39], v[208:223]
    ds_read_b64_tr_b16 v[52:53], v7 offset:6144
    v_mfma_f32_32x32x16_bf16 v[240:255], a[136:139], v[36:39], v[240:255]
    s_add_u32 s81, s81, s56
    ds_read_b64_tr_b16 v[54:55], v7 offset:6656
    s_waitcnt lgkmcnt(2)
    v_mfma_f32_32x32x16_bf16 v[192:207], a[12:15], v[48:51], v[192:207]
    ds_read_b64_tr_b16 v[32:33], v6 offset:8192
    v_cvt_pk_bf16_f32 v72, v72, v73
    v_mfma_f32_32x32x16_bf16 v[224:239], a[140:143], v[48:51], v[224:239]
    ds_read_b64_tr_b16 v[34:35], v6 offset:8704
    v_cvt_pk_bf16_f32 v73, v74, v75
    s_waitcnt lgkmcnt(2)
    v_mfma_f32_32x32x16_bf16 v[208:223], a[12:15], v[52:55], v[208:223]
    ds_read_b64_tr_b16 v[36:37], v7 offset:8192
    s_lshl_b32 s62, s81, 15
    v_mfma_f32_32x32x16_bf16 v[240:255], a[140:143], v[52:55], v[240:255]
    ds_read_b64_tr_b16 v[38:39], v7 offset:8704
    v_cvt_pk_bf16_f32 v74, v76, v77
    s_waitcnt lgkmcnt(2)
    v_mfma_f32_32x32x16_bf16 v[192:207], a[16:19], v[32:35], v[192:207]
    ds_read_b64_tr_b16 v[48:49], v6 offset:10240
    s_lshl_b32 s63, s30, 15
    v_mfma_f32_32x32x16_bf16 v[224:239], a[144:147], v[32:35], v[224:239]
    ds_read_b64_tr_b16 v[50:51], v6 offset:10752
    v_cvt_pk_bf16_f32 v75, v78, v79
    s_waitcnt lgkmcnt(2)
    v_mfma_f32_32x32x16_bf16 v[208:223], a[16:19], v[36:39], v[208:223]
    ds_read_b64_tr_b16 v[52:53], v7 offset:10240
    v_mfma_f32_32x32x16_bf16 v[240:255], a[144:147], v[36:39], v[240:255]
    s_add_u32 s3, s100, 0
    ds_read_b64_tr_b16 v[54:55], v7 offset:10752
    s_waitcnt lgkmcnt(2)
    v_mfma_f32_32x32x16_bf16 v[192:207], a[20:23], v[48:51], v[192:207]
    ds_read_b64_tr_b16 v[32:33], v6 offset:12288
    v_lshrrev_b32 v3, 3, v1
    v_mfma_f32_32x32x16_bf16 v[224:239], a[148:151], v[48:51], v[224:239]
    ds_read_b64_tr_b16 v[34:35], v6 offset:12800
    buffer_store_dwordx4 v[72:75], v2, s[32:35], s3 offen offset:1024 sc1
    s_waitcnt lgkmcnt(2)
    v_mfma_f32_32x32x16_bf16 v[208:223], a[20:23], v[52:55], v[208:223]
    ds_read_b64_tr_b16 v[36:37], v7 offset:12288
    v_cvt_pk_bf16_f32 v80, v80, v81
    v_mfma_f32_32x32x16_bf16 v[240:255], a[148:151], v[52:55], v[240:255]
    ds_read_b64_tr_b16 v[38:39], v7 offset:12800
    v_mul_u32_u24 v3, 0xe00, v3
    s_waitcnt lgkmcnt(2)
    v_mfma_f32_32x32x16_bf16 v[192:207], a[24:27], v[32:35], v[192:207]
    ds_read_b64_tr_b16 v[48:49], v6 offset:14336
    v_cvt_pk_bf16_f32 v81, v82, v83
    v_mfma_f32_32x32x16_bf16 v[224:239], a[152:155], v[32:35], v[224:239]
    ds_read_b64_tr_b16 v[50:51], v6 offset:14848
    v_cvt_pk_bf16_f32 v82, v84, v85
    s_waitcnt lgkmcnt(2)
    v_mfma_f32_32x32x16_bf16 v[208:223], a[24:27], v[36:39], v[208:223]
    ds_read_b64_tr_b16 v[52:53], v7 offset:14336
    v_mfma_f32_32x32x16_bf16 v[240:255], a[152:155], v[36:39], v[240:255]
    v_bfe_u32 v4, v1, 4, 1
    ds_read_b64_tr_b16 v[54:55], v7 offset:14848
    s_waitcnt lgkmcnt(0)
    s_waitcnt vmcnt(11)
    s_barrier
    v_mfma_f32_32x32x16_bf16 v[192:207], a[28:31], v[48:51], v[192:207]
    s_add_u32 m0, s59, 0
    s_add_u32 s60, s70, 0
    buffer_load_dwordx4 v12, s[44:47], s60 offen offset:0 lds
    ds_read_b64_tr_b16 v[32:33], v6 offset:16384
    v_cvt_pk_bf16_f32 v83, v86, v87
    v_mfma_f32_32x32x16_bf16 v[224:239], a[156:159], v[48:51], v[224:239]
    ds_read_b64_tr_b16 v[34:35], v6 offset:16896
    v_lshlrev_b32 v4, 2, v4
    ds_read_b64_tr_b16 v[36:37], v7 offset:16384
    v_mfma_f32_32x32x16_bf16 v[208:223], a[28:31], v[52:55], v[208:223]
    buffer_load_dwordx4 v13, s[44:47], s60 offen offset:1024 lds
    s_add_u32 s3, s100, 0
    ds_read_b64_tr_b16 v[38:39], v7 offset:16896
    v_mfma_f32_32x32x16_bf16 v[240:255], a[156:159], v[52:55], v[240:255]
    buffer_store_dwordx4 v[80:83], v2, s[32:35], s3 offen offset:2048 sc1
    s_waitcnt lgkmcnt(2)
    v_mfma_f32_32x32x16_bf16 v[192:207], a[32:35], v[32:35], v[192:207]
    buffer_load_dwordx4 v14, s[44:47], s60 offen offset:2048 lds
    ds_read_b64_tr_b16 v[48:49], v6 offset:18432
    v_xor_b32 v4, v4, v1
    v_mfma_f32_32x32x16_bf16 v[224:239], a[160:163], v[32:35], v[224:239]
    ds_read_b64_tr_b16 v[50:51], v6 offset:18944
    v_cvt_pk_bf16_f32 v88, v88, v89
    s_waitcnt lgkmcnt(2)
    v_mfma_f32_32x32x16_bf16 v[208:223], a[32:35], v[36:39], v[208:223]
    buffer_load_dwordx4 v15, s[44:47], s60 offen offset:3072 lds
    ds_read_b64_tr_b16 v[52:53], v7 offset:18432
    v_mfma_f32_32x32x16_bf16 v[240:255], a[160:163], v[36:39], v[240:255]
    v_cvt_pk_bf16_f32 v89, v90, v91
    ds_read_b64_tr_b16 v[54:55], v7 offset:18944
    s_waitcnt lgkmcnt(2)
    v_mfma_f32_32x32x16_bf16 v[192:207], a[36:39], v[48:51], v[192:207]
    ds_read_b64_tr_b16 v[32:33], v6 offset:20480
    v_and_b32 v4, 7, v4
    v_mfma_f32_32x32x16_bf16 v[224:239], a[164:167], v[48:51], v[224:239]
    ds_read_b64_tr_b16 v[34:35], v6 offset:20992
    v_cvt_pk_bf16_f32 v90, v92, v93
    s_waitcnt lgkmcnt(2)
    v_mfma_f32_32x32x16_bf16 v[208:223], a[36:39], v[52:55], v[208:223]
    ds_read_b64_tr_b16 v[36:37], v7 offset:20480
    v_cvt_pk_bf16_f32 v91, v94, v95
    v_mfma_f32_32x32x16_bf16 v[240:255], a[164:167], v[52:55], v[240:255]
    ds_read_b64_tr_b16 v[38:39], v7 offset:20992
    v_lshlrev_b32 v4, 4, v4
    s_waitcnt lgkmcnt(2)
    v_mfma_f32_32x32x16_bf16 v[192:207], a[40:43], v[32:35], v[192:207]
    ds_read_b64_tr_b16 v[48:49], v6 offset:22528
    s_add_u32 s3, s100, 0
    v_mfma_f32_32x32x16_bf16 v[224:239], a[168:171], v[32:35], v[224:239]
    ds_read_b64_tr_b16 v[50:51], v6 offset:23040
    v_add_u32 v8, v3, v4
    s_waitcnt lgkmcnt(2)
    v_mfma_f32_32x32x16_bf16 v[208:223], a[40:43], v[36:39], v[208:223]
    ds_read_b64_tr_b16 v[52:53], v7 offset:22528
    buffer_store_dwordx4 v[88:91], v2, s[32:35], s3 offen offset:3072 sc1
    v_mfma_f32_32x32x16_bf16 v[240:255], a[168:171], v[36:39], v[240:255]
    ds_read_b64_tr_b16 v[54:55], v7 offset:23040
    s_waitcnt lgkmcnt(2)
    v_mfma_f32_32x32x16_bf16 v[192:207], a[44:47], v[48:51], v[192:207]
    ds_read_b64_tr_b16 v[32:33], v6 offset:24576
    v_cvt_pk_bf16_f32 v96, v96, v97
    v_mfma_f32_32x32x16_bf16 v[224:239], a[172:175], v[48:51], v[224:239]
    ds_read_b64_tr_b16 v[34:35], v6 offset:25088
    v_add_u32 v9, 0x6c00, v8
    s_waitcnt lgkmcnt(2)
    v_mfma_f32_32x32x16_bf16 v[208:223], a[44:47], v[52:55], v[208:223]
    ds_read_b64_tr_b16 v[36:37], v7 offset:24576
    v_cvt_pk_bf16_f32 v97, v98, v99
    v_mfma_f32_32x32x16_bf16 v[240:255], a[172:175], v[52:55], v[240:255]
    ds_read_b64_tr_b16 v[38:39], v7 offset:25088
    v_cvt_pk_bf16_f32 v98, v100, v101
    s_waitcnt lgkmcnt(2)
    v_mfma_f32_32x32x16_bf16 v[192:207], a[48:51], v[32:35], v[192:207]
    ds_read_b64_tr_b16 v[48:49], v6 offset:26624
    v_add_u32 v10, 0x6c00, v9
    v_mfma_f32_32x32x16_bf16 v[224:239], a[176:179], v[32:35], v[224:239]
    ds_read_b64_tr_b16 v[50:51], v6 offset:27136
    v_cvt_pk_bf16_f32 v99, v102, v103
    s_waitcnt lgkmcnt(2)
    v_mfma_f32_32x32x16_bf16 v[208:223], a[48:51], v[36:39], v[208:223]
    ds_read_b64_tr_b16 v[52:53], v7 offset:26624
    v_mfma_f32_32x32x16_bf16 v[240:255], a[176:179], v[36:39], v[240:255]
    s_add_u32 s3, s100, 0x1000
    ds_read_b64_tr_b16 v[54:55], v7 offset:27136
    s_waitcnt lgkmcnt(2)
    v_mfma_f32_32x32x16_bf16 v[192:207], a[52:55], v[48:51], v[192:207]
    ds_read_b64_tr_b16 v[32:33], v6 offset:28672
    v_add_u32 v11, 0x6c00, v10
    v_mfma_f32_32x32x16_bf16 v[224:239], a[180:183], v[48:51], v[224:239]
    ds_read_b64_tr_b16 v[34:35], v6 offset:29184
    buffer_store_dwordx4 v[96:99], v2, s[32:35], s3 offen offset:0 sc1
    s_waitcnt lgkmcnt(2)
    v_mfma_f32_32x32x16_bf16 v[208:223], a[52:55], v[52:55], v[208:223]
    ds_read_b64_tr_b16 v[36:37], v7 offset:28672
    s_and_b32 s79, s56, 1
    v_mfma_f32_32x32x16_bf16 v[240:255], a[180:183], v[52:55], v[240:255]
    ds_read_b64_tr_b16 v[38:39], v7 offset:29184
    v_cvt_pk_bf16_f32 v104, v104, v105
    s_waitcnt lgkmcnt(2)
    v_mfma_f32_32x32x16_bf16 v[192:207], a[56:59], v[32:35], v[192:207]
    ds_read_b64_tr_b16 v[48:49], v6 offset:30720
    v_cvt_pk_bf16_f32 v105, v106, v107
    v_mfma_f32_32x32x16_bf16 v[224:239], a[184:187], v[32:35], v[224:239]
    ds_read_b64_tr_b16 v[50:51], v6 offset:31232
    s_mul_i32 s79, s79, 0x1c000
    s_waitcnt lgkmcnt(2)
    v_mfma_f32_32x32x16_bf16 v[208:223], a[56:59], v[36:39], v[208:223]
    ds_read_b64_tr_b16 v[52:53], v7 offset:30720
    v_mfma_f32_32x32x16_bf16 v[240:255], a[184:187], v[36:39], v[240:255]
    v_cvt_pk_bf16_f32 v106, v108, v109
    ds_read_b64_tr_b16 v[54:55], v7 offset:31232
    s_waitcnt lgkmcnt(0)
    s_waitcnt vmcnt(14)
    s_barrier
    v_mfma_f32_32x32x16_bf16 v[192:207], a[60:63], v[48:51], v[192:207]
    s_add_u32 m0, s59, 0x4000
    s_add_u32 s60, s70, 0x100000
    buffer_load_dwordx4 v12, s[44:47], s60 offen offset:0 lds
    ds_read_b64_tr_b16 v[32:33], v6 offset:32768
    v_cvt_pk_bf16_f32 v107, v110, v111
    v_mfma_f32_32x32x16_bf16 v[224:239], a[188:191], v[48:51], v[224:239]
    ds_read_b64_tr_b16 v[34:35], v6 offset:33280
    s_lshl_b32 s80, s57, 7
    ds_read_b64_tr_b16 v[36:37], v7 offset:32768
    v_mfma_f32_32x32x16_bf16 v[208:223], a[60:63], v[52:55], v[208:223]
    buffer_load_dwordx4 v13, s[44:47], s60 offen offset:1024 lds
    s_add_u32 s3, s100, 0x1000
    ds_read_b64_tr_b16 v[38:39], v7 offset:33280
    v_mfma_f32_32x32x16_bf16 v[240:255], a[188:191], v[52:55], v[240:255]
    buffer_store_dwordx4 v[104:107], v2, s[32:35], s3 offen offset:1024 sc1
    s_waitcnt lgkmcnt(2)
    v_mfma_f32_32x32x16_bf16 v[192:207], a[64:67], v[32:35], v[192:207]
    buffer_load_dwordx4 v14, s[44:47], s60 offen offset:2048 lds
    ds_read_b64_tr_b16 v[48:49], v6 offset:34816
    s_add_u32 s64, s79, s80
    v_mfma_f32_32x32x16_bf16 v[224:239], a[192:195], v[32:35], v[224:239]
    ds_read_b64_tr_b16 v[50:51], v6 offset:35328
    v_cvt_pk_bf16_f32 v112, v112, v113
    s_waitcnt lgkmcnt(2)
    v_mfma_f32_32x32x16_bf16 v[208:223], a[64:67], v[36:39], v[208:223]
    buffer_load_dwordx4 v15, s[44:47], s60 offen offset:3072 lds
    ds_read_b64_tr_b16 v[52:53], v7 offset:34816
    s_mov_b32 s65, s69
    v_mfma_f32_32x32x16_bf16 v[240:255], a[192:195], v[36:39], v[240:255]
    ds_read_b64_tr_b16 v[54:55], v7 offset:35328
    v_cvt_pk_bf16_f32 v113, v114, v115
    s_waitcnt lgkmcnt(2)
    v_mfma_f32_32x32x16_bf16 v[192:207], a[68:71], v[48:51], v[192:207]
    ds_read_b64_tr_b16 v[32:33], v6 offset:36864
    v_cvt_pk_bf16_f32 v114, v116, v117
    v_mfma_f32_32x32x16_bf16 v[224:239], a[196:199], v[48:51], v[224:239]
    ds_read_b64_tr_b16 v[34:35], v6 offset:37376
    s_mov_b32 s66, s70
    s_waitcnt lgkmcnt(2)
    v_mfma_f32_32x32x16_bf16 v[208:223], a[68:71], v[52:55], v[208:223]
    ds_read_b64_tr_b16 v[36:37], v7 offset:36864
    v_mfma_f32_32x32x16_bf16 v[240:255], a[196:199], v[52:55], v[240:255]
    v_cvt_pk_bf16_f32 v115, v118, v119
    ds_read_b64_tr_b16 v[38:39], v7 offset:37376
    s_waitcnt lgkmcnt(2)
    v_mfma_f32_32x32x16_bf16 v[192:207], a[72:75], v[32:35], v[192:207]
    ds_read_b64_tr_b16 v[48:49], v6 offset:38912
    s_add_u32 s3, s100, 0x1000
    v_mfma_f32_32x32x16_bf16 v[224:239], a[200:203], v[32:35], v[224:239]
    ds_read_b64_tr_b16 v[50:51], v6 offset:39424
    s_lshl_b32 s31, s57, 2
    ds_read_b64_tr_b16 v[52:53], v7 offset:38912
    s_waitcnt lgkmcnt(3)
    v_mfma_f32_32x32x16_bf16 v[208:223], a[72:75], v[36:39], v[208:223]
    buffer_store_dwordx4 v[112:115], v2, s[32:35], s3 offen offset:2048 sc1
    v_mfma_f32_32x32x16_bf16 v[240:255], a[200:203], v[36:39], v[240:255]
    ds_read_b64_tr_b16 v[54:55], v7 offset:39424
    v_cvt_pk_bf16_f32 v120, v120, v121
    s_waitcnt lgkmcnt(2)
    v_mfma_f32_32x32x16_bf16 v[192:207], a[76:79], v[48:51], v[192:207]
    ds_read_b64_tr_b16 v[32:33], v6 offset:40960
    s_add_u32 s31, s31, 4
    v_mfma_f32_32x32x16_bf16 v[224:239], a[204:207], v[48:51], v[224:239]
    ds_read_b64_tr_b16 v[34:35], v6 offset:41472
    v_cvt_pk_bf16_f32 v121, v122, v123
    s_waitcnt lgkmcnt(2)
    v_mfma_f32_32x32x16_bf16 v[208:223], a[76:79], v[52:55], v[208:223]
    ds_read_b64_tr_b16 v[36:37], v7 offset:40960
    v_mfma_f32_32x32x16_bf16 v[240:255], a[204:207], v[52:55], v[240:255]
    s_cmp_lt_u32 s56, 2
    ds_read_b64_tr_b16 v[38:39], v7 offset:41472
    s_waitcnt lgkmcnt(2)
    v_mfma_f32_32x32x16_bf16 v[192:207], a[80:83], v[32:35], v[192:207]
    ds_read_b64_tr_b16 v[48:49], v6 offset:43008
    v_cvt_pk_bf16_f32 v122, v124, v125
    v_mfma_f32_32x32x16_bf16 v[224:239], a[208:211], v[32:35], v[224:239]
    ds_read_b64_tr_b16 v[50:51], v6 offset:43520
    v_cvt_pk_bf16_f32 v123, v126, v127
    s_waitcnt lgkmcnt(2)
    v_mfma_f32_32x32x16_bf16 v[208:223], a[80:83], v[36:39], v[208:223]
    ds_read_b64_tr_b16 v[52:53], v7 offset:43008
    s_cmp_lt_u32 s56, 2
    s_cselect_b32 s36, s18, s20
    s_cselect_b32 s37, s19, s21
    v_mfma_f32_32x32x16_bf16 v[240:255], a[208:211], v[36:39], v[240:255]
    ds_read_b64_tr_b16 v[54:55], v7 offset:43520
    s_add_u32 s3, s100, 0x1000
    s_waitcnt lgkmcnt(2)
    v_mfma_f32_32x32x16_bf16 v[192:207], a[84:87], v[48:51], v[192:207]
    ds_read_b64_tr_b16 v[32:33], v6 offset:45056
    buffer_store_dwordx4 v[120:123], v2, s[32:35], s3 offen offset:3072 sc1
    v_mfma_f32_32x32x16_bf16 v[224:239], a[212:215], v[48:51], v[224:239]
    ds_read_b64_tr_b16 v[34:35], v6 offset:45568
    s_waitcnt lgkmcnt(2)
    v_mfma_f32_32x32x16_bf16 v[208:223], a[84:87], v[52:55], v[208:223]
    s_mov_b32 s38, 0x1c0000
    ds_read_b64_tr_b16 v[36:37], v7 offset:45056
    v_mfma_f32_32x32x16_bf16 v[240:255], a[212:215], v[52:55], v[240:255]
    v_cvt_pk_bf16_f32 v128, v128, v129
    ds_read_b64_tr_b16 v[38:39], v7 offset:45568
    s_waitcnt lgkmcnt(2)
    v_mfma_f32_32x32x16_bf16 v[192:207], a[88:91], v[32:35], v[192:207]
    ds_read_b64_tr_b16 v[48:49], v6 offset:47104
    v_cvt_pk_bf16_f32 v129, v130, v131
    v_mfma_f32_32x32x16_bf16 v[224:239], a[216:219], v[32:35], v[224:239]
    ds_read_b64_tr_b16 v[50:51], v6 offset:47616
    s_mov_b32 s40, s8
    s_waitcnt lgkmcnt(2)
    v_mfma_f32_32x32x16_bf16 v[208:223], a[88:91], v[36:39], v[208:223]
    ds_read_b64_tr_b16 v[52:53], v7 offset:47104
    v_cvt_pk_bf16_f32 v130, v132, v133
    v_mfma_f32_32x32x16_bf16 v[240:255], a[216:219], v[36:39], v[240:255]
    ds_read_b64_tr_b16 v[54:55], v7 offset:47616
    s_mov_b32 s41, s9
    s_waitcnt lgkmcnt(0)
    s_waitcnt vmcnt(17)
    s_barrier
    v_mfma_f32_32x32x16_bf16 v[192:207], a[92:95], v[48:51], v[192:207]
    s_add_u32 m0, s59, 0x8000
    s_add_u32 s60, s70, 0x200000
    buffer_load_dwordx4 v12, s[44:47], s60 offen offset:0 lds
    ds_read_b64_tr_b16 v[32:33], v6 offset:49152
    v_cvt_pk_bf16_f32 v131, v134, v135
    v_mfma_f32_32x32x16_bf16 v[224:239], a[220:223], v[48:51], v[224:239]
    ds_read_b64_tr_b16 v[34:35], v6 offset:49664
    s_add_u32 s3, s100, 0x2000
    v_mfma_f32_32x32x16_bf16 v[208:223], a[92:95], v[52:55], v[208:223]
    buffer_load_dwordx4 v13, s[44:47], s60 offen offset:1024 lds
    ds_read_b64_tr_b16 v[36:37], v7 offset:49152
    v_mfma_f32_32x32x16_bf16 v[240:255], a[220:223], v[52:55], v[240:255]
    s_mov_b32 s42, 0x400000
    ds_read_b64_tr_b16 v[38:39], v7 offset:49664
    s_waitcnt lgkmcnt(2)
    v_mfma_f32_32x32x16_bf16 v[192:207], a[96:99], v[32:35], v[192:207]
    buffer_load_dwordx4 v14, s[44:47], s60 offen offset:2048 lds
    ds_read_b64_tr_b16 v[48:49], v6 offset:51200
    buffer_store_dwordx4 v[128:131], v2, s[32:35], s3 offen offset:0 sc1
    v_mfma_f32_32x32x16_bf16 v[224:239], a[224:227], v[32:35], v[224:239]
    ds_read_b64_tr_b16 v[50:51], v6 offset:51712
    v_cvt_pk_bf16_f32 v136, v136, v137
    s_waitcnt lgkmcnt(2)
    v_mfma_f32_32x32x16_bf16 v[208:223], a[96:99], v[36:39], v[208:223]
    buffer_load_dwordx4 v15, s[44:47], s60 offen offset:3072 lds
    ds_read_b64_tr_b16 v[52:53], v7 offset:51200
    s_mov_b32 s43, 0x20000
    v_mfma_f32_32x32x16_bf16 v[240:255], a[224:227], v[36:39], v[240:255]
    ds_read_b64_tr_b16 v[54:55], v7 offset:51712
    v_cvt_pk_bf16_f32 v137, v138, v139
    s_waitcnt lgkmcnt(2)
    v_mfma_f32_32x32x16_bf16 v[192:207], a[100:103], v[48:51], v[192:207]
    ds_read_b64_tr_b16 v[32:33], v6 offset:53248
    v_cvt_pk_bf16_f32 v138, v140, v141
    v_mfma_f32_32x32x16_bf16 v[224:239], a[228:231], v[48:51], v[224:239]
    ds_read_b64_tr_b16 v[34:35], v6 offset:53760
    v_mov_b32 v16, 0xbdd2d3e8
    s_waitcnt lgkmcnt(2)
    v_mfma_f32_32x32x16_bf16 v[208:223], a[100:103], v[52:55], v[208:223]
    ds_read_b64_tr_b16 v[36:37], v7 offset:53248
    v_mfma_f32_32x32x16_bf16 v[240:255], a[228:231], v[52:55], v[240:255]
    v_cvt_pk_bf16_f32 v139, v142, v143
    ds_read_b64_tr_b16 v[38:39], v7 offset:53760
    s_waitcnt lgkmcnt(2)
    v_mfma_f32_32x32x16_bf16 v[192:207], a[104:107], v[32:35], v[192:207]
    ds_read_b64_tr_b16 v[48:49], v6 offset:55296
    s_mul_i32 s79, s81, 0x5c000
    v_mfma_f32_32x32x16_bf16 v[224:239], a[232:235], v[32:35], v[224:239]
    ds_read_b64_tr_b16 v[50:51], v6 offset:55808
    s_add_u32 s3, s100, 0x2000
    ds_read_b64_tr_b16 v[52:53], v7 offset:55296
    s_waitcnt lgkmcnt(3)
    v_mfma_f32_32x32x16_bf16 v[208:223], a[104:107], v[36:39], v[208:223]
    buffer_store_dwordx4 v[136:139], v2, s[32:35], s3 offen offset:1024 sc1
    v_mfma_f32_32x32x16_bf16 v[240:255], a[232:235], v[36:39], v[240:255]
    ds_read_b64_tr_b16 v[54:55], v7 offset:55808
    s_lshl_b32 s80, s57, 12
    s_waitcnt lgkmcnt(2)
    v_mfma_f32_32x32x16_bf16 v[192:207], a[108:111], v[48:51], v[192:207]
    ds_read_b64_tr_b16 v[32:33], v6 offset:57344
    v_cvt_pk_bf16_f32 v144, v144, v145
    v_mfma_f32_32x32x16_bf16 v[224:239], a[236:239], v[48:51], v[224:239]
    ds_read_b64_tr_b16 v[34:35], v6 offset:57856
    v_cvt_pk_bf16_f32 v145, v146, v147
    s_waitcnt lgkmcnt(2)
    v_mfma_f32_32x32x16_bf16 v[208:223], a[108:111], v[52:55], v[208:223]
    ds_read_b64_tr_b16 v[36:37], v7 offset:57344
    v_mfma_f32_32x32x16_bf16 v[240:255], a[236:239], v[52:55], v[240:255]
    s_add_u32 s67, s79, s80
    ds_read_b64_tr_b16 v[38:39], v7 offset:57856
    s_waitcnt lgkmcnt(2)
    v_mfma_f32_32x32x16_bf16 v[192:207], a[112:115], v[32:35], v[192:207]
    ds_read_b64_tr_b16 v[48:49], v6 offset:59392
    v_cvt_pk_bf16_f32 v146, v148, v149
    v_mfma_f32_32x32x16_bf16 v[224:239], a[240:243], v[32:35], v[224:239]
    ds_read_b64_tr_b16 v[50:51], v6 offset:59904
    v_cvt_pk_bf16_f32 v147, v150, v151
    s_waitcnt lgkmcnt(2)
    v_mfma_f32_32x32x16_bf16 v[208:223], a[112:115], v[36:39], v[208:223]
    ds_read_b64_tr_b16 v[52:53], v7 offset:59392
    s_add_u32 s67, s67, 0x2240000
    v_mfma_f32_32x32x16_bf16 v[240:255], a[240:243], v[36:39], v[240:255]
    ds_read_b64_tr_b16 v[54:55], v7 offset:59904
    s_add_u32 s3, s100, 0x2000
    s_waitcnt lgkmcnt(2)
    v_mfma_f32_32x32x16_bf16 v[192:207], a[116:119], v[48:51], v[192:207]
    ds_read_b64_tr_b16 v[32:33], v6 offset:61440
    s_mul_i32 s79, s30, 0x5c000
    v_mfma_f32_32x32x16_bf16 v[224:239], a[244:247], v[48:51], v[224:239]
    ds_read_b64_tr_b16 v[34:35], v6 offset:61952
    buffer_store_dwordx4 v[144:147], v2, s[32:35], s3 offen offset:2048 sc1
    s_waitcnt lgkmcnt(2)
    v_mfma_f32_32x32x16_bf16 v[208:223], a[116:119], v[52:55], v[208:223]
    ds_read_b64_tr_b16 v[36:37], v7 offset:61440
    v_mfma_f32_32x32x16_bf16 v[240:255], a[244:247], v[52:55], v[240:255]
    v_cvt_pk_bf16_f32 v152, v152, v153
    ds_read_b64_tr_b16 v[38:39], v7 offset:61952
    s_waitcnt lgkmcnt(2)
    v_mfma_f32_32x32x16_bf16 v[192:207], a[120:123], v[32:35], v[192:207]
    ds_read_b64_tr_b16 v[48:49], v6 offset:63488
    s_lshl_b32 s80, s57, 12
    v_mfma_f32_32x32x16_bf16 v[224:239], a[248:251], v[32:35], v[224:239]
    ds_read_b64_tr_b16 v[50:51], v6 offset:64000
    v_cvt_pk_bf16_f32 v153, v154, v155
    s_waitcnt lgkmcnt(2)
    v_mfma_f32_32x32x16_bf16 v[208:223], a[120:123], v[36:39], v[208:223]
    ds_read_b64_tr_b16 v[52:53], v7 offset:63488
    v_cvt_pk_bf16_f32 v154, v156, v157
    v_mfma_f32_32x32x16_bf16 v[240:255], a[248:251], v[36:39], v[240:255]
    ds_read_b64_tr_b16 v[54:55], v7 offset:64000
    s_add_u32 s68, s79, s80
    s_waitcnt lgkmcnt(0)
    s_waitcnt vmcnt(16)
    s_barrier
    buffer_load_dword v25, off, s[96:99], 0 offset:0 sc1
    v_mfma_f32_32x32x16_bf16 v[192:207], a[124:127], v[48:51], v[192:207]
    s_add_u32 m0, s59, 0xc000
    s_add_u32 s60, s70, 0x300000
    buffer_load_dwordx4 v12, s[44:47], s60 offen offset:0 lds
    ds_read_b64_tr_b16 v[32:33], v6 offset:0
    v_cvt_pk_bf16_f32 v155, v158, v159
    v_mfma_f32_32x32x16_bf16 v[224:239], a[252:255], v[48:51], v[224:239]
    ds_read_b64_tr_b16 v[34:35], v6 offset:512
    s_add_u32 s3, s100, 0x2000
    ds_read_b64_tr_b16 v[36:37], v7 offset:0
    v_mfma_f32_32x32x16_bf16 v[208:223], a[124:127], v[52:55], v[208:223]
    buffer_load_dwordx4 v13, s[44:47], s60 offen offset:1024 lds
    s_add_u32 s68, s68, 0x2240000
    ds_read_b64_tr_b16 v[38:39], v7 offset:512
    v_mfma_f32_32x32x16_bf16 v[240:255], a[252:255], v[52:55], v[240:255]
    buffer_store_dwordx4 v[152:155], v2, s[32:35], s3 offen offset:3072 sc1
    s_waitcnt lgkmcnt(2)
    v_mfma_f32_32x32x16_bf16 v[64:79], a[0:3], v[32:35], 0
    buffer_load_dwordx4 v14, s[44:47], s60 offen offset:2048 lds
    ds_read_b64_tr_b16 v[48:49], v6 offset:2048
    v_cvt_pk_bf16_f32 v160, v160, v161
    v_mfma_f32_32x32x16_bf16 v[96:111], a[128:131], v[32:35], 0
    ds_read_b64_tr_b16 v[50:51], v6 offset:2560
    s_waitcnt lgkmcnt(2)
    v_mfma_f32_32x32x16_bf16 v[80:95], a[0:3], v[36:39], 0
    buffer_load_dwordx4 v15, s[44:47], s60 offen offset:3072 lds
    ds_read_b64_tr_b16 v[52:53], v7 offset:2048
    v_cvt_pk_bf16_f32 v161, v162, v163
    v_mfma_f32_32x32x16_bf16 v[112:127], a[128:131], v[36:39], 0
    ds_read_b64_tr_b16 v[54:55], v7 offset:2560
    s_waitcnt lgkmcnt(2)
    v_mfma_f32_32x32x16_bf16 v[64:79], a[4:7], v[48:51], v[64:79]
    ds_read_b64_tr_b16 v[32:33], v6 offset:4096
    v_cvt_pk_bf16_f32 v162, v164, v165
    v_mfma_f32_32x32x16_bf16 v[96:111], a[132:135], v[48:51], v[96:111]
    ds_read_b64_tr_b16 v[34:35], v6 offset:4608
    v_cvt_pk_bf16_f32 v163, v166, v167
    s_waitcnt lgkmcnt(2)
    v_mfma_f32_32x32x16_bf16 v[80:95], a[4:7], v[52:55], v[80:95]
    ds_read_b64_tr_b16 v[36:37], v7 offset:4096
    v_mfma_f32_32x32x16_bf16 v[112:127], a[132:135], v[52:55], v[112:127]
    s_add_u32 s3, s100, 0x3000
    ds_read_b64_tr_b16 v[38:39], v7 offset:4608
    s_waitcnt lgkmcnt(2)
    v_mfma_f32_32x32x16_bf16 v[64:79], a[8:11], v[32:35], v[64:79]
    ds_read_b64_tr_b16 v[48:49], v6 offset:6144
    v_mfma_f32_32x32x16_bf16 v[96:111], a[136:139], v[32:35], v[96:111]
    buffer_store_dwordx4 v[160:163], v2, s[32:35], s3 offen offset:0 sc1
    ds_read_b64_tr_b16 v[50:51], v6 offset:6656
    s_waitcnt lgkmcnt(2)
    v_mfma_f32_32x32x16_bf16 v[80:95], a[8:11], v[36:39], v[80:95]
    ds_read_b64_tr_b16 v[52:53], v7 offset:6144
    v_mfma_f32_32x32x16_bf16 v[112:127], a[136:139], v[36:39], v[112:127]
    v_cvt_pk_bf16_f32 v168, v168, v169
    ds_read_b64_tr_b16 v[54:55], v7 offset:6656
    s_waitcnt lgkmcnt(2)
    v_mfma_f32_32x32x16_bf16 v[64:79], a[12:15], v[48:51], v[64:79]
    ds_read_b64_tr_b16 v[32:33], v6 offset:8192
    v_cvt_pk_bf16_f32 v169, v170, v171
    v_mfma_f32_32x32x16_bf16 v[96:111], a[140:143], v[48:51], v[96:111]
    ds_read_b64_tr_b16 v[34:35], v6 offset:8704
    v_cvt_pk_bf16_f32 v170, v172, v173
    s_waitcnt lgkmcnt(2)
    v_mfma_f32_32x32x16_bf16 v[80:95], a[12:15], v[52:55], v[80:95]
    ds_read_b64_tr_b16 v[36:37], v7 offset:8192
    v_mfma_f32_32x32x16_bf16 v[112:127], a[140:143], v[52:55], v[112:127]
    v_cvt_pk_bf16_f32 v171, v174, v175
    ds_read_b64_tr_b16 v[38:39], v7 offset:8704
    s_waitcnt lgkmcnt(2)
    v_mfma_f32_32x32x16_bf16 v[64:79], a[16:19], v[32:35], v[64:79]
    ds_read_b64_tr_b16 v[48:49], v6 offset:10240
    s_add_u32 s3, s100, 0x3000
    v_mfma_f32_32x32x16_bf16 v[96:111], a[144:147], v[32:35], v[96:111]
    ds_read_b64_tr_b16 v[50:51], v6 offset:10752
    buffer_store_dwordx4 v[168:171], v2, s[32:35], s3 offen offset:1024 sc1
    s_waitcnt lgkmcnt(2)
    v_mfma_f32_32x32x16_bf16 v[80:95], a[16:19], v[36:39], v[80:95]
    ds_read_b64_tr_b16 v[52:53], v7 offset:10240
    v_mfma_f32_32x32x16_bf16 v[112:127], a[144:147], v[36:39], v[112:127]
    v_cvt_pk_bf16_f32 v176, v176, v177
    ds_read_b64_tr_b16 v[54:55], v7 offset:10752
    s_waitcnt lgkmcnt(2)
    v_mfma_f32_32x32x16_bf16 v[64:79], a[20:23], v[48:51], v[64:79]
    ds_read_b64_tr_b16 v[32:33], v6 offset:12288
    v_cvt_pk_bf16_f32 v177, v178, v179
    v_mfma_f32_32x32x16_bf16 v[96:111], a[148:151], v[48:51], v[96:111]
    ds_read_b64_tr_b16 v[34:35], v6 offset:12800
    s_waitcnt lgkmcnt(2)
    v_mfma_f32_32x32x16_bf16 v[80:95], a[20:23], v[52:55], v[80:95]
    ds_read_b64_tr_b16 v[36:37], v7 offset:12288
    v_cvt_pk_bf16_f32 v178, v180, v181
    v_mfma_f32_32x32x16_bf16 v[112:127], a[148:151], v[52:55], v[112:127]
    ds_read_b64_tr_b16 v[38:39], v7 offset:12800
    s_waitcnt lgkmcnt(2)
    v_mfma_f32_32x32x16_bf16 v[64:79], a[24:27], v[32:35], v[64:79]
    ds_read_b64_tr_b16 v[48:49], v6 offset:14336
    v_cvt_pk_bf16_f32 v179, v182, v183
    v_mfma_f32_32x32x16_bf16 v[96:111], a[152:155], v[32:35], v[96:111]
    ds_read_b64_tr_b16 v[50:51], v6 offset:14848
    s_add_u32 s3, s100, 0x3000
    s_waitcnt lgkmcnt(2)
    v_mfma_f32_32x32x16_bf16 v[80:95], a[24:27], v[36:39], v[80:95]
    ds_read_b64_tr_b16 v[52:53], v7 offset:14336
    buffer_store_dwordx4 v[176:179], v2, s[32:35], s3 offen offset:2048 sc1
    v_mfma_f32_32x32x16_bf16 v[112:127], a[152:155], v[36:39], v[112:127]
    ds_read_b64_tr_b16 v[54:55], v7 offset:14848
    s_waitcnt lgkmcnt(0)
    s_waitcnt vmcnt(18)
    s_barrier
    s_waitcnt vmcnt(8)
    v_readfirstlane_b32 s74, v25
    s_nop 0
    s_cmp_ge_u32 s74, 0x100
    s_cbranch_scc1 L_pollx_lna
    s_mov_b32 s76, 0x10000
L_poll_lna:
    buffer_load_dword v25, off, s[96:99], 0 offset:0 sc1
    s_waitcnt vmcnt(0)
    v_readfirstlane_b32 s74, v25
    s_sub_u32 s76, s76, 1
    s_cmp_eq_u32 s76, 0
    s_cbranch_scc1 L_pollx_lna
    s_cmp_ge_u32 s74, 0x100
    s_cbranch_scc1 L_pollx_lna
    s_sleep 2
    s_branch L_poll_lna
L_pollx_lna:
    v_mfma_f32_32x32x16_bf16 v[64:79], a[28:31], v[48:51], v[64:79]
    s_add_u32 m0, s59, 0
    s_add_u32 s60, s64, 0
    buffer_load_dwordx4 v8, s[36:39], s60 offen offset:0 lds
    ds_read_b64_tr_b16 v[32:33], v6 offset:16384
    v_cvt_pk_bf16_f32 v184, v184, v185
    v_mfma_f32_32x32x16_bf16 v[96:111], a[156:159], v[48:51], v[96:111]
    ds_read_b64_tr_b16 v[34:35], v6 offset:16896
    v_cvt_pk_bf16_f32 v185, v186, v187
    v_mfma_f32_32x32x16_bf16 v[80:95], a[28:31], v[52:55], v[80:95]
    buffer_load_dwordx4 v9, s[36:39], s60 offen offset:1024 lds
    ds_read_b64_tr_b16 v[36:37], v7 offset:16384
    v_mfma_f32_32x32x16_bf16 v[112:127], a[156:159], v[52:55], v[112:127]
    v_cvt_pk_bf16_f32 v186, v188, v189
    ds_read_b64_tr_b16 v[38:39], v7 offset:16896
    s_waitcnt lgkmcnt(2)
    v_mfma_f32_32x32x16_bf16 v[64:79], a[32:35], v[32:35], v[64:79]
    buffer_load_dwordx4 v10, s[36:39], s60 offen offset:2048 lds
    ds_read_b64_tr_b16 v[48:49], v6 offset:18432
    v_cvt_pk_bf16_f32 v187, v190, v191
    v_mfma_f32_32x32x16_bf16 v[96:111], a[160:163], v[32:35], v[96:111]
    ds_read_b64_tr_b16 v[50:51], v6 offset:18944
    s_waitcnt lgkmcnt(2)
    v_mfma_f32_32x32x16_bf16 v[80:95], a[32:35], v[36:39], v[80:95]
    buffer_load_dwordx4 v11, s[36:39], s60 offen offset:3072 lds
    ds_read_b64_tr_b16 v[52:53], v7 offset:18432
    s_add_u32 s3, s100, 0x3000
    v_mfma_f32_32x32x16_bf16 v[112:127], a[160:163], v[36:39], v[112:127]
    ds_read_b64_tr_b16 v[54:55], v7 offset:18944
    s_waitcnt lgkmcnt(2)
    v_mfma_f32_32x32x16_bf16 v[64:79], a[36:39], v[48:51], v[64:79]
    ds_read_b64_tr_b16 v[32:33], v6 offset:20480
    buffer_store_dwordx4 v[184:187], v2, s[32:35], s3 offen offset:3072 sc1
    v_mfma_f32_32x32x16_bf16 v[96:111], a[164:167], v[48:51], v[96:111]
    ds_read_b64_tr_b16 v[34:35], v6 offset:20992
    s_waitcnt lgkmcnt(2)
    v_mfma_f32_32x32x16_bf16 v[80:95], a[36:39], v[52:55], v[80:95]
    v_cvt_pk_bf16_f32 v192, v192, v193
    ds_read_b64_tr_b16 v[36:37], v7 offset:20480
    v_mfma_f32_32x32x16_bf16 v[112:127], a[164:167], v[52:55], v[112:127]
    v_cvt_pk_bf16_f32 v193, v194, v195
    ds_read_b64_tr_b16 v[38:39], v7 offset:20992
    s_waitcnt lgkmcnt(2)
    v_mfma_f32_32x32x16_bf16 v[64:79], a[40:43], v[32:35], v[64:79]
    ds_read_b64_tr_b16 v[48:49], v6 offset:22528
    v_cvt_pk_bf16_f32 v194, v196, v197
    v_mfma_f32_32x32x16_bf16 v[96:111], a[168:171], v[32:35], v[96:111]
    ds_read_b64_tr_b16 v[50:51], v6 offset:23040
    s_waitcnt lgkmcnt(2)
    v_mfma_f32_32x32x16_bf16 v[80:95], a[40:43], v[36:39], v[80:95]
    ds_read_b64_tr_b16 v[52:53], v7 offset:22528
    v_cvt_pk_bf16_f32 v195, v198, v199
    v_mfma_f32_32x32x16_bf16 v[112:127], a[168:171], v[36:39], v[112:127]
    ds_read_b64_tr_b16 v[54:55], v7 offset:23040
    s_waitcnt lgkmcnt(2)
    v_mfma_f32_32x32x16_bf16 v[64:79], a[44:47], v[48:51], v[64:79]
    ds_read_b64_tr_b16 v[32:33], v6 offset:24576
    s_add_u32 s3, s101, 0
    v_mfma_f32_32x32x16_bf16 v[96:111], a[172:175], v[48:51], v[96:111]
    ds_read_b64_tr_b16 v[34:35], v6 offset:25088
    buffer_store_dwordx4 v[192:195], v2, s[32:35], s3 offen offset:0 sc1
    s_waitcnt lgkmcnt(2)
    v_mfma_f32_32x32x16_bf16 v[80:95], a[44:47], v[52:55], v[80:95]
    ds_read_b64_tr_b16 v[36:37], v7 offset:24576
    v_mfma_f32_32x32x16_bf16 v[112:127], a[172:175], v[52:55], v[112:127]
    v_cvt_pk_bf16_f32 v200, v200, v201
    ds_read_b64_tr_b16 v[38:39], v7 offset:25088
    s_waitcnt lgkmcnt(2)
    v_mfma_f32_32x32x16_bf16 v[64:79], a[48:51], v[32:35], v[64:79]
    s_add_u32 s79, s62, 0
    buffer_load_dwordx4 a[0:3], v2, s[32:35], s79 offen offset:0
    ds_read_b64_tr_b16 v[48:49], v6 offset:26624
    v_cvt_pk_bf16_f32 v201, v202, v203
    v_mfma_f32_32x32x16_bf16 v[96:111], a[176:179], v[32:35], v[96:111]
    ds_read_b64_tr_b16 v[50:51], v6 offset:27136
    v_cvt_pk_bf16_f32 v202, v204, v205
    s_waitcnt lgkmcnt(2)
    v_mfma_f32_32x32x16_bf16 v[80:95], a[48:51], v[36:39], v[80:95]
    buffer_load_dwordx4 a[4:7], v2, s[32:35], s79 offen offset:1024
    ds_read_b64_tr_b16 v[52:53], v7 offset:26624
    v_mfma_f32_32x32x16_bf16 v[112:127], a[176:179], v[36:39], v[112:127]
    v_cvt_pk_bf16_f32 v203, v206, v207
    ds_read_b64_tr_b16 v[54:55], v7 offset:27136
    s_waitcnt lgkmcnt(2)
    v_mfma_f32_32x32x16_bf16 v[64:79], a[52:55], v[48:51], v[64:79]
    buffer_load_dwordx4 a[8:11], v2, s[32:35], s79 offen offset:2048
    ds_read_b64_tr_b16 v[32:33], v6 offset:28672
    s_add_u32 s3, s101, 0x1000
    v_mfma_f32_32x32x16_bf16 v[96:111], a[180:183], v[48:51], v[96:111]
    ds_read_b64_tr_b16 v[34:35], v6 offset:29184
    ds_read_b64_tr_b16 v[36:37], v7 offset:28672
    s_waitcnt lgkmcnt(3)
    v_mfma_f32_32x32x16_bf16 v[80:95], a[52:55], v[52:55], v[80:95]
    buffer_load_dwordx4 a[12:15], v2, s[32:35], s79 offen offset:3072
    buffer_store_dwordx4 v[200:203], v2, s[32:35], s3 offen offset:0 sc1
    v_mfma_f32_32x32x16_bf16 v[112:127], a[180:183], v[52:55], v[112:127]
    ds_read_b64_tr_b16 v[38:39], v7 offset:29184
    s_waitcnt lgkmcnt(2)
    v_mfma_f32_32x32x16_bf16 v[64:79], a[56:59], v[32:35], v[64:79]
    s_add_u32 s80, s63, 0
    buffer_load_dwordx4 a[128:131], v2, s[32:35], s80 offen offset:0
    ds_read_b64_tr_b16 v[48:49], v6 offset:30720
    v_cvt_pk_bf16_f32 v208, v208, v209
    v_mfma_f32_32x32x16_bf16 v[96:111], a[184:187], v[32:35], v[96:111]
    ds_read_b64_tr_b16 v[50:51], v6 offset:31232
    v_cvt_pk_bf16_f32 v209, v210, v211
    s_waitcnt lgkmcnt(2)
    v_mfma_f32_32x32x16_bf16 v[80:95], a[56:59], v[36:39], v[80:95]
    buffer_load_dwordx4 a[132:135], v2, s[32:35], s80 offen offset:1024
    ds_read_b64_tr_b16 v[52:53], v7 offset:30720
    v_mfma_f32_32x32x16_bf16 v[112:127], a[184:187], v[36:39], v[112:127]
    v_cvt_pk_bf16_f32 v210, v212, v213
    ds_read_b64_tr_b16 v[54:55], v7 offset:31232
    s_waitcnt lgkmcnt(0)
    s_barrier
    v_mfma_f32_32x32x16_bf16 v[64:79], a[60:63], v[48:51], v[64:79]
    buffer_load_dwordx4 a[136:139], v2, s[32:35], s80 offen offset:2048
    ds_read_b64_tr_b16 v[32:33], v6 offset:32768
    v_cvt_pk_bf16_f32 v211, v214, v215
    v_mfma_f32_32x32x16_bf16 v[96:111], a[188:191], v[48:51], v[96:111]
    ds_read_b64_tr_b16 v[34:35], v6 offset:33280
    s_add_u32 s3, s101, 0
    v_mfma_f32_32x32x16_bf16 v[80:95], a[60:63], v[52:55], v[80:95]
    buffer_load_dwordx4 a[140:143], v2, s[32:35], s80 offen offset:3072
    ds_read_b64_tr_b16 v[36:37], v7 offset:32768
    buffer_store_dwordx4 v[208:211], v2, s[32:35], s3 offen offset:1024 sc1
    v_mfma_f32_32x32x16_bf16 v[112:127], a[188:191], v[52:55], v[112:127]
    ds_read_b64_tr_b16 v[38:39], v7 offset:33280
    s_waitcnt lgkmcnt(2)
    v_mfma_f32_32x32x16_bf16 v[64:79], a[64:67], v[32:35], v[64:79]
    s_add_u32 m0, s59, 0x4000
    s_add_u32 s60, s64, 0x38000
    buffer_load_dwordx4 v8, s[36:39], s60 offen offset:0 lds
    ds_read_b64_tr_b16 v[48:49], v6 offset:34816
    v_cvt_pk_bf16_f32 v216, v216, v217
    v_mfma_f32_32x32x16_bf16 v[96:111], a[192:195], v[32:35], v[96:111]
    ds_read_b64_tr_b16 v[50:51], v6 offset:35328
    s_waitcnt lgkmcnt(2)
    v_mfma_f32_32x32x16_bf16 v[80:95], a[64:67], v[36:39], v[80:95]
    buffer_load_dwordx4 v9, s[36:39], s60 offen offset:1024 lds
    ds_read_b64_tr_b16 v[52:53], v7 offset:34816
    v_cvt_pk_bf16_f32 v217, v218, v219
    v_mfma_f32_32x32x16_bf16 v[112:127], a[192:195], v[36:39], v[112:127]
    ds_read_b64_tr_b16 v[54:55], v7 offset:35328
    s_waitcnt lgkmcnt(2)
    v_mfma_f32_32x32x16_bf16 v[64:79], a[68:71], v[48:51], v[64:79]
    buffer_load_dwordx4 v10, s[36:39], s60 offen offset:2048 lds
    ds_read_b64_tr_b16 v[32:33], v6 offset:36864
    v_cvt_pk_bf16_f32 v218, v220, v221
    v_mfma_f32_32x32x16_bf16 v[96:111], a[196:199], v[48:51], v[96:111]
    ds_read_b64_tr_b16 v[34:35], v6 offset:37376
    v_cvt_pk_bf16_f32 v219, v222, v223
    s_waitcnt lgkmcnt(2)
    v_mfma_f32_32x32x16_bf16 v[80:95], a[68:71], v[52:55], v[80:95]
    buffer_load_dwordx4 v11, s[36:39], s60 offen offset:3072 lds
    ds_read_b64_tr_b16 v[36:37], v7 offset:36864
    v_mfma_f32_32x32x16_bf16 v[112:127], a[196:199], v[52:55], v[112:127]
    s_add_u32 s3, s101, 0x1000
    ds_read_b64_tr_b16 v[38:39], v7 offset:37376
    s_waitcnt lgkmcnt(2)
    v_mfma_f32_32x32x16_bf16 v[64:79], a[72:75], v[32:35], v[64:79]
    s_add_u32 s79, s62, 0x1000
    buffer_load_dwordx4 a[16:19], v2, s[32:35], s79 offen offset:0
    ds_read_b64_tr_b16 v[48:49], v6 offset:38912
    v_mfma_f32_32x32x16_bf16 v[96:111], a[200:203], v[32:35], v[96:111]
    buffer_store_dwordx4 v[216:219], v2, s[32:35], s3 offen offset:1024 sc1
    ds_read_b64_tr_b16 v[50:51], v6 offset:39424
    s_waitcnt lgkmcnt(2)
    v_mfma_f32_32x32x16_bf16 v[80:95], a[72:75], v[36:39], v[80:95]
    buffer_load_dwordx4 a[20:23], v2, s[32:35], s79 offen offset:1024
    ds_read_b64_tr_b16 v[52:53], v7 offset:38912
    v_mfma_f32_32x32x16_bf16 v[112:127], a[200:203], v[36:39], v[112:127]
    v_cvt_pk_bf16_f32 v224, v224, v225
    ds_read_b64_tr_b16 v[54:55], v7 offset:39424
    s_waitcnt lgkmcnt(2)
    v_mfma_f32_32x32x16_bf16 v[64:79], a[76:79], v[48:51], v[64:79]
    buffer_load_dwordx4 a[24:27], v2, s[32:35], s79 offen offset:2048
    ds_read_b64_tr_b16 v[32:33], v6 offset:40960
    v_cvt_pk_bf16_f32 v225, v226, v227
    v_mfma_f32_32x32x16_bf16 v[96:111], a[204:207], v[48:51], v[96:111]
    ds_read_b64_tr_b16 v[34:35], v6 offset:41472
    v_cvt_pk_bf16_f32 v226, v228, v229
    s_waitcnt lgkmcnt(2)
    v_mfma_f32_32x32x16_bf16 v[80:95], a[76:79], v[52:55], v[80:95]
    buffer_load_dwordx4 a[28:31], v2, s[32:35], s79 offen offset:3072
    ds_read_b64_tr_b16 v[36:37], v7 offset:40960
    v_mfma_f32_32x32x16_bf16 v[112:127], a[204:207], v[52:55], v[112:127]
    v_cvt_pk_bf16_f32 v227, v230, v231
    ds_read_b64_tr_b16 v[38:39], v7 offset:41472
    s_waitcnt lgkmcnt(2)
    v_mfma_f32_32x32x16_bf16 v[64:79], a[80:83], v[32:35], v[64:79]
    s_add_u32 s80, s63, 0x1000
    buffer_load_dwordx4 a[144:147], v2, s[32:35], s80 offen offset:0
    ds_read_b64_tr_b16 v[48:49], v6 offset:43008
    s_add_u32 s3, s101, 0x2000
    v_mfma_f32_32x32x16_bf16 v[96:111], a[208:211], v[32:35], v[96:111]
    ds_read_b64_tr_b16 v[50:51], v6 offset:43520
    buffer_store_dwordx4 v[224:227], v2, s[32:35], s3 offen offset:0 sc1
    s_waitcnt lgkmcnt(2)
    v_mfma_f32_32x32x16_bf16 v[80:95], a[80:83], v[36:39], v[80:95]
    buffer_load_dwordx4 a[148:151], v2, s[32:35], s80 offen offset:1024
    ds_read_b64_tr_b16 v[52:53], v7 offset:43008
    v_mfma_f32_32x32x16_bf16 v[112:127], a[208:211], v[36:39], v[112:127]
    v_cvt_pk_bf16_f32 v232, v232, v233
    ds_read_b64_tr_b16 v[54:55], v7 offset:43520
    s_waitcnt lgkmcnt(2)
    v_mfma_f32_32x32x16_bf16 v[64:79], a[84:87], v[48:51], v[64:79]
    buffer_load_dwordx4 a[152:155], v2, s[32:35], s80 offen offset:2048
    ds_read_b64_tr_b16 v[32:33], v6 offset:45056
    v_cvt_pk_bf16_f32 v233, v234, v235
    v_mfma_f32_32x32x16_bf16 v[96:111], a[212:215], v[48:51], v[96:111]
    ds_read_b64_tr_b16 v[34:35], v6 offset:45568
    s_waitcnt lgkmcnt(2)
    v_mfma_f32_32x32x16_bf16 v[80:95], a[84:87], v[52:55], v[80:95]
    buffer_load_dwordx4 a[156:159], v2, s[32:35], s80 offen offset:3072
    ds_read_b64_tr_b16 v[36:37], v7 offset:45056
    v_cvt_pk_bf16_f32 v234, v236, v237
    v_mfma_f32_32x32x16_bf16 v[112:127], a[212:215], v[52:55], v[112:127]
    ds_read_b64_tr_b16 v[38:39], v7 offset:45568
    s_waitcnt lgkmcnt(2)
    v_mfma_f32_32x32x16_bf16 v[64:79], a[88:91], v[32:35], v[64:79]
    ds_read_b64_tr_b16 v[48:49], v6 offset:47104
    v_cvt_pk_bf16_f32 v235, v238, v239
    v_mfma_f32_32x32x16_bf16 v[96:111], a[216:219], v[32:35], v[96:111]
    ds_read_b64_tr_b16 v[50:51], v6 offset:47616
    s_add_u32 s3, s101, 0x3000
    s_waitcnt lgkmcnt(2)
    v_mfma_f32_32x32x16_bf16 v[80:95], a[88:91], v[36:39], v[80:95]
    ds_read_b64_tr_b16 v[52:53], v7 offset:47104
    buffer_store_dwordx4 v[232:235], v2, s[32:35], s3 offen offset:0 sc1
    v_mfma_f32_32x32x16_bf16 v[112:127], a[216:219], v[36:39], v[112:127]
    ds_read_b64_tr_b16 v[54:55], v7 offset:47616
    s_waitcnt lgkmcnt(0)
    s_waitcnt vmcnt(34)
    s_barrier
    v_mfma_f32_32x32x16_bf16 v[64:79], a[92:95], v[48:51], v[64:79]
    s_add_u32 m0, s59, 0x8000
    s_add_u32 s60, s64, 0x70000
    buffer_load_dwordx4 v8, s[36:39], s60 offen offset:0 lds
    ds_read_b64_tr_b16 v[32:33], v6 offset:49152
    v_cvt_pk_bf16_f32 v240, v240, v241
    v_mfma_f32_32x32x16_bf16 v[96:111], a[220:223], v[48:51], v[96:111]
    ds_read_b64_tr_b16 v[34:35], v6 offset:49664
    v_cvt_pk_bf16_f32 v241, v242, v243
    v_mfma_f32_32x32x16_bf16 v[80:95], a[92:95], v[52:55], v[80:95]
    buffer_load_dwordx4 v9, s[36:39], s60 offen offset:1024 lds
    ds_read_b64_tr_b16 v[36:37], v7 offset:49152
    v_mfma_f32_32x32x16_bf16 v[112:127], a[220:223], v[52:55], v[112:127]
    v_cvt_pk_bf16_f32 v242, v244, v245
    ds_read_b64_tr_b16 v[38:39], v7 offset:49664
    s_waitcnt lgkmcnt(2)
    v_mfma_f32_32x32x16_bf16 v[64:79], a[96:99], v[32:35], v[64:79]
    buffer_load_dwordx4 v10, s[36:39], s60 offen offset:2048 lds
    ds_read_b64_tr_b16 v[48:49], v6 offset:51200
    v_cvt_pk_bf16_f32 v243, v246, v247
    v_mfma_f32_32x32x16_bf16 v[96:111], a[224:227], v[32:35], v[96:111]
    ds_read_b64_tr_b16 v[50:51], v6 offset:51712
    s_waitcnt lgkmcnt(2)
    v_mfma_f32_32x32x16_bf16 v[80:95], a[96:99], v[36:39], v[80:95]
    buffer_load_dwordx4 v11, s[36:39], s60 offen offset:3072 lds
    ds_read_b64_tr_b16 v[52:53], v7 offset:51200
    s_add_u32 s3, s101, 0x2000
    v_mfma_f32_32x32x16_bf16 v[112:127], a[224:227], v[36:39], v[112:127]
    ds_read_b64_tr_b16 v[54:55], v7 offset:51712
    s_waitcnt lgkmcnt(2)
    v_mfma_f32_32x32x16_bf16 v[64:79], a[100:103], v[48:51], v[64:79]
    s_add_u32 s79, s62, 0x2000
    buffer_load_dwordx4 a[32:35], v2, s[32:35], s79 offen offset:0
    ds_read_b64_tr_b16 v[32:33], v6 offset:53248
    buffer_store_dwordx4 v[240:243], v2, s[32:35], s3 offen offset:1024 sc1
    v_mfma_f32_32x32x16_bf16 v[96:111], a[228:231], v[48:51], v[96:111]
    ds_read_b64_tr_b16 v[34:35], v6 offset:53760
    s_waitcnt lgkmcnt(2)
    v_mfma_f32_32x32x16_bf16 v[80:95], a[100:103], v[52:55], v[80:95]
    buffer_load_dwordx4 a[36:39], v2, s[32:35], s79 offen offset:1024
    v_cvt_pk_bf16_f32 v248, v248, v249
    ds_read_b64_tr_b16 v[36:37], v7 offset:53248
    v_mfma_f32_32x32x16_bf16 v[112:127], a[228:231], v[52:55], v[112:127]
    v_cvt_pk_bf16_f32 v249, v250, v251
    ds_read_b64_tr_b16 v[38:39], v7 offset:53760
    s_waitcnt lgkmcnt(2)
    v_mfma_f32_32x32x16_bf16 v[64:79], a[104:107], v[32:35], v[64:79]
    buffer_load_dwordx4 a[40:43], v2, s[32:35], s79 offen offset:2048
    ds_read_b64_tr_b16 v[48:49], v6 offset:55296
    v_cvt_pk_bf16_f32 v250, v252, v253
    v_mfma_f32_32x32x16_bf16 v[96:111], a[232:235], v[32:35], v[96:111]
    ds_read_b64_tr_b16 v[50:51], v6 offset:55808
    s_waitcnt lgkmcnt(2)
    v_mfma_f32_32x32x16_bf16 v[80:95], a[104:107], v[36:39], v[80:95]
    buffer_load_dwordx4 a[44:47], v2, s[32:35], s79 offen offset:3072
    ds_read_b64_tr_b16 v[52:53], v7 offset:55296
    v_cvt_pk_bf16_f32 v251, v254, v255
    v_mfma_f32_32x32x16_bf16 v[112:127], a[232:235], v[36:39], v[112:127]
    ds_read_b64_tr_b16 v[54:55], v7 offset:55808
    s_waitcnt lgkmcnt(2)
    v_mfma_f32_32x32x16_bf16 v[64:79], a[108:111], v[48:51], v[64:79]
    s_add_u32 s80, s63, 0x2000
    buffer_load_dwordx4 a[160:163], v2, s[32:35], s80 offen offset:0
    ds_read_b64_tr_b16 v[32:33], v6 offset:57344
    s_add_u32 s3, s101, 0x3000
    v_mfma_f32_32x32x16_bf16 v[96:111], a[236:239], v[48:51], v[96:111]
    ds_read_b64_tr_b16 v[34:35], v6 offset:57856
    buffer_store_dwordx4 v[248:251], v2, s[32:35], s3 offen offset:1024 sc1
    s_waitcnt lgkmcnt(2)
    v_mfma_f32_32x32x16_bf16 v[80:95], a[108:111], v[52:55], v[80:95]
    buffer_load_dwordx4 a[164:167], v2, s[32:35], s80 offen offset:1024
    ds_read_b64_tr_b16 v[36:37], v7 offset:57344
    v_mfma_f32_32x32x16_bf16 v[112:127], a[236:239], v[52:55], v[112:127]
    ds_read_b64_tr_b16 v[38:39], v7 offset:57856
    s_waitcnt lgkmcnt(2)
    v_mfma_f32_32x32x16_bf16 v[64:79], a[112:115], v[32:35], v[64:79]
    buffer_load_dwordx4 a[168:171], v2, s[32:35], s80 offen offset:2048
    ds_read_b64_tr_b16 v[48:49], v6 offset:59392
    v_mfma_f32_32x32x16_bf16 v[96:111], a[240:243], v[32:35], v[96:111]
    ds_read_b64_tr_b16 v[50:51], v6 offset:59904
    s_waitcnt lgkmcnt(2)
    v_mfma_f32_32x32x16_bf16 v[80:95], a[112:115], v[36:39], v[80:95]
    buffer_load_dwordx4 a[172:175], v2, s[32:35], s80 offen offset:3072
    ds_read_b64_tr_b16 v[52:53], v7 offset:59392
    v_mfma_f32_32x32x16_bf16 v[112:127], a[240:243], v[36:39], v[112:127]
    ds_read_b64_tr_b16 v[54:55], v7 offset:59904
    s_waitcnt lgkmcnt(2)
    v_mfma_f32_32x32x16_bf16 v[64:79], a[116:119], v[48:51], v[64:79]
    ds_read_b64_tr_b16 v[32:33], v6 offset:61440
    v_mfma_f32_32x32x16_bf16 v[96:111], a[244:247], v[48:51], v[96:111]
    ds_read_b64_tr_b16 v[34:35], v6 offset:61952
    s_waitcnt lgkmcnt(2)
    v_mfma_f32_32x32x16_bf16 v[80:95], a[116:119], v[52:55], v[80:95]
    ds_read_b64_tr_b16 v[36:37], v7 offset:61440
    v_mfma_f32_32x32x16_bf16 v[112:127], a[244:247], v[52:55], v[112:127]
    ds_read_b64_tr_b16 v[38:39], v7 offset:61952
    s_waitcnt lgkmcnt(2)
    v_mfma_f32_32x32x16_bf16 v[64:79], a[120:123], v[32:35], v[64:79]
    ds_read_b64_tr_b16 v[48:49], v6 offset:63488
    v_mfma_f32_32x32x16_bf16 v[96:111], a[248:251], v[32:35], v[96:111]
    ds_read_b64_tr_b16 v[50:51], v6 offset:64000
    s_waitcnt lgkmcnt(2)
    v_mfma_f32_32x32x16_bf16 v[80:95], a[120:123], v[36:39], v[80:95]
    ds_read_b64_tr_b16 v[52:53], v7 offset:63488
    v_mfma_f32_32x32x16_bf16 v[112:127], a[248:251], v[36:39], v[112:127]
    ds_read_b64_tr_b16 v[54:55], v7 offset:64000
    s_waitcnt lgkmcnt(0)
    s_waitcnt vmcnt(41)
    s_barrier
    v_mfma_f32_32x32x16_bf16 v[64:79], a[124:127], v[48:51], v[64:79]
    s_add_u32 m0, s59, 0xc000
    s_add_u32 s60, s64, 0xa8000
    buffer_load_dwordx4 v8, s[36:39], s60 offen offset:0 lds
    ds_read_b64_tr_b16 v[32:33], v6 offset:0
    ds_read_b64_tr_b16 v[34:35], v6 offset:512
    v_mfma_f32_32x32x16_bf16 v[96:111], a[252:255], v[48:51], v[96:111]
    ds_read_b64_tr_b16 v[36:37], v7 offset:0
    ds_read_b64_tr_b16 v[38:39], v7 offset:512
    v_mfma_f32_32x32x16_bf16 v[80:95], a[124:127], v[52:55], v[80:95]
    buffer_load_dwordx4 v9, s[36:39], s60 offen offset:1024 lds
    ds_read_b64_tr_b16 v[40:41], v6 offset:8192
    ds_read_b64_tr_b16 v[42:43], v6 offset:8704
    v_mfma_f32_32x32x16_bf16 v[112:127], a[252:255], v[52:55], v[112:127]
    ds_read_b64_tr_b16 v[44:45], v7 offset:8192
    ds_read_b64_tr_b16 v[46:47], v7 offset:8704
    s_waitcnt vmcnt(40) lgkmcnt(6)
    v_mfma_f32_32x32x16_bf16 v[128:143], v[32:35], a[0:3], 0
    buffer_load_dwordx4 v10, s[36:39], s60 offen offset:2048 lds
    ds_read_b64_tr_b16 v[48:49], v6 offset:2048
    v_cvt_pk_bf16_f32 v64, v64, v65
    s_waitcnt vmcnt(36)
    v_mfma_f32_32x32x16_bf16 v[192:207], v[32:35], a[128:131], 0
    ds_read_b64_tr_b16 v[50:51], v6 offset:2560
    s_waitcnt lgkmcnt(6)
    v_mfma_f32_32x32x16_bf16 v[144:159], v[36:39], a[0:3], 0
    buffer_load_dwordx4 v11, s[36:39], s60 offen offset:3072 lds
    ds_read_b64_tr_b16 v[52:53], v7 offset:2048
    v_cvt_pk_bf16_f32 v65, v66, v67
    v_mfma_f32_32x32x16_bf16 v[208:223], v[36:39], a[128:131], 0
    ds_read_b64_tr_b16 v[54:55], v7 offset:2560
    s_waitcnt lgkmcnt(6)
    v_mfma_f32_32x32x16_bf16 v[160:175], v[40:43], a[0:3], 0
    ds_read_b64_tr_b16 v[56:57], v6 offset:10240
    v_cvt_pk_bf16_f32 v66, v68, v69
    v_mfma_f32_32x32x16_bf16 v[224:239], v[40:43], a[128:131], 0
    ds_read_b64_tr_b16 v[58:59], v6 offset:10752
    s_waitcnt lgkmcnt(6)
    v_mfma_f32_32x32x16_bf16 v[176:191], v[44:47], a[0:3], 0
    ds_read_b64_tr_b16 v[60:61], v7 offset:10240
    v_cvt_pk_bf16_f32 v67, v70, v71
    v_mfma_f32_32x32x16_bf16 v[240:255], v[44:47], a[128:131], 0
    ds_read_b64_tr_b16 v[62:63], v7 offset:10752
    s_waitcnt lgkmcnt(6)
    v_mfma_f32_32x32x16_bf16 v[128:143], v[48:51], a[4:7], v[128:143]
    ds_read_b64_tr_b16 v[32:33], v6 offset:4096
    s_add_u32 s3, s101, 0
    s_waitcnt vmcnt(36)
    v_mfma_f32_32x32x16_bf16 v[192:207], v[48:51], a[132:135], v[192:207]
    ds_read_b64_tr_b16 v[34:35], v6 offset:4608
    s_waitcnt lgkmcnt(6)
    v_mfma_f32_32x32x16_bf16 v[144:159], v[52:55], a[4:7], v[144:159]
    ds_read_b64_tr_b16 v[36:37], v7 offset:4096
    v_mfma_f32_32x32x16_bf16 v[208:223], v[52:55], a[132:135], v[208:223]
    buffer_store_dwordx4 v[64:67], v2, s[32:35], s3 offen offset:2048 sc1
    ds_read_b64_tr_b16 v[38:39], v7 offset:4608
    s_waitcnt lgkmcnt(6)
    v_mfma_f32_32x32x16_bf16 v[160:175], v[56:59], a[4:7], v[160:175]
    ds_read_b64_tr_b16 v[40:41], v6 offset:12288
    v_mfma_f32_32x32x16_bf16 v[224:239], v[56:59], a[132:135], v[224:239]
    v_cvt_pk_bf16_f32 v72, v72, v73
    ds_read_b64_tr_b16 v[42:43], v6 offset:12800
    s_waitcnt lgkmcnt(6)
    v_mfma_f32_32x32x16_bf16 v[176:191], v[60:63], a[4:7], v[176:191]
    ds_read_b64_tr_b16 v[44:45], v7 offset:12288
    v_mfma_f32_32x32x16_bf16 v[240:255], v[60:63], a[132:135], v[240:255]
    v_cvt_pk_bf16_f32 v73, v74, v75
    ds_read_b64_tr_b16 v[46:47], v7 offset:12800
    s_waitcnt lgkmcnt(6)
    v_mfma_f32_32x32x16_bf16 v[128:143], v[32:35], a[8:11], v[128:143]
    s_add_u32 s79, s62, 0x3000
    buffer_load_dwordx4 a[48:51], v2, s[32:35], s79 offen offset:0
    ds_read_b64_tr_b16 v[48:49], v6 offset:6144
    v_cvt_pk_bf16_f32 v74, v76, v77
    s_waitcnt vmcnt(37)
    v_mfma_f32_32x32x16_bf16 v[192:207], v[32:35], a[136:139], v[192:207]
    ds_read_b64_tr_b16 v[50:51], v6 offset:6656
    s_waitcnt lgkmcnt(6)
    v_mfma_f32_32x32x16_bf16 v[144:159], v[36:39], a[8:11], v[144:159]
    buffer_load_dwordx4 a[52:55], v2, s[32:35], s79 offen offset:1024
    ds_read_b64_tr_b16 v[52:53], v7 offset:6144
    v_cvt_pk_bf16_f32 v75, v78, v79
    v_mfma_f32_32x32x16_bf16 v[208:223], v[36:39], a[136:139], v[208:223]
    ds_read_b64_tr_b16 v[54:55], v7 offset:6656
    ds_read_b64_tr_b16 v[56:57], v6 offset:14336
    s_waitcnt lgkmcnt(7)
    v_mfma_f32_32x32x16_bf16 v[160:175], v[40:43], a[8:11], v[160:175]
    buffer_load_dwordx4 a[56:59], v2, s[32:35], s79 offen offset:2048
    s_add_u32 s3, s101, 0x1000
    v_mfma_f32_32x32x16_bf16 v[224:239], v[40:43], a[136:139], v[224:239]
    ds_read_b64_tr_b16 v[58:59], v6 offset:14848
    ds_read_b64_tr_b16 v[60:61], v7 offset:14336
    s_waitcnt lgkmcnt(7)
    v_mfma_f32_32x32x16_bf16 v[176:191], v[44:47], a[8:11], v[176:191]
    buffer_load_dwordx4 a[60:63], v2, s[32:35], s79 offen offset:3072
    buffer_store_dwordx4 v[72:75], v2, s[32:35], s3 offen offset:2048 sc1
    v_mfma_f32_32x32x16_bf16 v[240:255], v[44:47], a[136:139], v[240:255]
    ds_read_b64_tr_b16 v[62:63], v7 offset:14848
    s_waitcnt lgkmcnt(0)
    s_waitcnt vmcnt(35)
    s_barrier
    v_mfma_f32_32x32x16_bf16 v[128:143], v[48:51], a[12:15], v[128:143]
    s_add_u32 s80, s63, 0x3000
    buffer_load_dwordx4 a[176:179], v2, s[32:35], s80 offen offset:0
    ds_read_b64_tr_b16 v[32:33], v6 offset:16384
    v_cvt_pk_bf16_f32 v80, v80, v81
    v_mfma_f32_32x32x16_bf16 v[192:207], v[48:51], a[140:143], v[192:207]
    ds_read_b64_tr_b16 v[34:35], v6 offset:16896
    v_mfma_f32_32x32x16_bf16 v[144:159], v[52:55], a[12:15], v[144:159]
    buffer_load_dwordx4 a[180:183], v2, s[32:35], s80 offen offset:1024
    ds_read_b64_tr_b16 v[36:37], v7 offset:16384
    v_cvt_pk_bf16_f32 v81, v82, v83
    v_mfma_f32_32x32x16_bf16 v[208:223], v[52:55], a[140:143], v[208:223]
    ds_read_b64_tr_b16 v[38:39], v7 offset:16896
    v_mfma_f32_32x32x16_bf16 v[160:175], v[56:59], a[12:15], v[160:175]
    buffer_load_dwordx4 a[184:187], v2, s[32:35], s80 offen offset:2048
    ds_read_b64_tr_b16 v[40:41], v6 offset:24576
    v_cvt_pk_bf16_f32 v82, v84, v85
    v_mfma_f32_32x32x16_bf16 v[224:239], v[56:59], a[140:143], v[224:239]
    ds_read_b64_tr_b16 v[42:43], v6 offset:25088
    v_mfma_f32_32x32x16_bf16 v[176:191], v[60:63], a[12:15], v[176:191]
    buffer_load_dwordx4 a[188:191], v2, s[32:35], s80 offen offset:3072
    ds_read_b64_tr_b16 v[44:45], v7 offset:24576
    v_cvt_pk_bf16_f32 v83, v86, v87
    v_mfma_f32_32x32x16_bf16 v[240:255], v[60:63], a[140:143], v[240:255]
    ds_read_b64_tr_b16 v[46:47], v7 offset:25088
    s_waitcnt vmcnt(38) lgkmcnt(6)
    v_mfma_f32_32x32x16_bf16 v[128:143], v[32:35], a[16:19], v[128:143]
    s_add_u32 m0, s59, 0
    s_add_u32 s60, s64, 0xe0000
    buffer_load_dwordx4 v8, s[36:39], s60 offen offset:0 lds
    ds_read_b64_tr_b16 v[48:49], v6 offset:18432
    s_lshl_b32 s74, s2, 2
    s_add_u32 s74, s74, s56
    s_lshl_b32 s74, s74, 13
    s_mov_b32 s44, s14
    s_mov_b32 s45, s15
    s_mov_b32 s46, 0x400000
    s_mov_b32 s47, 0x20000
    s_cmp_ge_u32 s74, s46
    s_cselect_b32 s76, s46, 0
    s_cselect_b32 s44, s22, s44
    s_cselect_b32 s45, s23, s45
    s_cselect_b32 s46, 0x1c0000, s46
    s_sub_u32 s74, s74, s76
    v_lshlrev_b32 v5, 7, v1
    buffer_load_dword v28, v5, s[44:47], s74 offen
    s_waitcnt vmcnt(35)
    v_mfma_f32_32x32x16_bf16 v[192:207], v[32:35], a[144:147], v[192:207]
    ds_read_b64_tr_b16 v[50:51], v6 offset:18944
    s_add_u32 s3, s101, 0
    s_waitcnt lgkmcnt(6)
    v_mfma_f32_32x32x16_bf16 v[144:159], v[36:39], a[16:19], v[144:159]
    buffer_load_dwordx4 v9, s[36:39], s60 offen offset:1024 lds
    ds_read_b64_tr_b16 v[52:53], v7 offset:18432
    v_mfma_f32_32x32x16_bf16 v[208:223], v[36:39], a[144:147], v[208:223]
    buffer_store_dwordx4 v[80:83], v2, s[32:35], s3 offen offset:3072 sc1
    ds_read_b64_tr_b16 v[54:55], v7 offset:18944
    s_waitcnt lgkmcnt(6)
    v_mfma_f32_32x32x16_bf16 v[160:175], v[40:43], a[16:19], v[160:175]
    buffer_load_dwordx4 v10, s[36:39], s60 offen offset:2048 lds
    ds_read_b64_tr_b16 v[56:57], v6 offset:26624
    v_mfma_f32_32x32x16_bf16 v[224:239], v[40:43], a[144:147], v[224:239]
    v_cvt_pk_bf16_f32 v88, v88, v89
    ds_read_b64_tr_b16 v[58:59], v6 offset:27136
    s_waitcnt lgkmcnt(6)
    v_mfma_f32_32x32x16_bf16 v[176:191], v[44:47], a[16:19], v[176:191]
    buffer_load_dwordx4 v11, s[36:39], s60 offen offset:3072 lds
    v_cvt_pk_bf16_f32 v89, v90, v91
    ds_read_b64_tr_b16 v[60:61], v7 offset:26624
    v_mfma_f32_32x32x16_bf16 v[240:255], v[44:47], a[144:147], v[240:255]
    v_cvt_pk_bf16_f32 v90, v92, v93
    ds_read_b64_tr_b16 v[62:63], v7 offset:27136
    s_waitcnt lgkmcnt(6)
    v_mfma_f32_32x32x16_bf16 v[128:143], v[48:51], a[20:23], v[128:143]
    ds_read_b64_tr_b16 v[32:33], v6 offset:20480
    v_cvt_pk_bf16_f32 v91, v94, v95
    s_waitcnt vmcnt(37)
    v_mfma_f32_32x32x16_bf16 v[192:207], v[48:51], a[148:151], v[192:207]
    ds_read_b64_tr_b16 v[34:35], v6 offset:20992
    s_waitcnt lgkmcnt(6)
    v_mfma_f32_32x32x16_bf16 v[144:159], v[52:55], a[20:23], v[144:159]
    ds_read_b64_tr_b16 v[36:37], v7 offset:20480
    s_add_u32 s3, s101, 0x1000
    v_mfma_f32_32x32x16_bf16 v[208:223], v[52:55], a[148:151], v[208:223]
    ds_read_b64_tr_b16 v[38:39], v7 offset:20992
    ds_read_b64_tr_b16 v[40:41], v6 offset:28672
    s_waitcnt lgkmcnt(7)
    v_mfma_f32_32x32x16_bf16 v[160:175], v[56:59], a[20:23], v[160:175]
    buffer_store_dwordx4 v[88:91], v2, s[32:35], s3 offen offset:3072 sc1
    v_mfma_f32_32x32x16_bf16 v[224:239], v[56:59], a[148:151], v[224:239]
    ds_read_b64_tr_b16 v[42:43], v6 offset:29184
    s_waitcnt lgkmcnt(6)
    v_mfma_f32_32x32x16_bf16 v[176:191], v[60:63], a[20:23], v[176:191]
    ds_read_b64_tr_b16 v[44:45], v7 offset:28672
    v_mfma_f32_32x32x16_bf16 v[240:255], v[60:63], a[148:151], v[240:255]
    v_cvt_pk_bf16_f32 v96, v96, v97
    ds_read_b64_tr_b16 v[46:47], v7 offset:29184
    s_waitcnt lgkmcnt(6)
    v_mfma_f32_32x32x16_bf16 v[128:143], v[32:35], a[24:27], v[128:143]
    s_add_u32 s79, s62, 0x4000
    buffer_load_dwordx4 a[64:67], v2, s[32:35], s79 offen offset:0
    ds_read_b64_tr_b16 v[48:49], v6 offset:22528
    v_cvt_pk_bf16_f32 v97, v98, v99
    s_waitcnt vmcnt(38)
    v_mfma_f32_32x32x16_bf16 v[192:207], v[32:35], a[152:155], v[192:207]
    ds_read_b64_tr_b16 v[50:51], v6 offset:23040
    s_waitcnt lgkmcnt(6)
    v_mfma_f32_32x32x16_bf16 v[144:159], v[36:39], a[24:27], v[144:159]
    buffer_load_dwordx4 a[68:71], v2, s[32:35], s79 offen offset:1024
    ds_read_b64_tr_b16 v[52:53], v7 offset:22528
    v_cvt_pk_bf16_f32 v98, v100, v101
    v_mfma_f32_32x32x16_bf16 v[208:223], v[36:39], a[152:155], v[208:223]
    ds_read_b64_tr_b16 v[54:55], v7 offset:23040
    s_waitcnt lgkmcnt(6)
    v_mfma_f32_32x32x16_bf16 v[160:175], v[40:43], a[24:27], v[160:175]
    buffer_load_dwordx4 a[72:75], v2, s[32:35], s79 offen offset:2048
    ds_read_b64_tr_b16 v[56:57], v6 offset:30720
    v_cvt_pk_bf16_f32 v99, v102, v103
    v_mfma_f32_32x32x16_bf16 v[224:239], v[40:43], a[152:155], v[224:239]
    ds_read_b64_tr_b16 v[58:59], v6 offset:31232
    s_waitcnt lgkmcnt(6)
    v_mfma_f32_32x32x16_bf16 v[176:191], v[44:47], a[24:27], v[176:191]
    buffer_load_dwordx4 a[76:79], v2, s[32:35], s79 offen offset:3072
    ds_read_b64_tr_b16 v[60:61], v7 offset:30720
    s_add_u32 s3, s101, 0x2000
    v_mfma_f32_32x32x16_bf16 v[240:255], v[44:47], a[152:155], v[240:255]
    ds_read_b64_tr_b16 v[62:63], v7 offset:31232
    s_waitcnt lgkmcnt(0)
    s_waitcnt vmcnt(35)
    s_barrier
    v_mfma_f32_32x32x16_bf16 v[128:143], v[48:51], a[28:31], v[128:143]
    s_add_u32 s80, s63, 0x4000
    buffer_load_dwordx4 a[192:195], v2, s[32:35], s80 offen offset:0
    ds_read_b64_tr_b16 v[32:33], v6 offset:32768
    v_mfma_f32_32x32x16_bf16 v[192:207], v[48:51], a[156:159], v[192:207]
    buffer_store_dwordx4 v[96:99], v2, s[32:35], s3 offen offset:2048 sc1
    v_mfma_f32_32x32x16_bf16 v[144:159], v[52:55], a[28:31], v[144:159]
    buffer_load_dwordx4 a[196:199], v2, s[32:35], s80 offen offset:1024
    ds_read_b64_tr_b16 v[34:35], v6 offset:33280
    ds_read_b64_tr_b16 v[36:37], v7 offset:32768
    v_mfma_f32_32x32x16_bf16 v[208:223], v[52:55], a[156:159], v[208:223]
    v_cvt_pk_bf16_f32 v104, v104, v105
    ds_read_b64_tr_b16 v[38:39], v7 offset:33280
    v_mfma_f32_32x32x16_bf16 v[160:175], v[56:59], a[28:31], v[160:175]
    buffer_load_dwordx4 a[200:203], v2, s[32:35], s80 offen offset:2048
    ds_read_b64_tr_b16 v[40:41], v6 offset:40960
    v_mfma_f32_32x32x16_bf16 v[224:239], v[56:59], a[156:159], v[224:239]
    v_cvt_pk_bf16_f32 v105, v106, v107
    ds_read_b64_tr_b16 v[42:43], v6 offset:41472
    v_mfma_f32_32x32x16_bf16 v[176:191], v[60:63], a[28:31], v[176:191]
    buffer_load_dwordx4 a[204:207], v2, s[32:35], s80 offen offset:3072
    ds_read_b64_tr_b16 v[44:45], v7 offset:40960
    v_mfma_f32_32x32x16_bf16 v[240:255], v[60:63], a[156:159], v[240:255]
    v_cvt_pk_bf16_f32 v106, v108, v109
    ds_read_b64_tr_b16 v[46:47], v7 offset:41472
    s_waitcnt vmcnt(39) lgkmcnt(6)
    v_mfma_f32_32x32x16_bf16 v[128:143], v[32:35], a[32:35], v[128:143]
    s_add_u32 m0, s59, 0x4000
    s_add_u32 s60, s64, 0x118000
    buffer_load_dwordx4 v8, s[36:39], s60 offen offset:0 lds
    ds_read_b64_tr_b16 v[48:49], v6 offset:34816
    v_cvt_pk_bf16_f32 v107, v110, v111
    s_waitcnt vmcnt(35)
    v_mfma_f32_32x32x16_bf16 v[192:207], v[32:35], a[160:163], v[192:207]
    ds_read_b64_tr_b16 v[50:51], v6 offset:35328
    s_waitcnt lgkmcnt(6)
    v_mfma_f32_32x32x16_bf16 v[144:159], v[36:39], a[32:35], v[144:159]
    buffer_load_dwordx4 v9, s[36:39], s60 offen offset:1024 lds
    ds_read_b64_tr_b16 v[52:53], v7 offset:34816
    s_add_u32 s3, s101, 0x3000
    v_mfma_f32_32x32x16_bf16 v[208:223], v[36:39], a[160:163], v[208:223]
    ds_read_b64_tr_b16 v[54:55], v7 offset:35328
    ds_read_b64_tr_b16 v[56:57], v6 offset:43008
    s_waitcnt lgkmcnt(7)
    v_mfma_f32_32x32x16_bf16 v[160:175], v[40:43], a[32:35], v[160:175]
    buffer_load_dwordx4 v10, s[36:39], s60 offen offset:2048 lds
    buffer_store_dwordx4 v[104:107], v2, s[32:35], s3 offen offset:2048 sc1
    v_mfma_f32_32x32x16_bf16 v[224:239], v[40:43], a[160:163], v[224:239]
    ds_read_b64_tr_b16 v[58:59], v6 offset:43520
    s_waitcnt lgkmcnt(6)
    v_mfma_f32_32x32x16_bf16 v[176:191], v[44:47], a[32:35], v[176:191]
    buffer_load_dwordx4 v11, s[36:39], s60 offen offset:3072 lds
    ds_read_b64_tr_b16 v[60:61], v7 offset:43008
    v_mfma_f32_32x32x16_bf16 v[240:255], v[44:47], a[160:163], v[240:255]
    v_cvt_pk_bf16_f32 v112, v112, v113
    ds_read_b64_tr_b16 v[62:63], v7 offset:43520
    s_waitcnt lgkmcnt(6)
    v_mfma_f32_32x32x16_bf16 v[128:143], v[48:51], a[36:39], v[128:143]
    ds_read_b64_tr_b16 v[32:33], v6 offset:36864
    v_cvt_pk_bf16_f32 v113, v114, v115
    s_waitcnt vmcnt(37)
    v_mfma_f32_32x32x16_bf16 v[192:207], v[48:51], a[164:167], v[192:207]
    ds_read_b64_tr_b16 v[34:35], v6 offset:37376
    v_cvt_pk_bf16_f32 v114, v116, v117
    s_waitcnt lgkmcnt(6)
    v_mfma_f32_32x32x16_bf16 v[144:159], v[52:55], a[36:39], v[144:159]
    ds_read_b64_tr_b16 v[36:37], v7 offset:36864
    v_mfma_f32_32x32x16_bf16 v[208:223], v[52:55], a[164:167], v[208:223]
    ds_read_b64_tr_b16 v[38:39], v7 offset:37376
    v_cvt_pk_bf16_f32 v115, v118, v119
    s_waitcnt lgkmcnt(6)
    v_mfma_f32_32x32x16_bf16 v[160:175], v[56:59], a[36:39], v[160:175]
    ds_read_b64_tr_b16 v[40:41], v6 offset:45056
    s_add_u32 s3, s101, 0x2000
    v_mfma_f32_32x32x16_bf16 v[224:239], v[56:59], a[164:167], v[224:239]
    ds_read_b64_tr_b16 v[42:43], v6 offset:45568
    ds_read_b64_tr_b16 v[44:45], v7 offset:45056
    s_waitcnt lgkmcnt(7)
    v_mfma_f32_32x32x16_bf16 v[176:191], v[60:63], a[36:39], v[176:191]
    buffer_store_dwordx4 v[112:115], v2, s[32:35], s3 offen offset:3072 sc1
    v_mfma_f32_32x32x16_bf16 v[240:255], v[60:63], a[164:167], v[240:255]
    ds_read_b64_tr_b16 v[46:47], v7 offset:45568
    s_waitcnt lgkmcnt(6)
    v_mfma_f32_32x32x16_bf16 v[128:143], v[32:35], a[40:43], v[128:143]
    s_add_u32 s79, s62, 0x5000
    buffer_load_dwordx4 a[80:83], v2, s[32:35], s79 offen offset:0
    ds_read_b64_tr_b16 v[48:49], v6 offset:38912
    v_cvt_pk_bf16_f32 v120, v120, v121
    s_waitcnt vmcnt(38)
    v_mfma_f32_32x32x16_bf16 v[192:207], v[32:35], a[168:171], v[192:207]
    ds_read_b64_tr_b16 v[50:51], v6 offset:39424
    s_waitcnt lgkmcnt(6)
    v_mfma_f32_32x32x16_bf16 v[144:159], v[36:39], a[40:43], v[144:159]
    buffer_load_dwordx4 a[84:87], v2, s[32:35], s79 offen offset:1024
    ds_read_b64_tr_b16 v[52:53], v7 offset:38912
    v_cvt_pk_bf16_f32 v121, v122, v123
    v_mfma_f32_32x32x16_bf16 v[208:223], v[36:39], a[168:171], v[208:223]
    ds_read_b64_tr_b16 v[54:55], v7 offset:39424
    s_waitcnt lgkmcnt(6)
    v_mfma_f32_32x32x16_bf16 v[160:175], v[40:43], a[40:43], v[160:175]
    buffer_load_dwordx4 a[88:91], v2, s[32:35], s79 offen offset:2048
    ds_read_b64_tr_b16 v[56:57], v6 offset:47104
    v_cvt_pk_bf16_f32 v122, v124, v125
    v_mfma_f32_32x32x16_bf16 v[224:239], v[40:43], a[168:171], v[224:239]
    ds_read_b64_tr_b16 v[58:59], v6 offset:47616
    s_waitcnt lgkmcnt(6)
    v_mfma_f32_32x32x16_bf16 v[176:191], v[44:47], a[40:43], v[176:191]
    buffer_load_dwordx4 a[92:95], v2, s[32:35], s79 offen offset:3072
    ds_read_b64_tr_b16 v[60:61], v7 offset:47104
    v_cvt_pk_bf16_f32 v123, v126, v127
    v_mfma_f32_32x32x16_bf16 v[240:255], v[44:47], a[168:171], v[240:255]
    ds_read_b64_tr_b16 v[62:63], v7 offset:47616
    s_waitcnt lgkmcnt(0)
    s_waitcnt vmcnt(36)
    s_barrier
    v_mfma_f32_32x32x16_bf16 v[128:143], v[48:51], a[44:47], v[128:143]
    s_add_u32 s80, s63, 0x5000
    buffer_load_dwordx4 a[208:211], v2, s[32:35], s80 offen offset:0
    ds_read_b64_tr_b16 v[32:33], v6 offset:49152
    s_add_u32 s3, s101, 0x3000
    v_mfma_f32_32x32x16_bf16 v[192:207], v[48:51], a[172:175], v[192:207]
    ds_read_b64_tr_b16 v[34:35], v6 offset:49664
    v_mfma_f32_32x32x16_bf16 v[144:159], v[52:55], a[44:47], v[144:159]
    buffer_load_dwordx4 a[212:215], v2, s[32:35], s80 offen offset:1024
    ds_read_b64_tr_b16 v[36:37], v7 offset:49152
    v_mfma_f32_32x32x16_bf16 v[208:223], v[52:55], a[172:175], v[208:223]
    buffer_store_dwordx4 v[120:123], v2, s[32:35], s3 offen offset:3072 sc1
    ds_read_b64_tr_b16 v[38:39], v7 offset:49664
    v_mfma_f32_32x32x16_bf16 v[160:175], v[56:59], a[44:47], v[160:175]
    buffer_load_dwordx4 a[216:219], v2, s[32:35], s80 offen offset:2048
    ds_read_b64_tr_b16 v[40:41], v6 offset:57344
    v_mfma_f32_32x32x16_bf16 v[224:239], v[56:59], a[172:175], v[224:239]
    s_lshl_b32 s61, s57, 12
    ds_read_b64_tr_b16 v[42:43], v6 offset:57856
    v_mfma_f32_32x32x16_bf16 v[176:191], v[60:63], a[44:47], v[176:191]
    buffer_load_dwordx4 a[220:223], v2, s[32:35], s80 offen offset:3072
    ds_read_b64_tr_b16 v[44:45], v7 offset:57344
    v_mfma_f32_32x32x16_bf16 v[240:255], v[60:63], a[172:175], v[240:255]
    s_add_u32 s69, s67, s61
    ds_read_b64_tr_b16 v[46:47], v7 offset:57856
    s_waitcnt vmcnt(39) lgkmcnt(6)
    v_mfma_f32_32x32x16_bf16 v[128:143], v[32:35], a[48:51], v[128:143]
    s_add_u32 m0, s59, 0x8000
    s_add_u32 s60, s64, 0x150000
    buffer_load_dwordx4 v8, s[36:39], s60 offen offset:0 lds
    ds_read_b64_tr_b16 v[48:49], v6 offset:51200
    s_sub_u32 s69, s69, 0x40000
    s_waitcnt vmcnt(35)
    v_mfma_f32_32x32x16_bf16 v[192:207], v[32:35], a[176:179], v[192:207]
    ds_read_b64_tr_b16 v[50:51], v6 offset:51712
    s_waitcnt lgkmcnt(6)
    v_mfma_f32_32x32x16_bf16 v[144:159], v[36:39], a[48:51], v[144:159]
    buffer_load_dwordx4 v9, s[36:39], s60 offen offset:1024 lds
    ds_read_b64_tr_b16 v[52:53], v7 offset:51200
    s_lshl_b32 s61, s57, 12
    v_mfma_f32_32x32x16_bf16 v[208:223], v[36:39], a[176:179], v[208:223]
    ds_read_b64_tr_b16 v[54:55], v7 offset:51712
    s_waitcnt lgkmcnt(6)
    v_mfma_f32_32x32x16_bf16 v[160:175], v[40:43], a[48:51], v[160:175]
    buffer_load_dwordx4 v10, s[36:39], s60 offen offset:2048 lds
    ds_read_b64_tr_b16 v[56:57], v6 offset:59392
    s_add_u32 s70, s68, s61
    v_mfma_f32_32x32x16_bf16 v[224:239], v[40:43], a[176:179], v[224:239]
    ds_read_b64_tr_b16 v[58:59], v6 offset:59904
    s_waitcnt lgkmcnt(6)
    v_mfma_f32_32x32x16_bf16 v[176:191], v[44:47], a[48:51], v[176:191]
    buffer_load_dwordx4 v11, s[36:39], s60 offen offset:3072 lds
    ds_read_b64_tr_b16 v[60:61], v7 offset:59392
    s_sub_u32 s70, s70, 0x40000
    v_mfma_f32_32x32x16_bf16 v[240:255], v[44:47], a[176:179], v[240:255]
    ds_read_b64_tr_b16 v[62:63], v7 offset:59904
    s_waitcnt lgkmcnt(6)
    v_mfma_f32_32x32x16_bf16 v[128:143], v[48:51], a[52:55], v[128:143]
    ds_read_b64_tr_b16 v[32:33], v6 offset:53248
    s_lshl_b32 s61, s57, 19
    s_add_u32 s61, s61, 0x200000
    s_add_u32 s48, s28, s61
    s_addc_u32 s49, s29, 0
    s_waitcnt vmcnt(37)
    v_mfma_f32_32x32x16_bf16 v[192:207], v[48:51], a[180:183], v[192:207]
    ds_read_b64_tr_b16 v[34:35], v6 offset:53760
    s_waitcnt lgkmcnt(6)
    v_mfma_f32_32x32x16_bf16 v[144:159], v[52:55], a[52:55], v[144:159]
    s_lshl_b32 s61, s58, 15
    ds_read_b64_tr_b16 v[36:37], v7 offset:53248
    v_mfma_f32_32x32x16_bf16 v[208:223], v[52:55], a[180:183], v[208:223]
    ds_read_b64_tr_b16 v[38:39], v7 offset:53760
    s_sub_u32 s50, 0x80000, s61
    s_waitcnt lgkmcnt(6)
    v_mfma_f32_32x32x16_bf16 v[160:175], v[56:59], a[52:55], v[160:175]
    ds_read_b64_tr_b16 v[40:41], v6 offset:61440
    v_mfma_f32_32x32x16_bf16 v[224:239], v[56:59], a[180:183], v[224:239]
    s_mov_b32 s51, 0x20000
    ds_read_b64_tr_b16 v[42:43], v6 offset:61952
    s_waitcnt lgkmcnt(6)
    v_mfma_f32_32x32x16_bf16 v[176:191], v[60:63], a[52:55], v[176:191]
    ds_read_b64_tr_b16 v[44:45], v7 offset:61440
    v_mfma_f32_32x32x16_bf16 v[240:255], v[60:63], a[180:183], v[240:255]
    s_lshl_b32 s61, s57, 19
    s_add_u32 s61, s61, 0x1200000
    s_add_u32 s52, s28, s61
    s_addc_u32 s53, s29, 0
    ds_read_b64_tr_b16 v[46:47], v7 offset:61952
    s_waitcnt lgkmcnt(6)
    v_mfma_f32_32x32x16_bf16 v[128:143], v[32:35], a[56:59], v[128:143]
    s_add_u32 s79, s62, 0x6000
    buffer_load_dwordx4 a[96:99], v2, s[32:35], s79 offen offset:0
    ds_read_b64_tr_b16 v[48:49], v6 offset:55296
    s_lshl_b32 s61, s58, 15
    s_waitcnt vmcnt(37)
    v_mfma_f32_32x32x16_bf16 v[192:207], v[32:35], a[184:187], v[192:207]
    ds_read_b64_tr_b16 v[50:51], v6 offset:55808
    s_waitcnt lgkmcnt(6)
    v_mfma_f32_32x32x16_bf16 v[144:159], v[36:39], a[56:59], v[144:159]
    buffer_load_dwordx4 a[100:103], v2, s[32:35], s79 offen offset:1024
    ds_read_b64_tr_b16 v[52:53], v7 offset:55296
    s_sub_u32 s54, 0x80000, s61
    v_mfma_f32_32x32x16_bf16 v[208:223], v[36:39], a[184:187], v[208:223]
    ds_read_b64_tr_b16 v[54:55], v7 offset:55808
    s_waitcnt lgkmcnt(6)
    v_mfma_f32_32x32x16_bf16 v[160:175], v[40:43], a[56:59], v[160:175]
    buffer_load_dwordx4 a[104:107], v2, s[32:35], s79 offen offset:2048
    ds_read_b64_tr_b16 v[56:57], v6 offset:63488
    s_mov_b32 s55, 0x20000
    v_mfma_f32_32x32x16_bf16 v[224:239], v[40:43], a[184:187], v[224:239]
    ds_read_b64_tr_b16 v[58:59], v6 offset:64000
    s_waitcnt lgkmcnt(6)
    v_mfma_f32_32x32x16_bf16 v[176:191], v[44:47], a[56:59], v[176:191]
    buffer_load_dwordx4 a[108:111], v2, s[32:35], s79 offen offset:3072
    ds_read_b64_tr_b16 v[60:61], v7 offset:63488
    s_lshl_b32 s71, s56, 12
    v_mfma_f32_32x32x16_bf16 v[240:255], v[44:47], a[184:187], v[240:255]
    ds_read_b64_tr_b16 v[62:63], v7 offset:64000
    s_waitcnt lgkmcnt(0)
    s_waitcnt vmcnt(33)
    s_barrier
    v_mfma_f32_32x32x16_bf16 v[128:143], v[48:51], a[60:63], v[128:143]
    s_add_u32 s80, s63, 0x6000
    buffer_load_dwordx4 a[224:227], v2, s[32:35], s80 offen offset:0
    ds_read_b64_tr_b16 v[32:33], v6 offset:0
    s_mov_b32 s72, s71
    v_mfma_f32_32x32x16_bf16 v[192:207], v[48:51], a[188:191], v[192:207]
    ds_read_b64_tr_b16 v[34:35], v6 offset:512
    v_mfma_f32_32x32x16_bf16 v[144:159], v[52:55], a[60:63], v[144:159]
    buffer_load_dwordx4 a[228:231], v2, s[32:35], s80 offen offset:1024
    ds_read_b64_tr_b16 v[36:37], v7 offset:0
    s_mov_b32 s78, 0x4b800000
    v_mfma_f32_32x32x16_bf16 v[208:223], v[52:55], a[188:191], v[208:223]
    ds_read_b64_tr_b16 v[38:39], v7 offset:512
    v_mfma_f32_32x32x16_bf16 v[160:175], v[56:59], a[60:63], v[160:175]
    buffer_load_dwordx4 a[232:235], v2, s[32:35], s80 offen offset:2048
    ds_read_b64_tr_b16 v[40:41], v6 offset:8192
    v_mfma_f32_32x32x16_bf16 v[224:239], v[56:59], a[188:191], v[224:239]
    ds_read_b64_tr_b16 v[42:43], v6 offset:8704
    v_mfma_f32_32x32x16_bf16 v[176:191], v[60:63], a[60:63], v[176:191]
    buffer_load_dwordx4 a[236:239], v2, s[32:35], s80 offen offset:3072
    ds_read_b64_tr_b16 v[44:45], v7 offset:8192
    v_mfma_f32_32x32x16_bf16 v[240:255], v[60:63], a[188:191], v[240:255]
    ds_read_b64_tr_b16 v[46:47], v7 offset:8704
    s_waitcnt vmcnt(35) lgkmcnt(6)
    v_mfma_f32_32x32x16_bf16 v[128:143], v[32:35], a[64:67], v[128:143]
    s_add_u32 m0, s59, 0xc000
    s_add_u32 s60, s64, 0x188000
    buffer_load_dwordx4 v8, s[36:39], s60 offen offset:0 lds
    ds_read_b64_tr_b16 v[48:49], v6 offset:2048
    s_waitcnt vmcnt(32)
    v_mfma_f32_32x32x16_bf16 v[192:207], v[32:35], a[192:195], v[192:207]
    ds_read_b64_tr_b16 v[50:51], v6 offset:2560
    s_waitcnt lgkmcnt(6)
    v_mfma_f32_32x32x16_bf16 v[144:159], v[36:39], a[64:67], v[144:159]
    buffer_load_dwordx4 v9, s[36:39], s60 offen offset:1024 lds
    ds_read_b64_tr_b16 v[52:53], v7 offset:2048
    v_mfma_f32_32x32x16_bf16 v[208:223], v[36:39], a[192:195], v[208:223]
    ds_read_b64_tr_b16 v[54:55], v7 offset:2560
    s_waitcnt lgkmcnt(6)
    v_mfma_f32_32x32x16_bf16 v[160:175], v[40:43], a[64:67], v[160:175]
    buffer_load_dwordx4 v10, s[36:39], s60 offen offset:2048 lds
    ds_read_b64_tr_b16 v[56:57], v6 offset:10240
    v_mfma_f32_32x32x16_bf16 v[224:239], v[40:43], a[192:195], v[224:239]
    ds_read_b64_tr_b16 v[58:59], v6 offset:10752
    s_waitcnt lgkmcnt(6)
    v_mfma_f32_32x32x16_bf16 v[176:191], v[44:47], a[64:67], v[176:191]
    buffer_load_dwordx4 v11, s[36:39], s60 offen offset:3072 lds
    ds_read_b64_tr_b16 v[60:61], v7 offset:10240
    v_mfma_f32_32x32x16_bf16 v[240:255], v[44:47], a[192:195], v[240:255]
    ds_read_b64_tr_b16 v[62:63], v7 offset:10752
    s_waitcnt lgkmcnt(6)
    v_mfma_f32_32x32x16_bf16 v[128:143], v[48:51], a[68:71], v[128:143]
    ds_read_b64_tr_b16 v[32:33], v6 offset:4096
    s_waitcnt vmcnt(33)
    v_mfma_f32_32x32x16_bf16 v[192:207], v[48:51], a[196:199], v[192:207]
    ds_read_b64_tr_b16 v[34:35], v6 offset:4608
    s_waitcnt lgkmcnt(6)
    v_mfma_f32_32x32x16_bf16 v[144:159], v[52:55], a[68:71], v[144:159]
    ds_read_b64_tr_b16 v[36:37], v7 offset:4096
    v_mfma_f32_32x32x16_bf16 v[208:223], v[52:55], a[196:199], v[208:223]
    ds_read_b64_tr_b16 v[38:39], v7 offset:4608
    s_waitcnt lgkmcnt(6)
    v_mfma_f32_32x32x16_bf16 v[160:175], v[56:59], a[68:71], v[160:175]
    ds_read_b64_tr_b16 v[40:41], v6 offset:12288
    v_mfma_f32_32x32x16_bf16 v[224:239], v[56:59], a[196:199], v[224:239]
    ds_read_b64_tr_b16 v[42:43], v6 offset:12800
    s_waitcnt lgkmcnt(6)
    v_mfma_f32_32x32x16_bf16 v[176:191], v[60:63], a[68:71], v[176:191]
    ds_read_b64_tr_b16 v[44:45], v7 offset:12288
    v_mfma_f32_32x32x16_bf16 v[240:255], v[60:63], a[196:199], v[240:255]
    ds_read_b64_tr_b16 v[46:47], v7 offset:12800
    s_waitcnt lgkmcnt(6)
    v_mfma_f32_32x32x16_bf16 v[128:143], v[32:35], a[72:75], v[128:143]
    s_add_u32 s79, s62, 0x7000
    buffer_load_dwordx4 a[112:115], v2, s[32:35], s79 offen offset:0
    ds_read_b64_tr_b16 v[48:49], v6 offset:6144
    s_waitcnt vmcnt(33)
    v_mfma_f32_32x32x16_bf16 v[192:207], v[32:35], a[200:203], v[192:207]
    ds_read_b64_tr_b16 v[50:51], v6 offset:6656
    s_waitcnt lgkmcnt(6)
    v_mfma_f32_32x32x16_bf16 v[144:159], v[36:39], a[72:75], v[144:159]
    buffer_load_dwordx4 a[116:119], v2, s[32:35], s79 offen offset:1024
    ds_read_b64_tr_b16 v[52:53], v7 offset:6144
    v_mfma_f32_32x32x16_bf16 v[208:223], v[36:39], a[200:203], v[208:223]
    ds_read_b64_tr_b16 v[54:55], v7 offset:6656
    s_waitcnt lgkmcnt(6)
    v_mfma_f32_32x32x16_bf16 v[160:175], v[40:43], a[72:75], v[160:175]
    buffer_load_dwordx4 a[120:123], v2, s[32:35], s79 offen offset:2048
    ds_read_b64_tr_b16 v[56:57], v6 offset:14336
    v_mfma_f32_32x32x16_bf16 v[224:239], v[40:43], a[200:203], v[224:239]
    ds_read_b64_tr_b16 v[58:59], v6 offset:14848
    s_waitcnt lgkmcnt(6)
    v_mfma_f32_32x32x16_bf16 v[176:191], v[44:47], a[72:75], v[176:191]
    buffer_load_dwordx4 a[124:127], v2, s[32:35], s79 offen offset:3072
    ds_read_b64_tr_b16 v[60:61], v7 offset:14336
    v_mfma_f32_32x32x16_bf16 v[240:255], v[44:47], a[200:203], v[240:255]
    ds_read_b64_tr_b16 v[62:63], v7 offset:14848
    s_waitcnt lgkmcnt(0)
    s_waitcnt vmcnt(30)
    s_waitcnt vmcnt(22)
    s_barrier
    s_cmp_lg_u32 s56, 0
    s_cbranch_scc1 L_sig_kva
    s_mov_b64 exec, 1
    v_mov_b32 v26, 1
    buffer_atomic_add v26, off, s[96:99], s31
    s_mov_b64 exec, -1
L_sig_kva:
    v_mfma_f32_32x32x16_bf16 v[128:143], v[48:51], a[76:79], v[128:143]
    s_add_u32 s80, s63, 0x7000
    buffer_load_dwordx4 a[240:243], v2, s[32:35], s80 offen offset:0
    ds_read_b64_tr_b16 v[32:33], v6 offset:16384
    v_mfma_f32_32x32x16_bf16 v[192:207], v[48:51], a[204:207], v[192:207]
    ds_read_b64_tr_b16 v[34:35], v6 offset:16896
    v_mfma_f32_32x32x16_bf16 v[144:159], v[52:55], a[76:79], v[144:159]
    buffer_load_dwordx4 a[244:247], v2, s[32:35], s80 offen offset:1024
    ds_read_b64_tr_b16 v[36:37], v7 offset:16384
    v_mfma_f32_32x32x16_bf16 v[208:223], v[52:55], a[204:207], v[208:223]
    ds_read_b64_tr_b16 v[38:39], v7 offset:16896
    v_mfma_f32_32x32x16_bf16 v[160:175], v[56:59], a[76:79], v[160:175]
    buffer_load_dwordx4 a[248:251], v2, s[32:35], s80 offen offset:2048
    ds_read_b64_tr_b16 v[40:41], v6 offset:24576
    v_mfma_f32_32x32x16_bf16 v[224:239], v[56:59], a[204:207], v[224:239]
    ds_read_b64_tr_b16 v[42:43], v6 offset:25088
    v_mfma_f32_32x32x16_bf16 v[176:191], v[60:63], a[76:79], v[176:191]
    buffer_load_dwordx4 a[252:255], v2, s[32:35], s80 offen offset:3072
    ds_read_b64_tr_b16 v[44:45], v7 offset:24576
    v_mfma_f32_32x32x16_bf16 v[240:255], v[60:63], a[204:207], v[240:255]
    ds_read_b64_tr_b16 v[46:47], v7 offset:25088
    s_waitcnt lgkmcnt(6)
    v_mfma_f32_32x32x16_bf16 v[128:143], v[32:35], a[80:83], v[128:143]
    s_add_u32 m0, s59, 0
    s_add_u32 s60, s65, 0
    buffer_load_dwordx4 v12, s[40:43], s60 offen offset:0 lds
    ds_read_b64_tr_b16 v[48:49], v6 offset:18432
    v_mfma_f32_32x32x16_bf16 v[192:207], v[32:35], a[208:211], v[192:207]
    ds_read_b64_tr_b16 v[50:51], v6 offset:18944
    s_waitcnt lgkmcnt(6)
    v_mfma_f32_32x32x16_bf16 v[144:159], v[36:39], a[80:83], v[144:159]
    buffer_load_dwordx4 v13, s[40:43], s60 offen offset:1024 lds
    ds_read_b64_tr_b16 v[52:53], v7 offset:18432
    v_mfma_f32_32x32x16_bf16 v[208:223], v[36:39], a[208:211], v[208:223]
    ds_read_b64_tr_b16 v[54:55], v7 offset:18944
    s_waitcnt lgkmcnt(6)
    v_mfma_f32_32x32x16_bf16 v[160:175], v[40:43], a[80:83], v[160:175]
    buffer_load_dwordx4 v14, s[40:43], s60 offen offset:2048 lds
    ds_read_b64_tr_b16 v[56:57], v6 offset:26624
    v_mfma_f32_32x32x16_bf16 v[224:239], v[40:43], a[208:211], v[224:239]
    ds_read_b64_tr_b16 v[58:59], v6 offset:27136
    s_waitcnt lgkmcnt(6)
    v_mfma_f32_32x32x16_bf16 v[176:191], v[44:47], a[80:83], v[176:191]
    buffer_load_dwordx4 v15, s[40:43], s60 offen offset:3072 lds
    ds_read_b64_tr_b16 v[60:61], v7 offset:26624
    v_mfma_f32_32x32x16_bf16 v[240:255], v[44:47], a[208:211], v[240:255]
    ds_read_b64_tr_b16 v[62:63], v7 offset:27136
    s_waitcnt lgkmcnt(6)
    v_mfma_f32_32x32x16_bf16 v[128:143], v[48:51], a[84:87], v[128:143]
    ds_read_b64_tr_b16 v[32:33], v6 offset:20480
    v_mfma_f32_32x32x16_bf16 v[192:207], v[48:51], a[212:215], v[192:207]
    ds_read_b64_tr_b16 v[34:35], v6 offset:20992
    s_waitcnt lgkmcnt(6)
    v_mfma_f32_32x32x16_bf16 v[144:159], v[52:55], a[84:87], v[144:159]
    ds_read_b64_tr_b16 v[36:37], v7 offset:20480
    v_mfma_f32_32x32x16_bf16 v[208:223], v[52:55], a[212:215], v[208:223]
    ds_read_b64_tr_b16 v[38:39], v7 offset:20992
    s_waitcnt lgkmcnt(6)
    v_mfma_f32_32x32x16_bf16 v[160:175], v[56:59], a[84:87], v[160:175]
    ds_read_b64_tr_b16 v[40:41], v6 offset:28672
    v_mfma_f32_32x32x16_bf16 v[224:239], v[56:59], a[212:215], v[224:239]
    ds_read_b64_tr_b16 v[42:43], v6 offset:29184
    s_waitcnt lgkmcnt(6)
    v_mfma_f32_32x32x16_bf16 v[176:191], v[60:63], a[84:87], v[176:191]
    ds_read_b64_tr_b16 v[44:45], v7 offset:28672
    v_mfma_f32_32x32x16_bf16 v[240:255], v[60:63], a[212:215], v[240:255]
    ds_read_b64_tr_b16 v[46:47], v7 offset:29184
    s_waitcnt lgkmcnt(6)
    v_mfma_f32_32x32x16_bf16 v[128:143], v[32:35], a[88:91], v[128:143]
    ds_read_b64_tr_b16 v[48:49], v6 offset:22528
    s_waitcnt vmcnt(29)
    v_mfma_f32_32x32x16_bf16 v[192:207], v[32:35], a[216:219], v[192:207]
    ds_read_b64_tr_b16 v[50:51], v6 offset:23040
    s_waitcnt lgkmcnt(6)
    v_mfma_f32_32x32x16_bf16 v[144:159], v[36:39], a[88:91], v[144:159]
    ds_read_b64_tr_b16 v[52:53], v7 offset:22528
    v_mfma_f32_32x32x16_bf16 v[208:223], v[36:39], a[216:219], v[208:223]
    ds_read_b64_tr_b16 v[54:55], v7 offset:23040
    s_waitcnt lgkmcnt(6)
    v_mfma_f32_32x32x16_bf16 v[160:175], v[40:43], a[88:91], v[160:175]
    ds_read_b64_tr_b16 v[56:57], v6 offset:30720
    v_mfma_f32_32x32x16_bf16 v[224:239], v[40:43], a[216:219], v[224:239]
    ds_read_b64_tr_b16 v[58:59], v6 offset:31232
    s_waitcnt lgkmcnt(6)
    v_mfma_f32_32x32x16_bf16 v[176:191], v[44:47], a[88:91], v[176:191]
    ds_read_b64_tr_b16 v[60:61], v7 offset:30720
    v_mfma_f32_32x32x16_bf16 v[240:255], v[44:47], a[216:219], v[240:255]
    ds_read_b64_tr_b16 v[62:63], v7 offset:31232
    s_waitcnt lgkmcnt(0)
    s_waitcnt vmcnt(24)
    s_barrier
    v_mfma_f32_32x32x16_bf16 v[128:143], v[48:51], a[92:95], v[128:143]
    s_add_u32 m0, s59, 0x4000
    s_add_u32 s60, s65, 0x100000
    buffer_load_dwordx4 v12, s[40:43], s60 offen offset:0 lds
    ds_read_b64_tr_b16 v[32:33], v6 offset:32768
    v_mfma_f32_32x32x16_bf16 v[192:207], v[48:51], a[220:223], v[192:207]
    ds_read_b64_tr_b16 v[34:35], v6 offset:33280
    v_mfma_f32_32x32x16_bf16 v[144:159], v[52:55], a[92:95], v[144:159]
    buffer_load_dwordx4 v13, s[40:43], s60 offen offset:1024 lds
    ds_read_b64_tr_b16 v[36:37], v7 offset:32768
    v_mfma_f32_32x32x16_bf16 v[208:223], v[52:55], a[220:223], v[208:223]
    ds_read_b64_tr_b16 v[38:39], v7 offset:33280
    v_mfma_f32_32x32x16_bf16 v[160:175], v[56:59], a[92:95], v[160:175]
    buffer_load_dwordx4 v14, s[40:43], s60 offen offset:2048 lds
    ds_read_b64_tr_b16 v[40:41], v6 offset:40960
    v_mfma_f32_32x32x16_bf16 v[224:239], v[56:59], a[220:223], v[224:239]
    ds_read_b64_tr_b16 v[42:43], v6 offset:41472
    v_mfma_f32_32x32x16_bf16 v[176:191], v[60:63], a[92:95], v[176:191]
    buffer_load_dwordx4 v15, s[40:43], s60 offen offset:3072 lds
    ds_read_b64_tr_b16 v[44:45], v7 offset:40960
    v_mfma_f32_32x32x16_bf16 v[240:255], v[60:63], a[220:223], v[240:255]
    ds_read_b64_tr_b16 v[46:47], v7 offset:41472
    s_waitcnt vmcnt(27) lgkmcnt(6)
    v_mfma_f32_32x32x16_bf16 v[128:143], v[32:35], a[96:99], v[128:143]
    ds_read_b64_tr_b16 v[48:49], v6 offset:34816
    s_waitcnt vmcnt(23)
    v_mfma_f32_32x32x16_bf16 v[192:207], v[32:35], a[224:227], v[192:207]
    ds_read_b64_tr_b16 v[50:51], v6 offset:35328
    s_waitcnt lgkmcnt(6)
    v_mfma_f32_32x32x16_bf16 v[144:159], v[36:39], a[96:99], v[144:159]
    ds_read_b64_tr_b16 v[52:53], v7 offset:34816
    v_mfma_f32_32x32x16_bf16 v[208:223], v[36:39], a[224:227], v[208:223]
    ds_read_b64_tr_b16 v[54:55], v7 offset:35328
    s_waitcnt lgkmcnt(6)
    v_mfma_f32_32x32x16_bf16 v[160:175], v[40:43], a[96:99], v[160:175]
    ds_read_b64_tr_b16 v[56:57], v6 offset:43008
    v_mfma_f32_32x32x16_bf16 v[224:239], v[40:43], a[224:227], v[224:239]
    ds_read_b64_tr_b16 v[58:59], v6 offset:43520
    s_waitcnt lgkmcnt(6)
    v_mfma_f32_32x32x16_bf16 v[176:191], v[44:47], a[96:99], v[176:191]
    ds_read_b64_tr_b16 v[60:61], v7 offset:43008
    v_mfma_f32_32x32x16_bf16 v[240:255], v[44:47], a[224:227], v[240:255]
    ds_read_b64_tr_b16 v[62:63], v7 offset:43520
    s_waitcnt lgkmcnt(6)
    v_mfma_f32_32x32x16_bf16 v[128:143], v[48:51], a[100:103], v[128:143]
    ds_read_b64_tr_b16 v[32:33], v6 offset:36864
    s_waitcnt vmcnt(22)
    v_mfma_f32_32x32x16_bf16 v[192:207], v[48:51], a[228:231], v[192:207]
    ds_read_b64_tr_b16 v[34:35], v6 offset:37376
    s_waitcnt lgkmcnt(6)
    v_mfma_f32_32x32x16_bf16 v[144:159], v[52:55], a[100:103], v[144:159]
    ds_read_b64_tr_b16 v[36:37], v7 offset:36864
    v_mfma_f32_32x32x16_bf16 v[208:223], v[52:55], a[228:231], v[208:223]
    ds_read_b64_tr_b16 v[38:39], v7 offset:37376
    s_waitcnt lgkmcnt(6)
    v_mfma_f32_32x32x16_bf16 v[160:175], v[56:59], a[100:103], v[160:175]
    ds_read_b64_tr_b16 v[40:41], v6 offset:45056
    v_mfma_f32_32x32x16_bf16 v[224:239], v[56:59], a[228:231], v[224:239]
    ds_read_b64_tr_b16 v[42:43], v6 offset:45568
    s_waitcnt lgkmcnt(6)
    v_mfma_f32_32x32x16_bf16 v[176:191], v[60:63], a[100:103], v[176:191]
    ds_read_b64_tr_b16 v[44:45], v7 offset:45056
    v_mfma_f32_32x32x16_bf16 v[240:255], v[60:63], a[228:231], v[240:255]
    ds_read_b64_tr_b16 v[46:47], v7 offset:45568
    s_waitcnt lgkmcnt(6)
    v_mfma_f32_32x32x16_bf16 v[128:143], v[32:35], a[104:107], v[128:143]
    ds_read_b64_tr_b16 v[48:49], v6 offset:38912
    s_waitcnt vmcnt(21)
    v_mfma_f32_32x32x16_bf16 v[192:207], v[32:35], a[232:235], v[192:207]
    ds_read_b64_tr_b16 v[50:51], v6 offset:39424
    s_waitcnt lgkmcnt(6)
    v_mfma_f32_32x32x16_bf16 v[144:159], v[36:39], a[104:107], v[144:159]
    ds_read_b64_tr_b16 v[52:53], v7 offset:38912
    v_mfma_f32_32x32x16_bf16 v[208:223], v[36:39], a[232:235], v[208:223]
    ds_read_b64_tr_b16 v[54:55], v7 offset:39424
    s_waitcnt lgkmcnt(6)
    v_mfma_f32_32x32x16_bf16 v[160:175], v[40:43], a[104:107], v[160:175]
    ds_read_b64_tr_b16 v[56:57], v6 offset:47104
    v_mfma_f32_32x32x16_bf16 v[224:239], v[40:43], a[232:235], v[224:239]
    ds_read_b64_tr_b16 v[58:59], v6 offset:47616
    s_waitcnt lgkmcnt(6)
    v_mfma_f32_32x32x16_bf16 v[176:191], v[44:47], a[104:107], v[176:191]
    ds_read_b64_tr_b16 v[60:61], v7 offset:47104
    v_mfma_f32_32x32x16_bf16 v[240:255], v[44:47], a[232:235], v[240:255]
    ds_read_b64_tr_b16 v[62:63], v7 offset:47616
    s_waitcnt lgkmcnt(0)
    s_waitcnt vmcnt(16)
    s_barrier
    v_mfma_f32_32x32x16_bf16 v[128:143], v[48:51], a[108:111], v[128:143]
    s_add_u32 m0, s59, 0x8000
    s_add_u32 s60, s65, 0x200000
    buffer_load_dwordx4 v12, s[40:43], s60 offen offset:0 lds
    ds_read_b64_tr_b16 v[32:33], v6 offset:49152
    v_mfma_f32_32x32x16_bf16 v[192:207], v[48:51], a[236:239], v[192:207]
    ds_read_b64_tr_b16 v[34:35], v6 offset:49664
    v_mfma_f32_32x32x16_bf16 v[144:159], v[52:55], a[108:111], v[144:159]
    buffer_load_dwordx4 v13, s[40:43], s60 offen offset:1024 lds
    ds_read_b64_tr_b16 v[36:37], v7 offset:49152
    v_mfma_f32_32x32x16_bf16 v[208:223], v[52:55], a[236:239], v[208:223]
    ds_read_b64_tr_b16 v[38:39], v7 offset:49664
    v_mfma_f32_32x32x16_bf16 v[160:175], v[56:59], a[108:111], v[160:175]
    buffer_load_dwordx4 v14, s[40:43], s60 offen offset:2048 lds
    ds_read_b64_tr_b16 v[40:41], v6 offset:57344
    v_mfma_f32_32x32x16_bf16 v[224:239], v[56:59], a[236:239], v[224:239]
    ds_read_b64_tr_b16 v[42:43], v6 offset:57856
    v_mfma_f32_32x32x16_bf16 v[176:191], v[60:63], a[108:111], v[176:191]
    buffer_load_dwordx4 v15, s[40:43], s60 offen offset:3072 lds
    ds_read_b64_tr_b16 v[44:45], v7 offset:57344
    v_mfma_f32_32x32x16_bf16 v[240:255], v[60:63], a[236:239], v[240:255]
    ds_read_b64_tr_b16 v[46:47], v7 offset:57856
    s_waitcnt vmcnt(19) lgkmcnt(6)
    v_mfma_f32_32x32x16_bf16 v[128:143], v[32:35], a[112:115], v[128:143]
    ds_read_b64_tr_b16 v[48:49], v6 offset:51200
    s_waitcnt vmcnt(15)
    v_mfma_f32_32x32x16_bf16 v[192:207], v[32:35], a[240:243], v[192:207]
    ds_read_b64_tr_b16 v[50:51], v6 offset:51712
    s_waitcnt lgkmcnt(6)
    v_mfma_f32_32x32x16_bf16 v[144:159], v[36:39], a[112:115], v[144:159]
    ds_read_b64_tr_b16 v[52:53], v7 offset:51200
    v_mfma_f32_32x32x16_bf16 v[208:223], v[36:39], a[240:243], v[208:223]
    ds_read_b64_tr_b16 v[54:55], v7 offset:51712
    s_waitcnt lgkmcnt(6)
    v_mfma_f32_32x32x16_bf16 v[160:175], v[40:43], a[112:115], v[160:175]
    ds_read_b64_tr_b16 v[56:57], v6 offset:59392
    v_mfma_f32_32x32x16_bf16 v[224:239], v[40:43], a[240:243], v[224:239]
    ds_read_b64_tr_b16 v[58:59], v6 offset:59904
    s_waitcnt lgkmcnt(6)
    v_mfma_f32_32x32x16_bf16 v[176:191], v[44:47], a[112:115], v[176:191]
    ds_read_b64_tr_b16 v[60:61], v7 offset:59392
    v_mfma_f32_32x32x16_bf16 v[240:255], v[44:47], a[240:243], v[240:255]
    ds_read_b64_tr_b16 v[62:63], v7 offset:59904
    s_waitcnt lgkmcnt(6)
    v_mfma_f32_32x32x16_bf16 v[128:143], v[48:51], a[116:119], v[128:143]
    ds_read_b64_tr_b16 v[32:33], v6 offset:53248
    s_waitcnt vmcnt(14)
    v_mfma_f32_32x32x16_bf16 v[192:207], v[48:51], a[244:247], v[192:207]
    ds_read_b64_tr_b16 v[34:35], v6 offset:53760
    s_waitcnt lgkmcnt(6)
    v_mfma_f32_32x32x16_bf16 v[144:159], v[52:55], a[116:119], v[144:159]
    ds_read_b64_tr_b16 v[36:37], v7 offset:53248
    v_mfma_f32_32x32x16_bf16 v[208:223], v[52:55], a[244:247], v[208:223]
    ds_read_b64_tr_b16 v[38:39], v7 offset:53760
    s_waitcnt lgkmcnt(6)
    v_mfma_f32_32x32x16_bf16 v[160:175], v[56:59], a[116:119], v[160:175]
    ds_read_b64_tr_b16 v[40:41], v6 offset:61440
    v_mfma_f32_32x32x16_bf16 v[224:239], v[56:59], a[244:247], v[224:239]
    ds_read_b64_tr_b16 v[42:43], v6 offset:61952
    s_waitcnt lgkmcnt(6)
    v_mfma_f32_32x32x16_bf16 v[176:191], v[60:63], a[116:119], v[176:191]
    ds_read_b64_tr_b16 v[44:45], v7 offset:61440
    v_mfma_f32_32x32x16_bf16 v[240:255], v[60:63], a[244:247], v[240:255]
    ds_read_b64_tr_b16 v[46:47], v7 offset:61952
    s_waitcnt lgkmcnt(6)
    v_mfma_f32_32x32x16_bf16 v[128:143], v[32:35], a[120:123], v[128:143]
    ds_read_b64_tr_b16 v[48:49], v6 offset:55296
    s_waitcnt vmcnt(13)
    v_mfma_f32_32x32x16_bf16 v[192:207], v[32:35], a[248:251], v[192:207]
    ds_read_b64_tr_b16 v[50:51], v6 offset:55808
    s_waitcnt lgkmcnt(6)
    v_mfma_f32_32x32x16_bf16 v[144:159], v[36:39], a[120:123], v[144:159]
    ds_read_b64_tr_b16 v[52:53], v7 offset:55296
    v_mfma_f32_32x32x16_bf16 v[208:223], v[36:39], a[248:251], v[208:223]
    ds_read_b64_tr_b16 v[54:55], v7 offset:55808
    s_waitcnt lgkmcnt(6)
    v_mfma_f32_32x32x16_bf16 v[160:175], v[40:43], a[120:123], v[160:175]
    ds_read_b64_tr_b16 v[56:57], v6 offset:63488
    v_mfma_f32_32x32x16_bf16 v[224:239], v[40:43], a[248:251], v[224:239]
    ds_read_b64_tr_b16 v[58:59], v6 offset:64000
    s_waitcnt lgkmcnt(6)
    v_mfma_f32_32x32x16_bf16 v[176:191], v[44:47], a[120:123], v[176:191]
    ds_read_b64_tr_b16 v[60:61], v7 offset:63488
    v_mfma_f32_32x32x16_bf16 v[240:255], v[44:47], a[248:251], v[240:255]
    ds_read_b64_tr_b16 v[62:63], v7 offset:64000
    s_waitcnt lgkmcnt(0)
    s_waitcnt vmcnt(8)
    s_barrier
    v_mfma_f32_32x32x16_bf16 v[128:143], v[48:51], a[124:127], v[128:143]
    s_add_u32 m0, s59, 0xc000
    s_add_u32 s60, s65, 0x300000
    buffer_load_dwordx4 v12, s[40:43], s60 offen offset:0 lds
    ds_read_b64_tr_b16 v[32:33], v6 offset:0
    v_mfma_f32_32x32x16_bf16 v[192:207], v[48:51], a[252:255], v[192:207]
    v_mfma_f32_32x32x16_bf16 v[144:159], v[52:55], a[124:127], v[144:159]
    buffer_load_dwordx4 v13, s[40:43], s60 offen offset:1024 lds
    v_mfma_f32_32x32x16_bf16 v[208:223], v[52:55], a[252:255], v[208:223]
    ds_read_b64_tr_b16 v[34:35], v6 offset:512
    v_mfma_f32_32x32x16_bf16 v[160:175], v[56:59], a[124:127], v[160:175]
    buffer_load_dwordx4 v14, s[40:43], s60 offen offset:2048 lds
    ds_read_b64_tr_b16 v[36:37], v7 offset:0
    v_mfma_f32_32x32x16_bf16 v[224:239], v[56:59], a[252:255], v[224:239]
    v_mfma_f32_32x32x16_bf16 v[176:191], v[60:63], a[124:127], v[176:191]
    buffer_load_dwordx4 v15, s[40:43], s60 offen offset:3072 lds
    ds_read_b64_tr_b16 v[38:39], v7 offset:512
    v_mfma_f32_32x32x16_bf16 v[240:255], v[60:63], a[252:255], v[240:255]
    s_waitcnt lgkmcnt(2)
    v_mfma_f32_32x32x16_bf16 v[64:79], v[32:35], a[0:3], 0
    ds_read_b64_tr_b16 v[48:49], v6 offset:2048
    v_mul_f32 v17, v128, v128
    v_mul_f32 v18, v129, v129
    v_mfma_f32_32x32x16_bf16 v[96:111], v[32:35], a[128:131], 0
    ds_read_b64_tr_b16 v[50:51], v6 offset:2560
    v_mul_f32 v19, v130, v130
    v_mul_f32 v20, v131, v131
    s_waitcnt lgkmcnt(2)
    v_mfma_f32_32x32x16_bf16 v[80:95], v[36:39], a[0:3], 0
    ds_read_b64_tr_b16 v[52:53], v7 offset:2048
    v_fmaak_f32 v17, v17, v16, 0xc0135761
    v_fmaak_f32 v18, v18, v16, 0xc0135761
    v_mfma_f32_32x32x16_bf16 v[112:127], v[36:39], a[128:131], 0
    ds_read_b64_tr_b16 v[54:55], v7 offset:2560
    v_fmaak_f32 v19, v19, v16, 0xc0135761
    v_fmaak_f32 v20, v20, v16, 0xc0135761
    s_waitcnt lgkmcnt(2)
    v_mfma_f32_32x32x16_bf16 v[64:79], v[48:51], a[4:7], v[64:79]
    ds_read_b64_tr_b16 v[32:33], v6 offset:4096
    v_mul_f32 v17, v17, v128
    v_mul_f32 v18, v18, v129
    v_mul_f32 v19, v19, v130
    v_mfma_f32_32x32x16_bf16 v[96:111], v[48:51], a[132:135], v[96:111]
    ds_read_b64_tr_b16 v[34:35], v6 offset:4608
    v_mul_f32 v20, v20, v131
    v_exp_f32 v17, v17
    ds_read_b64_tr_b16 v[36:37], v7 offset:4096
    s_waitcnt lgkmcnt(3)
    v_mfma_f32_32x32x16_bf16 v[80:95], v[52:55], a[4:7], v[80:95]
    v_exp_f32 v18, v18
    v_exp_f32 v19, v19
    v_mfma_f32_32x32x16_bf16 v[112:127], v[52:55], a[132:135], v[112:127]
    ds_read_b64_tr_b16 v[38:39], v7 offset:4608
    v_exp_f32 v20, v20
    v_mul_f32 v21, v128, v160
    s_waitcnt lgkmcnt(2)
    v_mfma_f32_32x32x16_bf16 v[64:79], v[32:35], a[8:11], v[64:79]
    ds_read_b64_tr_b16 v[48:49], v6 offset:6144
    v_mul_f32 v22, v129, v161
    v_mul_f32 v23, v130, v162
    v_mul_f32 v24, v131, v163
    v_mfma_f32_32x32x16_bf16 v[96:111], v[32:35], a[136:139], v[96:111]
    ds_read_b64_tr_b16 v[50:51], v6 offset:6656
    v_add_f32 v17, 1.0, v17
    v_add_f32 v18, 1.0, v18
    ds_read_b64_tr_b16 v[52:53], v7 offset:6144
    s_waitcnt lgkmcnt(3)
    v_mfma_f32_32x32x16_bf16 v[80:95], v[36:39], a[8:11], v[80:95]
    v_add_f32 v19, 1.0, v19
    v_add_f32 v20, 1.0, v20
    ds_read_b64_tr_b16 v[54:55], v7 offset:6656
    v_mfma_f32_32x32x16_bf16 v[112:127], v[36:39], a[136:139], v[112:127]
    v_rcp_f32 v17, v17
    v_rcp_f32 v18, v18
    s_waitcnt lgkmcnt(2)
    v_mfma_f32_32x32x16_bf16 v[64:79], v[48:51], a[12:15], v[64:79]
    ds_read_b64_tr_b16 v[32:33], v6 offset:8192
    v_rcp_f32 v19, v19
    v_mfma_f32_32x32x16_bf16 v[96:111], v[48:51], a[140:143], v[96:111]
    v_rcp_f32 v20, v20
    s_nop 0
    ds_read_b64_tr_b16 v[34:35], v6 offset:8704
    v_mul_f32 v128, v21, v17
    s_waitcnt lgkmcnt(2)
    v_mfma_f32_32x32x16_bf16 v[80:95], v[52:55], a[12:15], v[80:95]
    v_mul_f32 v129, v22, v18
    ds_read_b64_tr_b16 v[36:37], v7 offset:8192
    v_mul_f32 v130, v23, v19
    v_mfma_f32_32x32x16_bf16 v[112:127], v[52:55], a[140:143], v[112:127]
    v_mul_f32 v131, v24, v20
    ds_read_b64_tr_b16 v[38:39], v7 offset:8704
    v_mul_f32 v17, v132, v132
    v_mul_f32 v18, v133, v133
    s_waitcnt lgkmcnt(2)
    v_mfma_f32_32x32x16_bf16 v[64:79], v[32:35], a[16:19], v[64:79]
    ds_read_b64_tr_b16 v[48:49], v6 offset:10240
    v_mul_f32 v19, v134, v134
    v_mul_f32 v20, v135, v135
    v_mfma_f32_32x32x16_bf16 v[96:111], v[32:35], a[144:147], v[96:111]
    v_fmaak_f32 v17, v17, v16, 0xc0135761
    ds_read_b64_tr_b16 v[50:51], v6 offset:10752
    v_fmaak_f32 v18, v18, v16, 0xc0135761
    v_fmaak_f32 v19, v19, v16, 0xc0135761
    s_waitcnt lgkmcnt(2)
    v_mfma_f32_32x32x16_bf16 v[80:95], v[36:39], a[16:19], v[80:95]
    ds_read_b64_tr_b16 v[52:53], v7 offset:10240
    v_fmaak_f32 v20, v20, v16, 0xc0135761
    v_mul_f32 v17, v17, v132
    v_mfma_f32_32x32x16_bf16 v[112:127], v[36:39], a[144:147], v[112:127]
    ds_read_b64_tr_b16 v[54:55], v7 offset:10752
    v_mul_f32 v18, v18, v133
    v_mul_f32 v19, v19, v134
    s_waitcnt lgkmcnt(2)
    v_mfma_f32_32x32x16_bf16 v[64:79], v[48:51], a[20:23], v[64:79]
    ds_read_b64_tr_b16 v[32:33], v6 offset:12288
    v_mul_f32 v20, v20, v135
    v_exp_f32 v17, v17
    v_mfma_f32_32x32x16_bf16 v[96:111], v[48:51], a[148:151], v[96:111]
    v_exp_f32 v18, v18
    ds_read_b64_tr_b16 v[34:35], v6 offset:12800
    v_exp_f32 v19, v19
    s_waitcnt lgkmcnt(2)
    v_mfma_f32_32x32x16_bf16 v[80:95], v[52:55], a[20:23], v[80:95]
    v_exp_f32 v20, v20
    ds_read_b64_tr_b16 v[36:37], v7 offset:12288
    v_mul_f32 v21, v132, v164
    v_mfma_f32_32x32x16_bf16 v[112:127], v[52:55], a[148:151], v[112:127]
    v_mul_f32 v22, v133, v165
    ds_read_b64_tr_b16 v[38:39], v7 offset:12800
    v_mul_f32 v23, v134, v166
    v_mul_f32 v24, v135, v167
    s_waitcnt lgkmcnt(2)
    v_mfma_f32_32x32x16_bf16 v[64:79], v[32:35], a[24:27], v[64:79]
    ds_read_b64_tr_b16 v[48:49], v6 offset:14336
    v_add_f32 v17, 1.0, v17
    v_add_f32 v18, 1.0, v18
    v_add_f32 v19, 1.0, v19
    v_mfma_f32_32x32x16_bf16 v[96:111], v[32:35], a[152:155], v[96:111]
    ds_read_b64_tr_b16 v[50:51], v6 offset:14848
    v_add_f32 v20, 1.0, v20
    v_rcp_f32 v17, v17
    ds_read_b64_tr_b16 v[52:53], v7 offset:14336
    s_waitcnt lgkmcnt(3)
    v_mfma_f32_32x32x16_bf16 v[80:95], v[36:39], a[24:27], v[80:95]
    v_rcp_f32 v18, v18
    v_rcp_f32 v19, v19
    v_mfma_f32_32x32x16_bf16 v[112:127], v[36:39], a[152:155], v[112:127]
    ds_read_b64_tr_b16 v[54:55], v7 offset:14848
    v_rcp_f32 v20, v20
    s_nop 0
    s_waitcnt lgkmcnt(0)
    s_waitcnt vmcnt(8)
    s_barrier
    v_mfma_f32_32x32x16_bf16 v[64:79], v[48:51], a[28:31], v[64:79]
    s_add_u32 m0, s59, 0
    s_add_u32 s60, s66, 0
    buffer_load_dwordx4 v12, s[40:43], s60 offen offset:0 lds
    ds_read_b64_tr_b16 v[32:33], v6 offset:16384
    v_mul_f32 v132, v21, v17
    v_mul_f32 v133, v22, v18
    v_mul_f32 v134, v23, v19
    v_mfma_f32_32x32x16_bf16 v[96:111], v[48:51], a[156:159], v[96:111]
    ds_read_b64_tr_b16 v[34:35], v6 offset:16896
    v_mul_f32 v135, v24, v20
    v_cvt_pk_bf16_f32 v128, v128, v129
    v_mfma_f32_32x32x16_bf16 v[80:95], v[52:55], a[28:31], v[80:95]
    buffer_load_dwordx4 v13, s[40:43], s60 offen offset:1024 lds
    ds_read_b64_tr_b16 v[36:37], v7 offset:16384
    v_cvt_pk_bf16_f32 v129, v130, v131
    v_cvt_pk_bf16_f32 v130, v132, v133
    ds_read_b64_tr_b16 v[38:39], v7 offset:16896
    v_mfma_f32_32x32x16_bf16 v[112:127], v[52:55], a[156:159], v[112:127]
    v_cvt_pk_bf16_f32 v131, v134, v135
    buffer_store_dwordx4 v[128:131], v2, s[32:35], s67 offen offset:0 sc1
    s_waitcnt lgkmcnt(2)
    v_mfma_f32_32x32x16_bf16 v[64:79], v[32:35], a[32:35], v[64:79]
    buffer_load_dwordx4 v14, s[40:43], s60 offen offset:2048 lds
    ds_read_b64_tr_b16 v[48:49], v6 offset:18432
    v_mul_f32 v17, v136, v136
    v_mul_f32 v18, v137, v137
    v_mfma_f32_32x32x16_bf16 v[96:111], v[32:35], a[160:163], v[96:111]
    ds_read_b64_tr_b16 v[50:51], v6 offset:18944
    v_mul_f32 v19, v138, v138
    v_mul_f32 v20, v139, v139
    s_waitcnt lgkmcnt(2)
    v_mfma_f32_32x32x16_bf16 v[80:95], v[36:39], a[32:35], v[80:95]
    buffer_load_dwordx4 v15, s[40:43], s60 offen offset:3072 lds
    ds_read_b64_tr_b16 v[52:53], v7 offset:18432
    v_fmaak_f32 v17, v17, v16, 0xc0135761
    v_fmaak_f32 v18, v18, v16, 0xc0135761
    v_mfma_f32_32x32x16_bf16 v[112:127], v[36:39], a[160:163], v[112:127]
    ds_read_b64_tr_b16 v[54:55], v7 offset:18944
    v_fmaak_f32 v19, v19, v16, 0xc0135761
    v_fmaak_f32 v20, v20, v16, 0xc0135761
    s_waitcnt lgkmcnt(2)
    v_mfma_f32_32x32x16_bf16 v[64:79], v[48:51], a[36:39], v[64:79]
    ds_read_b64_tr_b16 v[32:33], v6 offset:20480
    v_mul_f32 v17, v17, v136
    v_mul_f32 v18, v18, v137
    v_mul_f32 v19, v19, v138
    v_mfma_f32_32x32x16_bf16 v[96:111], v[48:51], a[164:167], v[96:111]
    ds_read_b64_tr_b16 v[34:35], v6 offset:20992
    v_mul_f32 v20, v20, v139
    v_exp_f32 v17, v17
    ds_read_b64_tr_b16 v[36:37], v7 offset:20480
    s_waitcnt lgkmcnt(3)
    v_mfma_f32_32x32x16_bf16 v[80:95], v[52:55], a[36:39], v[80:95]
    v_exp_f32 v18, v18
    v_exp_f32 v19, v19
    v_mfma_f32_32x32x16_bf16 v[112:127], v[52:55], a[164:167], v[112:127]
    ds_read_b64_tr_b16 v[38:39], v7 offset:20992
    v_exp_f32 v20, v20
    v_mul_f32 v21, v136, v168
    s_waitcnt lgkmcnt(2)
    v_mfma_f32_32x32x16_bf16 v[64:79], v[32:35], a[40:43], v[64:79]
    ds_read_b64_tr_b16 v[48:49], v6 offset:22528
    v_mul_f32 v22, v137, v169
    v_mul_f32 v23, v138, v170
    v_mul_f32 v24, v139, v171
    v_mfma_f32_32x32x16_bf16 v[96:111], v[32:35], a[168:171], v[96:111]
    ds_read_b64_tr_b16 v[50:51], v6 offset:23040
    v_add_f32 v17, 1.0, v17
    v_add_f32 v18, 1.0, v18
    ds_read_b64_tr_b16 v[52:53], v7 offset:22528
    s_waitcnt lgkmcnt(3)
    v_mfma_f32_32x32x16_bf16 v[80:95], v[36:39], a[40:43], v[80:95]
    v_add_f32 v19, 1.0, v19
    v_add_f32 v20, 1.0, v20
    ds_read_b64_tr_b16 v[54:55], v7 offset:23040
    v_mfma_f32_32x32x16_bf16 v[112:127], v[36:39], a[168:171], v[112:127]
    v_rcp_f32 v17, v17
    v_rcp_f32 v18, v18
    s_waitcnt lgkmcnt(2)
    v_mfma_f32_32x32x16_bf16 v[64:79], v[48:51], a[44:47], v[64:79]
    ds_read_b64_tr_b16 v[32:33], v6 offset:24576
    v_rcp_f32 v19, v19
    v_mfma_f32_32x32x16_bf16 v[96:111], v[48:51], a[172:175], v[96:111]
    v_rcp_f32 v20, v20
    s_nop 0
    ds_read_b64_tr_b16 v[34:35], v6 offset:25088
    v_mul_f32 v136, v21, v17
    s_waitcnt lgkmcnt(2)
    v_mfma_f32_32x32x16_bf16 v[80:95], v[52:55], a[44:47], v[80:95]
    v_mul_f32 v137, v22, v18
    ds_read_b64_tr_b16 v[36:37], v7 offset:24576
    v_mul_f32 v138, v23, v19
    v_mfma_f32_32x32x16_bf16 v[112:127], v[52:55], a[172:175], v[112:127]
    v_mul_f32 v139, v24, v20
    ds_read_b64_tr_b16 v[38:39], v7 offset:25088
    v_mul_f32 v17, v140, v140
    v_mul_f32 v18, v141, v141
    s_waitcnt lgkmcnt(2)
    v_mfma_f32_32x32x16_bf16 v[64:79], v[32:35], a[48:51], v[64:79]
    ds_read_b64_tr_b16 v[48:49], v6 offset:26624
    v_mul_f32 v19, v142, v142
    v_mul_f32 v20, v143, v143
    v_mfma_f32_32x32x16_bf16 v[96:111], v[32:35], a[176:179], v[96:111]
    v_fmaak_f32 v17, v17, v16, 0xc0135761
    ds_read_b64_tr_b16 v[50:51], v6 offset:27136
    v_fmaak_f32 v18, v18, v16, 0xc0135761
    v_fmaak_f32 v19, v19, v16, 0xc0135761
    s_waitcnt lgkmcnt(2)
    v_mfma_f32_32x32x16_bf16 v[80:95], v[36:39], a[48:51], v[80:95]
    ds_read_b64_tr_b16 v[52:53], v7 offset:26624
    v_fmaak_f32 v20, v20, v16, 0xc0135761
    v_mul_f32 v17, v17, v140
    v_mfma_f32_32x32x16_bf16 v[112:127], v[36:39], a[176:179], v[112:127]
    ds_read_b64_tr_b16 v[54:55], v7 offset:27136
    v_mul_f32 v18, v18, v141
    v_mul_f32 v19, v19, v142
    s_waitcnt lgkmcnt(2)
    v_mfma_f32_32x32x16_bf16 v[64:79], v[48:51], a[52:55], v[64:79]
    ds_read_b64_tr_b16 v[32:33], v6 offset:28672
    v_mul_f32 v20, v20, v143
    v_exp_f32 v17, v17
    v_mfma_f32_32x32x16_bf16 v[96:111], v[48:51], a[180:183], v[96:111]
    v_exp_f32 v18, v18
    ds_read_b64_tr_b16 v[34:35], v6 offset:29184
    v_exp_f32 v19, v19
    s_waitcnt lgkmcnt(2)
    v_mfma_f32_32x32x16_bf16 v[80:95], v[52:55], a[52:55], v[80:95]
    v_exp_f32 v20, v20
    ds_read_b64_tr_b16 v[36:37], v7 offset:28672
    v_mul_f32 v21, v140, v172
    v_mfma_f32_32x32x16_bf16 v[112:127], v[52:55], a[180:183], v[112:127]
    v_mul_f32 v22, v141, v173
    ds_read_b64_tr_b16 v[38:39], v7 offset:29184
    v_mul_f32 v23, v142, v174
    v_mul_f32 v24, v143, v175
    s_waitcnt lgkmcnt(2)
    v_mfma_f32_32x32x16_bf16 v[64:79], v[32:35], a[56:59], v[64:79]
    ds_read_b64_tr_b16 v[48:49], v6 offset:30720
    v_add_f32 v17, 1.0, v17
    v_add_f32 v18, 1.0, v18
    v_add_f32 v19, 1.0, v19
    v_mfma_f32_32x32x16_bf16 v[96:111], v[32:35], a[184:187], v[96:111]
    ds_read_b64_tr_b16 v[50:51], v6 offset:31232
    v_add_f32 v20, 1.0, v20
    v_rcp_f32 v17, v17
    ds_read_b64_tr_b16 v[52:53], v7 offset:30720
    s_waitcnt lgkmcnt(3)
    v_mfma_f32_32x32x16_bf16 v[80:95], v[36:39], a[56:59], v[80:95]
    v_rcp_f32 v18, v18
    v_rcp_f32 v19, v19
    v_mfma_f32_32x32x16_bf16 v[112:127], v[36:39], a[184:187], v[112:127]
    ds_read_b64_tr_b16 v[54:55], v7 offset:31232
    v_rcp_f32 v20, v20
    s_nop 0
    s_waitcnt lgkmcnt(0)
    s_waitcnt vmcnt(9)
    s_barrier
    v_mfma_f32_32x32x16_bf16 v[64:79], v[48:51], a[60:63], v[64:79]
    s_add_u32 m0, s59, 0x4000
    s_add_u32 s60, s66, 0x100000
    buffer_load_dwordx4 v12, s[40:43], s60 offen offset:0 lds
    ds_read_b64_tr_b16 v[32:33], v6 offset:32768
    v_mul_f32 v140, v21, v17
    v_mul_f32 v141, v22, v18
    v_mul_f32 v142, v23, v19
    v_mfma_f32_32x32x16_bf16 v[96:111], v[48:51], a[188:191], v[96:111]
    ds_read_b64_tr_b16 v[34:35], v6 offset:33280
    v_mul_f32 v143, v24, v20
    v_cvt_pk_bf16_f32 v136, v136, v137
    v_mfma_f32_32x32x16_bf16 v[80:95], v[52:55], a[60:63], v[80:95]
    buffer_load_dwordx4 v13, s[40:43], s60 offen offset:1024 lds
    ds_read_b64_tr_b16 v[36:37], v7 offset:32768
    v_cvt_pk_bf16_f32 v137, v138, v139
    v_cvt_pk_bf16_f32 v138, v140, v141
    ds_read_b64_tr_b16 v[38:39], v7 offset:33280
    v_mfma_f32_32x32x16_bf16 v[112:127], v[52:55], a[188:191], v[112:127]
    v_cvt_pk_bf16_f32 v139, v142, v143
    buffer_store_dwordx4 v[136:139], v2, s[32:35], s67 offen offset:1024 sc1
    s_waitcnt lgkmcnt(2)
    v_mfma_f32_32x32x16_bf16 v[64:79], v[32:35], a[64:67], v[64:79]
    buffer_load_dwordx4 v14, s[40:43], s60 offen offset:2048 lds
    ds_read_b64_tr_b16 v[48:49], v6 offset:34816
    v_mul_f32 v17, v144, v144
    v_mul_f32 v18, v145, v145
    v_mfma_f32_32x32x16_bf16 v[96:111], v[32:35], a[192:195], v[96:111]
    ds_read_b64_tr_b16 v[50:51], v6 offset:35328
    v_mul_f32 v19, v146, v146
    v_mul_f32 v20, v147, v147
    s_waitcnt lgkmcnt(2)
    v_mfma_f32_32x32x16_bf16 v[80:95], v[36:39], a[64:67], v[80:95]
    buffer_load_dwordx4 v15, s[40:43], s60 offen offset:3072 lds
    ds_read_b64_tr_b16 v[52:53], v7 offset:34816
    v_fmaak_f32 v17, v17, v16, 0xc0135761
    v_fmaak_f32 v18, v18, v16, 0xc0135761
    v_mfma_f32_32x32x16_bf16 v[112:127], v[36:39], a[192:195], v[112:127]
    ds_read_b64_tr_b16 v[54:55], v7 offset:35328
    v_fmaak_f32 v19, v19, v16, 0xc0135761
    v_fmaak_f32 v20, v20, v16, 0xc0135761
    s_waitcnt lgkmcnt(2)
    v_mfma_f32_32x32x16_bf16 v[64:79], v[48:51], a[68:71], v[64:79]
    ds_read_b64_tr_b16 v[32:33], v6 offset:36864
    v_mul_f32 v17, v17, v144
    v_mul_f32 v18, v18, v145
    v_mul_f32 v19, v19, v146
    v_mfma_f32_32x32x16_bf16 v[96:111], v[48:51], a[196:199], v[96:111]
    ds_read_b64_tr_b16 v[34:35], v6 offset:37376
    v_mul_f32 v20, v20, v147
    v_exp_f32 v17, v17
    ds_read_b64_tr_b16 v[36:37], v7 offset:36864
    s_waitcnt lgkmcnt(3)
    v_mfma_f32_32x32x16_bf16 v[80:95], v[52:55], a[68:71], v[80:95]
    v_exp_f32 v18, v18
    v_exp_f32 v19, v19
    v_mfma_f32_32x32x16_bf16 v[112:127], v[52:55], a[196:199], v[112:127]
    ds_read_b64_tr_b16 v[38:39], v7 offset:37376
    v_exp_f32 v20, v20
    v_mul_f32 v21, v144, v176
    s_waitcnt lgkmcnt(2)
    v_mfma_f32_32x32x16_bf16 v[64:79], v[32:35], a[72:75], v[64:79]
    ds_read_b64_tr_b16 v[48:49], v6 offset:38912
    v_mul_f32 v22, v145, v177
    v_mul_f32 v23, v146, v178
    v_mul_f32 v24, v147, v179
    v_mfma_f32_32x32x16_bf16 v[96:111], v[32:35], a[200:203], v[96:111]
    ds_read_b64_tr_b16 v[50:51], v6 offset:39424
    v_add_f32 v17, 1.0, v17
    v_add_f32 v18, 1.0, v18
    ds_read_b64_tr_b16 v[52:53], v7 offset:38912
    s_waitcnt lgkmcnt(3)
    v_mfma_f32_32x32x16_bf16 v[80:95], v[36:39], a[72:75], v[80:95]
    v_add_f32 v19, 1.0, v19
    v_add_f32 v20, 1.0, v20
    ds_read_b64_tr_b16 v[54:55], v7 offset:39424
    v_mfma_f32_32x32x16_bf16 v[112:127], v[36:39], a[200:203], v[112:127]
    v_rcp_f32 v17, v17
    v_rcp_f32 v18, v18
    s_waitcnt lgkmcnt(2)
    v_mfma_f32_32x32x16_bf16 v[64:79], v[48:51], a[76:79], v[64:79]
    ds_read_b64_tr_b16 v[32:33], v6 offset:40960
    v_rcp_f32 v19, v19
    v_mfma_f32_32x32x16_bf16 v[96:111], v[48:51], a[204:207], v[96:111]
    v_rcp_f32 v20, v20
    s_nop 0
    ds_read_b64_tr_b16 v[34:35], v6 offset:41472
    v_mul_f32 v144, v21, v17
    s_waitcnt lgkmcnt(2)
    v_mfma_f32_32x32x16_bf16 v[80:95], v[52:55], a[76:79], v[80:95]
    v_mul_f32 v145, v22, v18
    ds_read_b64_tr_b16 v[36:37], v7 offset:40960
    v_mul_f32 v146, v23, v19
    v_mfma_f32_32x32x16_bf16 v[112:127], v[52:55], a[204:207], v[112:127]
    v_mul_f32 v147, v24, v20
    ds_read_b64_tr_b16 v[38:39], v7 offset:41472
    v_mul_f32 v17, v148, v148
    v_mul_f32 v18, v149, v149
    s_waitcnt lgkmcnt(2)
    v_mfma_f32_32x32x16_bf16 v[64:79], v[32:35], a[80:83], v[64:79]
    ds_read_b64_tr_b16 v[48:49], v6 offset:43008
    v_mul_f32 v19, v150, v150
    v_mul_f32 v20, v151, v151
    v_mfma_f32_32x32x16_bf16 v[96:111], v[32:35], a[208:211], v[96:111]
    v_fmaak_f32 v17, v17, v16, 0xc0135761
    ds_read_b64_tr_b16 v[50:51], v6 offset:43520
    v_fmaak_f32 v18, v18, v16, 0xc0135761
    v_fmaak_f32 v19, v19, v16, 0xc0135761
    s_waitcnt lgkmcnt(2)
    v_mfma_f32_32x32x16_bf16 v[80:95], v[36:39], a[80:83], v[80:95]
    ds_read_b64_tr_b16 v[52:53], v7 offset:43008
    v_fmaak_f32 v20, v20, v16, 0xc0135761
    v_mul_f32 v17, v17, v148
    v_mfma_f32_32x32x16_bf16 v[112:127], v[36:39], a[208:211], v[112:127]
    ds_read_b64_tr_b16 v[54:55], v7 offset:43520
    v_mul_f32 v18, v18, v149
    v_mul_f32 v19, v19, v150
    s_waitcnt lgkmcnt(2)
    v_mfma_f32_32x32x16_bf16 v[64:79], v[48:51], a[84:87], v[64:79]
    ds_read_b64_tr_b16 v[32:33], v6 offset:45056
    v_mul_f32 v20, v20, v151
    v_exp_f32 v17, v17
    v_mfma_f32_32x32x16_bf16 v[96:111], v[48:51], a[212:215], v[96:111]
    v_exp_f32 v18, v18
    ds_read_b64_tr_b16 v[34:35], v6 offset:45568
    v_exp_f32 v19, v19
    s_waitcnt lgkmcnt(2)
    v_mfma_f32_32x32x16_bf16 v[80:95], v[52:55], a[84:87], v[80:95]
    v_exp_f32 v20, v20
    ds_read_b64_tr_b16 v[36:37], v7 offset:45056
    v_mul_f32 v21, v148, v180
    v_mfma_f32_32x32x16_bf16 v[112:127], v[52:55], a[212:215], v[112:127]
    v_mul_f32 v22, v149, v181
    ds_read_b64_tr_b16 v[38:39], v7 offset:45568
    v_mul_f32 v23, v150, v182
    v_mul_f32 v24, v151, v183
    s_waitcnt lgkmcnt(2)
    v_mfma_f32_32x32x16_bf16 v[64:79], v[32:35], a[88:91], v[64:79]
    ds_read_b64_tr_b16 v[48:49], v6 offset:47104
    v_add_f32 v17, 1.0, v17
    v_add_f32 v18, 1.0, v18
    v_add_f32 v19, 1.0, v19
    v_mfma_f32_32x32x16_bf16 v[96:111], v[32:35], a[216:219], v[96:111]
    ds_read_b64_tr_b16 v[50:51], v6 offset:47616
    v_add_f32 v20, 1.0, v20
    v_rcp_f32 v17, v17
    ds_read_b64_tr_b16 v[52:53], v7 offset:47104
    s_waitcnt lgkmcnt(3)
    v_mfma_f32_32x32x16_bf16 v[80:95], v[36:39], a[88:91], v[80:95]
    v_rcp_f32 v18, v18
    v_rcp_f32 v19, v19
    v_mfma_f32_32x32x16_bf16 v[112:127], v[36:39], a[216:219], v[112:127]
    ds_read_b64_tr_b16 v[54:55], v7 offset:47616
    v_rcp_f32 v20, v20
    s_nop 0
    s_waitcnt lgkmcnt(0)
    s_waitcnt vmcnt(10)
    s_barrier
    buffer_load_dword v27, off, s[96:99], s31 sc1
    v_mfma_f32_32x32x16_bf16 v[64:79], v[48:51], a[92:95], v[64:79]
    s_add_u32 m0, s59, 0x8000
    s_add_u32 s60, s66, 0x200000
    buffer_load_dwordx4 v12, s[40:43], s60 offen offset:0 lds
    ds_read_b64_tr_b16 v[32:33], v6 offset:49152
    v_mul_f32 v148, v21, v17
    v_mul_f32 v149, v22, v18
    v_mul_f32 v150, v23, v19
    v_mfma_f32_32x32x16_bf16 v[96:111], v[48:51], a[220:223], v[96:111]
    ds_read_b64_tr_b16 v[34:35], v6 offset:49664
    v_mul_f32 v151, v24, v20
    v_cvt_pk_bf16_f32 v144, v144, v145
    v_mfma_f32_32x32x16_bf16 v[80:95], v[52:55], a[92:95], v[80:95]
    buffer_load_dwordx4 v13, s[40:43], s60 offen offset:1024 lds
    ds_read_b64_tr_b16 v[36:37], v7 offset:49152
    v_cvt_pk_bf16_f32 v145, v146, v147
    v_cvt_pk_bf16_f32 v146, v148, v149
    ds_read_b64_tr_b16 v[38:39], v7 offset:49664
    v_mfma_f32_32x32x16_bf16 v[112:127], v[52:55], a[220:223], v[112:127]
    v_cvt_pk_bf16_f32 v147, v150, v151
    buffer_store_dwordx4 v[144:147], v2, s[32:35], s67 offen offset:2048 sc1
    s_waitcnt lgkmcnt(2)
    v_mfma_f32_32x32x16_bf16 v[64:79], v[32:35], a[96:99], v[64:79]
    buffer_load_dwordx4 v14, s[40:43], s60 offen offset:2048 lds
    ds_read_b64_tr_b16 v[48:49], v6 offset:51200
    v_mul_f32 v17, v152, v152
    v_mul_f32 v18, v153, v153
    v_mfma_f32_32x32x16_bf16 v[96:111], v[32:35], a[224:227], v[96:111]
    ds_read_b64_tr_b16 v[50:51], v6 offset:51712
    v_mul_f32 v19, v154, v154
    v_mul_f32 v20, v155, v155
    s_waitcnt lgkmcnt(2)
    v_mfma_f32_32x32x16_bf16 v[80:95], v[36:39], a[96:99], v[80:95]
    buffer_load_dwordx4 v15, s[40:43], s60 offen offset:3072 lds
    ds_read_b64_tr_b16 v[52:53], v7 offset:51200
    v_fmaak_f32 v17, v17, v16, 0xc0135761
    v_fmaak_f32 v18, v18, v16, 0xc0135761
    v_mfma_f32_32x32x16_bf16 v[112:127], v[36:39], a[224:227], v[112:127]
    ds_read_b64_tr_b16 v[54:55], v7 offset:51712
    v_fmaak_f32 v19, v19, v16, 0xc0135761
    v_fmaak_f32 v20, v20, v16, 0xc0135761
    s_waitcnt lgkmcnt(2)
    v_mfma_f32_32x32x16_bf16 v[64:79], v[48:51], a[100:103], v[64:79]
    ds_read_b64_tr_b16 v[32:33], v6 offset:53248
    v_mul_f32 v17, v17, v152
    v_mul_f32 v18, v18, v153
    v_mul_f32 v19, v19, v154
    v_mfma_f32_32x32x16_bf16 v[96:111], v[48:51], a[228:231], v[96:111]
    ds_read_b64_tr_b16 v[34:35], v6 offset:53760
    v_mul_f32 v20, v20, v155
    v_exp_f32 v17, v17
    ds_read_b64_tr_b16 v[36:37], v7 offset:53248
    s_waitcnt lgkmcnt(3)
    v_mfma_f32_32x32x16_bf16 v[80:95], v[52:55], a[100:103], v[80:95]
    v_exp_f32 v18, v18
    v_exp_f32 v19, v19
    v_mfma_f32_32x32x16_bf16 v[112:127], v[52:55], a[228:231], v[112:127]
    ds_read_b64_tr_b16 v[38:39], v7 offset:53760
    v_exp_f32 v20, v20
    v_mul_f32 v21, v152, v184
    s_waitcnt lgkmcnt(2)
    v_mfma_f32_32x32x16_bf16 v[64:79], v[32:35], a[104:107], v[64:79]
    ds_read_b64_tr_b16 v[48:49], v6 offset:55296
    v_mul_f32 v22, v153, v185
    v_mul_f32 v23, v154, v186
    v_mul_f32 v24, v155, v187
    v_mfma_f32_32x32x16_bf16 v[96:111], v[32:35], a[232:235], v[96:111]
    ds_read_b64_tr_b16 v[50:51], v6 offset:55808
    v_add_f32 v17, 1.0, v17
    v_add_f32 v18, 1.0, v18
    ds_read_b64_tr_b16 v[52:53], v7 offset:55296
    s_waitcnt lgkmcnt(3)
    v_mfma_f32_32x32x16_bf16 v[80:95], v[36:39], a[104:107], v[80:95]
    v_add_f32 v19, 1.0, v19
    v_add_f32 v20, 1.0, v20
    ds_read_b64_tr_b16 v[54:55], v7 offset:55808
    v_mfma_f32_32x32x16_bf16 v[112:127], v[36:39], a[232:235], v[112:127]
    v_rcp_f32 v17, v17
    v_rcp_f32 v18, v18
    s_waitcnt lgkmcnt(2)
    v_mfma_f32_32x32x16_bf16 v[64:79], v[48:51], a[108:111], v[64:79]
    ds_read_b64_tr_b16 v[32:33], v6 offset:57344
    v_rcp_f32 v19, v19
    v_mfma_f32_32x32x16_bf16 v[96:111], v[48:51], a[236:239], v[96:111]
    v_rcp_f32 v20, v20
    s_nop 0
    ds_read_b64_tr_b16 v[34:35], v6 offset:57856
    v_mul_f32 v152, v21, v17
    s_waitcnt lgkmcnt(2)
    v_mfma_f32_32x32x16_bf16 v[80:95], v[52:55], a[108:111], v[80:95]
    v_mul_f32 v153, v22, v18
    ds_read_b64_tr_b16 v[36:37], v7 offset:57344
    v_mul_f32 v154, v23, v19
    v_mfma_f32_32x32x16_bf16 v[112:127], v[52:55], a[236:239], v[112:127]
    v_mul_f32 v155, v24, v20
    ds_read_b64_tr_b16 v[38:39], v7 offset:57856
    v_mul_f32 v17, v156, v156
    v_mul_f32 v18, v157, v157
    s_waitcnt lgkmcnt(2)
    v_mfma_f32_32x32x16_bf16 v[64:79], v[32:35], a[112:115], v[64:79]
    ds_read_b64_tr_b16 v[48:49], v6 offset:59392
    v_mul_f32 v19, v158, v158
    v_mul_f32 v20, v159, v159
    v_mfma_f32_32x32x16_bf16 v[96:111], v[32:35], a[240:243], v[96:111]
    v_fmaak_f32 v17, v17, v16, 0xc0135761
    ds_read_b64_tr_b16 v[50:51], v6 offset:59904
    v_fmaak_f32 v18, v18, v16, 0xc0135761
    v_fmaak_f32 v19, v19, v16, 0xc0135761
    s_waitcnt lgkmcnt(2)
    v_mfma_f32_32x32x16_bf16 v[80:95], v[36:39], a[112:115], v[80:95]
    ds_read_b64_tr_b16 v[52:53], v7 offset:59392
    v_fmaak_f32 v20, v20, v16, 0xc0135761
    v_mul_f32 v17, v17, v156
    v_mfma_f32_32x32x16_bf16 v[112:127], v[36:39], a[240:243], v[112:127]
    ds_read_b64_tr_b16 v[54:55], v7 offset:59904
    v_mul_f32 v18, v18, v157
    v_mul_f32 v19, v19, v158
    s_waitcnt lgkmcnt(2)
    v_mfma_f32_32x32x16_bf16 v[64:79], v[48:51], a[116:119], v[64:79]
    ds_read_b64_tr_b16 v[32:33], v6 offset:61440
    v_mul_f32 v20, v20, v159
    v_exp_f32 v17, v17
    v_mfma_f32_32x32x16_bf16 v[96:111], v[48:51], a[244:247], v[96:111]
    v_exp_f32 v18, v18
    ds_read_b64_tr_b16 v[34:35], v6 offset:61952
    v_exp_f32 v19, v19
    s_waitcnt lgkmcnt(2)
    v_mfma_f32_32x32x16_bf16 v[80:95], v[52:55], a[116:119], v[80:95]
    v_exp_f32 v20, v20
    ds_read_b64_tr_b16 v[36:37], v7 offset:61440
    v_mul_f32 v21, v156, v188
    v_mfma_f32_32x32x16_bf16 v[112:127], v[52:55], a[244:247], v[112:127]
    v_mul_f32 v22, v157, v189
    ds_read_b64_tr_b16 v[38:39], v7 offset:61952
    v_mul_f32 v23, v158, v190
    v_mul_f32 v24, v159, v191
    s_waitcnt lgkmcnt(2)
    v_mfma_f32_32x32x16_bf16 v[64:79], v[32:35], a[120:123], v[64:79]
    ds_read_b64_tr_b16 v[48:49], v6 offset:63488
    v_add_f32 v17, 1.0, v17
    v_add_f32 v18, 1.0, v18
    v_add_f32 v19, 1.0, v19
    v_mfma_f32_32x32x16_bf16 v[96:111], v[32:35], a[248:251], v[96:111]
    ds_read_b64_tr_b16 v[50:51], v6 offset:64000
    v_add_f32 v20, 1.0, v20
    v_rcp_f32 v17, v17
    ds_read_b64_tr_b16 v[52:53], v7 offset:63488
    s_waitcnt lgkmcnt(3)
    v_mfma_f32_32x32x16_bf16 v[80:95], v[36:39], a[120:123], v[80:95]
    v_rcp_f32 v18, v18
    v_rcp_f32 v19, v19
    v_mfma_f32_32x32x16_bf16 v[112:127], v[36:39], a[248:251], v[112:127]
    ds_read_b64_tr_b16 v[54:55], v7 offset:64000
    v_rcp_f32 v20, v20
    s_nop 0
    s_waitcnt lgkmcnt(0)
    s_waitcnt vmcnt(11)
    s_barrier
    s_waitcnt vmcnt(5)
    v_readfirstlane_b32 s74, v27
    s_nop 0
    s_cmp_ge_u32 s74, 8
    s_cbranch_scc1 L_pollx_kva
    s_mov_b32 s76, 0x10000
L_poll_kva:
    buffer_load_dword v27, off, s[96:99], s31 sc1
    s_waitcnt vmcnt(0)
    v_readfirstlane_b32 s74, v27
    s_sub_u32 s76, s76, 1
    s_cmp_eq_u32 s76, 0
    s_cbranch_scc1 L_pollx_kva
    s_cmp_ge_u32 s74, 8
    s_cbranch_scc1 L_pollx_kva
    s_sleep 2
    s_branch L_poll_kva
L_pollx_kva:
    v_mfma_f32_32x32x16_bf16 v[64:79], v[48:51], a[124:127], v[64:79]
    s_add_u32 m0, s59, 0xc000
    s_add_u32 s60, s66, 0x300000
    buffer_load_dwordx4 v12, s[40:43], s60 offen offset:0 lds
    ds_read_b64_tr_b16 v[32:33], v6 offset:0
    v_mul_f32 v156, v21, v17
    v_mul_f32 v157, v22, v18
    v_mul_f32 v158, v23, v19
    v_mfma_f32_32x32x16_bf16 v[96:111], v[48:51], a[252:255], v[96:111]
    buffer_load_dwordx4 v13, s[40:43], s60 offen offset:1024 lds
    ds_read_b64_tr_b16 v[34:35], v6 offset:512
    v_mul_f32 v159, v24, v20
    v_cvt_pk_bf16_f32 v152, v152, v153
    v_mfma_f32_32x32x16_bf16 v[80:95], v[52:55], a[124:127], v[80:95]
    buffer_load_dwordx4 v14, s[40:43], s60 offen offset:2048 lds
    ds_read_b64_tr_b16 v[36:37], v7 offset:0
    v_cvt_pk_bf16_f32 v153, v154, v155
    v_cvt_pk_bf16_f32 v154, v156, v157
    ds_read_b64_tr_b16 v[38:39], v7 offset:512
    v_mfma_f32_32x32x16_bf16 v[112:127], v[52:55], a[252:255], v[112:127]
    buffer_load_dwordx4 v15, s[40:43], s60 offen offset:3072 lds
    v_cvt_pk_bf16_f32 v155, v158, v159
    buffer_store_dwordx4 v[152:155], v2, s[32:35], s67 offen offset:3072 sc1
    s_waitcnt lgkmcnt(2)
    v_mfma_f32_32x32x16_bf16 v[128:143], v[32:35], a[0:3], 0
    s_lshl_b32 s61, s56, 12
    s_add_u32 m0, s61, 0
    s_add_u32 s61, s61, 0
    buffer_load_dwordx4 v2, s[48:51], s61 offen offset:0 sc1 lds
    ds_read_b64_tr_b16 v[48:49], v6 offset:2048
    v_mul_f32 v17, v192, v192
    v_mul_f32 v18, v193, v193
    v_mul_f32 v19, v194, v194
    v_mfma_f32_32x32x16_bf16 v[160:175], v[32:35], a[128:131], 0
    buffer_load_dwordx4 v2, s[48:51], s61 offen offset:1024 sc1 lds
    ds_read_b64_tr_b16 v[50:51], v6 offset:2560
    v_mul_f32 v20, v195, v195
    v_fmaak_f32 v17, v17, v16, 0xc0135761
    v_fmaak_f32 v18, v18, v16, 0xc0135761
    s_waitcnt lgkmcnt(2)
    v_mfma_f32_32x32x16_bf16 v[144:159], v[36:39], a[0:3], 0
    buffer_load_dwordx4 v2, s[48:51], s61 offen offset:2048 sc1 lds
    ds_read_b64_tr_b16 v[52:53], v7 offset:2048
    v_fmaak_f32 v19, v19, v16, 0xc0135761
    v_fmaak_f32 v20, v20, v16, 0xc0135761
    v_mfma_f32_32x32x16_bf16 v[176:191], v[36:39], a[128:131], 0
    buffer_load_dwordx4 v2, s[48:51], s61 offen offset:3072 sc1 lds
    v_mul_f32 v17, v17, v192
    ds_read_b64_tr_b16 v[54:55], v7 offset:2560
    v_mul_f32 v18, v18, v193
    v_mul_f32 v19, v19, v194
    s_waitcnt lgkmcnt(2)
    v_mfma_f32_32x32x16_bf16 v[128:143], v[48:51], a[4:7], v[128:143]
    s_lshl_b32 s61, s56, 12
    s_add_u32 m0, s61, 0x4000
    s_add_u32 s61, s61, 0x4000
    buffer_load_dwordx4 v2, s[48:51], s61 offen offset:0 sc1 lds
    ds_read_b64_tr_b16 v[32:33], v6 offset:4096
    v_mul_f32 v20, v20, v195
    v_exp_f32 v17, v17
    v_exp_f32 v18, v18
    v_mfma_f32_32x32x16_bf16 v[160:175], v[48:51], a[132:135], v[160:175]
    buffer_load_dwordx4 v2, s[48:51], s61 offen offset:1024 sc1 lds
    ds_read_b64_tr_b16 v[34:35], v6 offset:4608
    v_exp_f32 v19, v19
    v_exp_f32 v20, v20
    s_waitcnt lgkmcnt(2)
    v_mfma_f32_32x32x16_bf16 v[144:159], v[52:55], a[4:7], v[144:159]
    buffer_load_dwordx4 v2, s[48:51], s61 offen offset:2048 sc1 lds
    v_mul_f32 v21, v192, v224
    ds_read_b64_tr_b16 v[36:37], v7 offset:4096
    v_mul_f32 v22, v193, v225
    v_mul_f32 v23, v194, v226
    v_mfma_f32_32x32x16_bf16 v[176:191], v[52:55], a[132:135], v[176:191]
    v_mul_f32 v24, v195, v227
    ds_read_b64_tr_b16 v[38:39], v7 offset:4608
    v_add_f32 v17, 1.0, v17
    v_add_f32 v18, 1.0, v18
    v_add_f32 v19, 1.0, v19
    s_waitcnt lgkmcnt(2)
    v_mfma_f32_32x32x16_bf16 v[128:143], v[32:35], a[8:11], v[128:143]
    buffer_load_dwordx4 v2, s[48:51], s61 offen offset:3072 sc1 lds
    ds_read_b64_tr_b16 v[48:49], v6 offset:6144
    v_add_f32 v20, 1.0, v20
    v_rcp_f32 v17, v17
    v_rcp_f32 v18, v18
    v_mfma_f32_32x32x16_bf16 v[160:175], v[32:35], a[136:139], v[160:175]
    ds_read_b64_tr_b16 v[50:51], v6 offset:6656
    v_rcp_f32 v19, v19
    v_rcp_f32 v20, v20
    s_waitcnt lgkmcnt(2)
    v_mfma_f32_32x32x16_bf16 v[144:159], v[36:39], a[8:11], v[144:159]
    s_lshl_b32 s61, s56, 12
    s_add_u32 m0, s61, 0x10000
    s_add_u32 s61, s61, 0
    buffer_load_dwordx4 v2, s[52:55], s61 offen offset:0 sc1 lds
    s_nop 0
    ds_read_b64_tr_b16 v[52:53], v7 offset:6144
    v_mul_f32 v192, v21, v17
    v_mul_f32 v193, v22, v18
    v_mfma_f32_32x32x16_bf16 v[176:191], v[36:39], a[136:139], v[176:191]
    v_mul_f32 v194, v23, v19
    ds_read_b64_tr_b16 v[54:55], v7 offset:6656
    v_mul_f32 v195, v24, v20
    v_mul_f32 v17, v196, v196
    v_mul_f32 v18, v197, v197
    s_waitcnt lgkmcnt(2)
    v_mfma_f32_32x32x16_bf16 v[128:143], v[48:51], a[12:15], v[128:143]
    buffer_load_dwordx4 v2, s[52:55], s61 offen offset:1024 sc1 lds
    ds_read_b64_tr_b16 v[32:33], v6 offset:8192
    v_mul_f32 v19, v198, v198
    v_mul_f32 v20, v199, v199
    v_fmaak_f32 v17, v17, v16, 0xc0135761
    ds_read_b64_tr_b16 v[34:35], v6 offset:8704
    v_mfma_f32_32x32x16_bf16 v[160:175], v[48:51], a[140:143], v[160:175]
    v_fmaak_f32 v18, v18, v16, 0xc0135761
    v_fmaak_f32 v19, v19, v16, 0xc0135761
    v_fmaak_f32 v20, v20, v16, 0xc0135761
    ds_read_b64_tr_b16 v[36:37], v7 offset:8192
    s_waitcnt lgkmcnt(3)
    v_mfma_f32_32x32x16_bf16 v[144:159], v[52:55], a[12:15], v[144:159]
    buffer_load_dwordx4 v2, s[52:55], s61 offen offset:2048 sc1 lds
    v_mul_f32 v17, v17, v196
    v_mul_f32 v18, v18, v197
    v_mul_f32 v19, v19, v198
    ds_read_b64_tr_b16 v[38:39], v7 offset:8704
    v_mul_f32 v20, v20, v199
    v_mfma_f32_32x32x16_bf16 v[176:191], v[52:55], a[140:143], v[176:191]
    v_exp_f32 v17, v17
    v_exp_f32 v18, v18
    s_waitcnt lgkmcnt(2)
    v_mfma_f32_32x32x16_bf16 v[128:143], v[32:35], a[16:19], v[128:143]
    buffer_load_dwordx4 v2, s[52:55], s61 offen offset:3072 sc1 lds
    ds_read_b64_tr_b16 v[48:49], v6 offset:10240
    v_exp_f32 v19, v19
    v_exp_f32 v20, v20
    v_mfma_f32_32x32x16_bf16 v[160:175], v[32:35], a[144:147], v[160:175]
    v_mul_f32 v21, v196, v228
    ds_read_b64_tr_b16 v[50:51], v6 offset:10752
    v_mul_f32 v22, v197, v229
    v_mul_f32 v23, v198, v230
    v_mul_f32 v24, v199, v231
    s_waitcnt lgkmcnt(2)
    v_mfma_f32_32x32x16_bf16 v[144:159], v[36:39], a[16:19], v[144:159]
    s_lshl_b32 s61, s56, 12
    s_add_u32 m0, s61, 0x8000
    s_add_u32 s61, s61, 0x8000
    buffer_load_dwordx4 v2, s[48:51], s61 offen offset:0 sc1 lds
    ds_read_b64_tr_b16 v[52:53], v7 offset:10240
    v_add_f32 v17, 1.0, v17
    v_add_f32 v18, 1.0, v18
    v_add_f32 v19, 1.0, v19
    ds_read_b64_tr_b16 v[54:55], v7 offset:10752
    v_mfma_f32_32x32x16_bf16 v[176:191], v[36:39], a[144:147], v[176:191]
    v_add_f32 v20, 1.0, v20
    v_rcp_f32 v17, v17
    v_rcp_f32 v18, v18
    s_waitcnt lgkmcnt(2)
    v_mfma_f32_32x32x16_bf16 v[128:143], v[48:51], a[20:23], v[128:143]
    buffer_load_dwordx4 v2, s[48:51], s61 offen offset:1024 sc1 lds
    ds_read_b64_tr_b16 v[32:33], v6 offset:12288
    v_rcp_f32 v19, v19
    v_rcp_f32 v20, v20
    v_mfma_f32_32x32x16_bf16 v[160:175], v[48:51], a[148:151], v[160:175]
    s_nop 0
    ds_read_b64_tr_b16 v[34:35], v6 offset:12800
    v_mul_f32 v196, v21, v17
    v_mul_f32 v197, v22, v18
    v_mul_f32 v198, v23, v19
    s_waitcnt lgkmcnt(2)
    v_mfma_f32_32x32x16_bf16 v[144:159], v[52:55], a[20:23], v[144:159]
    buffer_load_dwordx4 v2, s[48:51], s61 offen offset:2048 sc1 lds
    ds_read_b64_tr_b16 v[36:37], v7 offset:12288
    v_mul_f32 v199, v24, v20
    v_cvt_pk_bf16_f32 v192, v192, v193
    v_cvt_pk_bf16_f32 v193, v194, v195
    v_mfma_f32_32x32x16_bf16 v[176:191], v[52:55], a[148:151], v[176:191]
    ds_read_b64_tr_b16 v[38:39], v7 offset:12800
    v_cvt_pk_bf16_f32 v194, v196, v197
    v_cvt_pk_bf16_f32 v195, v198, v199
    buffer_store_dwordx4 v[192:195], v2, s[32:35], s68 offen offset:0 sc1
    s_waitcnt lgkmcnt(2)
    v_mfma_f32_32x32x16_bf16 v[128:143], v[32:35], a[24:27], v[128:143]
    buffer_load_dwordx4 v2, s[48:51], s61 offen offset:3072 sc1 lds
    ds_read_b64_tr_b16 v[48:49], v6 offset:14336
    v_mul_f32 v17, v200, v200
    v_mul_f32 v18, v201, v201
    v_mul_f32 v19, v202, v202
    v_mfma_f32_32x32x16_bf16 v[160:175], v[32:35], a[152:155], v[160:175]
    ds_read_b64_tr_b16 v[50:51], v6 offset:14848
    v_mul_f32 v20, v203, v203
    v_fmaak_f32 v17, v17, v16, 0xc0135761
    v_fmaak_f32 v18, v18, v16, 0xc0135761
    s_waitcnt lgkmcnt(2)
    v_mfma_f32_32x32x16_bf16 v[144:159], v[36:39], a[24:27], v[144:159]
    s_lshl_b32 s61, s56, 12
    s_add_u32 m0, s61, 0x14000
    s_add_u32 s61, s61, 0x4000
    buffer_load_dwordx4 v2, s[52:55], s61 offen offset:0 sc1 lds
    ds_read_b64_tr_b16 v[52:53], v7 offset:14336
    v_fmaak_f32 v19, v19, v16, 0xc0135761
    v_fmaak_f32 v20, v20, v16, 0xc0135761
    v_mul_f32 v17, v17, v200
    v_mfma_f32_32x32x16_bf16 v[176:191], v[36:39], a[152:155], v[176:191]
    ds_read_b64_tr_b16 v[54:55], v7 offset:14848
    v_mul_f32 v18, v18, v201
    v_mul_f32 v19, v19, v202
    v_mul_f32 v20, v20, v203
    s_waitcnt lgkmcnt(0)
    s_barrier
    v_mfma_f32_32x32x16_bf16 v[128:143], v[48:51], a[28:31], v[128:143]
    buffer_load_dwordx4 v2, s[52:55], s61 offen offset:1024 sc1 lds
    ds_read_b64_tr_b16 v[32:33], v6 offset:16384
    v_exp_f32 v17, v17
    v_exp_f32 v18, v18
    v_mfma_f32_32x32x16_bf16 v[160:175], v[48:51], a[156:159], v[160:175]
    v_exp_f32 v19, v19
    ds_read_b64_tr_b16 v[34:35], v6 offset:16896
    v_exp_f32 v20, v20
    v_mfma_f32_32x32x16_bf16 v[144:159], v[52:55], a[28:31], v[144:159]
    buffer_load_dwordx4 v2, s[52:55], s61 offen offset:2048 sc1 lds
    v_mul_f32 v21, v200, v232
    v_mul_f32 v22, v201, v233
    ds_read_b64_tr_b16 v[36:37], v7 offset:16384
    v_mul_f32 v23, v202, v234
    v_mul_f32 v24, v203, v235
    v_mfma_f32_32x32x16_bf16 v[176:191], v[52:55], a[156:159], v[176:191]
    v_add_f32 v17, 1.0, v17
    ds_read_b64_tr_b16 v[38:39], v7 offset:16896
    v_add_f32 v18, 1.0, v18
    v_add_f32 v19, 1.0, v19
    v_add_f32 v20, 1.0, v20
    s_waitcnt lgkmcnt(2)
    v_mfma_f32_32x32x16_bf16 v[128:143], v[32:35], a[32:35], v[128:143]
    buffer_load_dwordx4 v2, s[52:55], s61 offen offset:3072 sc1 lds
    ds_read_b64_tr_b16 v[48:49], v6 offset:18432
    v_rcp_f32 v17, v17
    v_rcp_f32 v18, v18
    v_mfma_f32_32x32x16_bf16 v[160:175], v[32:35], a[160:163], v[160:175]
    v_rcp_f32 v19, v19
    ds_read_b64_tr_b16 v[50:51], v6 offset:18944
    v_rcp_f32 v20, v20
    s_waitcnt lgkmcnt(2)
    v_mfma_f32_32x32x16_bf16 v[144:159], v[36:39], a[32:35], v[144:159]
    s_nop 0
    v_mul_f32 v200, v21, v17
    ds_read_b64_tr_b16 v[52:53], v7 offset:18432
    v_mul_f32 v201, v22, v18
    v_mfma_f32_32x32x16_bf16 v[176:191], v[36:39], a[160:163], v[176:191]
    v_mul_f32 v202, v23, v19
    v_mul_f32 v203, v24, v20
    ds_read_b64_tr_b16 v[54:55], v7 offset:18944
    v_mul_f32 v17, v204, v204
    v_mul_f32 v18, v205, v205
    s_waitcnt lgkmcnt(2)
    v_mfma_f32_32x32x16_bf16 v[128:143], v[48:51], a[36:39], v[128:143]
    ds_read_b64_tr_b16 v[32:33], v6 offset:20480
    v_mul_f32 v19, v206, v206
    v_mul_f32 v20, v207, v207
    v_fmaak_f32 v17, v17, v16, 0xc0135761
    ds_read_b64_tr_b16 v[34:35], v6 offset:20992
    v_mfma_f32_32x32x16_bf16 v[160:175], v[48:51], a[164:167], v[160:175]
    v_fmaak_f32 v18, v18, v16, 0xc0135761
    v_fmaak_f32 v19, v19, v16, 0xc0135761
    v_fmaak_f32 v20, v20, v16, 0xc0135761
    ds_read_b64_tr_b16 v[36:37], v7 offset:20480
    s_waitcnt lgkmcnt(3)
    v_mfma_f32_32x32x16_bf16 v[144:159], v[52:55], a[36:39], v[144:159]
    v_mul_f32 v17, v17, v204
    v_mul_f32 v18, v18, v205
    v_mul_f32 v19, v19, v206
    ds_read_b64_tr_b16 v[38:39], v7 offset:20992
    v_mul_f32 v20, v20, v207
    v_mfma_f32_32x32x16_bf16 v[176:191], v[52:55], a[164:167], v[176:191]
    v_exp_f32 v17, v17
    v_exp_f32 v18, v18
    s_waitcnt lgkmcnt(2)
    v_mfma_f32_32x32x16_bf16 v[128:143], v[32:35], a[40:43], v[128:143]
    ds_read_b64_tr_b16 v[48:49], v6 offset:22528
    v_exp_f32 v19, v19
    v_exp_f32 v20, v20
    v_mfma_f32_32x32x16_bf16 v[160:175], v[32:35], a[168:171], v[160:175]
    v_mul_f32 v21, v204, v236
    ds_read_b64_tr_b16 v[50:51], v6 offset:23040
    v_mul_f32 v22, v205, v237
    v_mul_f32 v23, v206, v238
    v_mul_f32 v24, v207, v239
    s_waitcnt lgkmcnt(2)
    v_mfma_f32_32x32x16_bf16 v[144:159], v[36:39], a[40:43], v[144:159]
    ds_read_b64_tr_b16 v[52:53], v7 offset:22528
    v_add_f32 v17, 1.0, v17
    v_add_f32 v18, 1.0, v18
    v_add_f32 v19, 1.0, v19
    ds_read_b64_tr_b16 v[54:55], v7 offset:23040
    v_mfma_f32_32x32x16_bf16 v[176:191], v[36:39], a[168:171], v[176:191]
    v_add_f32 v20, 1.0, v20
    v_rcp_f32 v17, v17
    v_rcp_f32 v18, v18
    s_waitcnt lgkmcnt(2)
    v_mfma_f32_32x32x16_bf16 v[128:143], v[48:51], a[44:47], v[128:143]
    ds_read_b64_tr_b16 v[32:33], v6 offset:24576
    v_rcp_f32 v19, v19
    v_rcp_f32 v20, v20
    v_mfma_f32_32x32x16_bf16 v[160:175], v[48:51], a[172:175], v[160:175]
    s_nop 0
    ds_read_b64_tr_b16 v[34:35], v6 offset:25088
    v_mul_f32 v204, v21, v17
    v_mul_f32 v205, v22, v18
    v_mul_f32 v206, v23, v19
    s_waitcnt lgkmcnt(2)
    v_mfma_f32_32x32x16_bf16 v[144:159], v[52:55], a[44:47], v[144:159]
    ds_read_b64_tr_b16 v[36:37], v7 offset:24576
    v_mul_f32 v207, v24, v20
    v_cvt_pk_bf16_f32 v200, v200, v201
    v_cvt_pk_bf16_f32 v201, v202, v203
    v_mfma_f32_32x32x16_bf16 v[176:191], v[52:55], a[172:175], v[176:191]
    ds_read_b64_tr_b16 v[38:39], v7 offset:25088
    v_cvt_pk_bf16_f32 v202, v204, v205
    v_cvt_pk_bf16_f32 v203, v206, v207
    buffer_store_dwordx4 v[200:203], v2, s[32:35], s68 offen offset:1024 sc1
    s_waitcnt lgkmcnt(2)
    v_mfma_f32_32x32x16_bf16 v[128:143], v[32:35], a[48:51], v[128:143]
    ds_read_b64_tr_b16 v[48:49], v6 offset:26624
    v_mul_f32 v17, v208, v208
    v_mul_f32 v18, v209, v209
    v_mul_f32 v19, v210, v210
    v_mfma_f32_32x32x16_bf16 v[160:175], v[32:35], a[176:179], v[160:175]
    ds_read_b64_tr_b16 v[50:51], v6 offset:27136
    v_mul_f32 v20, v211, v211
    v_fmaak_f32 v17, v17, v16, 0xc0135761
    v_fmaak_f32 v18, v18, v16, 0xc0135761
    s_waitcnt lgkmcnt(2)
    v_mfma_f32_32x32x16_bf16 v[144:159], v[36:39], a[48:51], v[144:159]
    ds_read_b64_tr_b16 v[52:53], v7 offset:26624
    v_fmaak_f32 v19, v19, v16, 0xc0135761
    v_fmaak_f32 v20, v20, v16, 0xc0135761
    v_mul_f32 v17, v17, v208
    v_mfma_f32_32x32x16_bf16 v[176:191], v[36:39], a[176:179], v[176:191]
    ds_read_b64_tr_b16 v[54:55], v7 offset:27136
    v_mul_f32 v18, v18, v209
    v_mul_f32 v19, v19, v210
    v_mul_f32 v20, v20, v211
    s_waitcnt lgkmcnt(2)
    v_mfma_f32_32x32x16_bf16 v[128:143], v[48:51], a[52:55], v[128:143]
    ds_read_b64_tr_b16 v[32:33], v6 offset:28672
    v_exp_f32 v17, v17
    v_exp_f32 v18, v18
    v_mfma_f32_32x32x16_bf16 v[160:175], v[48:51], a[180:183], v[160:175]
    v_exp_f32 v19, v19
    ds_read_b64_tr_b16 v[34:35], v6 offset:29184
    v_exp_f32 v20, v20
    s_waitcnt lgkmcnt(2)
    v_mfma_f32_32x32x16_bf16 v[144:159], v[52:55], a[52:55], v[144:159]
    v_mul_f32 v21, v208, v240
    v_mul_f32 v22, v209, v241
    ds_read_b64_tr_b16 v[36:37], v7 offset:28672
    v_mul_f32 v23, v210, v242
    v_mul_f32 v24, v211, v243
    v_mfma_f32_32x32x16_bf16 v[176:191], v[52:55], a[180:183], v[176:191]
    v_add_f32 v17, 1.0, v17
    ds_read_b64_tr_b16 v[38:39], v7 offset:29184
    v_add_f32 v18, 1.0, v18
    v_add_f32 v19, 1.0, v19
    v_add_f32 v20, 1.0, v20
    s_waitcnt lgkmcnt(2)
    v_mfma_f32_32x32x16_bf16 v[128:143], v[32:35], a[56:59], v[128:143]
    ds_read_b64_tr_b16 v[48:49], v6 offset:30720
    v_rcp_f32 v17, v17
    v_rcp_f32 v18, v18
    v_mfma_f32_32x32x16_bf16 v[160:175], v[32:35], a[184:187], v[160:175]
    v_rcp_f32 v19, v19
    ds_read_b64_tr_b16 v[50:51], v6 offset:31232
    v_rcp_f32 v20, v20
    s_waitcnt lgkmcnt(2)
    v_mfma_f32_32x32x16_bf16 v[144:159], v[36:39], a[56:59], v[144:159]
    s_nop 0
    v_mul_f32 v208, v21, v17
    ds_read_b64_tr_b16 v[52:53], v7 offset:30720
    v_mul_f32 v209, v22, v18
    v_mul_f32 v210, v23, v19
    v_mfma_f32_32x32x16_bf16 v[176:191], v[36:39], a[184:187], v[176:191]
    v_mul_f32 v211, v24, v20
    ds_read_b64_tr_b16 v[54:55], v7 offset:31232
    v_mul_f32 v17, v212, v212
    v_mul_f32 v18, v213, v213
    v_mul_f32 v19, v214, v214
    s_waitcnt lgkmcnt(0)
    s_waitcnt vmcnt(27)
    s_barrier
    v_mfma_f32_32x32x16_bf16 v[128:143], v[48:51], a[60:63], v[128:143]
    ds_read_b64_tr_b16 v[32:33], v6 offset:32768
    v_mul_f32 v20, v215, v215
    v_fmaak_f32 v17, v17, v16, 0xc0135761
    v_fmaak_f32 v18, v18, v16, 0xc0135761
    ds_read_b64_tr_b16 v[34:35], v6 offset:33280
    v_mfma_f32_32x32x16_bf16 v[160:175], v[48:51], a[188:191], v[160:175]
    v_fmaak_f32 v19, v19, v16, 0xc0135761
    v_fmaak_f32 v20, v20, v16, 0xc0135761
    v_mul_f32 v17, v17, v212
    ds_read_b64_tr_b16 v[36:37], v7 offset:32768
    v_mul_f32 v18, v18, v213
    v_mfma_f32_32x32x16_bf16 v[144:159], v[52:55], a[60:63], v[144:159]
    v_mul_f32 v19, v19, v214
    v_mul_f32 v20, v20, v215
    ds_read_b64_tr_b16 v[38:39], v7 offset:33280
    v_exp_f32 v17, v17
    v_mfma_f32_32x32x16_bf16 v[176:191], v[52:55], a[188:191], v[176:191]
    v_exp_f32 v18, v18
    v_exp_f32 v19, v19
    s_waitcnt lgkmcnt(2)
    v_mfma_f32_32x32x16_bf16 v[128:143], v[32:35], a[64:67], v[128:143]
    ds_read_b64_tr_b16 v[48:49], v6 offset:34816
    v_exp_f32 v20, v20
    v_mul_f32 v21, v212, v244
    v_mul_f32 v22, v213, v245
    v_mfma_f32_32x32x16_bf16 v[160:175], v[32:35], a[192:195], v[160:175]
    ds_read_b64_tr_b16 v[50:51], v6 offset:35328
    v_mul_f32 v23, v214, v246
    v_mul_f32 v24, v215, v247
    v_add_f32 v17, 1.0, v17
    s_waitcnt lgkmcnt(2)
    v_mfma_f32_32x32x16_bf16 v[144:159], v[36:39], a[64:67], v[144:159]
    ds_read_b64_tr_b16 v[52:53], v7 offset:34816
    v_add_f32 v18, 1.0, v18
    v_add_f32 v19, 1.0, v19
    v_add_f32 v20, 1.0, v20
    ds_read_b64_tr_b16 v[54:55], v7 offset:35328
    v_mfma_f32_32x32x16_bf16 v[176:191], v[36:39], a[192:195], v[176:191]
    v_rcp_f32 v17, v17
    v_rcp_f32 v18, v18
    s_waitcnt lgkmcnt(2)
    v_mfma_f32_32x32x16_bf16 v[128:143], v[48:51], a[68:71], v[128:143]
    ds_read_b64_tr_b16 v[32:33], v6 offset:36864
    v_rcp_f32 v19, v19
    v_rcp_f32 v20, v20
    v_mfma_f32_32x32x16_bf16 v[160:175], v[48:51], a[196:199], v[160:175]
    s_nop 0
    ds_read_b64_tr_b16 v[34:35], v6 offset:37376
    v_mul_f32 v212, v21, v17
    v_mul_f32 v213, v22, v18
    v_mul_f32 v214, v23, v19
    s_waitcnt lgkmcnt(2)
    v_mfma_f32_32x32x16_bf16 v[144:159], v[52:55], a[68:71], v[144:159]
    ds_read_b64_tr_b16 v[36:37], v7 offset:36864
    v_mul_f32 v215, v24, v20
    v_cvt_pk_bf16_f32 v208, v208, v209
    v_cvt_pk_bf16_f32 v209, v210, v211
    v_mfma_f32_32x32x16_bf16 v[176:191], v[52:55], a[196:199], v[176:191]
    ds_read_b64_tr_b16 v[38:39], v7 offset:37376
    v_cvt_pk_bf16_f32 v210, v212, v213
    v_cvt_pk_bf16_f32 v211, v214, v215
    buffer_store_dwordx4 v[208:211], v2, s[32:35], s68 offen offset:2048 sc1
    s_waitcnt lgkmcnt(2)
    v_mfma_f32_32x32x16_bf16 v[128:143], v[32:35], a[72:75], v[128:143]
    ds_read_b64_tr_b16 v[48:49], v6 offset:38912
    v_mul_f32 v17, v216, v216
    v_mul_f32 v18, v217, v217
    v_mul_f32 v19, v218, v218
    v_mfma_f32_32x32x16_bf16 v[160:175], v[32:35], a[200:203], v[160:175]
    ds_read_b64_tr_b16 v[50:51], v6 offset:39424
    v_mul_f32 v20, v219, v219
    v_fmaak_f32 v17, v17, v16, 0xc0135761
    v_fmaak_f32 v18, v18, v16, 0xc0135761
    s_waitcnt lgkmcnt(2)
    v_mfma_f32_32x32x16_bf16 v[144:159], v[36:39], a[72:75], v[144:159]
    ds_read_b64_tr_b16 v[52:53], v7 offset:38912
    v_fmaak_f32 v19, v19, v16, 0xc0135761
    v_fmaak_f32 v20, v20, v16, 0xc0135761
    v_mul_f32 v17, v17, v216
    v_mfma_f32_32x32x16_bf16 v[176:191], v[36:39], a[200:203], v[176:191]
    ds_read_b64_tr_b16 v[54:55], v7 offset:39424
    v_mul_f32 v18, v18, v217
    v_mul_f32 v19, v19, v218
    v_mul_f32 v20, v20, v219
    s_waitcnt lgkmcnt(2)
    v_mfma_f32_32x32x16_bf16 v[128:143], v[48:51], a[76:79], v[128:143]
    ds_read_b64_tr_b16 v[32:33], v6 offset:40960
    v_exp_f32 v17, v17
    v_exp_f32 v18, v18
    v_mfma_f32_32x32x16_bf16 v[160:175], v[48:51], a[204:207], v[160:175]
    v_exp_f32 v19, v19
    ds_read_b64_tr_b16 v[34:35], v6 offset:41472
    v_exp_f32 v20, v20
    s_waitcnt lgkmcnt(2)
    v_mfma_f32_32x32x16_bf16 v[144:159], v[52:55], a[76:79], v[144:159]
    v_mul_f32 v21, v216, v248
    v_mul_f32 v22, v217, v249
    ds_read_b64_tr_b16 v[36:37], v7 offset:40960
    v_mul_f32 v23, v218, v250
    v_mul_f32 v24, v219, v251
    v_mfma_f32_32x32x16_bf16 v[176:191], v[52:55], a[204:207], v[176:191]
    v_add_f32 v17, 1.0, v17
    ds_read_b64_tr_b16 v[38:39], v7 offset:41472
    v_add_f32 v18, 1.0, v18
    v_add_f32 v19, 1.0, v19
    v_add_f32 v20, 1.0, v20
    s_waitcnt lgkmcnt(2)
    v_mfma_f32_32x32x16_bf16 v[128:143], v[32:35], a[80:83], v[128:143]
    ds_read_b64_tr_b16 v[48:49], v6 offset:43008
    v_rcp_f32 v17, v17
    v_rcp_f32 v18, v18
    v_mfma_f32_32x32x16_bf16 v[160:175], v[32:35], a[208:211], v[160:175]
    v_rcp_f32 v19, v19
    ds_read_b64_tr_b16 v[50:51], v6 offset:43520
    v_rcp_f32 v20, v20
    s_waitcnt lgkmcnt(2)
    v_mfma_f32_32x32x16_bf16 v[144:159], v[36:39], a[80:83], v[144:159]
    s_nop 0
    v_mul_f32 v216, v21, v17
    ds_read_b64_tr_b16 v[52:53], v7 offset:43008
    v_mul_f32 v217, v22, v18
    v_mul_f32 v218, v23, v19
    v_mfma_f32_32x32x16_bf16 v[176:191], v[36:39], a[208:211], v[176:191]
    v_mul_f32 v219, v24, v20
    ds_read_b64_tr_b16 v[54:55], v7 offset:43520
    v_mul_f32 v17, v220, v220
    v_mul_f32 v18, v221, v221
    v_mul_f32 v19, v222, v222
    s_waitcnt lgkmcnt(2)
    v_mfma_f32_32x32x16_bf16 v[128:143], v[48:51], a[84:87], v[128:143]
    ds_read_b64_tr_b16 v[32:33], v6 offset:45056
    v_mul_f32 v20, v223, v223
    v_fmaak_f32 v17, v17, v16, 0xc0135761
    v_fmaak_f32 v18, v18, v16, 0xc0135761
    ds_read_b64_tr_b16 v[34:35], v6 offset:45568
    v_mfma_f32_32x32x16_bf16 v[160:175], v[48:51], a[212:215], v[160:175]
    v_fmaak_f32 v19, v19, v16, 0xc0135761
    v_fmaak_f32 v20, v20, v16, 0xc0135761
    v_mul_f32 v17, v17, v220
    ds_read_b64_tr_b16 v[36:37], v7 offset:45056
    v_mul_f32 v18, v18, v221
    s_waitcnt lgkmcnt(3)
    v_mfma_f32_32x32x16_bf16 v[144:159], v[52:55], a[84:87], v[144:159]
    v_mul_f32 v19, v19, v222
    v_mul_f32 v20, v20, v223
    ds_read_b64_tr_b16 v[38:39], v7 offset:45568
    v_exp_f32 v17, v17
    v_mfma_f32_32x32x16_bf16 v[176:191], v[52:55], a[212:215], v[176:191]
    v_exp_f32 v18, v18
    v_exp_f32 v19, v19
    s_waitcnt lgkmcnt(2)
    v_mfma_f32_32x32x16_bf16 v[128:143], v[32:35], a[88:91], v[128:143]
    ds_read_b64_tr_b16 v[48:49], v6 offset:47104
    v_exp_f32 v20, v20
    v_mul_f32 v21, v220, v252
    v_mul_f32 v22, v221, v253
    v_mfma_f32_32x32x16_bf16 v[160:175], v[32:35], a[216:219], v[160:175]
    ds_read_b64_tr_b16 v[50:51], v6 offset:47616
    v_mul_f32 v23, v222, v254
    v_mul_f32 v24, v223, v255
    v_add_f32 v17, 1.0, v17
    ds_read_b64_tr_b16 v[52:53], v7 offset:47104
    s_waitcnt lgkmcnt(3)
    v_mfma_f32_32x32x16_bf16 v[144:159], v[36:39], a[88:91], v[144:159]
    v_add_f32 v18, 1.0, v18
    v_add_f32 v19, 1.0, v19
    v_add_f32 v20, 1.0, v20
    ds_read_b64_tr_b16 v[54:55], v7 offset:47616
    v_rcp_f32 v17, v17
    v_mfma_f32_32x32x16_bf16 v[176:191], v[36:39], a[216:219], v[176:191]
    v_rcp_f32 v18, v18
    v_rcp_f32 v19, v19
    s_waitcnt lgkmcnt(0)
    s_waitcnt vmcnt(24)
    s_barrier
    v_mfma_f32_32x32x16_bf16 v[128:143], v[48:51], a[92:95], v[128:143]
    s_lshl_b32 s61, s56, 12
    s_add_u32 m0, s61, 0xc000
    s_add_u32 s61, s61, 0xc000
    buffer_load_dwordx4 v2, s[48:51], s61 offen offset:0 sc1 lds
    ds_read_b64_tr_b16 v[32:33], v6 offset:49152
    v_rcp_f32 v20, v20
    s_nop 0
    v_mul_f32 v220, v21, v17
    v_mfma_f32_32x32x16_bf16 v[160:175], v[48:51], a[220:223], v[160:175]
    ds_read_b64_tr_b16 v[34:35], v6 offset:49664
    v_mul_f32 v221, v22, v18
    v_mul_f32 v222, v23, v19
    v_mul_f32 v223, v24, v20
    v_mfma_f32_32x32x16_bf16 v[144:159], v[52:55], a[92:95], v[144:159]
    buffer_load_dwordx4 v2, s[48:51], s61 offen offset:1024 sc1 lds
    ds_read_b64_tr_b16 v[36:37], v7 offset:49152
    v_cvt_pk_bf16_f32 v216, v216, v217
    v_cvt_pk_bf16_f32 v217, v218, v219
    v_cvt_pk_bf16_f32 v218, v220, v221
    ds_read_b64_tr_b16 v[38:39], v7 offset:49664
    v_mfma_f32_32x32x16_bf16 v[176:191], v[52:55], a[220:223], v[176:191]
    v_cvt_pk_bf16_f32 v219, v222, v223
    buffer_store_dwordx4 v[216:219], v2, s[32:35], s68 offen offset:3072 sc1
    v_mul_f32 v64, 0x3e0293ee, v64
    s_waitcnt lgkmcnt(2)
    v_mfma_f32_32x32x16_bf16 v[128:143], v[32:35], a[96:99], v[128:143]
    buffer_load_dwordx4 v2, s[48:51], s61 offen offset:2048 sc1 lds
    ds_read_b64_tr_b16 v[48:49], v6 offset:51200
    v_mul_f32 v65, 0x3e0293ee, v65
    v_mul_f32 v66, 0x3e0293ee, v66
    v_mul_f32 v67, 0x3e0293ee, v67
    v_mfma_f32_32x32x16_bf16 v[160:175], v[32:35], a[224:227], v[160:175]
    ds_read_b64_tr_b16 v[50:51], v6 offset:51712
    v_mul_f32 v68, 0x3e0293ee, v68
    v_mul_f32 v69, 0x3e0293ee, v69
    v_mul_f32 v70, 0x3e0293ee, v70
    s_waitcnt lgkmcnt(2)
    v_mfma_f32_32x32x16_bf16 v[144:159], v[36:39], a[96:99], v[144:159]
    buffer_load_dwordx4 v2, s[48:51], s61 offen offset:3072 sc1 lds
    ds_read_b64_tr_b16 v[52:53], v7 offset:51200
    v_mul_f32 v71, 0x3e0293ee, v71
    v_mul_f32 v72, 0x3e0293ee, v72
    v_mfma_f32_32x32x16_bf16 v[176:191], v[36:39], a[224:227], v[176:191]
    v_mul_f32 v73, 0x3e0293ee, v73
    ds_read_b64_tr_b16 v[54:55], v7 offset:51712
    v_mul_f32 v74, 0x3e0293ee, v74
    v_mul_f32 v75, 0x3e0293ee, v75
    s_waitcnt lgkmcnt(2)
    v_mfma_f32_32x32x16_bf16 v[128:143], v[48:51], a[100:103], v[128:143]
    s_lshl_b32 s61, s56, 12
    s_add_u32 m0, s61, 0x18000
    s_add_u32 s61, s61, 0x8000
    buffer_load_dwordx4 v2, s[52:55], s61 offen offset:0 sc1 lds
    ds_read_b64_tr_b16 v[32:33], v6 offset:53248
    v_mul_f32 v76, 0x3e0293ee, v76
    v_mul_f32 v77, 0x3e0293ee, v77
    v_mul_f32 v78, 0x3e0293ee, v78
    v_mfma_f32_32x32x16_bf16 v[160:175], v[48:51], a[228:231], v[160:175]
    ds_read_b64_tr_b16 v[34:35], v6 offset:53760
    v_mul_f32 v79, 0x3e0293ee, v79
    v_cvt_pk_bf16_f32 v64, v64, v65
    v_cvt_pk_bf16_f32 v65, v66, v67
    s_waitcnt lgkmcnt(2)
    v_mfma_f32_32x32x16_bf16 v[144:159], v[52:55], a[100:103], v[144:159]
    buffer_load_dwordx4 v2, s[52:55], s61 offen offset:1024 sc1 lds
    ds_read_b64_tr_b16 v[36:37], v7 offset:53248
    v_cvt_pk_bf16_f32 v66, v68, v69
    v_cvt_pk_bf16_f32 v67, v70, v71
    v_cvt_pk_bf16_f32 v72, v72, v73
    v_mfma_f32_32x32x16_bf16 v[176:191], v[52:55], a[228:231], v[176:191]
    ds_read_b64_tr_b16 v[38:39], v7 offset:53760
    v_cvt_pk_bf16_f32 v73, v74, v75
    v_cvt_pk_bf16_f32 v74, v76, v77
    v_cvt_pk_bf16_f32 v75, v78, v79
    s_waitcnt lgkmcnt(2)
    v_mfma_f32_32x32x16_bf16 v[128:143], v[32:35], a[104:107], v[128:143]
    buffer_load_dwordx4 v2, s[52:55], s61 offen offset:2048 sc1 lds
    ds_read_b64_tr_b16 v[48:49], v6 offset:55296
    v_mul_f32 v80, 0x3e0293ee, v80
    v_mul_f32 v81, 0x3e0293ee, v81
    v_mul_f32 v82, 0x3e0293ee, v82
    v_mfma_f32_32x32x16_bf16 v[160:175], v[32:35], a[232:235], v[160:175]
    ds_read_b64_tr_b16 v[50:51], v6 offset:55808
    v_mul_f32 v83, 0x3e0293ee, v83
    v_mul_f32 v84, 0x3e0293ee, v84
    v_mul_f32 v85, 0x3e0293ee, v85
    s_waitcnt lgkmcnt(2)
    v_mfma_f32_32x32x16_bf16 v[144:159], v[36:39], a[104:107], v[144:159]
    buffer_load_dwordx4 v2, s[52:55], s61 offen offset:3072 sc1 lds
    ds_read_b64_tr_b16 v[52:53], v7 offset:55296
    v_mul_f32 v86, 0x3e0293ee, v86
    v_mul_f32 v87, 0x3e0293ee, v87
    v_mul_f32 v88, 0x3e0293ee, v88
    v_mfma_f32_32x32x16_bf16 v[176:191], v[36:39], a[232:235], v[176:191]
    ds_read_b64_tr_b16 v[54:55], v7 offset:55808
    v_mul_f32 v89, 0x3e0293ee, v89
    v_mul_f32 v90, 0x3e0293ee, v90
    v_mul_f32 v91, 0x3e0293ee, v91
    s_waitcnt lgkmcnt(2)
    v_mfma_f32_32x32x16_bf16 v[128:143], v[48:51], a[108:111], v[128:143]
    ds_read_b64_tr_b16 v[32:33], v6 offset:57344
    v_mul_f32 v92, 0x3e0293ee, v92
    v_mul_f32 v93, 0x3e0293ee, v93
    v_mul_f32 v94, 0x3e0293ee, v94
    v_mfma_f32_32x32x16_bf16 v[160:175], v[48:51], a[236:239], v[160:175]
    ds_read_b64_tr_b16 v[34:35], v6 offset:57856
    v_mul_f32 v95, 0x3e0293ee, v95
    v_cvt_pk_bf16_f32 v80, v80, v81
    v_cvt_pk_bf16_f32 v81, v82, v83
    s_waitcnt lgkmcnt(2)
    v_mfma_f32_32x32x16_bf16 v[144:159], v[52:55], a[108:111], v[144:159]
    ds_read_b64_tr_b16 v[36:37], v7 offset:57344
    v_cvt_pk_bf16_f32 v82, v84, v85
    v_cvt_pk_bf16_f32 v83, v86, v87
    v_cvt_pk_bf16_f32 v88, v88, v89
    v_mfma_f32_32x32x16_bf16 v[176:191], v[52:55], a[236:239], v[176:191]
    ds_read_b64_tr_b16 v[38:39], v7 offset:57856
    v_cvt_pk_bf16_f32 v89, v90, v91
    v_cvt_pk_bf16_f32 v90, v92, v93
    v_cvt_pk_bf16_f32 v91, v94, v95
    s_waitcnt lgkmcnt(2)
    v_mfma_f32_32x32x16_bf16 v[128:143], v[32:35], a[112:115], v[128:143]
    ds_read_b64_tr_b16 v[48:49], v6 offset:59392
    v_mul_f32 v96, 0x3e0293ee, v96
    v_mul_f32 v97, 0x3e0293ee, v97
    v_mul_f32 v98, 0x3e0293ee, v98
    v_mfma_f32_32x32x16_bf16 v[160:175], v[32:35], a[240:243], v[160:175]
    ds_read_b64_tr_b16 v[50:51], v6 offset:59904
    v_mul_f32 v99, 0x3e0293ee, v99
    v_mul_f32 v100, 0x3e0293ee, v100
    v_mul_f32 v101, 0x3e0293ee, v101
    s_waitcnt lgkmcnt(2)
    v_mfma_f32_32x32x16_bf16 v[144:159], v[36:39], a[112:115], v[144:159]
    ds_read_b64_tr_b16 v[52:53], v7 offset:59392
    v_mul_f32 v102, 0x3e0293ee, v102
    v_mul_f32 v103, 0x3e0293ee, v103
    v_mul_f32 v104, 0x3e0293ee, v104
    v_mfma_f32_32x32x16_bf16 v[176:191], v[36:39], a[240:243], v[176:191]
    ds_read_b64_tr_b16 v[54:55], v7 offset:59904
    v_mul_f32 v105, 0x3e0293ee, v105
    v_mul_f32 v106, 0x3e0293ee, v106
    v_mul_f32 v107, 0x3e0293ee, v107
    s_waitcnt lgkmcnt(2)
    v_mfma_f32_32x32x16_bf16 v[128:143], v[48:51], a[116:119], v[128:143]
    ds_read_b64_tr_b16 v[32:33], v6 offset:61440
    v_mul_f32 v108, 0x3e0293ee, v108
    v_mul_f32 v109, 0x3e0293ee, v109
    v_mul_f32 v110, 0x3e0293ee, v110
    v_mfma_f32_32x32x16_bf16 v[160:175], v[48:51], a[244:247], v[160:175]
    ds_read_b64_tr_b16 v[34:35], v6 offset:61952
    v_mul_f32 v111, 0x3e0293ee, v111
    v_cvt_pk_bf16_f32 v96, v96, v97
    v_cvt_pk_bf16_f32 v97, v98, v99
    s_waitcnt lgkmcnt(2)
    v_mfma_f32_32x32x16_bf16 v[144:159], v[52:55], a[116:119], v[144:159]
    ds_read_b64_tr_b16 v[36:37], v7 offset:61440
    v_cvt_pk_bf16_f32 v98, v100, v101
    v_cvt_pk_bf16_f32 v99, v102, v103
    v_cvt_pk_bf16_f32 v104, v104, v105
    v_mfma_f32_32x32x16_bf16 v[176:191], v[52:55], a[244:247], v[176:191]
    ds_read_b64_tr_b16 v[38:39], v7 offset:61952
    v_cvt_pk_bf16_f32 v105, v106, v107
    v_cvt_pk_bf16_f32 v106, v108, v109
    v_cvt_pk_bf16_f32 v107, v110, v111
    s_waitcnt lgkmcnt(2)
    v_mfma_f32_32x32x16_bf16 v[128:143], v[32:35], a[120:123], v[128:143]
    ds_read_b64_tr_b16 v[48:49], v6 offset:63488
    v_mul_f32 v112, 0x3e0293ee, v112
    v_mul_f32 v113, 0x3e0293ee, v113
    v_mul_f32 v114, 0x3e0293ee, v114
    v_mfma_f32_32x32x16_bf16 v[160:175], v[32:35], a[248:251], v[160:175]
    ds_read_b64_tr_b16 v[50:51], v6 offset:64000
    v_mul_f32 v115, 0x3e0293ee, v115
    v_mul_f32 v116, 0x3e0293ee, v116
    v_mul_f32 v117, 0x3e0293ee, v117
    s_waitcnt lgkmcnt(2)
    v_mfma_f32_32x32x16_bf16 v[144:159], v[36:39], a[120:123], v[144:159]
    ds_read_b64_tr_b16 v[52:53], v7 offset:63488
    v_mul_f32 v118, 0x3e0293ee, v118
    v_mul_f32 v119, 0x3e0293ee, v119
    v_mul_f32 v120, 0x3e0293ee, v120
    v_mfma_f32_32x32x16_bf16 v[176:191], v[36:39], a[248:251], v[176:191]
    ds_read_b64_tr_b16 v[54:55], v7 offset:64000
    v_mul_f32 v121, 0x3e0293ee, v121
    v_mul_f32 v122, 0x3e0293ee, v122
    v_mul_f32 v123, 0x3e0293ee, v123
    s_waitcnt lgkmcnt(2)
    v_mfma_f32_32x32x16_bf16 v[128:143], v[48:51], a[124:127], v[128:143]
    v_mul_f32 v124, 0x3e0293ee, v124
    v_mul_f32 v125, 0x3e0293ee, v125
    v_mul_f32 v126, 0x3e0293ee, v126
    v_mfma_f32_32x32x16_bf16 v[160:175], v[48:51], a[252:255], v[160:175]
    v_mul_f32 v127, 0x3e0293ee, v127
    v_cvt_pk_bf16_f32 v112, v112, v113
    v_cvt_pk_bf16_f32 v113, v114, v115
    s_waitcnt lgkmcnt(0)
    v_mfma_f32_32x32x16_bf16 v[144:159], v[52:55], a[124:127], v[144:159]
    v_cvt_pk_bf16_f32 v114, v116, v117
    v_cvt_pk_bf16_f32 v115, v118, v119
    v_cvt_pk_bf16_f32 v120, v120, v121
    v_mfma_f32_32x32x16_bf16 v[176:191], v[52:55], a[252:255], v[176:191]
    v_cvt_pk_bf16_f32 v121, v122, v123
    v_cvt_pk_bf16_f32 v122, v124, v125
    v_cvt_pk_bf16_f32 v123, v126, v127
    v_mul_f32 v128, 0x3e0293ee, v128
    v_mul_f32 v129, 0x3e0293ee, v129
    v_mul_f32 v130, 0x3e0293ee, v130
    v_mul_f32 v131, 0x3e0293ee, v131
    v_mul_f32 v132, 0x3e0293ee, v132
    v_mul_f32 v133, 0x3e0293ee, v133
    v_mul_f32 v134, 0x3e0293ee, v134
    v_mul_f32 v135, 0x3e0293ee, v135
    v_mul_f32 v136, 0x3e0293ee, v136
    v_mul_f32 v137, 0x3e0293ee, v137
    v_mul_f32 v138, 0x3e0293ee, v138
    v_mul_f32 v139, 0x3e0293ee, v139
    v_mul_f32 v140, 0x3e0293ee, v140
    v_mul_f32 v141, 0x3e0293ee, v141
    v_mul_f32 v142, 0x3e0293ee, v142
    v_mul_f32 v143, 0x3e0293ee, v143
    v_cvt_pk_bf16_f32 v68, v128, v129
    v_cvt_pk_bf16_f32 v69, v130, v131
    v_cvt_pk_bf16_f32 v70, v132, v133
    v_cvt_pk_bf16_f32 v71, v134, v135
    v_cvt_pk_bf16_f32 v76, v136, v137
    v_cvt_pk_bf16_f32 v77, v138, v139
    v_cvt_pk_bf16_f32 v78, v140, v141
    v_cvt_pk_bf16_f32 v79, v142, v143
    v_mul_f32 v144, 0x3e0293ee, v144
    v_mul_f32 v145, 0x3e0293ee, v145
    v_mul_f32 v146, 0x3e0293ee, v146
    v_mul_f32 v147, 0x3e0293ee, v147
    v_mul_f32 v148, 0x3e0293ee, v148
    v_mul_f32 v149, 0x3e0293ee, v149
    v_mul_f32 v150, 0x3e0293ee, v150
    v_mul_f32 v151, 0x3e0293ee, v151
    v_mul_f32 v152, 0x3e0293ee, v152
    v_mul_f32 v153, 0x3e0293ee, v153
    v_mul_f32 v154, 0x3e0293ee, v154
    v_mul_f32 v155, 0x3e0293ee, v155
    v_mul_f32 v156, 0x3e0293ee, v156
    v_mul_f32 v157, 0x3e0293ee, v157
    v_mul_f32 v158, 0x3e0293ee, v158
    v_mul_f32 v159, 0x3e0293ee, v159
    v_cvt_pk_bf16_f32 v84, v144, v145
    v_cvt_pk_bf16_f32 v85, v146, v147
    v_cvt_pk_bf16_f32 v86, v148, v149
    v_cvt_pk_bf16_f32 v87, v150, v151
    v_cvt_pk_bf16_f32 v92, v152, v153
    v_cvt_pk_bf16_f32 v93, v154, v155
    v_cvt_pk_bf16_f32 v94, v156, v157
    v_cvt_pk_bf16_f32 v95, v158, v159
    v_mul_f32 v160, 0x3e0293ee, v160
    v_mul_f32 v161, 0x3e0293ee, v161
    v_mul_f32 v162, 0x3e0293ee, v162
    v_mul_f32 v163, 0x3e0293ee, v163
    v_mul_f32 v164, 0x3e0293ee, v164
    v_mul_f32 v165, 0x3e0293ee, v165
    v_mul_f32 v166, 0x3e0293ee, v166
    v_mul_f32 v167, 0x3e0293ee, v167
    v_mul_f32 v168, 0x3e0293ee, v168
    v_mul_f32 v169, 0x3e0293ee, v169
    v_mul_f32 v170, 0x3e0293ee, v170
    v_mul_f32 v171, 0x3e0293ee, v171
    v_mul_f32 v172, 0x3e0293ee, v172
    v_mul_f32 v173, 0x3e0293ee, v173
    v_mul_f32 v174, 0x3e0293ee, v174
    v_mul_f32 v175, 0x3e0293ee, v175
    v_cvt_pk_bf16_f32 v100, v160, v161
    v_cvt_pk_bf16_f32 v101, v162, v163
    v_cvt_pk_bf16_f32 v102, v164, v165
    v_cvt_pk_bf16_f32 v103, v166, v167
    v_cvt_pk_bf16_f32 v108, v168, v169
    v_cvt_pk_bf16_f32 v109, v170, v171
    v_cvt_pk_bf16_f32 v110, v172, v173
    v_cvt_pk_bf16_f32 v111, v174, v175
    v_mul_f32 v176, 0x3e0293ee, v176
    v_mul_f32 v177, 0x3e0293ee, v177
    v_mul_f32 v178, 0x3e0293ee, v178
    v_mul_f32 v179, 0x3e0293ee, v179
    v_mul_f32 v180, 0x3e0293ee, v180
    v_mul_f32 v181, 0x3e0293ee, v181
    v_mul_f32 v182, 0x3e0293ee, v182
    v_mul_f32 v183, 0x3e0293ee, v183
    v_mul_f32 v184, 0x3e0293ee, v184
    v_mul_f32 v185, 0x3e0293ee, v185
    v_mul_f32 v186, 0x3e0293ee, v186
    v_mul_f32 v187, 0x3e0293ee, v187
    v_mul_f32 v188, 0x3e0293ee, v188
    v_mul_f32 v189, 0x3e0293ee, v189
    v_mul_f32 v190, 0x3e0293ee, v190
    v_mul_f32 v191, 0x3e0293ee, v191
    v_cvt_pk_bf16_f32 v116, v176, v177
    v_cvt_pk_bf16_f32 v117, v178, v179
    v_cvt_pk_bf16_f32 v118, v180, v181
    v_cvt_pk_bf16_f32 v119, v182, v183
    v_cvt_pk_bf16_f32 v124, v184, v185
    v_cvt_pk_bf16_f32 v125, v186, v187
    v_cvt_pk_bf16_f32 v126, v188, v189
    v_cvt_pk_bf16_f32 v127, v190, v191
    s_waitcnt vmcnt(28)
    s_branch K2_ATT
K2_NOGU:
    s_add_u32 m0, s67, 0
    s_nop 0
    buffer_load_dwordx4 v17, s[36:39], s71 offen offset:0 lds
    buffer_load_dwordx4 v18, s[36:39], s72 offen offset:1024 lds
    buffer_load_dwordx4 v17, s[36:39], s73 offen offset:2048 lds
    buffer_load_dwordx4 v18, s[36:39], s74 offen offset:3072 lds
    s_add_u32 m0, s67, 0x1000
    s_nop 0
    buffer_load_dwordx4 v17, s[36:39], s75 offen offset:0 lds
    buffer_load_dwordx4 v18, s[36:39], s76 offen offset:1024 lds
    buffer_load_dwordx4 v17, s[36:39], s77 offen offset:2048 lds
    buffer_load_dwordx4 v18, s[36:39], s78 offen offset:3072 lds
    v_add_u32 v17, 0x80, v17
    v_add_u32 v18, 0x80, v18
    v_lshrrev_b32 v3, 3, v1
    v_mul_u32_u24 v3, 0x2000, v3
    v_bfe_u32 v4, v1, 4, 1
    v_lshlrev_b32 v4, 2, v4
    v_xor_b32 v4, v4, v1
    v_and_b32 v4, 7, v4
    v_lshlrev_b32 v4, 4, v4
    v_add_u32 v12, v3, v4
    v_add_u32 v13, 0xfc00, v12
    v_add_u32 v14, 0xfc00, v13
    v_add_u32 v15, 0xfc00, v14
    s_and_b32 s79, s56, 1
    s_lshl_b32 s79, s79, 18
    s_lshr_b32 s80, s56, 1
    s_lshl_b32 s80, s80, 7
    s_lshl_b32 s3, s57, 8
    s_add_u32 s68, s3, s79
    s_add_u32 s68, s68, s80
    s_lshl_b32 s79, s56, 18
    s_add_u32 s69, s3, s79
    s_add_u32 s70, s69, 0x80
    s_lshl_b32 s59, s56, 12
    s_add_u32 s59, s59, 0x18000
    s_mov_b32 s40, s10
    s_mov_b32 s41, s11
    s_mov_b32 s42, 0x400000
    s_mov_b32 s43, 0x20000
    s_add_u32 m0, s59, 0
    s_add_u32 s60, s68, 0
    buffer_load_dwordx4 v12, s[40:43], s60 offen offset:0 lds
    buffer_load_dwordx4 v13, s[40:43], s60 offen offset:1024 lds
    buffer_load_dwordx4 v14, s[40:43], s60 offen offset:2048 lds
    buffer_load_dwordx4 v15, s[40:43], s60 offen offset:3072 lds
    s_add_u32 m0, s67, 0x2000
    s_nop 0
    buffer_load_dwordx4 v17, s[36:39], s71 offen offset:0 lds
    buffer_load_dwordx4 v18, s[36:39], s72 offen offset:1024 lds
    buffer_load_dwordx4 v17, s[36:39], s73 offen offset:2048 lds
    buffer_load_dwordx4 v18, s[36:39], s74 offen offset:3072 lds
    s_add_u32 m0, s67, 0x3000
    s_nop 0
    buffer_load_dwordx4 v17, s[36:39], s75 offen offset:0 lds
    buffer_load_dwordx4 v18, s[36:39], s76 offen offset:1024 lds
    buffer_load_dwordx4 v17, s[36:39], s77 offen offset:2048 lds
    buffer_load_dwordx4 v18, s[36:39], s78 offen offset:3072 lds
    v_add_u32 v17, 0x80, v17
    v_add_u32 v18, 0x80, v18
    s_add_u32 m0, s59, 0x4000
    s_add_u32 s60, s68, 0x80000
    buffer_load_dwordx4 v12, s[40:43], s60 offen offset:0 lds
    buffer_load_dwordx4 v13, s[40:43], s60 offen offset:1024 lds
    buffer_load_dwordx4 v14, s[40:43], s60 offen offset:2048 lds
    buffer_load_dwordx4 v15, s[40:43], s60 offen offset:3072 lds
    s_add_u32 m0, s67, 0x4000
    s_nop 0
    buffer_load_dwordx4 v17, s[36:39], s71 offen offset:0 lds
    buffer_load_dwordx4 v18, s[36:39], s72 offen offset:1024 lds
    buffer_load_dwordx4 v17, s[36:39], s73 offen offset:2048 lds
    buffer_load_dwordx4 v18, s[36:39], s74 offen offset:3072 lds
    s_add_u32 m0, s67, 0x5000
    s_nop 0
    buffer_load_dwordx4 v17, s[36:39], s75 offen offset:0 lds
    buffer_load_dwordx4 v18, s[36:39], s76 offen offset:1024 lds
    buffer_load_dwordx4 v17, s[36:39], s77 offen offset:2048 lds
    buffer_load_dwordx4 v18, s[36:39], s78 offen offset:3072 lds
    v_add_u32 v17, 0x80, v17
    v_add_u32 v18, 0x80, v18
    v_and_b32 v3, 31, v1
    v_lshlrev_b32 v4, 7, v3
    v_add_u32 v4, s67, v4
    v_bfe_u32 v3, v1, 1, 3
    v_lshrrev_b32 v5, 5, v1
    v_xor_b32 v3, v3, v5
    v_xor_b32 v5, 0, v3
    v_lshlrev_b32 v5, 4, v5
    v_add_u32 v19, v4, v5
    v_xor_b32 v5, 2, v3
    v_lshlrev_b32 v5, 4, v5
    v_add_u32 v20, v4, v5
    v_xor_b32 v5, 4, v3
    v_lshlrev_b32 v5, 4, v5
    v_add_u32 v21, v4, v5
    v_xor_b32 v5, 6, v3
    v_lshlrev_b32 v5, 4, v5
    v_add_u32 v22, v4, v5
    v_lshrrev_b32 v3, 5, v1
    v_lshlrev_b32 v3, 10, v3
    v_bfe_u32 v4, v1, 2, 2
    v_lshlrev_b32 v4, 7, v4
    v_add_u32 v3, v3, v4
    v_bfe_u32 v4, v1, 4, 1
    v_lshlrev_b32 v4, 5, v4
    v_add_u32 v3, v3, v4
    v_and_b32 v4, 3, v1
    v_lshlrev_b32 v4, 3, v4
    v_add_u32 v3, v3, v4
    v_add_u32 v3, 0x18000, v3
    v_bfe_u32 v5, v1, 3, 1
    v_lshlrev_b32 v5, 6, v5
    v_add_u32 v6, v3, v5
    v_xor_b32 v5, 64, v5
    v_add_u32 v7, v3, v5
    s_waitcnt vmcnt(24)
    ds_read_b128 a[0:3], v19 offset:0
    ds_read_b128 a[128:131], v19 offset:4096
    ds_read_b128 a[4:7], v20 offset:0
    ds_read_b128 a[132:135], v20 offset:4096
    ds_read_b128 a[8:11], v21 offset:0
    ds_read_b128 a[136:139], v21 offset:4096
    ds_read_b128 a[12:15], v22 offset:0
    ds_read_b128 a[140:143], v22 offset:4096
    s_waitcnt vmcnt(20)
    s_barrier
    ds_read_b64_tr_b16 v[32:33], v6 offset:0
    ds_read_b64_tr_b16 v[34:35], v6 offset:512
    ds_read_b64_tr_b16 v[36:37], v7 offset:0
    ds_read_b64_tr_b16 v[38:39], v7 offset:512
    ds_read_b64_tr_b16 v[40:41], v6 offset:8192
    ds_read_b64_tr_b16 v[42:43], v6 offset:8704
    ds_read_b64_tr_b16 v[44:45], v7 offset:8192
    s_waitcnt lgkmcnt(8)
    ds_read_b64_tr_b16 v[46:47], v7 offset:8704
    s_waitcnt lgkmcnt(6)
    v_mfma_f32_32x32x16_bf16 v[64:79], v[32:35], a[0:3], 0
    s_add_u32 m0, s59, 0x8000
    s_add_u32 s60, s68, 0x100000
    buffer_load_dwordx4 v12, s[40:43], s60 offen offset:0 lds
    ds_read_b64_tr_b16 v[48:49], v6 offset:2048
    s_waitcnt lgkmcnt(0)
    s_mov_b32 s48, s4
    s_mov_b32 s49, s5
    v_mfma_f32_32x32x16_bf16 v[128:143], v[32:35], a[128:131], 0
    buffer_load_dwordx4 v13, s[40:43], s60 offen offset:1024 lds
    ds_read_b64_tr_b16 v[50:51], v6 offset:2560
    s_mov_b32 s50, 0x200000
    s_mov_b32 s51, 0x20000
    v_lshrrev_b32 v3, 5, v0
    v_mfma_f32_32x32x16_bf16 v[80:95], v[36:39], a[0:3], 0
    buffer_load_dwordx4 v14, s[40:43], s60 offen offset:2048 lds
    ds_read_b64_tr_b16 v[52:53], v7 offset:2048
    v_lshlrev_b32 v4, 10, v3
    v_and_b32 v5, 31, v1
    v_lshlrev_b32 v23, 4, v5
    v_mfma_f32_32x32x16_bf16 v[144:159], v[36:39], a[128:131], 0
    buffer_load_dwordx4 v15, s[40:43], s60 offen offset:3072 lds
    ds_read_b64_tr_b16 v[54:55], v7 offset:2560
    v_add_u32 v23, v23, v4
    s_lshl_b32 s79, s2, 13
    buffer_load_dwordx4 v[192:195], v23, s[48:51], s79 offen
    v_mfma_f32_32x32x16_bf16 v[96:111], v[40:43], a[0:3], 0
    s_add_u32 m0, s67, 0
    s_nop 0
    buffer_load_dwordx4 v17, s[36:39], s71 offen offset:0 lds
    ds_read_b64_tr_b16 v[56:57], v6 offset:10240
    buffer_load_dwordx4 v[196:199], v23, s[48:51], s79 offen offset:512
    v_lshrrev_b32 v4, 1, v5
    v_mfma_f32_32x32x16_bf16 v[160:175], v[40:43], a[128:131], 0
    buffer_load_dwordx4 v18, s[36:39], s72 offen offset:1024 lds
    v_lshlrev_b32 v4, 10, v4
    ds_read_b64_tr_b16 v[58:59], v6 offset:10752
    v_and_b32 v5, 1, v5
    v_lshlrev_b32 v5, 9, v5
    v_mfma_f32_32x32x16_bf16 v[112:127], v[44:47], a[0:3], 0
    buffer_load_dwordx4 v17, s[36:39], s73 offen offset:2048 lds
    v_add_u32 v4, v4, v5
    ds_read_b64_tr_b16 v[60:61], v7 offset:10240
    v_lshlrev_b32 v3, 4, v3
    v_add_u32 v24, v4, v3
    v_mfma_f32_32x32x16_bf16 v[176:191], v[44:47], a[128:131], 0
    buffer_load_dwordx4 v18, s[36:39], s74 offen offset:3072 lds
    s_mov_b32 s44, s12
    ds_read_b64_tr_b16 v[62:63], v7 offset:10752
    s_mov_b32 s45, s13
    s_mov_b32 s46, 0x400000
    s_waitcnt lgkmcnt(6)
    v_mfma_f32_32x32x16_bf16 v[64:79], v[48:51], a[4:7], v[64:79]
    s_add_u32 m0, s67, 0x1000
    s_nop 0
    buffer_load_dwordx4 v17, s[36:39], s75 offen offset:0 lds
    ds_read_b64_tr_b16 v[32:33], v6 offset:4096
    s_waitcnt vmcnt(23)
    ds_read_b128 a[16:19], v19 offset:8192
    ds_read_b128 a[144:147], v19 offset:12288
    ds_read_b128 a[20:23], v20 offset:8192
    v_mfma_f32_32x32x16_bf16 v[128:143], v[48:51], a[132:135], v[128:143]
    buffer_load_dwordx4 v18, s[36:39], s76 offen offset:1024 lds
    ds_read_b64_tr_b16 v[34:35], v6 offset:4608
    ds_read_b128 a[148:151], v20 offset:12288
    ds_read_b128 a[24:27], v21 offset:8192
    ds_read_b128 a[152:155], v21 offset:12288
    ds_read_b128 a[28:31], v22 offset:8192
    s_waitcnt lgkmcnt(13)
    v_mfma_f32_32x32x16_bf16 v[80:95], v[52:55], a[4:7], v[80:95]
    buffer_load_dwordx4 v17, s[36:39], s77 offen offset:2048 lds
    ds_read_b64_tr_b16 v[36:37], v7 offset:4096
    ds_read_b128 a[156:159], v22 offset:12288
    s_mov_b32 s47, 0x20000
    s_mov_b32 s32, s28
    s_mov_b32 s33, s29
    v_mfma_f32_32x32x16_bf16 v[144:159], v[52:55], a[132:135], v[144:159]
    buffer_load_dwordx4 v18, s[36:39], s78 offen offset:3072 lds
    v_add_u32 v17, 0x80, v17
    v_add_u32 v18, 0x80, v18
    s_waitcnt lgkmcnt(8)
    ds_read_b64_tr_b16 v[38:39], v7 offset:4608
    s_mov_b32 s34, 0x10000000
    s_mov_b32 s35, 0x20000
    s_mov_b32 s96, s26
    s_mov_b32 s97, s27
    v_mfma_f32_32x32x16_bf16 v[96:111], v[56:59], a[4:7], v[96:111]
    ds_read_b64_tr_b16 v[40:41], v6 offset:12288
    s_mov_b32 s98, 0x100
    s_mov_b32 s99, 0x20000
    s_lshr_b32 s64, s2, 2
    v_mfma_f32_32x32x16_bf16 v[160:175], v[56:59], a[132:135], v[160:175]
    s_lshl_b32 s64, s64, 15
    ds_read_b64_tr_b16 v[42:43], v6 offset:12800
    s_and_b32 s65, s2, 3
    s_lshl_b32 s65, s65, 7
    s_add_u32 s64, s64, s65
    v_mfma_f32_32x32x16_bf16 v[112:127], v[60:63], a[4:7], v[112:127]
    s_add_u32 s65, s64, 0x4000
    ds_read_b64_tr_b16 v[44:45], v7 offset:12288
    s_lshl_b32 s79, s57, 6
    s_lshl_b32 s80, s58, 3
    s_add_u32 s79, s79, s80
    v_mfma_f32_32x32x16_bf16 v[176:191], v[60:63], a[132:135], v[176:191]
    s_lshl_b32 s80, s56, 1
    ds_read_b64_tr_b16 v[46:47], v7 offset:12800
    s_add_u32 s79, s79, s80
    s_lshl_b32 s79, s79, 13
    s_add_u32 s100, s79, 0x200000
    s_waitcnt lgkmcnt(0)
    v_mfma_f32_32x32x16_bf16 v[64:79], v[32:35], a[8:11], v[64:79]
    s_add_u32 m0, s67, 0x2000
    s_nop 0
    buffer_load_dwordx4 v17, s[36:39], s71 offen offset:0 lds
    ds_read_b64_tr_b16 v[48:49], v6 offset:6144
    s_add_u32 s101, s79, 0x1200000
    v_mfma_f32_32x32x16_bf16 v[128:143], v[32:35], a[136:139], v[128:143]
    buffer_load_dwordx4 v18, s[36:39], s72 offen offset:1024 lds
    ds_read_b64_tr_b16 v[50:51], v6 offset:6656
    v_mfma_f32_32x32x16_bf16 v[80:95], v[36:39], a[8:11], v[80:95]
    buffer_load_dwordx4 v17, s[36:39], s73 offen offset:2048 lds
    ds_read_b64_tr_b16 v[52:53], v7 offset:6144
    v_mfma_f32_32x32x16_bf16 v[144:159], v[36:39], a[136:139], v[144:159]
    buffer_load_dwordx4 v18, s[36:39], s74 offen offset:3072 lds
    ds_read_b64_tr_b16 v[54:55], v7 offset:6656
    v_mfma_f32_32x32x16_bf16 v[96:111], v[40:43], a[8:11], v[96:111]
    s_add_u32 m0, s67, 0x3000
    s_nop 0
    buffer_load_dwordx4 v17, s[36:39], s75 offen offset:0 lds
    ds_read_b64_tr_b16 v[56:57], v6 offset:14336
    v_mfma_f32_32x32x16_bf16 v[160:175], v[40:43], a[136:139], v[160:175]
    buffer_load_dwordx4 v18, s[36:39], s76 offen offset:1024 lds
    ds_read_b64_tr_b16 v[58:59], v6 offset:14848
    v_mfma_f32_32x32x16_bf16 v[112:127], v[44:47], a[8:11], v[112:127]
    buffer_load_dwordx4 v17, s[36:39], s77 offen offset:2048 lds
    ds_read_b64_tr_b16 v[60:61], v7 offset:14336
    v_mfma_f32_32x32x16_bf16 v[176:191], v[44:47], a[136:139], v[176:191]
    buffer_load_dwordx4 v18, s[36:39], s78 offen offset:3072 lds
    v_add_u32 v17, 0x80, v17
    v_add_u32 v18, 0x80, v18
    ds_read_b64_tr_b16 v[62:63], v7 offset:14848
    s_waitcnt lgkmcnt(0)
    s_waitcnt vmcnt(30)
    s_barrier
    v_mfma_f32_32x32x16_bf16 v[64:79], v[48:51], a[12:15], v[64:79]
    s_add_u32 m0, s59, 0xc000
    s_add_u32 s60, s68, 0x180000
    buffer_load_dwordx4 v12, s[40:43], s60 offen offset:0 lds
    ds_read_b64_tr_b16 v[32:33], v6 offset:16384
    s_waitcnt vmcnt(23)
    ds_read_b128 a[32:35], v19 offset:16384
    ds_read_b128 a[160:163], v19 offset:20480
    ds_read_b128 a[36:39], v20 offset:16384
    v_mfma_f32_32x32x16_bf16 v[128:143], v[48:51], a[140:143], v[128:143]
    buffer_load_dwordx4 v13, s[40:43], s60 offen offset:1024 lds
    ds_read_b64_tr_b16 v[34:35], v6 offset:16896
    ds_read_b128 a[164:167], v20 offset:20480
    ds_read_b128 a[40:43], v21 offset:16384
    ds_read_b128 a[168:171], v21 offset:20480
    ds_read_b128 a[44:47], v22 offset:16384
    v_mfma_f32_32x32x16_bf16 v[80:95], v[52:55], a[12:15], v[80:95]
    buffer_load_dwordx4 v14, s[40:43], s60 offen offset:2048 lds
    ds_read_b64_tr_b16 v[36:37], v7 offset:16384
    ds_read_b128 a[172:175], v22 offset:20480
    v_mfma_f32_32x32x16_bf16 v[144:159], v[52:55], a[140:143], v[144:159]
    buffer_load_dwordx4 v15, s[40:43], s60 offen offset:3072 lds
    ds_read_b64_tr_b16 v[38:39], v7 offset:16896
    v_mfma_f32_32x32x16_bf16 v[96:111], v[56:59], a[12:15], v[96:111]
    ds_read_b64_tr_b16 v[40:41], v6 offset:24576
    v_mfma_f32_32x32x16_bf16 v[160:175], v[56:59], a[140:143], v[160:175]
    ds_read_b64_tr_b16 v[42:43], v6 offset:25088
    v_mfma_f32_32x32x16_bf16 v[112:127], v[60:63], a[12:15], v[112:127]
    ds_read_b64_tr_b16 v[44:45], v7 offset:24576
    v_mfma_f32_32x32x16_bf16 v[176:191], v[60:63], a[140:143], v[176:191]
    s_waitcnt lgkmcnt(8)
    ds_read_b64_tr_b16 v[46:47], v7 offset:25088
    s_waitcnt lgkmcnt(0)
    v_mfma_f32_32x32x16_bf16 v[64:79], v[32:35], a[16:19], v[64:79]
    s_add_u32 m0, s67, 0x4000
    s_nop 0
    buffer_load_dwordx4 v17, s[36:39], s71 offen offset:0 lds
    ds_read_b64_tr_b16 v[48:49], v6 offset:18432
    v_mfma_f32_32x32x16_bf16 v[128:143], v[32:35], a[144:147], v[128:143]
    buffer_load_dwordx4 v18, s[36:39], s72 offen offset:1024 lds
    ds_read_b64_tr_b16 v[50:51], v6 offset:18944
    v_mfma_f32_32x32x16_bf16 v[80:95], v[36:39], a[16:19], v[80:95]
    buffer_load_dwordx4 v17, s[36:39], s73 offen offset:2048 lds
    ds_read_b64_tr_b16 v[52:53], v7 offset:18432
    v_mfma_f32_32x32x16_bf16 v[144:159], v[36:39], a[144:147], v[144:159]
    buffer_load_dwordx4 v18, s[36:39], s74 offen offset:3072 lds
    ds_read_b64_tr_b16 v[54:55], v7 offset:18944
    v_mfma_f32_32x32x16_bf16 v[96:111], v[40:43], a[16:19], v[96:111]
    s_add_u32 m0, s67, 0x5000
    s_nop 0
    buffer_load_dwordx4 v17, s[36:39], s75 offen offset:0 lds
    ds_read_b64_tr_b16 v[56:57], v6 offset:26624
    v_mfma_f32_32x32x16_bf16 v[160:175], v[40:43], a[144:147], v[160:175]
    buffer_load_dwordx4 v18, s[36:39], s76 offen offset:1024 lds
    ds_read_b64_tr_b16 v[58:59], v6 offset:27136
    v_mfma_f32_32x32x16_bf16 v[112:127], v[44:47], a[16:19], v[112:127]
    buffer_load_dwordx4 v17, s[36:39], s77 offen offset:2048 lds
    ds_read_b64_tr_b16 v[60:61], v7 offset:26624
    v_mfma_f32_32x32x16_bf16 v[176:191], v[44:47], a[144:147], v[176:191]
    buffer_load_dwordx4 v18, s[36:39], s78 offen offset:3072 lds
    v_add_u32 v17, 0x80, v17
    v_add_u32 v18, 0x80, v18
    ds_read_b64_tr_b16 v[62:63], v7 offset:27136
    s_waitcnt lgkmcnt(6)
    v_mfma_f32_32x32x16_bf16 v[64:79], v[48:51], a[20:23], v[64:79]
    ds_read_b64_tr_b16 v[32:33], v6 offset:20480
    s_waitcnt vmcnt(29)
    v_lshlrev_b32 v200, 16, v192
    v_and_b32 v201, 0xffff0000, v192
    v_mfma_f32_32x32x16_bf16 v[128:143], v[48:51], a[148:151], v[128:143]
    ds_read_b64_tr_b16 v[34:35], v6 offset:20992
    s_waitcnt vmcnt(27)
    v_lshlrev_b32 v208, 16, v196
    v_and_b32 v209, 0xffff0000, v196
    v_lshlrev_b32 v202, 16, v193
    s_waitcnt lgkmcnt(6)
    v_mfma_f32_32x32x16_bf16 v[80:95], v[52:55], a[20:23], v[80:95]
    ds_read_b64_tr_b16 v[36:37], v7 offset:20480
    v_and_b32 v203, 0xffff0000, v193
    v_lshlrev_b32 v210, 16, v197
    v_mfma_f32_32x32x16_bf16 v[144:159], v[52:55], a[148:151], v[144:159]
    v_and_b32 v211, 0xffff0000, v197
    ds_read_b64_tr_b16 v[38:39], v7 offset:20992
    v_lshlrev_b32 v204, 16, v194
    v_and_b32 v205, 0xffff0000, v194
    s_waitcnt lgkmcnt(6)
    v_mfma_f32_32x32x16_bf16 v[96:111], v[56:59], a[20:23], v[96:111]
    ds_read_b64_tr_b16 v[40:41], v6 offset:28672
    v_lshlrev_b32 v212, 16, v198
    v_and_b32 v213, 0xffff0000, v198
    v_lshlrev_b32 v206, 16, v195
    v_mfma_f32_32x32x16_bf16 v[160:175], v[56:59], a[148:151], v[160:175]
    ds_read_b64_tr_b16 v[42:43], v6 offset:29184
    v_and_b32 v207, 0xffff0000, v195
    v_lshlrev_b32 v214, 16, v199
    v_and_b32 v215, 0xffff0000, v199
    s_waitcnt lgkmcnt(6)
    v_mfma_f32_32x32x16_bf16 v[112:127], v[60:63], a[20:23], v[112:127]
    ds_read_b64_tr_b16 v[44:45], v7 offset:28672
    v_add_f32 v232, v200, v201
    v_add_f32 v232, v232, v202
    v_mfma_f32_32x32x16_bf16 v[176:191], v[60:63], a[148:151], v[176:191]
    v_add_f32 v232, v232, v203
    ds_read_b64_tr_b16 v[46:47], v7 offset:29184
    v_add_f32 v232, v232, v204
    v_add_f32 v232, v232, v205
    s_waitcnt lgkmcnt(6)
    v_mfma_f32_32x32x16_bf16 v[64:79], v[32:35], a[24:27], v[64:79]
    ds_read_b64_tr_b16 v[48:49], v6 offset:22528
    s_waitcnt vmcnt(20)
    ds_read_b128 a[48:51], v19 offset:0
    ds_read_b128 a[176:179], v19 offset:4096
    ds_read_b128 a[52:55], v20 offset:0
    v_mfma_f32_32x32x16_bf16 v[128:143], v[32:35], a[152:155], v[128:143]
    ds_read_b64_tr_b16 v[50:51], v6 offset:23040
    ds_read_b128 a[180:183], v20 offset:4096
    ds_read_b128 a[56:59], v21 offset:0
    ds_read_b128 a[184:187], v21 offset:4096
    ds_read_b128 a[60:63], v22 offset:0
    s_waitcnt lgkmcnt(13)
    v_mfma_f32_32x32x16_bf16 v[80:95], v[36:39], a[24:27], v[80:95]
    ds_read_b64_tr_b16 v[52:53], v7 offset:22528
    ds_read_b128 a[188:191], v22 offset:4096
    v_add_f32 v232, v232, v206
    v_add_f32 v232, v232, v207
    v_add_f32 v232, v232, v208
    v_mfma_f32_32x32x16_bf16 v[144:159], v[36:39], a[152:155], v[144:159]
    s_waitcnt lgkmcnt(8)
    ds_read_b64_tr_b16 v[54:55], v7 offset:23040
    v_add_f32 v232, v232, v209
    v_add_f32 v232, v232, v210
    v_add_f32 v232, v232, v211
    v_add_f32 v232, v232, v212
    v_mfma_f32_32x32x16_bf16 v[96:111], v[40:43], a[24:27], v[96:111]
    ds_read_b64_tr_b16 v[56:57], v6 offset:30720
    v_add_f32 v232, v232, v213
    v_add_f32 v232, v232, v214
    v_add_f32 v232, v232, v215
    v_mfma_f32_32x32x16_bf16 v[160:175], v[40:43], a[152:155], v[160:175]
    ds_swizzle_b32 v233, v232 offset:0x041f
    ds_read_b64_tr_b16 v[58:59], v6 offset:31232
    s_waitcnt lgkmcnt(1)
    v_add_f32 v232, v232, v233
    ds_swizzle_b32 v233, v232 offset:0x081f
    s_waitcnt lgkmcnt(0)
    v_add_f32 v232, v232, v233
    v_mfma_f32_32x32x16_bf16 v[112:127], v[44:47], a[24:27], v[112:127]
    ds_swizzle_b32 v233, v232 offset:0x101f
    ds_read_b64_tr_b16 v[60:61], v7 offset:30720
    s_waitcnt lgkmcnt(1)
    v_add_f32 v232, v232, v233
    ds_swizzle_b32 v233, v232 offset:0x201f
    s_waitcnt lgkmcnt(0)
    v_add_f32 v232, v232, v233
    v_mfma_f32_32x32x16_bf16 v[176:191], v[44:47], a[152:155], v[176:191]
    ds_swizzle_b32 v233, v232 offset:0x401f
    ds_read_b64_tr_b16 v[62:63], v7 offset:31232
    s_waitcnt lgkmcnt(1)
    v_add_f32 v232, v232, v233
    v_mul_f32 v234, 0x3b000000, v232
    v_sub_f32 v216, v200, v234
    s_waitcnt lgkmcnt(0)
    s_barrier
    v_mfma_f32_32x32x16_bf16 v[64:79], v[48:51], a[28:31], v[64:79]
    s_add_u32 m0, s67, 0
    s_nop 0
    buffer_load_dwordx4 v17, s[36:39], s71 offen offset:0 lds
    ds_read_b64_tr_b16 v[32:33], v6 offset:32768
    v_sub_f32 v217, v201, v234
    v_sub_f32 v218, v202, v234
    v_sub_f32 v219, v203, v234
    v_mfma_f32_32x32x16_bf16 v[128:143], v[48:51], a[156:159], v[128:143]
    buffer_load_dwordx4 v18, s[36:39], s72 offen offset:1024 lds
    ds_read_b64_tr_b16 v[34:35], v6 offset:33280
    v_sub_f32 v220, v204, v234
    v_sub_f32 v221, v205, v234
    v_sub_f32 v222, v206, v234
    v_mfma_f32_32x32x16_bf16 v[80:95], v[52:55], a[28:31], v[80:95]
    buffer_load_dwordx4 v17, s[36:39], s73 offen offset:2048 lds
    ds_read_b64_tr_b16 v[36:37], v7 offset:32768
    v_sub_f32 v223, v207, v234
    v_sub_f32 v224, v208, v234
    v_mfma_f32_32x32x16_bf16 v[144:159], v[52:55], a[156:159], v[144:159]
    buffer_load_dwordx4 v18, s[36:39], s74 offen offset:3072 lds
    v_sub_f32 v225, v209, v234
    ds_read_b64_tr_b16 v[38:39], v7 offset:33280
    v_sub_f32 v226, v210, v234
    v_sub_f32 v227, v211, v234
    v_mfma_f32_32x32x16_bf16 v[96:111], v[56:59], a[28:31], v[96:111]
    s_add_u32 m0, s67, 0x1000
    s_nop 0
    buffer_load_dwordx4 v17, s[36:39], s75 offen offset:0 lds
    ds_read_b64_tr_b16 v[40:41], v6 offset:40960
    v_sub_f32 v228, v212, v234
    v_sub_f32 v229, v213, v234
    v_sub_f32 v230, v214, v234
    v_mfma_f32_32x32x16_bf16 v[160:175], v[56:59], a[156:159], v[160:175]
    buffer_load_dwordx4 v18, s[36:39], s76 offen offset:1024 lds
    ds_read_b64_tr_b16 v[42:43], v6 offset:41472
    v_sub_f32 v231, v215, v234
    v_mul_f32 v232, v216, v216
    v_fmac_f32 v232, v217, v217
    v_mfma_f32_32x32x16_bf16 v[112:127], v[60:63], a[28:31], v[112:127]
    buffer_load_dwordx4 v17, s[36:39], s77 offen offset:2048 lds
    ds_read_b64_tr_b16 v[44:45], v7 offset:40960
    v_fmac_f32 v232, v218, v218
    v_fmac_f32 v232, v219, v219
    v_mfma_f32_32x32x16_bf16 v[176:191], v[60:63], a[156:159], v[176:191]
    buffer_load_dwordx4 v18, s[36:39], s78 offen offset:3072 lds
    v_add_u32 v17, 0x80, v17
    v_add_u32 v18, 0x80, v18
    v_fmac_f32 v232, v220, v220
    ds_read_b64_tr_b16 v[46:47], v7 offset:41472
    v_fmac_f32 v232, v221, v221
    v_fmac_f32 v232, v222, v222
    s_waitcnt lgkmcnt(6)
    v_mfma_f32_32x32x16_bf16 v[64:79], v[32:35], a[32:35], v[64:79]
    s_add_u32 m0, s59, 0
    s_add_u32 s60, s68, 0x200000
    buffer_load_dwordx4 v12, s[40:43], s60 offen offset:0 lds
    ds_read_b64_tr_b16 v[48:49], v6 offset:34816
    v_fmac_f32 v232, v223, v223
    v_fmac_f32 v232, v224, v224
    v_fmac_f32 v232, v225, v225
    v_mfma_f32_32x32x16_bf16 v[128:143], v[32:35], a[160:163], v[128:143]
    buffer_load_dwordx4 v13, s[40:43], s60 offen offset:1024 lds
    ds_read_b64_tr_b16 v[50:51], v6 offset:35328
    v_fmac_f32 v232, v226, v226
    v_fmac_f32 v232, v227, v227
    v_fmac_f32 v232, v228, v228
    s_waitcnt lgkmcnt(6)
    v_mfma_f32_32x32x16_bf16 v[80:95], v[36:39], a[32:35], v[80:95]
    buffer_load_dwordx4 v14, s[40:43], s60 offen offset:2048 lds
    ds_read_b64_tr_b16 v[52:53], v7 offset:34816
    v_fmac_f32 v232, v229, v229
    v_fmac_f32 v232, v230, v230
    v_mfma_f32_32x32x16_bf16 v[144:159], v[36:39], a[160:163], v[144:159]
    buffer_load_dwordx4 v15, s[40:43], s60 offen offset:3072 lds
    v_fmac_f32 v232, v231, v231
    ds_read_b64_tr_b16 v[54:55], v7 offset:35328
    ds_swizzle_b32 v233, v232 offset:0x041f
    s_waitcnt lgkmcnt(0)
    v_add_f32 v232, v232, v233
    v_mfma_f32_32x32x16_bf16 v[96:111], v[40:43], a[32:35], v[96:111]
    ds_read_b64_tr_b16 v[56:57], v6 offset:43008
    ds_swizzle_b32 v233, v232 offset:0x081f
    s_waitcnt lgkmcnt(0)
    v_add_f32 v232, v232, v233
    ds_swizzle_b32 v233, v232 offset:0x101f
    v_mfma_f32_32x32x16_bf16 v[160:175], v[40:43], a[160:163], v[160:175]
    ds_read_b64_tr_b16 v[58:59], v6 offset:43520
    s_waitcnt lgkmcnt(1)
    v_add_f32 v232, v232, v233
    ds_swizzle_b32 v233, v232 offset:0x201f
    s_waitcnt lgkmcnt(0)
    v_add_f32 v232, v232, v233
    v_mfma_f32_32x32x16_bf16 v[112:127], v[44:47], a[32:35], v[112:127]
    ds_read_b64_tr_b16 v[60:61], v7 offset:43008
    ds_swizzle_b32 v233, v232 offset:0x401f
    s_waitcnt lgkmcnt(0)
    v_add_f32 v232, v232, v233
    v_mfma_f32_32x32x16_bf16 v[176:191], v[44:47], a[160:163], v[176:191]
    v_mul_f32 v235, 0x3b000000, v232
    ds_read_b64_tr_b16 v[62:63], v7 offset:43520
    v_cvt_pk_bf16_f32 v236, v234, v235
    v_lshlrev_b32 v237, 16, v236
    v_mfma_f32_32x32x16_bf16 v[64:79], v[48:51], a[36:39], v[64:79]
    ds_read_b64_tr_b16 v[32:33], v6 offset:36864
    s_waitcnt vmcnt(24)
    ds_read_b128 a[64:67], v19 offset:8192
    ds_read_b128 a[192:195], v19 offset:12288
    ds_read_b128 a[68:71], v20 offset:8192
    v_mfma_f32_32x32x16_bf16 v[128:143], v[48:51], a[164:167], v[128:143]
    ds_read_b64_tr_b16 v[34:35], v6 offset:37376
    ds_read_b128 a[196:199], v20 offset:12288
    ds_read_b128 a[72:75], v21 offset:8192
    ds_read_b128 a[200:203], v21 offset:12288
    ds_read_b128 a[76:79], v22 offset:8192
    v_mfma_f32_32x32x16_bf16 v[80:95], v[52:55], a[36:39], v[80:95]
    ds_read_b64_tr_b16 v[36:37], v7 offset:36864
    ds_read_b128 a[204:207], v22 offset:12288
    v_and_b32 v238, 0xffff0000, v236
    v_add_f32 v238, 0x3727c5ac, v238
    v_cvt_pk_bf16_f32 v236, v238, v238
    v_mfma_f32_32x32x16_bf16 v[144:159], v[52:55], a[164:167], v[144:159]
    ds_read_b64_tr_b16 v[38:39], v7 offset:37376
    v_lshlrev_b32 v238, 16, v236
    v_sqrt_f32 v238, v238
    s_nop 0
    v_cvt_pk_bf16_f32 v236, v238, v238
    v_lshlrev_b32 v239, 16, v236
    v_mfma_f32_32x32x16_bf16 v[96:111], v[56:59], a[36:39], v[96:111]
    ds_read_b64_tr_b16 v[40:41], v6 offset:45056
    v_rcp_f32 v240, v239
    v_sub_f32 v216, v200, v237
    v_sub_f32 v217, v201, v237
    v_mfma_f32_32x32x16_bf16 v[160:175], v[56:59], a[164:167], v[160:175]
    v_sub_f32 v218, v202, v237
    ds_read_b64_tr_b16 v[42:43], v6 offset:45568
    v_sub_f32 v219, v203, v237
    v_sub_f32 v220, v204, v237
    v_sub_f32 v221, v205, v237
    s_waitcnt lgkmcnt(14)
    v_mfma_f32_32x32x16_bf16 v[112:127], v[60:63], a[36:39], v[112:127]
    v_sub_f32 v222, v206, v237
    ds_read_b64_tr_b16 v[44:45], v7 offset:45056
    v_sub_f32 v223, v207, v237
    v_sub_f32 v224, v208, v237
    v_sub_f32 v225, v209, v237
    v_mfma_f32_32x32x16_bf16 v[176:191], v[60:63], a[164:167], v[176:191]
    v_sub_f32 v226, v210, v237
    s_waitcnt lgkmcnt(8)
    ds_read_b64_tr_b16 v[46:47], v7 offset:45568
    v_sub_f32 v227, v211, v237
    v_sub_f32 v228, v212, v237
    v_sub_f32 v229, v213, v237
    s_waitcnt lgkmcnt(0)
    v_mfma_f32_32x32x16_bf16 v[64:79], v[32:35], a[40:43], v[64:79]
    s_add_u32 m0, s67, 0x2000
    s_nop 0
    buffer_load_dwordx4 v17, s[36:39], s71 offen offset:0 lds
    ds_read_b64_tr_b16 v[48:49], v6 offset:38912
    v_sub_f32 v230, v214, v237
    v_sub_f32 v231, v215, v237
    v_cvt_pk_bf16_f32 v236, v216, v217
    v_mfma_f32_32x32x16_bf16 v[128:143], v[32:35], a[168:171], v[128:143]
    buffer_load_dwordx4 v18, s[36:39], s72 offen offset:1024 lds
    ds_read_b64_tr_b16 v[50:51], v6 offset:39424
    v_lshlrev_b32 v216, 16, v236
    v_and_b32 v217, 0xffff0000, v236
    v_cvt_pk_bf16_f32 v236, v218, v219
    v_mfma_f32_32x32x16_bf16 v[80:95], v[36:39], a[40:43], v[80:95]
    buffer_load_dwordx4 v17, s[36:39], s73 offen offset:2048 lds
    ds_read_b64_tr_b16 v[52:53], v7 offset:38912
    v_lshlrev_b32 v218, 16, v236
    v_and_b32 v219, 0xffff0000, v236
    v_mfma_f32_32x32x16_bf16 v[144:159], v[36:39], a[168:171], v[144:159]
    buffer_load_dwordx4 v18, s[36:39], s74 offen offset:3072 lds
    v_cvt_pk_bf16_f32 v236, v220, v221
    ds_read_b64_tr_b16 v[54:55], v7 offset:39424
    v_lshlrev_b32 v220, 16, v236
    v_and_b32 v221, 0xffff0000, v236
    v_mfma_f32_32x32x16_bf16 v[96:111], v[40:43], a[40:43], v[96:111]
    s_add_u32 m0, s67, 0x3000
    s_nop 0
    buffer_load_dwordx4 v17, s[36:39], s75 offen offset:0 lds
    ds_read_b64_tr_b16 v[56:57], v6 offset:47104
    v_cvt_pk_bf16_f32 v236, v222, v223
    v_lshlrev_b32 v222, 16, v236
    v_and_b32 v223, 0xffff0000, v236
    v_mfma_f32_32x32x16_bf16 v[160:175], v[40:43], a[168:171], v[160:175]
    buffer_load_dwordx4 v18, s[36:39], s76 offen offset:1024 lds
    ds_read_b64_tr_b16 v[58:59], v6 offset:47616
    v_cvt_pk_bf16_f32 v236, v224, v225
    v_lshlrev_b32 v224, 16, v236
    v_and_b32 v225, 0xffff0000, v236
    v_mfma_f32_32x32x16_bf16 v[112:127], v[44:47], a[40:43], v[112:127]
    buffer_load_dwordx4 v17, s[36:39], s77 offen offset:2048 lds
    ds_read_b64_tr_b16 v[60:61], v7 offset:47104
    v_cvt_pk_bf16_f32 v236, v226, v227
    v_lshlrev_b32 v226, 16, v236
    v_mfma_f32_32x32x16_bf16 v[176:191], v[44:47], a[168:171], v[176:191]
    buffer_load_dwordx4 v18, s[36:39], s78 offen offset:3072 lds
    v_add_u32 v17, 0x80, v17
    v_add_u32 v18, 0x80, v18
    v_and_b32 v227, 0xffff0000, v236
    ds_read_b64_tr_b16 v[62:63], v7 offset:47616
    v_cvt_pk_bf16_f32 v236, v228, v229
    v_lshlrev_b32 v228, 16, v236
    s_waitcnt lgkmcnt(0)
    s_waitcnt vmcnt(28)
    s_barrier
    v_mfma_f32_32x32x16_bf16 v[64:79], v[48:51], a[44:47], v[64:79]
    s_add_u32 m0, s59, 0x4000
    s_add_u32 s60, s68, 0x280000
    buffer_load_dwordx4 v12, s[40:43], s60 offen offset:0 lds
    ds_read_b64_tr_b16 v[32:33], v6 offset:49152
    v_and_b32 v229, 0xffff0000, v236
    v_cvt_pk_bf16_f32 v236, v230, v231
    v_lshlrev_b32 v230, 16, v236
    v_mfma_f32_32x32x16_bf16 v[128:143], v[48:51], a[172:175], v[128:143]
    buffer_load_dwordx4 v13, s[40:43], s60 offen offset:1024 lds
    ds_read_b64_tr_b16 v[34:35], v6 offset:49664
    v_and_b32 v231, 0xffff0000, v236
    v_mul_f32 v200, v216, v240
    v_fma_f32 v216, -v200, v239, v216
    v_mfma_f32_32x32x16_bf16 v[80:95], v[52:55], a[44:47], v[80:95]
    buffer_load_dwordx4 v14, s[40:43], s60 offen offset:2048 lds
    ds_read_b64_tr_b16 v[36:37], v7 offset:49152
    v_fmac_f32 v200, v216, v240
    v_mul_f32 v201, v217, v240
    v_mfma_f32_32x32x16_bf16 v[144:159], v[52:55], a[172:175], v[144:159]
    buffer_load_dwordx4 v15, s[40:43], s60 offen offset:3072 lds
    v_fma_f32 v217, -v201, v239, v217
    ds_read_b64_tr_b16 v[38:39], v7 offset:49664
    v_fmac_f32 v201, v217, v240
    v_mul_f32 v202, v218, v240
    v_mfma_f32_32x32x16_bf16 v[96:111], v[56:59], a[44:47], v[96:111]
    s_add_u32 m0, s59, 0x8000
    s_add_u32 s60, s68, 0x300000
    buffer_load_dwordx4 v12, s[40:43], s60 offen offset:0 lds
    ds_read_b64_tr_b16 v[40:41], v6 offset:57344
    v_fma_f32 v218, -v202, v239, v218
    v_fmac_f32 v202, v218, v240
    v_mul_f32 v203, v219, v240
    v_mfma_f32_32x32x16_bf16 v[160:175], v[56:59], a[172:175], v[160:175]
    buffer_load_dwordx4 v13, s[40:43], s60 offen offset:1024 lds
    ds_read_b64_tr_b16 v[42:43], v6 offset:57856
    v_fma_f32 v219, -v203, v239, v219
    v_fmac_f32 v203, v219, v240
    v_mul_f32 v204, v220, v240
    v_mfma_f32_32x32x16_bf16 v[112:127], v[60:63], a[44:47], v[112:127]
    buffer_load_dwordx4 v14, s[40:43], s60 offen offset:2048 lds
    ds_read_b64_tr_b16 v[44:45], v7 offset:57344
    v_fma_f32 v220, -v204, v239, v220
    v_fmac_f32 v204, v220, v240
    v_mfma_f32_32x32x16_bf16 v[176:191], v[60:63], a[172:175], v[176:191]
    buffer_load_dwordx4 v15, s[40:43], s60 offen offset:3072 lds
    v_mul_f32 v205, v221, v240
    ds_read_b64_tr_b16 v[46:47], v7 offset:57856
    v_fma_f32 v221, -v205, v239, v221
    v_fmac_f32 v205, v221, v240
    s_waitcnt lgkmcnt(6)
    v_mfma_f32_32x32x16_bf16 v[64:79], v[32:35], a[48:51], v[64:79]
    ds_read_b64_tr_b16 v[48:49], v6 offset:51200
    s_waitcnt vmcnt(28)
    ds_read_b128 a[80:83], v19 offset:16384
    ds_read_b128 a[208:211], v19 offset:20480
    ds_read_b128 a[84:87], v20 offset:16384
    v_mfma_f32_32x32x16_bf16 v[128:143], v[32:35], a[176:179], v[128:143]
    ds_read_b64_tr_b16 v[50:51], v6 offset:51712
    ds_read_b128 a[212:215], v20 offset:20480
    ds_read_b128 a[88:91], v21 offset:16384
    ds_read_b128 a[216:219], v21 offset:20480
    ds_read_b128 a[92:95], v22 offset:16384
    s_waitcnt lgkmcnt(13)
    v_mfma_f32_32x32x16_bf16 v[80:95], v[36:39], a[48:51], v[80:95]
    ds_read_b64_tr_b16 v[52:53], v7 offset:51200
    ds_read_b128 a[220:223], v22 offset:20480
    v_mul_f32 v206, v222, v240
    v_fma_f32 v222, -v206, v239, v222
    v_fmac_f32 v206, v222, v240
    v_mfma_f32_32x32x16_bf16 v[144:159], v[36:39], a[176:179], v[144:159]
    s_waitcnt lgkmcnt(8)
    ds_read_b64_tr_b16 v[54:55], v7 offset:51712
    v_mul_f32 v207, v223, v240
    v_fma_f32 v223, -v207, v239, v223
    v_fmac_f32 v207, v223, v240
    v_mul_f32 v208, v224, v240
    v_mfma_f32_32x32x16_bf16 v[96:111], v[40:43], a[48:51], v[96:111]
    ds_read_b64_tr_b16 v[56:57], v6 offset:59392
    v_fma_f32 v224, -v208, v239, v224
    v_fmac_f32 v208, v224, v240
    v_mul_f32 v209, v225, v240
    v_mfma_f32_32x32x16_bf16 v[160:175], v[40:43], a[176:179], v[160:175]
    v_fma_f32 v225, -v209, v239, v225
    ds_read_b64_tr_b16 v[58:59], v6 offset:59904
    v_fmac_f32 v209, v225, v240
    v_mul_f32 v210, v226, v240
    v_fma_f32 v226, -v210, v239, v226
    v_mfma_f32_32x32x16_bf16 v[112:127], v[44:47], a[48:51], v[112:127]
    v_fmac_f32 v210, v226, v240
    ds_read_b64_tr_b16 v[60:61], v7 offset:59392
    v_mul_f32 v211, v227, v240
    v_fma_f32 v227, -v211, v239, v227
    v_fmac_f32 v211, v227, v240
    v_mfma_f32_32x32x16_bf16 v[176:191], v[44:47], a[176:179], v[176:191]
    v_mul_f32 v212, v228, v240
    ds_read_b64_tr_b16 v[62:63], v7 offset:59904
    v_fma_f32 v228, -v212, v239, v228
    v_fmac_f32 v212, v228, v240
    v_mul_f32 v213, v229, v240
    s_waitcnt lgkmcnt(0)
    v_mfma_f32_32x32x16_bf16 v[64:79], v[48:51], a[52:55], v[64:79]
    ds_read_b64_tr_b16 v[32:33], v6 offset:53248
    v_fma_f32 v229, -v213, v239, v229
    v_fmac_f32 v213, v229, v240
    v_mul_f32 v214, v230, v240
    v_mfma_f32_32x32x16_bf16 v[128:143], v[48:51], a[180:183], v[128:143]
    ds_read_b64_tr_b16 v[34:35], v6 offset:53760
    v_fma_f32 v230, -v214, v239, v230
    v_fmac_f32 v214, v230, v240
    v_mul_f32 v215, v231, v240
    v_mfma_f32_32x32x16_bf16 v[80:95], v[52:55], a[52:55], v[80:95]
    ds_read_b64_tr_b16 v[36:37], v7 offset:53248
    v_fma_f32 v231, -v215, v239, v231
    v_fmac_f32 v215, v231, v240
    v_cvt_pk_bf16_f32 v192, v200, v201
    v_mfma_f32_32x32x16_bf16 v[144:159], v[52:55], a[180:183], v[144:159]
    ds_read_b64_tr_b16 v[38:39], v7 offset:53760
    v_cvt_pk_bf16_f32 v196, v208, v209
    v_cvt_pk_bf16_f32 v193, v202, v203
    ds_read_b64_tr_b16 v[40:41], v6 offset:61440
    v_mfma_f32_32x32x16_bf16 v[96:111], v[56:59], a[52:55], v[96:111]
    v_cvt_pk_bf16_f32 v197, v210, v211
    v_cvt_pk_bf16_f32 v194, v204, v205
    v_cvt_pk_bf16_f32 v198, v212, v213
    ds_read_b64_tr_b16 v[42:43], v6 offset:61952
    v_mfma_f32_32x32x16_bf16 v[160:175], v[56:59], a[180:183], v[160:175]
    v_cvt_pk_bf16_f32 v195, v206, v207
    v_cvt_pk_bf16_f32 v199, v214, v215
    v_mov_b32 v242, 0
    ds_read_b64_tr_b16 v[44:45], v7 offset:61440
    v_mfma_f32_32x32x16_bf16 v[112:127], v[60:63], a[52:55], v[112:127]
    v_mov_b32 v243, 0
    s_lshl_b32 s31, s2, 7
    s_add_u32 s31, s31, 0x4800000
    ds_read_b64_tr_b16 v[46:47], v7 offset:61952
    v_mfma_f32_32x32x16_bf16 v[176:191], v[60:63], a[180:183], v[176:191]
    buffer_store_dwordx2 v[242:243], off, s[32:35], s31 sc1
    buffer_store_dwordx4 v[192:195], v24, s[32:35], s64 offen sc1
    s_waitcnt lgkmcnt(6)
    v_mfma_f32_32x32x16_bf16 v[64:79], v[32:35], a[56:59], v[64:79]
    ds_read_b64_tr_b16 v[48:49], v6 offset:55296
    buffer_store_dwordx4 v[196:199], v24, s[32:35], s65 offen sc1
    v_mfma_f32_32x32x16_bf16 v[128:143], v[32:35], a[184:187], v[128:143]
    ds_read_b64_tr_b16 v[50:51], v6 offset:55808
    s_waitcnt lgkmcnt(6)
    v_mfma_f32_32x32x16_bf16 v[80:95], v[36:39], a[56:59], v[80:95]
    ds_read_b64_tr_b16 v[52:53], v7 offset:55296
    v_mfma_f32_32x32x16_bf16 v[144:159], v[36:39], a[184:187], v[144:159]
    ds_read_b64_tr_b16 v[54:55], v7 offset:55808
    s_waitcnt lgkmcnt(6)
    v_mfma_f32_32x32x16_bf16 v[96:111], v[40:43], a[56:59], v[96:111]
    ds_read_b64_tr_b16 v[56:57], v6 offset:63488
    v_mfma_f32_32x32x16_bf16 v[160:175], v[40:43], a[184:187], v[160:175]
    ds_read_b64_tr_b16 v[58:59], v6 offset:64000
    s_waitcnt lgkmcnt(6)
    v_mfma_f32_32x32x16_bf16 v[112:127], v[44:47], a[56:59], v[112:127]
    ds_read_b64_tr_b16 v[60:61], v7 offset:63488
    v_mfma_f32_32x32x16_bf16 v[176:191], v[44:47], a[184:187], v[176:191]
    ds_read_b64_tr_b16 v[62:63], v7 offset:64000
    s_waitcnt lgkmcnt(0)
    s_waitcnt vmcnt(19)
    s_barrier
    v_mfma_f32_32x32x16_bf16 v[64:79], v[48:51], a[60:63], v[64:79]
    s_add_u32 m0, s59, 0xc000
    s_add_u32 s60, s68, 0x380000
    buffer_load_dwordx4 v12, s[40:43], s60 offen offset:0 lds
    ds_read_b64_tr_b16 v[32:33], v6 offset:0
    v_mfma_f32_32x32x16_bf16 v[128:143], v[48:51], a[188:191], v[128:143]
    ds_read_b64_tr_b16 v[34:35], v6 offset:512
    v_mfma_f32_32x32x16_bf16 v[80:95], v[52:55], a[60:63], v[80:95]
    buffer_load_dwordx4 v13, s[40:43], s60 offen offset:1024 lds
    ds_read_b64_tr_b16 v[36:37], v7 offset:0
    v_mfma_f32_32x32x16_bf16 v[144:159], v[52:55], a[188:191], v[144:159]
    ds_read_b64_tr_b16 v[38:39], v7 offset:512
    v_mfma_f32_32x32x16_bf16 v[96:111], v[56:59], a[60:63], v[96:111]
    buffer_load_dwordx4 v14, s[40:43], s60 offen offset:2048 lds
    ds_read_b64_tr_b16 v[40:41], v6 offset:8192
    v_mfma_f32_32x32x16_bf16 v[160:175], v[56:59], a[188:191], v[160:175]
    ds_read_b64_tr_b16 v[42:43], v6 offset:8704
    v_mfma_f32_32x32x16_bf16 v[112:127], v[60:63], a[60:63], v[112:127]
    buffer_load_dwordx4 v15, s[40:43], s60 offen offset:3072 lds
    ds_read_b64_tr_b16 v[44:45], v7 offset:8192
    v_mfma_f32_32x32x16_bf16 v[176:191], v[60:63], a[188:191], v[176:191]
    ds_read_b64_tr_b16 v[46:47], v7 offset:8704
    s_waitcnt lgkmcnt(6)
    v_mfma_f32_32x32x16_bf16 v[64:79], v[32:35], a[64:67], v[64:79]
    ds_read_b64_tr_b16 v[48:49], v6 offset:2048
    ds_read_b128 a[96:99], v19 offset:0
    ds_read_b128 a[224:227], v19 offset:4096
    ds_read_b128 a[100:103], v20 offset:0
    v_mfma_f32_32x32x16_bf16 v[128:143], v[32:35], a[192:195], v[128:143]
    ds_read_b64_tr_b16 v[50:51], v6 offset:2560
    ds_read_b128 a[228:231], v20 offset:4096
    ds_read_b128 a[104:107], v21 offset:0
    ds_read_b128 a[232:235], v21 offset:4096
    ds_read_b128 a[108:111], v22 offset:0
    s_waitcnt lgkmcnt(13)
    v_mfma_f32_32x32x16_bf16 v[80:95], v[36:39], a[64:67], v[80:95]
    ds_read_b64_tr_b16 v[52:53], v7 offset:2048
    ds_read_b128 a[236:239], v22 offset:4096
    v_mfma_f32_32x32x16_bf16 v[144:159], v[36:39], a[192:195], v[144:159]
    s_waitcnt lgkmcnt(8)
    ds_read_b64_tr_b16 v[54:55], v7 offset:2560
    v_mfma_f32_32x32x16_bf16 v[96:111], v[40:43], a[64:67], v[96:111]
    ds_read_b64_tr_b16 v[56:57], v6 offset:10240
    v_mfma_f32_32x32x16_bf16 v[160:175], v[40:43], a[192:195], v[160:175]
    ds_read_b64_tr_b16 v[58:59], v6 offset:10752
    v_mfma_f32_32x32x16_bf16 v[112:127], v[44:47], a[64:67], v[112:127]
    ds_read_b64_tr_b16 v[60:61], v7 offset:10240
    v_mfma_f32_32x32x16_bf16 v[176:191], v[44:47], a[192:195], v[176:191]
    ds_read_b64_tr_b16 v[62:63], v7 offset:10752
    s_waitcnt lgkmcnt(0)
    v_mfma_f32_32x32x16_bf16 v[64:79], v[48:51], a[68:71], v[64:79]
    ds_read_b64_tr_b16 v[32:33], v6 offset:4096
    v_mfma_f32_32x32x16_bf16 v[128:143], v[48:51], a[196:199], v[128:143]
    ds_read_b64_tr_b16 v[34:35], v6 offset:4608
    v_mfma_f32_32x32x16_bf16 v[80:95], v[52:55], a[68:71], v[80:95]
    ds_read_b64_tr_b16 v[36:37], v7 offset:4096
    v_mfma_f32_32x32x16_bf16 v[144:159], v[52:55], a[196:199], v[144:159]
    ds_read_b64_tr_b16 v[38:39], v7 offset:4608
    v_mfma_f32_32x32x16_bf16 v[96:111], v[56:59], a[68:71], v[96:111]
    ds_read_b64_tr_b16 v[40:41], v6 offset:12288
    v_mfma_f32_32x32x16_bf16 v[160:175], v[56:59], a[196:199], v[160:175]
    ds_read_b64_tr_b16 v[42:43], v6 offset:12800
    v_mfma_f32_32x32x16_bf16 v[112:127], v[60:63], a[68:71], v[112:127]
    ds_read_b64_tr_b16 v[44:45], v7 offset:12288
    v_mfma_f32_32x32x16_bf16 v[176:191], v[60:63], a[196:199], v[176:191]
    ds_read_b64_tr_b16 v[46:47], v7 offset:12800
    s_waitcnt lgkmcnt(6)
    v_mfma_f32_32x32x16_bf16 v[64:79], v[32:35], a[72:75], v[64:79]
    ds_read_b64_tr_b16 v[48:49], v6 offset:6144
    v_mfma_f32_32x32x16_bf16 v[128:143], v[32:35], a[200:203], v[128:143]
    ds_read_b64_tr_b16 v[50:51], v6 offset:6656
    s_waitcnt lgkmcnt(6)
    v_mfma_f32_32x32x16_bf16 v[80:95], v[36:39], a[72:75], v[80:95]
    ds_read_b64_tr_b16 v[52:53], v7 offset:6144
    v_mfma_f32_32x32x16_bf16 v[144:159], v[36:39], a[200:203], v[144:159]
    ds_read_b64_tr_b16 v[54:55], v7 offset:6656
    s_waitcnt lgkmcnt(6)
    v_mfma_f32_32x32x16_bf16 v[96:111], v[40:43], a[72:75], v[96:111]
    ds_read_b64_tr_b16 v[56:57], v6 offset:14336
    v_mfma_f32_32x32x16_bf16 v[160:175], v[40:43], a[200:203], v[160:175]
    ds_read_b64_tr_b16 v[58:59], v6 offset:14848
    s_waitcnt lgkmcnt(6)
    v_mfma_f32_32x32x16_bf16 v[112:127], v[44:47], a[72:75], v[112:127]
    ds_read_b64_tr_b16 v[60:61], v7 offset:14336
    v_mfma_f32_32x32x16_bf16 v[176:191], v[44:47], a[200:203], v[176:191]
    ds_read_b64_tr_b16 v[62:63], v7 offset:14848
    s_waitcnt lgkmcnt(0)
    s_waitcnt vmcnt(11)
    s_barrier
    v_mfma_f32_32x32x16_bf16 v[64:79], v[48:51], a[76:79], v[64:79]
    s_add_u32 m0, s59, 0
    s_add_u32 s60, s69, 0
    buffer_load_dwordx4 v12, s[44:47], s60 offen offset:0 lds
    ds_read_b64_tr_b16 v[32:33], v6 offset:16384
    v_mfma_f32_32x32x16_bf16 v[128:143], v[48:51], a[204:207], v[128:143]
    ds_read_b64_tr_b16 v[34:35], v6 offset:16896
    v_mfma_f32_32x32x16_bf16 v[80:95], v[52:55], a[76:79], v[80:95]
    buffer_load_dwordx4 v13, s[44:47], s60 offen offset:1024 lds
    ds_read_b64_tr_b16 v[36:37], v7 offset:16384
    v_mfma_f32_32x32x16_bf16 v[144:159], v[52:55], a[204:207], v[144:159]
    ds_read_b64_tr_b16 v[38:39], v7 offset:16896
    v_mfma_f32_32x32x16_bf16 v[96:111], v[56:59], a[76:79], v[96:111]
    buffer_load_dwordx4 v14, s[44:47], s60 offen offset:2048 lds
    ds_read_b64_tr_b16 v[40:41], v6 offset:24576
    v_mfma_f32_32x32x16_bf16 v[160:175], v[56:59], a[204:207], v[160:175]
    ds_read_b64_tr_b16 v[42:43], v6 offset:25088
    v_mfma_f32_32x32x16_bf16 v[112:127], v[60:63], a[76:79], v[112:127]
    buffer_load_dwordx4 v15, s[44:47], s60 offen offset:3072 lds
    ds_read_b64_tr_b16 v[44:45], v7 offset:24576
    v_mfma_f32_32x32x16_bf16 v[176:191], v[60:63], a[204:207], v[176:191]
    ds_read_b64_tr_b16 v[46:47], v7 offset:25088
    s_waitcnt lgkmcnt(6)
    v_mfma_f32_32x32x16_bf16 v[64:79], v[32:35], a[80:83], v[64:79]
    ds_read_b64_tr_b16 v[48:49], v6 offset:18432
    ds_read_b128 a[112:115], v19 offset:8192
    ds_read_b128 a[240:243], v19 offset:12288
    ds_read_b128 a[116:119], v20 offset:8192
    v_mfma_f32_32x32x16_bf16 v[128:143], v[32:35], a[208:211], v[128:143]
    ds_read_b64_tr_b16 v[50:51], v6 offset:18944
    ds_read_b128 a[244:247], v20 offset:12288
    ds_read_b128 a[120:123], v21 offset:8192
    ds_read_b128 a[248:251], v21 offset:12288
    ds_read_b128 a[124:127], v22 offset:8192
    s_waitcnt lgkmcnt(13)
    v_mfma_f32_32x32x16_bf16 v[80:95], v[36:39], a[80:83], v[80:95]
    ds_read_b64_tr_b16 v[52:53], v7 offset:18432
    ds_read_b128 a[252:255], v22 offset:12288
    v_mfma_f32_32x32x16_bf16 v[144:159], v[36:39], a[208:211], v[144:159]
    s_waitcnt lgkmcnt(8)
    ds_read_b64_tr_b16 v[54:55], v7 offset:18944
    v_mfma_f32_32x32x16_bf16 v[96:111], v[40:43], a[80:83], v[96:111]
    ds_read_b64_tr_b16 v[56:57], v6 offset:26624
    v_mfma_f32_32x32x16_bf16 v[160:175], v[40:43], a[208:211], v[160:175]
    ds_read_b64_tr_b16 v[58:59], v6 offset:27136
    v_mfma_f32_32x32x16_bf16 v[112:127], v[44:47], a[80:83], v[112:127]
    ds_read_b64_tr_b16 v[60:61], v7 offset:26624
    v_mfma_f32_32x32x16_bf16 v[176:191], v[44:47], a[208:211], v[176:191]
    ds_read_b64_tr_b16 v[62:63], v7 offset:27136
    s_waitcnt lgkmcnt(0)
    v_mfma_f32_32x32x16_bf16 v[64:79], v[48:51], a[84:87], v[64:79]
    ds_read_b64_tr_b16 v[32:33], v6 offset:20480
    v_mfma_f32_32x32x16_bf16 v[128:143], v[48:51], a[212:215], v[128:143]
    ds_read_b64_tr_b16 v[34:35], v6 offset:20992
    v_mfma_f32_32x32x16_bf16 v[80:95], v[52:55], a[84:87], v[80:95]
    ds_read_b64_tr_b16 v[36:37], v7 offset:20480
    v_mfma_f32_32x32x16_bf16 v[144:159], v[52:55], a[212:215], v[144:159]
    ds_read_b64_tr_b16 v[38:39], v7 offset:20992
    v_mfma_f32_32x32x16_bf16 v[96:111], v[56:59], a[84:87], v[96:111]
    ds_read_b64_tr_b16 v[40:41], v6 offset:28672
    v_mfma_f32_32x32x16_bf16 v[160:175], v[56:59], a[212:215], v[160:175]
    ds_read_b64_tr_b16 v[42:43], v6 offset:29184
    v_mfma_f32_32x32x16_bf16 v[112:127], v[60:63], a[84:87], v[112:127]
    ds_read_b64_tr_b16 v[44:45], v7 offset:28672
    v_mfma_f32_32x32x16_bf16 v[176:191], v[60:63], a[212:215], v[176:191]
    ds_read_b64_tr_b16 v[46:47], v7 offset:29184
    s_waitcnt lgkmcnt(6)
    v_mfma_f32_32x32x16_bf16 v[64:79], v[32:35], a[88:91], v[64:79]
    ds_read_b64_tr_b16 v[48:49], v6 offset:22528
    v_mfma_f32_32x32x16_bf16 v[128:143], v[32:35], a[216:219], v[128:143]
    ds_read_b64_tr_b16 v[50:51], v6 offset:23040
    s_waitcnt lgkmcnt(6)
    v_mfma_f32_32x32x16_bf16 v[80:95], v[36:39], a[88:91], v[80:95]
    ds_read_b64_tr_b16 v[52:53], v7 offset:22528
    v_mfma_f32_32x32x16_bf16 v[144:159], v[36:39], a[216:219], v[144:159]
    ds_read_b64_tr_b16 v[54:55], v7 offset:23040
    s_waitcnt lgkmcnt(6)
    v_mfma_f32_32x32x16_bf16 v[96:111], v[40:43], a[88:91], v[96:111]
    ds_read_b64_tr_b16 v[56:57], v6 offset:30720
    v_mfma_f32_32x32x16_bf16 v[160:175], v[40:43], a[216:219], v[160:175]
    ds_read_b64_tr_b16 v[58:59], v6 offset:31232
    s_waitcnt lgkmcnt(6)
    v_mfma_f32_32x32x16_bf16 v[112:127], v[44:47], a[88:91], v[112:127]
    ds_read_b64_tr_b16 v[60:61], v7 offset:30720
    v_mfma_f32_32x32x16_bf16 v[176:191], v[44:47], a[216:219], v[176:191]
    ds_read_b64_tr_b16 v[62:63], v7 offset:31232
    s_waitcnt lgkmcnt(0)
    s_waitcnt vmcnt(11)
    s_waitcnt vmcnt(8)
    s_barrier
    s_cmp_lg_u32 s56, 0
    s_cbranch_scc1 L_sig_lnb
    s_mov_b64 exec, 1
    v_mov_b32 v26, 1
    buffer_atomic_add v26, off, s[96:99], 0 offset:0
    s_mov_b64 exec, -1
L_sig_lnb:
    v_mfma_f32_32x32x16_bf16 v[64:79], v[48:51], a[92:95], v[64:79]
    s_add_u32 m0, s59, 0x4000
    s_add_u32 s60, s69, 0x100000
    buffer_load_dwordx4 v12, s[44:47], s60 offen offset:0 lds
    ds_read_b64_tr_b16 v[32:33], v6 offset:32768
    v_mfma_f32_32x32x16_bf16 v[128:143], v[48:51], a[220:223], v[128:143]
    ds_read_b64_tr_b16 v[34:35], v6 offset:33280
    v_mfma_f32_32x32x16_bf16 v[80:95], v[52:55], a[92:95], v[80:95]
    buffer_load_dwordx4 v13, s[44:47], s60 offen offset:1024 lds
    ds_read_b64_tr_b16 v[36:37], v7 offset:32768
    v_mfma_f32_32x32x16_bf16 v[144:159], v[52:55], a[220:223], v[144:159]
    ds_read_b64_tr_b16 v[38:39], v7 offset:33280
    v_mfma_f32_32x32x16_bf16 v[96:111], v[56:59], a[92:95], v[96:111]
    buffer_load_dwordx4 v14, s[44:47], s60 offen offset:2048 lds
    ds_read_b64_tr_b16 v[40:41], v6 offset:40960
    v_mfma_f32_32x32x16_bf16 v[160:175], v[56:59], a[220:223], v[160:175]
    ds_read_b64_tr_b16 v[42:43], v6 offset:41472
    v_mfma_f32_32x32x16_bf16 v[112:127], v[60:63], a[92:95], v[112:127]
    buffer_load_dwordx4 v15, s[44:47], s60 offen offset:3072 lds
    ds_read_b64_tr_b16 v[44:45], v7 offset:40960
    v_mfma_f32_32x32x16_bf16 v[176:191], v[60:63], a[220:223], v[176:191]
    ds_read_b64_tr_b16 v[46:47], v7 offset:41472
    s_waitcnt lgkmcnt(6)
    v_mfma_f32_32x32x16_bf16 v[64:79], v[32:35], a[96:99], v[64:79]
    ds_read_b64_tr_b16 v[48:49], v6 offset:34816
    v_mfma_f32_32x32x16_bf16 v[128:143], v[32:35], a[224:227], v[128:143]
    ds_read_b64_tr_b16 v[50:51], v6 offset:35328
    s_waitcnt lgkmcnt(6)
    v_mfma_f32_32x32x16_bf16 v[80:95], v[36:39], a[96:99], v[80:95]
    ds_read_b64_tr_b16 v[52:53], v7 offset:34816
    v_mfma_f32_32x32x16_bf16 v[144:159], v[36:39], a[224:227], v[144:159]
    ds_read_b64_tr_b16 v[54:55], v7 offset:35328
    s_waitcnt lgkmcnt(6)
    v_mfma_f32_32x32x16_bf16 v[96:111], v[40:43], a[96:99], v[96:111]
    ds_read_b64_tr_b16 v[56:57], v6 offset:43008
    v_mfma_f32_32x32x16_bf16 v[160:175], v[40:43], a[224:227], v[160:175]
    ds_read_b64_tr_b16 v[58:59], v6 offset:43520
    s_waitcnt lgkmcnt(6)
    v_mfma_f32_32x32x16_bf16 v[112:127], v[44:47], a[96:99], v[112:127]
    ds_read_b64_tr_b16 v[60:61], v7 offset:43008
    v_mfma_f32_32x32x16_bf16 v[176:191], v[44:47], a[224:227], v[176:191]
    ds_read_b64_tr_b16 v[62:63], v7 offset:43520
    s_waitcnt lgkmcnt(6)
    v_mfma_f32_32x32x16_bf16 v[64:79], v[48:51], a[100:103], v[64:79]
    ds_read_b64_tr_b16 v[32:33], v6 offset:36864
    v_mfma_f32_32x32x16_bf16 v[128:143], v[48:51], a[228:231], v[128:143]
    ds_read_b64_tr_b16 v[34:35], v6 offset:37376
    s_waitcnt lgkmcnt(6)
    v_mfma_f32_32x32x16_bf16 v[80:95], v[52:55], a[100:103], v[80:95]
    ds_read_b64_tr_b16 v[36:37], v7 offset:36864
    v_mfma_f32_32x32x16_bf16 v[144:159], v[52:55], a[228:231], v[144:159]
    ds_read_b64_tr_b16 v[38:39], v7 offset:37376
    s_waitcnt lgkmcnt(6)
    v_mfma_f32_32x32x16_bf16 v[96:111], v[56:59], a[100:103], v[96:111]
    ds_read_b64_tr_b16 v[40:41], v6 offset:45056
    v_mfma_f32_32x32x16_bf16 v[160:175], v[56:59], a[228:231], v[160:175]
    ds_read_b64_tr_b16 v[42:43], v6 offset:45568
    s_waitcnt lgkmcnt(6)
    v_mfma_f32_32x32x16_bf16 v[112:127], v[60:63], a[100:103], v[112:127]
    ds_read_b64_tr_b16 v[44:45], v7 offset:45056
    v_mfma_f32_32x32x16_bf16 v[176:191], v[60:63], a[228:231], v[176:191]
    ds_read_b64_tr_b16 v[46:47], v7 offset:45568
    s_waitcnt lgkmcnt(6)
    v_mfma_f32_32x32x16_bf16 v[64:79], v[32:35], a[104:107], v[64:79]
    ds_read_b64_tr_b16 v[48:49], v6 offset:38912
    v_mfma_f32_32x32x16_bf16 v[128:143], v[32:35], a[232:235], v[128:143]
    ds_read_b64_tr_b16 v[50:51], v6 offset:39424
    s_waitcnt lgkmcnt(6)
    v_mfma_f32_32x32x16_bf16 v[80:95], v[36:39], a[104:107], v[80:95]
    ds_read_b64_tr_b16 v[52:53], v7 offset:38912
    v_mfma_f32_32x32x16_bf16 v[144:159], v[36:39], a[232:235], v[144:159]
    ds_read_b64_tr_b16 v[54:55], v7 offset:39424
    s_waitcnt lgkmcnt(6)
    v_mfma_f32_32x32x16_bf16 v[96:111], v[40:43], a[104:107], v[96:111]
    ds_read_b64_tr_b16 v[56:57], v6 offset:47104
    v_mfma_f32_32x32x16_bf16 v[160:175], v[40:43], a[232:235], v[160:175]
    ds_read_b64_tr_b16 v[58:59], v6 offset:47616
    s_waitcnt lgkmcnt(6)
    v_mfma_f32_32x32x16_bf16 v[112:127], v[44:47], a[104:107], v[112:127]
    ds_read_b64_tr_b16 v[60:61], v7 offset:47104
    v_mfma_f32_32x32x16_bf16 v[176:191], v[44:47], a[232:235], v[176:191]
    ds_read_b64_tr_b16 v[62:63], v7 offset:47616
    s_waitcnt lgkmcnt(0)
    s_waitcnt vmcnt(8)
    s_barrier
    v_mfma_f32_32x32x16_bf16 v[64:79], v[48:51], a[108:111], v[64:79]
    s_add_u32 m0, s59, 0x8000
    s_add_u32 s60, s69, 0x200000
    buffer_load_dwordx4 v12, s[44:47], s60 offen offset:0 lds
    ds_read_b64_tr_b16 v[32:33], v6 offset:49152
    v_mfma_f32_32x32x16_bf16 v[128:143], v[48:51], a[236:239], v[128:143]
    ds_read_b64_tr_b16 v[34:35], v6 offset:49664
    v_mfma_f32_32x32x16_bf16 v[80:95], v[52:55], a[108:111], v[80:95]
    buffer_load_dwordx4 v13, s[44:47], s60 offen offset:1024 lds
    ds_read_b64_tr_b16 v[36:37], v7 offset:49152
    v_mfma_f32_32x32x16_bf16 v[144:159], v[52:55], a[236:239], v[144:159]
    ds_read_b64_tr_b16 v[38:39], v7 offset:49664
    v_mfma_f32_32x32x16_bf16 v[96:111], v[56:59], a[108:111], v[96:111]
    buffer_load_dwordx4 v14, s[44:47], s60 offen offset:2048 lds
    ds_read_b64_tr_b16 v[40:41], v6 offset:57344
    v_mfma_f32_32x32x16_bf16 v[160:175], v[56:59], a[236:239], v[160:175]
    ds_read_b64_tr_b16 v[42:43], v6 offset:57856
    v_mfma_f32_32x32x16_bf16 v[112:127], v[60:63], a[108:111], v[112:127]
    buffer_load_dwordx4 v15, s[44:47], s60 offen offset:3072 lds
    ds_read_b64_tr_b16 v[44:45], v7 offset:57344
    v_mfma_f32_32x32x16_bf16 v[176:191], v[60:63], a[236:239], v[176:191]
    ds_read_b64_tr_b16 v[46:47], v7 offset:57856
    s_waitcnt lgkmcnt(6)
    v_mfma_f32_32x32x16_bf16 v[64:79], v[32:35], a[112:115], v[64:79]
    ds_read_b64_tr_b16 v[48:49], v6 offset:51200
    v_mfma_f32_32x32x16_bf16 v[128:143], v[32:35], a[240:243], v[128:143]
    ds_read_b64_tr_b16 v[50:51], v6 offset:51712
    s_waitcnt lgkmcnt(6)
    v_mfma_f32_32x32x16_bf16 v[80:95], v[36:39], a[112:115], v[80:95]
    ds_read_b64_tr_b16 v[52:53], v7 offset:51200
    v_mfma_f32_32x32x16_bf16 v[144:159], v[36:39], a[240:243], v[144:159]
    ds_read_b64_tr_b16 v[54:55], v7 offset:51712
    s_waitcnt lgkmcnt(6)
    v_mfma_f32_32x32x16_bf16 v[96:111], v[40:43], a[112:115], v[96:111]
    ds_read_b64_tr_b16 v[56:57], v6 offset:59392
    v_mfma_f32_32x32x16_bf16 v[160:175], v[40:43], a[240:243], v[160:175]
    ds_read_b64_tr_b16 v[58:59], v6 offset:59904
    s_waitcnt lgkmcnt(6)
    v_mfma_f32_32x32x16_bf16 v[112:127], v[44:47], a[112:115], v[112:127]
    ds_read_b64_tr_b16 v[60:61], v7 offset:59392
    v_mfma_f32_32x32x16_bf16 v[176:191], v[44:47], a[240:243], v[176:191]
    ds_read_b64_tr_b16 v[62:63], v7 offset:59904
    s_waitcnt lgkmcnt(6)
    v_mfma_f32_32x32x16_bf16 v[64:79], v[48:51], a[116:119], v[64:79]
    ds_read_b64_tr_b16 v[32:33], v6 offset:53248
    v_mfma_f32_32x32x16_bf16 v[128:143], v[48:51], a[244:247], v[128:143]
    ds_read_b64_tr_b16 v[34:35], v6 offset:53760
    s_waitcnt lgkmcnt(6)
    v_mfma_f32_32x32x16_bf16 v[80:95], v[52:55], a[116:119], v[80:95]
    ds_read_b64_tr_b16 v[36:37], v7 offset:53248
    v_mfma_f32_32x32x16_bf16 v[144:159], v[52:55], a[244:247], v[144:159]
    ds_read_b64_tr_b16 v[38:39], v7 offset:53760
    s_waitcnt lgkmcnt(6)
    v_mfma_f32_32x32x16_bf16 v[96:111], v[56:59], a[116:119], v[96:111]
    ds_read_b64_tr_b16 v[40:41], v6 offset:61440
    v_mfma_f32_32x32x16_bf16 v[160:175], v[56:59], a[244:247], v[160:175]
    ds_read_b64_tr_b16 v[42:43], v6 offset:61952
    s_waitcnt lgkmcnt(6)
    v_mfma_f32_32x32x16_bf16 v[112:127], v[60:63], a[116:119], v[112:127]
    ds_read_b64_tr_b16 v[44:45], v7 offset:61440
    v_mfma_f32_32x32x16_bf16 v[176:191], v[60:63], a[244:247], v[176:191]
    ds_read_b64_tr_b16 v[46:47], v7 offset:61952
    s_waitcnt lgkmcnt(6)
    v_mfma_f32_32x32x16_bf16 v[64:79], v[32:35], a[120:123], v[64:79]
    ds_read_b64_tr_b16 v[48:49], v6 offset:55296
    v_mfma_f32_32x32x16_bf16 v[128:143], v[32:35], a[248:251], v[128:143]
    ds_read_b64_tr_b16 v[50:51], v6 offset:55808
    s_waitcnt lgkmcnt(6)
    v_mfma_f32_32x32x16_bf16 v[80:95], v[36:39], a[120:123], v[80:95]
    ds_read_b64_tr_b16 v[52:53], v7 offset:55296
    v_mfma_f32_32x32x16_bf16 v[144:159], v[36:39], a[248:251], v[144:159]
    ds_read_b64_tr_b16 v[54:55], v7 offset:55808
    s_waitcnt lgkmcnt(6)
    v_mfma_f32_32x32x16_bf16 v[96:111], v[40:43], a[120:123], v[96:111]
    ds_read_b64_tr_b16 v[56:57], v6 offset:63488
    v_mfma_f32_32x32x16_bf16 v[160:175], v[40:43], a[248:251], v[160:175]
    ds_read_b64_tr_b16 v[58:59], v6 offset:64000
    s_waitcnt lgkmcnt(6)
    v_mfma_f32_32x32x16_bf16 v[112:127], v[44:47], a[120:123], v[112:127]
    ds_read_b64_tr_b16 v[60:61], v7 offset:63488
    v_mfma_f32_32x32x16_bf16 v[176:191], v[44:47], a[248:251], v[176:191]
    ds_read_b64_tr_b16 v[62:63], v7 offset:64000
    s_waitcnt lgkmcnt(0)
    s_waitcnt vmcnt(8)
    s_barrier
    v_mfma_f32_32x32x16_bf16 v[64:79], v[48:51], a[124:127], v[64:79]
    s_add_u32 m0, s59, 0xc000
    s_add_u32 s60, s69, 0x300000
    buffer_load_dwordx4 v12, s[44:47], s60 offen offset:0 lds
    ds_read_b64_tr_b16 v[32:33], v6 offset:0
    v_mfma_f32_32x32x16_bf16 v[128:143], v[48:51], a[252:255], v[128:143]
    v_mfma_f32_32x32x16_bf16 v[80:95], v[52:55], a[124:127], v[80:95]
    buffer_load_dwordx4 v13, s[44:47], s60 offen offset:1024 lds
    ds_read_b64_tr_b16 v[34:35], v6 offset:512
    v_mfma_f32_32x32x16_bf16 v[144:159], v[52:55], a[252:255], v[144:159]
    v_mfma_f32_32x32x16_bf16 v[96:111], v[56:59], a[124:127], v[96:111]
    buffer_load_dwordx4 v14, s[44:47], s60 offen offset:2048 lds
    ds_read_b64_tr_b16 v[36:37], v7 offset:0
    v_mfma_f32_32x32x16_bf16 v[160:175], v[56:59], a[252:255], v[160:175]
    v_mfma_f32_32x32x16_bf16 v[112:127], v[60:63], a[124:127], v[112:127]
    buffer_load_dwordx4 v15, s[44:47], s60 offen offset:3072 lds
    ds_read_b64_tr_b16 v[38:39], v7 offset:512
    v_mfma_f32_32x32x16_bf16 v[176:191], v[60:63], a[252:255], v[176:191]
    s_waitcnt lgkmcnt(2)
    v_mfma_f32_32x32x16_bf16 v[192:207], a[0:3], v[32:35], 0
    ds_read_b64_tr_b16 v[48:49], v6 offset:2048
    v_cvt_pk_bf16_f32 v64, v64, v65
    v_mfma_f32_32x32x16_bf16 v[224:239], a[128:131], v[32:35], 0
    ds_read_b64_tr_b16 v[50:51], v6 offset:2560
    s_lshl_b32 s79, s58, 2
    s_waitcnt lgkmcnt(2)
    v_mfma_f32_32x32x16_bf16 v[208:223], a[0:3], v[36:39], 0
    ds_read_b64_tr_b16 v[52:53], v7 offset:2048
    v_mfma_f32_32x32x16_bf16 v[240:255], a[128:131], v[36:39], 0
    v_cvt_pk_bf16_f32 v65, v66, v67
    ds_read_b64_tr_b16 v[54:55], v7 offset:2560
    s_waitcnt lgkmcnt(2)
    v_mfma_f32_32x32x16_bf16 v[192:207], a[4:7], v[48:51], v[192:207]
    ds_read_b64_tr_b16 v[32:33], v6 offset:4096
    s_lshl_b32 s74, s2, 2
    s_add_u32 s74, s74, s56
    s_lshl_b32 s74, s74, 13
    s_mov_b32 s48, s8
    s_mov_b32 s49, s9
    s_mov_b32 s50, 0x400000
    s_mov_b32 s51, 0x20000
    s_cmp_ge_u32 s74, s50
    s_cselect_b32 s76, s50, 0
    s_cselect_b32 s48, s18, s48
    s_cselect_b32 s49, s19, s49
    s_cselect_b32 s50, 0x1c0000, s50
    s_sub_u32 s74, s74, s76
    s_cmp_ge_u32 s74, s50
    s_cselect_b32 s76, s50, 0
    s_cselect_b32 s48, s20, s48
    s_cselect_b32 s49, s21, s49
    s_cselect_b32 s50, 0x1c0000, s50
    s_sub_u32 s74, s74, s76
    v_lshlrev_b32 v5, 7, v1
    buffer_load_dword v28, v5, s[48:51], s74 offen
    v_mfma_f32_32x32x16_bf16 v[224:239], a[132:135], v[48:51], v[224:239]
    s_add_u32 s30, s79, s56
    ds_read_b64_tr_b16 v[34:35], v6 offset:4608
    v_cvt_pk_bf16_f32 v66, v68, v69
    s_waitcnt lgkmcnt(2)
    v_mfma_f32_32x32x16_bf16 v[208:223], a[4:7], v[52:55], v[208:223]
    ds_read_b64_tr_b16 v[36:37], v7 offset:4096
    v_cvt_pk_bf16_f32 v67, v70, v71
    v_mfma_f32_32x32x16_bf16 v[240:255], a[132:135], v[52:55], v[240:255]
    ds_read_b64_tr_b16 v[38:39], v7 offset:4608
    s_sub_u32 s81, 60, s79
    s_waitcnt lgkmcnt(2)
    v_mfma_f32_32x32x16_bf16 v[192:207], a[8:11], v[32:35], v[192:207]
    ds_read_b64_tr_b16 v[48:49], v6 offset:6144
    s_add_u32 s3, s100, 0
    v_mfma_f32_32x32x16_bf16 v[224:239], a[136:139], v[32:35], v[224:239]
    ds_read_b64_tr_b16 v[50:51], v6 offset:6656
    buffer_store_dwordx4 v[64:67], v2, s[32:35], s3 offen offset:0 sc1
    s_waitcnt lgkmcnt(2)
    v_mfma_f32_32x32x16_bf16 v[208:223], a[8:11], v[36:39], v[208:223]
    ds_read_b64_tr_b16 v[52:53], v7 offset:6144
    v_mfma_f32_32x32x16_bf16 v[240:255], a[136:139], v[36:39], v[240:255]
    s_add_u32 s81, s81, s56
    ds_read_b64_tr_b16 v[54:55], v7 offset:6656
    s_waitcnt lgkmcnt(2)
    v_mfma_f32_32x32x16_bf16 v[192:207], a[12:15], v[48:51], v[192:207]
    ds_read_b64_tr_b16 v[32:33], v6 offset:8192
    v_cvt_pk_bf16_f32 v72, v72, v73
    v_mfma_f32_32x32x16_bf16 v[224:239], a[140:143], v[48:51], v[224:239]
    ds_read_b64_tr_b16 v[34:35], v6 offset:8704
    v_cvt_pk_bf16_f32 v73, v74, v75
    s_waitcnt lgkmcnt(2)
    v_mfma_f32_32x32x16_bf16 v[208:223], a[12:15], v[52:55], v[208:223]
    ds_read_b64_tr_b16 v[36:37], v7 offset:8192
    s_lshl_b32 s62, s81, 15
    v_mfma_f32_32x32x16_bf16 v[240:255], a[140:143], v[52:55], v[240:255]
    ds_read_b64_tr_b16 v[38:39], v7 offset:8704
    v_cvt_pk_bf16_f32 v74, v76, v77
    s_waitcnt lgkmcnt(2)
    v_mfma_f32_32x32x16_bf16 v[192:207], a[16:19], v[32:35], v[192:207]
    ds_read_b64_tr_b16 v[48:49], v6 offset:10240
    s_lshl_b32 s63, s30, 15
    v_mfma_f32_32x32x16_bf16 v[224:239], a[144:147], v[32:35], v[224:239]
    ds_read_b64_tr_b16 v[50:51], v6 offset:10752
    v_cvt_pk_bf16_f32 v75, v78, v79
    s_waitcnt lgkmcnt(2)
    v_mfma_f32_32x32x16_bf16 v[208:223], a[16:19], v[36:39], v[208:223]
    ds_read_b64_tr_b16 v[52:53], v7 offset:10240
    v_mfma_f32_32x32x16_bf16 v[240:255], a[144:147], v[36:39], v[240:255]
    s_add_u32 s3, s100, 0
    ds_read_b64_tr_b16 v[54:55], v7 offset:10752
    s_waitcnt lgkmcnt(2)
    v_mfma_f32_32x32x16_bf16 v[192:207], a[20:23], v[48:51], v[192:207]
    ds_read_b64_tr_b16 v[32:33], v6 offset:12288
    v_lshrrev_b32 v3, 3, v1
    v_mfma_f32_32x32x16_bf16 v[224:239], a[148:151], v[48:51], v[224:239]
    ds_read_b64_tr_b16 v[34:35], v6 offset:12800
    buffer_store_dwordx4 v[72:75], v2, s[32:35], s3 offen offset:1024 sc1
    s_waitcnt lgkmcnt(2)
    v_mfma_f32_32x32x16_bf16 v[208:223], a[20:23], v[52:55], v[208:223]
    ds_read_b64_tr_b16 v[36:37], v7 offset:12288
    v_cvt_pk_bf16_f32 v80, v80, v81
    v_mfma_f32_32x32x16_bf16 v[240:255], a[148:151], v[52:55], v[240:255]
    ds_read_b64_tr_b16 v[38:39], v7 offset:12800
    v_mul_u32_u24 v3, 0xe00, v3
    s_waitcnt lgkmcnt(2)
    v_mfma_f32_32x32x16_bf16 v[192:207], a[24:27], v[32:35], v[192:207]
    ds_read_b64_tr_b16 v[48:49], v6 offset:14336
    v_cvt_pk_bf16_f32 v81, v82, v83
    v_mfma_f32_32x32x16_bf16 v[224:239], a[152:155], v[32:35], v[224:239]
    ds_read_b64_tr_b16 v[50:51], v6 offset:14848
    v_cvt_pk_bf16_f32 v82, v84, v85
    s_waitcnt lgkmcnt(2)
    v_mfma_f32_32x32x16_bf16 v[208:223], a[24:27], v[36:39], v[208:223]
    ds_read_b64_tr_b16 v[52:53], v7 offset:14336
    v_mfma_f32_32x32x16_bf16 v[240:255], a[152:155], v[36:39], v[240:255]
    v_bfe_u32 v4, v1, 4, 1
    ds_read_b64_tr_b16 v[54:55], v7 offset:14848
    s_waitcnt lgkmcnt(0)
    s_waitcnt vmcnt(11)
    s_barrier
    v_mfma_f32_32x32x16_bf16 v[192:207], a[28:31], v[48:51], v[192:207]
    s_add_u32 m0, s59, 0
    s_add_u32 s60, s70, 0
    buffer_load_dwordx4 v12, s[44:47], s60 offen offset:0 lds
    ds_read_b64_tr_b16 v[32:33], v6 offset:16384
    v_cvt_pk_bf16_f32 v83, v86, v87
    v_mfma_f32_32x32x16_bf16 v[224:239], a[156:159], v[48:51], v[224:239]
    ds_read_b64_tr_b16 v[34:35], v6 offset:16896
    v_lshlrev_b32 v4, 2, v4
    ds_read_b64_tr_b16 v[36:37], v7 offset:16384
    v_mfma_f32_32x32x16_bf16 v[208:223], a[28:31], v[52:55], v[208:223]
    buffer_load_dwordx4 v13, s[44:47], s60 offen offset:1024 lds
    s_add_u32 s3, s100, 0
    ds_read_b64_tr_b16 v[38:39], v7 offset:16896
    v_mfma_f32_32x32x16_bf16 v[240:255], a[156:159], v[52:55], v[240:255]
    buffer_store_dwordx4 v[80:83], v2, s[32:35], s3 offen offset:2048 sc1
    s_waitcnt lgkmcnt(2)
    v_mfma_f32_32x32x16_bf16 v[192:207], a[32:35], v[32:35], v[192:207]
    buffer_load_dwordx4 v14, s[44:47], s60 offen offset:2048 lds
    ds_read_b64_tr_b16 v[48:49], v6 offset:18432
    v_xor_b32 v4, v4, v1
    v_mfma_f32_32x32x16_bf16 v[224:239], a[160:163], v[32:35], v[224:239]
    ds_read_b64_tr_b16 v[50:51], v6 offset:18944
    v_cvt_pk_bf16_f32 v88, v88, v89
    s_waitcnt lgkmcnt(2)
    v_mfma_f32_32x32x16_bf16 v[208:223], a[32:35], v[36:39], v[208:223]
    buffer_load_dwordx4 v15, s[44:47], s60 offen offset:3072 lds
    ds_read_b64_tr_b16 v[52:53], v7 offset:18432
    v_mfma_f32_32x32x16_bf16 v[240:255], a[160:163], v[36:39], v[240:255]
    v_cvt_pk_bf16_f32 v89, v90, v91
    ds_read_b64_tr_b16 v[54:55], v7 offset:18944
    s_waitcnt lgkmcnt(2)
    v_mfma_f32_32x32x16_bf16 v[192:207], a[36:39], v[48:51], v[192:207]
    ds_read_b64_tr_b16 v[32:33], v6 offset:20480
    v_and_b32 v4, 7, v4
    v_mfma_f32_32x32x16_bf16 v[224:239], a[164:167], v[48:51], v[224:239]
    ds_read_b64_tr_b16 v[34:35], v6 offset:20992
    v_cvt_pk_bf16_f32 v90, v92, v93
    s_waitcnt lgkmcnt(2)
    v_mfma_f32_32x32x16_bf16 v[208:223], a[36:39], v[52:55], v[208:223]
    ds_read_b64_tr_b16 v[36:37], v7 offset:20480
    v_cvt_pk_bf16_f32 v91, v94, v95
    v_mfma_f32_32x32x16_bf16 v[240:255], a[164:167], v[52:55], v[240:255]
    ds_read_b64_tr_b16 v[38:39], v7 offset:20992
    v_lshlrev_b32 v4, 4, v4
    s_waitcnt lgkmcnt(2)
    v_mfma_f32_32x32x16_bf16 v[192:207], a[40:43], v[32:35], v[192:207]
    ds_read_b64_tr_b16 v[48:49], v6 offset:22528
    s_add_u32 s3, s100, 0
    v_mfma_f32_32x32x16_bf16 v[224:239], a[168:171], v[32:35], v[224:239]
    ds_read_b64_tr_b16 v[50:51], v6 offset:23040
    v_add_u32 v8, v3, v4
    s_waitcnt lgkmcnt(2)
    v_mfma_f32_32x32x16_bf16 v[208:223], a[40:43], v[36:39], v[208:223]
    ds_read_b64_tr_b16 v[52:53], v7 offset:22528
    buffer_store_dwordx4 v[88:91], v2, s[32:35], s3 offen offset:3072 sc1
    v_mfma_f32_32x32x16_bf16 v[240:255], a[168:171], v[36:39], v[240:255]
    ds_read_b64_tr_b16 v[54:55], v7 offset:23040
    s_waitcnt lgkmcnt(2)
    v_mfma_f32_32x32x16_bf16 v[192:207], a[44:47], v[48:51], v[192:207]
    ds_read_b64_tr_b16 v[32:33], v6 offset:24576
    v_cvt_pk_bf16_f32 v96, v96, v97
    v_mfma_f32_32x32x16_bf16 v[224:239], a[172:175], v[48:51], v[224:239]
    ds_read_b64_tr_b16 v[34:35], v6 offset:25088
    v_add_u32 v9, 0x6c00, v8
    s_waitcnt lgkmcnt(2)
    v_mfma_f32_32x32x16_bf16 v[208:223], a[44:47], v[52:55], v[208:223]
    ds_read_b64_tr_b16 v[36:37], v7 offset:24576
    v_cvt_pk_bf16_f32 v97, v98, v99
    v_mfma_f32_32x32x16_bf16 v[240:255], a[172:175], v[52:55], v[240:255]
    ds_read_b64_tr_b16 v[38:39], v7 offset:25088
    v_cvt_pk_bf16_f32 v98, v100, v101
    s_waitcnt lgkmcnt(2)
    v_mfma_f32_32x32x16_bf16 v[192:207], a[48:51], v[32:35], v[192:207]
    ds_read_b64_tr_b16 v[48:49], v6 offset:26624
    v_add_u32 v10, 0x6c00, v9
    v_mfma_f32_32x32x16_bf16 v[224:239], a[176:179], v[32:35], v[224:239]
    ds_read_b64_tr_b16 v[50:51], v6 offset:27136
    v_cvt_pk_bf16_f32 v99, v102, v103
    s_waitcnt lgkmcnt(2)
    v_mfma_f32_32x32x16_bf16 v[208:223], a[48:51], v[36:39], v[208:223]
    ds_read_b64_tr_b16 v[52:53], v7 offset:26624
    v_mfma_f32_32x32x16_bf16 v[240:255], a[176:179], v[36:39], v[240:255]
    s_add_u32 s3, s100, 0x1000
    ds_read_b64_tr_b16 v[54:55], v7 offset:27136
    s_waitcnt lgkmcnt(2)
    v_mfma_f32_32x32x16_bf16 v[192:207], a[52:55], v[48:51], v[192:207]
    ds_read_b64_tr_b16 v[32:33], v6 offset:28672
    v_add_u32 v11, 0x6c00, v10
    v_mfma_f32_32x32x16_bf16 v[224:239], a[180:183], v[48:51], v[224:239]
    ds_read_b64_tr_b16 v[34:35], v6 offset:29184
    buffer_store_dwordx4 v[96:99], v2, s[32:35], s3 offen offset:0 sc1
    s_waitcnt lgkmcnt(2)
    v_mfma_f32_32x32x16_bf16 v[208:223], a[52:55], v[52:55], v[208:223]
    ds_read_b64_tr_b16 v[36:37], v7 offset:28672
    s_and_b32 s79, s56, 1
    v_mfma_f32_32x32x16_bf16 v[240:255], a[180:183], v[52:55], v[240:255]
    ds_read_b64_tr_b16 v[38:39], v7 offset:29184
    v_cvt_pk_bf16_f32 v104, v104, v105
    s_waitcnt lgkmcnt(2)
    v_mfma_f32_32x32x16_bf16 v[192:207], a[56:59], v[32:35], v[192:207]
    ds_read_b64_tr_b16 v[48:49], v6 offset:30720
    v_cvt_pk_bf16_f32 v105, v106, v107
    v_mfma_f32_32x32x16_bf16 v[224:239], a[184:187], v[32:35], v[224:239]
    ds_read_b64_tr_b16 v[50:51], v6 offset:31232
    s_mul_i32 s79, s79, 0x1c000
    s_waitcnt lgkmcnt(2)
    v_mfma_f32_32x32x16_bf16 v[208:223], a[56:59], v[36:39], v[208:223]
    ds_read_b64_tr_b16 v[52:53], v7 offset:30720
    v_mfma_f32_32x32x16_bf16 v[240:255], a[184:187], v[36:39], v[240:255]
    v_cvt_pk_bf16_f32 v106, v108, v109
    ds_read_b64_tr_b16 v[54:55], v7 offset:31232
    s_waitcnt lgkmcnt(0)
    s_waitcnt vmcnt(14)
    s_barrier
    v_mfma_f32_32x32x16_bf16 v[192:207], a[60:63], v[48:51], v[192:207]
    s_add_u32 m0, s59, 0x4000
    s_add_u32 s60, s70, 0x100000
    buffer_load_dwordx4 v12, s[44:47], s60 offen offset:0 lds
    ds_read_b64_tr_b16 v[32:33], v6 offset:32768
    v_cvt_pk_bf16_f32 v107, v110, v111
    v_mfma_f32_32x32x16_bf16 v[224:239], a[188:191], v[48:51], v[224:239]
    ds_read_b64_tr_b16 v[34:35], v6 offset:33280
    s_lshl_b32 s80, s57, 7
    ds_read_b64_tr_b16 v[36:37], v7 offset:32768
    v_mfma_f32_32x32x16_bf16 v[208:223], a[60:63], v[52:55], v[208:223]
    buffer_load_dwordx4 v13, s[44:47], s60 offen offset:1024 lds
    s_add_u32 s3, s100, 0x1000
    ds_read_b64_tr_b16 v[38:39], v7 offset:33280
    v_mfma_f32_32x32x16_bf16 v[240:255], a[188:191], v[52:55], v[240:255]
    buffer_store_dwordx4 v[104:107], v2, s[32:35], s3 offen offset:1024 sc1
    s_waitcnt lgkmcnt(2)
    v_mfma_f32_32x32x16_bf16 v[192:207], a[64:67], v[32:35], v[192:207]
    buffer_load_dwordx4 v14, s[44:47], s60 offen offset:2048 lds
    ds_read_b64_tr_b16 v[48:49], v6 offset:34816
    s_add_u32 s64, s79, s80
    v_mfma_f32_32x32x16_bf16 v[224:239], a[192:195], v[32:35], v[224:239]
    ds_read_b64_tr_b16 v[50:51], v6 offset:35328
    v_cvt_pk_bf16_f32 v112, v112, v113
    s_waitcnt lgkmcnt(2)
    v_mfma_f32_32x32x16_bf16 v[208:223], a[64:67], v[36:39], v[208:223]
    buffer_load_dwordx4 v15, s[44:47], s60 offen offset:3072 lds
    ds_read_b64_tr_b16 v[52:53], v7 offset:34816
    s_mov_b32 s65, s69
    v_mfma_f32_32x32x16_bf16 v[240:255], a[192:195], v[36:39], v[240:255]
    ds_read_b64_tr_b16 v[54:55], v7 offset:35328
    v_cvt_pk_bf16_f32 v113, v114, v115
    s_waitcnt lgkmcnt(2)
    v_mfma_f32_32x32x16_bf16 v[192:207], a[68:71], v[48:51], v[192:207]
    ds_read_b64_tr_b16 v[32:33], v6 offset:36864
    v_cvt_pk_bf16_f32 v114, v116, v117
    v_mfma_f32_32x32x16_bf16 v[224:239], a[196:199], v[48:51], v[224:239]
    ds_read_b64_tr_b16 v[34:35], v6 offset:37376
    s_mov_b32 s66, s70
    s_waitcnt lgkmcnt(2)
    v_mfma_f32_32x32x16_bf16 v[208:223], a[68:71], v[52:55], v[208:223]
    ds_read_b64_tr_b16 v[36:37], v7 offset:36864
    v_mfma_f32_32x32x16_bf16 v[240:255], a[196:199], v[52:55], v[240:255]
    v_cvt_pk_bf16_f32 v115, v118, v119
    ds_read_b64_tr_b16 v[38:39], v7 offset:37376
    s_waitcnt lgkmcnt(2)
    v_mfma_f32_32x32x16_bf16 v[192:207], a[72:75], v[32:35], v[192:207]
    ds_read_b64_tr_b16 v[48:49], v6 offset:38912
    s_add_u32 s3, s100, 0x1000
    v_mfma_f32_32x32x16_bf16 v[224:239], a[200:203], v[32:35], v[224:239]
    ds_read_b64_tr_b16 v[50:51], v6 offset:39424
    s_lshl_b32 s31, s57, 2
    ds_read_b64_tr_b16 v[52:53], v7 offset:38912
    s_waitcnt lgkmcnt(3)
    v_mfma_f32_32x32x16_bf16 v[208:223], a[72:75], v[36:39], v[208:223]
    buffer_store_dwordx4 v[112:115], v2, s[32:35], s3 offen offset:2048 sc1
    v_mfma_f32_32x32x16_bf16 v[240:255], a[200:203], v[36:39], v[240:255]
    ds_read_b64_tr_b16 v[54:55], v7 offset:39424
    v_cvt_pk_bf16_f32 v120, v120, v121
    s_waitcnt lgkmcnt(2)
    v_mfma_f32_32x32x16_bf16 v[192:207], a[76:79], v[48:51], v[192:207]
    ds_read_b64_tr_b16 v[32:33], v6 offset:40960
    s_add_u32 s31, s31, 4
    v_mfma_f32_32x32x16_bf16 v[224:239], a[204:207], v[48:51], v[224:239]
    ds_read_b64_tr_b16 v[34:35], v6 offset:41472
    v_cvt_pk_bf16_f32 v121, v122, v123
    s_waitcnt lgkmcnt(2)
    v_mfma_f32_32x32x16_bf16 v[208:223], a[76:79], v[52:55], v[208:223]
    ds_read_b64_tr_b16 v[36:37], v7 offset:40960
    v_mfma_f32_32x32x16_bf16 v[240:255], a[204:207], v[52:55], v[240:255]
    s_cmp_lt_u32 s56, 2
    ds_read_b64_tr_b16 v[38:39], v7 offset:41472
    s_waitcnt lgkmcnt(2)
    v_mfma_f32_32x32x16_bf16 v[192:207], a[80:83], v[32:35], v[192:207]
    ds_read_b64_tr_b16 v[48:49], v6 offset:43008
    v_cvt_pk_bf16_f32 v122, v124, v125
    v_mfma_f32_32x32x16_bf16 v[224:239], a[208:211], v[32:35], v[224:239]
    ds_read_b64_tr_b16 v[50:51], v6 offset:43520
    v_cvt_pk_bf16_f32 v123, v126, v127
    s_waitcnt lgkmcnt(2)
    v_mfma_f32_32x32x16_bf16 v[208:223], a[80:83], v[36:39], v[208:223]
    ds_read_b64_tr_b16 v[52:53], v7 offset:43008
    s_cmp_lt_u32 s56, 2
    s_cselect_b32 s36, s18, s20
    s_cselect_b32 s37, s19, s21
    v_mfma_f32_32x32x16_bf16 v[240:255], a[208:211], v[36:39], v[240:255]
    ds_read_b64_tr_b16 v[54:55], v7 offset:43520
    s_add_u32 s3, s100, 0x1000
    s_waitcnt lgkmcnt(2)
    v_mfma_f32_32x32x16_bf16 v[192:207], a[84:87], v[48:51], v[192:207]
    ds_read_b64_tr_b16 v[32:33], v6 offset:45056
    buffer_store_dwordx4 v[120:123], v2, s[32:35], s3 offen offset:3072 sc1
    v_mfma_f32_32x32x16_bf16 v[224:239], a[212:215], v[48:51], v[224:239]
    ds_read_b64_tr_b16 v[34:35], v6 offset:45568
    s_waitcnt lgkmcnt(2)
    v_mfma_f32_32x32x16_bf16 v[208:223], a[84:87], v[52:55], v[208:223]
    s_mov_b32 s38, 0x1c0000
    ds_read_b64_tr_b16 v[36:37], v7 offset:45056
    v_mfma_f32_32x32x16_bf16 v[240:255], a[212:215], v[52:55], v[240:255]
    v_cvt_pk_bf16_f32 v128, v128, v129
    ds_read_b64_tr_b16 v[38:39], v7 offset:45568
    s_waitcnt lgkmcnt(2)
    v_mfma_f32_32x32x16_bf16 v[192:207], a[88:91], v[32:35], v[192:207]
    ds_read_b64_tr_b16 v[48:49], v6 offset:47104
    v_cvt_pk_bf16_f32 v129, v130, v131
    v_mfma_f32_32x32x16_bf16 v[224:239], a[216:219], v[32:35], v[224:239]
    ds_read_b64_tr_b16 v[50:51], v6 offset:47616
    s_mov_b32 s40, s8
    s_waitcnt lgkmcnt(2)
    v_mfma_f32_32x32x16_bf16 v[208:223], a[88:91], v[36:39], v[208:223]
    ds_read_b64_tr_b16 v[52:53], v7 offset:47104
    v_cvt_pk_bf16_f32 v130, v132, v133
    v_mfma_f32_32x32x16_bf16 v[240:255], a[216:219], v[36:39], v[240:255]
    ds_read_b64_tr_b16 v[54:55], v7 offset:47616
    s_mov_b32 s41, s9
    s_waitcnt lgkmcnt(0)
    s_waitcnt vmcnt(17)
    s_barrier
    v_mfma_f32_32x32x16_bf16 v[192:207], a[92:95], v[48:51], v[192:207]
    s_add_u32 m0, s59, 0x8000
    s_add_u32 s60, s70, 0x200000
    buffer_load_dwordx4 v12, s[44:47], s60 offen offset:0 lds
    ds_read_b64_tr_b16 v[32:33], v6 offset:49152
    v_cvt_pk_bf16_f32 v131, v134, v135
    v_mfma_f32_32x32x16_bf16 v[224:239], a[220:223], v[48:51], v[224:239]
    ds_read_b64_tr_b16 v[34:35], v6 offset:49664
    s_add_u32 s3, s100, 0x2000
    v_mfma_f32_32x32x16_bf16 v[208:223], a[92:95], v[52:55], v[208:223]
    buffer_load_dwordx4 v13, s[44:47], s60 offen offset:1024 lds
    ds_read_b64_tr_b16 v[36:37], v7 offset:49152
    v_mfma_f32_32x32x16_bf16 v[240:255], a[220:223], v[52:55], v[240:255]
    s_mov_b32 s42, 0x400000
    ds_read_b64_tr_b16 v[38:39], v7 offset:49664
    s_waitcnt lgkmcnt(2)
    v_mfma_f32_32x32x16_bf16 v[192:207], a[96:99], v[32:35], v[192:207]
    buffer_load_dwordx4 v14, s[44:47], s60 offen offset:2048 lds
    ds_read_b64_tr_b16 v[48:49], v6 offset:51200
    buffer_store_dwordx4 v[128:131], v2, s[32:35], s3 offen offset:0 sc1
    v_mfma_f32_32x32x16_bf16 v[224:239], a[224:227], v[32:35], v[224:239]
    ds_read_b64_tr_b16 v[50:51], v6 offset:51712
    v_cvt_pk_bf16_f32 v136, v136, v137
    s_waitcnt lgkmcnt(2)
    v_mfma_f32_32x32x16_bf16 v[208:223], a[96:99], v[36:39], v[208:223]
    buffer_load_dwordx4 v15, s[44:47], s60 offen offset:3072 lds
    ds_read_b64_tr_b16 v[52:53], v7 offset:51200
    s_mov_b32 s43, 0x20000
    v_mfma_f32_32x32x16_bf16 v[240:255], a[224:227], v[36:39], v[240:255]
    ds_read_b64_tr_b16 v[54:55], v7 offset:51712
    v_cvt_pk_bf16_f32 v137, v138, v139
    s_waitcnt lgkmcnt(2)
    v_mfma_f32_32x32x16_bf16 v[192:207], a[100:103], v[48:51], v[192:207]
    ds_read_b64_tr_b16 v[32:33], v6 offset:53248
    v_cvt_pk_bf16_f32 v138, v140, v141
    v_mfma_f32_32x32x16_bf16 v[224:239], a[228:231], v[48:51], v[224:239]
    ds_read_b64_tr_b16 v[34:35], v6 offset:53760
    v_mov_b32 v16, 0xbdd2d3e8
    s_waitcnt lgkmcnt(2)
    v_mfma_f32_32x32x16_bf16 v[208:223], a[100:103], v[52:55], v[208:223]
    ds_read_b64_tr_b16 v[36:37], v7 offset:53248
    v_mfma_f32_32x32x16_bf16 v[240:255], a[228:231], v[52:55], v[240:255]
    v_cvt_pk_bf16_f32 v139, v142, v143
    ds_read_b64_tr_b16 v[38:39], v7 offset:53760
    s_waitcnt lgkmcnt(2)
    v_mfma_f32_32x32x16_bf16 v[192:207], a[104:107], v[32:35], v[192:207]
    ds_read_b64_tr_b16 v[48:49], v6 offset:55296
    s_mul_i32 s79, s81, 0x5c000
    v_mfma_f32_32x32x16_bf16 v[224:239], a[232:235], v[32:35], v[224:239]
    ds_read_b64_tr_b16 v[50:51], v6 offset:55808
    s_add_u32 s3, s100, 0x2000
    ds_read_b64_tr_b16 v[52:53], v7 offset:55296
    s_waitcnt lgkmcnt(3)
    v_mfma_f32_32x32x16_bf16 v[208:223], a[104:107], v[36:39], v[208:223]
    buffer_store_dwordx4 v[136:139], v2, s[32:35], s3 offen offset:1024 sc1
    v_mfma_f32_32x32x16_bf16 v[240:255], a[232:235], v[36:39], v[240:255]
    ds_read_b64_tr_b16 v[54:55], v7 offset:55808
    s_lshl_b32 s80, s57, 12
    s_waitcnt lgkmcnt(2)
    v_mfma_f32_32x32x16_bf16 v[192:207], a[108:111], v[48:51], v[192:207]
    ds_read_b64_tr_b16 v[32:33], v6 offset:57344
    v_cvt_pk_bf16_f32 v144, v144, v145
    v_mfma_f32_32x32x16_bf16 v[224:239], a[236:239], v[48:51], v[224:239]
    ds_read_b64_tr_b16 v[34:35], v6 offset:57856
    v_cvt_pk_bf16_f32 v145, v146, v147
    s_waitcnt lgkmcnt(2)
    v_mfma_f32_32x32x16_bf16 v[208:223], a[108:111], v[52:55], v[208:223]
    ds_read_b64_tr_b16 v[36:37], v7 offset:57344
    v_mfma_f32_32x32x16_bf16 v[240:255], a[236:239], v[52:55], v[240:255]
    s_add_u32 s67, s79, s80
    ds_read_b64_tr_b16 v[38:39], v7 offset:57856
    s_waitcnt lgkmcnt(2)
    v_mfma_f32_32x32x16_bf16 v[192:207], a[112:115], v[32:35], v[192:207]
    ds_read_b64_tr_b16 v[48:49], v6 offset:59392
    v_cvt_pk_bf16_f32 v146, v148, v149
    v_mfma_f32_32x32x16_bf16 v[224:239], a[240:243], v[32:35], v[224:239]
    ds_read_b64_tr_b16 v[50:51], v6 offset:59904
    v_cvt_pk_bf16_f32 v147, v150, v151
    s_waitcnt lgkmcnt(2)
    v_mfma_f32_32x32x16_bf16 v[208:223], a[112:115], v[36:39], v[208:223]
    ds_read_b64_tr_b16 v[52:53], v7 offset:59392
    s_add_u32 s67, s67, 0x2240000
    v_mfma_f32_32x32x16_bf16 v[240:255], a[240:243], v[36:39], v[240:255]
    ds_read_b64_tr_b16 v[54:55], v7 offset:59904
    s_add_u32 s3, s100, 0x2000
    s_waitcnt lgkmcnt(2)
    v_mfma_f32_32x32x16_bf16 v[192:207], a[116:119], v[48:51], v[192:207]
    ds_read_b64_tr_b16 v[32:33], v6 offset:61440
    s_mul_i32 s79, s30, 0x5c000
    v_mfma_f32_32x32x16_bf16 v[224:239], a[244:247], v[48:51], v[224:239]
    ds_read_b64_tr_b16 v[34:35], v6 offset:61952
    buffer_store_dwordx4 v[144:147], v2, s[32:35], s3 offen offset:2048 sc1
    s_waitcnt lgkmcnt(2)
    v_mfma_f32_32x32x16_bf16 v[208:223], a[116:119], v[52:55], v[208:223]
    ds_read_b64_tr_b16 v[36:37], v7 offset:61440
    v_mfma_f32_32x32x16_bf16 v[240:255], a[244:247], v[52:55], v[240:255]
    v_cvt_pk_bf16_f32 v152, v152, v153
    ds_read_b64_tr_b16 v[38:39], v7 offset:61952
    s_waitcnt lgkmcnt(2)
    v_mfma_f32_32x32x16_bf16 v[192:207], a[120:123], v[32:35], v[192:207]
    ds_read_b64_tr_b16 v[48:49], v6 offset:63488
    s_lshl_b32 s80, s57, 12
    v_mfma_f32_32x32x16_bf16 v[224:239], a[248:251], v[32:35], v[224:239]
    ds_read_b64_tr_b16 v[50:51], v6 offset:64000
    v_cvt_pk_bf16_f32 v153, v154, v155
    s_waitcnt lgkmcnt(2)
    v_mfma_f32_32x32x16_bf16 v[208:223], a[120:123], v[36:39], v[208:223]
    ds_read_b64_tr_b16 v[52:53], v7 offset:63488
    v_cvt_pk_bf16_f32 v154, v156, v157
    v_mfma_f32_32x32x16_bf16 v[240:255], a[248:251], v[36:39], v[240:255]
    ds_read_b64_tr_b16 v[54:55], v7 offset:64000
    s_add_u32 s68, s79, s80
    s_waitcnt lgkmcnt(0)
    s_waitcnt vmcnt(16)
    s_barrier
    buffer_load_dword v25, off, s[96:99], 0 offset:0 sc1
    v_mfma_f32_32x32x16_bf16 v[192:207], a[124:127], v[48:51], v[192:207]
    s_add_u32 m0, s59, 0xc000
    s_add_u32 s60, s70, 0x300000
    buffer_load_dwordx4 v12, s[44:47], s60 offen offset:0 lds
    ds_read_b64_tr_b16 v[32:33], v6 offset:0
    v_cvt_pk_bf16_f32 v155, v158, v159
    v_mfma_f32_32x32x16_bf16 v[224:239], a[252:255], v[48:51], v[224:239]
    ds_read_b64_tr_b16 v[34:35], v6 offset:512
    s_add_u32 s3, s100, 0x2000
    ds_read_b64_tr_b16 v[36:37], v7 offset:0
    v_mfma_f32_32x32x16_bf16 v[208:223], a[124:127], v[52:55], v[208:223]
    buffer_load_dwordx4 v13, s[44:47], s60 offen offset:1024 lds
    s_add_u32 s68, s68, 0x2240000
    ds_read_b64_tr_b16 v[38:39], v7 offset:512
    v_mfma_f32_32x32x16_bf16 v[240:255], a[252:255], v[52:55], v[240:255]
    buffer_store_dwordx4 v[152:155], v2, s[32:35], s3 offen offset:3072 sc1
    s_waitcnt lgkmcnt(2)
    v_mfma_f32_32x32x16_bf16 v[64:79], a[0:3], v[32:35], 0
    buffer_load_dwordx4 v14, s[44:47], s60 offen offset:2048 lds
    ds_read_b64_tr_b16 v[48:49], v6 offset:2048
    v_cvt_pk_bf16_f32 v160, v160, v161
    v_mfma_f32_32x32x16_bf16 v[96:111], a[128:131], v[32:35], 0
    ds_read_b64_tr_b16 v[50:51], v6 offset:2560
    s_waitcnt lgkmcnt(2)
    v_mfma_f32_32x32x16_bf16 v[80:95], a[0:3], v[36:39], 0
    buffer_load_dwordx4 v15, s[44:47], s60 offen offset:3072 lds
    ds_read_b64_tr_b16 v[52:53], v7 offset:2048
    v_cvt_pk_bf16_f32 v161, v162, v163
    v_mfma_f32_32x32x16_bf16 v[112:127], a[128:131], v[36:39], 0
    ds_read_b64_tr_b16 v[54:55], v7 offset:2560
    s_waitcnt lgkmcnt(2)
    v_mfma_f32_32x32x16_bf16 v[64:79], a[4:7], v[48:51], v[64:79]
    ds_read_b64_tr_b16 v[32:33], v6 offset:4096
    v_cvt_pk_bf16_f32 v162, v164, v165
    v_mfma_f32_32x32x16_bf16 v[96:111], a[132:135], v[48:51], v[96:111]
    ds_read_b64_tr_b16 v[34:35], v6 offset:4608
    v_cvt_pk_bf16_f32 v163, v166, v167
    s_waitcnt lgkmcnt(2)
    v_mfma_f32_32x32x16_bf16 v[80:95], a[4:7], v[52:55], v[80:95]
    ds_read_b64_tr_b16 v[36:37], v7 offset:4096
    v_mfma_f32_32x32x16_bf16 v[112:127], a[132:135], v[52:55], v[112:127]
    s_add_u32 s3, s100, 0x3000
    ds_read_b64_tr_b16 v[38:39], v7 offset:4608
    s_waitcnt lgkmcnt(2)
    v_mfma_f32_32x32x16_bf16 v[64:79], a[8:11], v[32:35], v[64:79]
    ds_read_b64_tr_b16 v[48:49], v6 offset:6144
    v_mfma_f32_32x32x16_bf16 v[96:111], a[136:139], v[32:35], v[96:111]
    buffer_store_dwordx4 v[160:163], v2, s[32:35], s3 offen offset:0 sc1
    ds_read_b64_tr_b16 v[50:51], v6 offset:6656
    s_waitcnt lgkmcnt(2)
    v_mfma_f32_32x32x16_bf16 v[80:95], a[8:11], v[36:39], v[80:95]
    ds_read_b64_tr_b16 v[52:53], v7 offset:6144
    v_mfma_f32_32x32x16_bf16 v[112:127], a[136:139], v[36:39], v[112:127]
    v_cvt_pk_bf16_f32 v168, v168, v169
    ds_read_b64_tr_b16 v[54:55], v7 offset:6656
    s_waitcnt lgkmcnt(2)
    v_mfma_f32_32x32x16_bf16 v[64:79], a[12:15], v[48:51], v[64:79]
    ds_read_b64_tr_b16 v[32:33], v6 offset:8192
    v_cvt_pk_bf16_f32 v169, v170, v171
    v_mfma_f32_32x32x16_bf16 v[96:111], a[140:143], v[48:51], v[96:111]
    ds_read_b64_tr_b16 v[34:35], v6 offset:8704
    v_cvt_pk_bf16_f32 v170, v172, v173
    s_waitcnt lgkmcnt(2)
    v_mfma_f32_32x32x16_bf16 v[80:95], a[12:15], v[52:55], v[80:95]
    ds_read_b64_tr_b16 v[36:37], v7 offset:8192
    v_mfma_f32_32x32x16_bf16 v[112:127], a[140:143], v[52:55], v[112:127]
    v_cvt_pk_bf16_f32 v171, v174, v175
    ds_read_b64_tr_b16 v[38:39], v7 offset:8704
    s_waitcnt lgkmcnt(2)
    v_mfma_f32_32x32x16_bf16 v[64:79], a[16:19], v[32:35], v[64:79]
    ds_read_b64_tr_b16 v[48:49], v6 offset:10240
    s_add_u32 s3, s100, 0x3000
    v_mfma_f32_32x32x16_bf16 v[96:111], a[144:147], v[32:35], v[96:111]
    ds_read_b64_tr_b16 v[50:51], v6 offset:10752
    buffer_store_dwordx4 v[168:171], v2, s[32:35], s3 offen offset:1024 sc1
    s_waitcnt lgkmcnt(2)
    v_mfma_f32_32x32x16_bf16 v[80:95], a[16:19], v[36:39], v[80:95]
    ds_read_b64_tr_b16 v[52:53], v7 offset:10240
    v_mfma_f32_32x32x16_bf16 v[112:127], a[144:147], v[36:39], v[112:127]
    v_cvt_pk_bf16_f32 v176, v176, v177
    ds_read_b64_tr_b16 v[54:55], v7 offset:10752
    s_waitcnt lgkmcnt(2)
    v_mfma_f32_32x32x16_bf16 v[64:79], a[20:23], v[48:51], v[64:79]
    ds_read_b64_tr_b16 v[32:33], v6 offset:12288
    v_cvt_pk_bf16_f32 v177, v178, v179
    v_mfma_f32_32x32x16_bf16 v[96:111], a[148:151], v[48:51], v[96:111]
    ds_read_b64_tr_b16 v[34:35], v6 offset:12800
    s_waitcnt lgkmcnt(2)
    v_mfma_f32_32x32x16_bf16 v[80:95], a[20:23], v[52:55], v[80:95]
    ds_read_b64_tr_b16 v[36:37], v7 offset:12288
    v_cvt_pk_bf16_f32 v178, v180, v181
    v_mfma_f32_32x32x16_bf16 v[112:127], a[148:151], v[52:55], v[112:127]
    ds_read_b64_tr_b16 v[38:39], v7 offset:12800
    s_waitcnt lgkmcnt(2)
    v_mfma_f32_32x32x16_bf16 v[64:79], a[24:27], v[32:35], v[64:79]
    ds_read_b64_tr_b16 v[48:49], v6 offset:14336
    v_cvt_pk_bf16_f32 v179, v182, v183
    v_mfma_f32_32x32x16_bf16 v[96:111], a[152:155], v[32:35], v[96:111]
    ds_read_b64_tr_b16 v[50:51], v6 offset:14848
    s_add_u32 s3, s100, 0x3000
    s_waitcnt lgkmcnt(2)
    v_mfma_f32_32x32x16_bf16 v[80:95], a[24:27], v[36:39], v[80:95]
    ds_read_b64_tr_b16 v[52:53], v7 offset:14336
    buffer_store_dwordx4 v[176:179], v2, s[32:35], s3 offen offset:2048 sc1
    v_mfma_f32_32x32x16_bf16 v[112:127], a[152:155], v[36:39], v[112:127]
    ds_read_b64_tr_b16 v[54:55], v7 offset:14848
    s_waitcnt lgkmcnt(0)
    s_waitcnt vmcnt(18)
    s_barrier
    s_waitcnt vmcnt(8)
    v_readfirstlane_b32 s74, v25
    s_nop 0
    s_cmp_ge_u32 s74, 0x100
    s_cbranch_scc1 L_pollx_lnb
    s_mov_b32 s76, 0x10000
L_poll_lnb:
    buffer_load_dword v25, off, s[96:99], 0 offset:0 sc1
    s_waitcnt vmcnt(0)
    v_readfirstlane_b32 s74, v25
    s_sub_u32 s76, s76, 1
    s_cmp_eq_u32 s76, 0
    s_cbranch_scc1 L_pollx_lnb
    s_cmp_ge_u32 s74, 0x100
    s_cbranch_scc1 L_pollx_lnb
    s_sleep 2
    s_branch L_poll_lnb
L_pollx_lnb:
    v_mfma_f32_32x32x16_bf16 v[64:79], a[28:31], v[48:51], v[64:79]
    s_add_u32 s79, s62, 0
    buffer_load_dwordx4 a[0:3], v2, s[32:35], s79 offen offset:0
    ds_read_b64_tr_b16 v[32:33], v6 offset:16384
    v_cvt_pk_bf16_f32 v184, v184, v185
    v_mfma_f32_32x32x16_bf16 v[96:111], a[156:159], v[48:51], v[96:111]
    ds_read_b64_tr_b16 v[34:35], v6 offset:16896
    v_cvt_pk_bf16_f32 v185, v186, v187
    v_mfma_f32_32x32x16_bf16 v[80:95], a[28:31], v[52:55], v[80:95]
    buffer_load_dwordx4 a[4:7], v2, s[32:35], s79 offen offset:1024
    ds_read_b64_tr_b16 v[36:37], v7 offset:16384
    v_mfma_f32_32x32x16_bf16 v[112:127], a[156:159], v[52:55], v[112:127]
    v_cvt_pk_bf16_f32 v186, v188, v189
    ds_read_b64_tr_b16 v[38:39], v7 offset:16896
    s_waitcnt lgkmcnt(2)
    v_mfma_f32_32x32x16_bf16 v[64:79], a[32:35], v[32:35], v[64:79]
    buffer_load_dwordx4 a[8:11], v2, s[32:35], s79 offen offset:2048
    ds_read_b64_tr_b16 v[48:49], v6 offset:18432
    v_cvt_pk_bf16_f32 v187, v190, v191
    v_mfma_f32_32x32x16_bf16 v[96:111], a[160:163], v[32:35], v[96:111]
    buffer_load_dwordx4 a[12:15], v2, s[32:35], s79 offen offset:3072
    ds_read_b64_tr_b16 v[50:51], v6 offset:18944
    s_waitcnt lgkmcnt(2)
    v_mfma_f32_32x32x16_bf16 v[80:95], a[32:35], v[36:39], v[80:95]
    s_add_u32 s80, s63, 0
    buffer_load_dwordx4 a[128:131], v2, s[32:35], s80 offen offset:0
    ds_read_b64_tr_b16 v[52:53], v7 offset:18432
    s_add_u32 s3, s100, 0x3000
    v_mfma_f32_32x32x16_bf16 v[112:127], a[160:163], v[36:39], v[112:127]
    buffer_load_dwordx4 a[132:135], v2, s[32:35], s80 offen offset:1024
    ds_read_b64_tr_b16 v[54:55], v7 offset:18944
    s_waitcnt lgkmcnt(2)
    v_mfma_f32_32x32x16_bf16 v[64:79], a[36:39], v[48:51], v[64:79]
    buffer_load_dwordx4 a[136:139], v2, s[32:35], s80 offen offset:2048
    ds_read_b64_tr_b16 v[32:33], v6 offset:20480
    buffer_store_dwordx4 v[184:187], v2, s[32:35], s3 offen offset:3072 sc1
    v_mfma_f32_32x32x16_bf16 v[96:111], a[164:167], v[48:51], v[96:111]
    ds_read_b64_tr_b16 v[34:35], v6 offset:20992
    s_waitcnt lgkmcnt(2)
    v_mfma_f32_32x32x16_bf16 v[80:95], a[36:39], v[52:55], v[80:95]
    buffer_load_dwordx4 a[140:143], v2, s[32:35], s80 offen offset:3072
    v_cvt_pk_bf16_f32 v192, v192, v193
    ds_read_b64_tr_b16 v[36:37], v7 offset:20480
    v_mfma_f32_32x32x16_bf16 v[112:127], a[164:167], v[52:55], v[112:127]
    v_cvt_pk_bf16_f32 v193, v194, v195
    ds_read_b64_tr_b16 v[38:39], v7 offset:20992
    s_waitcnt lgkmcnt(2)
    v_mfma_f32_32x32x16_bf16 v[64:79], a[40:43], v[32:35], v[64:79]
    s_add_u32 s79, s62, 0x1000
    buffer_load_dwordx4 a[16:19], v2, s[32:35], s79 offen offset:0
    ds_read_b64_tr_b16 v[48:49], v6 offset:22528
    v_cvt_pk_bf16_f32 v194, v196, v197
    v_mfma_f32_32x32x16_bf16 v[96:111], a[168:171], v[32:35], v[96:111]
    ds_read_b64_tr_b16 v[50:51], v6 offset:23040
    s_waitcnt lgkmcnt(2)
    v_mfma_f32_32x32x16_bf16 v[80:95], a[40:43], v[36:39], v[80:95]
    buffer_load_dwordx4 a[20:23], v2, s[32:35], s79 offen offset:1024
    ds_read_b64_tr_b16 v[52:53], v7 offset:22528
    v_cvt_pk_bf16_f32 v195, v198, v199
    v_mfma_f32_32x32x16_bf16 v[112:127], a[168:171], v[36:39], v[112:127]
    ds_read_b64_tr_b16 v[54:55], v7 offset:23040
    s_waitcnt lgkmcnt(2)
    v_mfma_f32_32x32x16_bf16 v[64:79], a[44:47], v[48:51], v[64:79]
    buffer_load_dwordx4 a[24:27], v2, s[32:35], s79 offen offset:2048
    ds_read_b64_tr_b16 v[32:33], v6 offset:24576
    s_add_u32 s3, s101, 0
    v_mfma_f32_32x32x16_bf16 v[96:111], a[172:175], v[48:51], v[96:111]
    ds_read_b64_tr_b16 v[34:35], v6 offset:25088
    buffer_store_dwordx4 v[192:195], v2, s[32:35], s3 offen offset:0 sc1
    s_waitcnt lgkmcnt(2)
    v_mfma_f32_32x32x16_bf16 v[80:95], a[44:47], v[52:55], v[80:95]
    buffer_load_dwordx4 a[28:31], v2, s[32:35], s79 offen offset:3072
    ds_read_b64_tr_b16 v[36:37], v7 offset:24576
    v_mfma_f32_32x32x16_bf16 v[112:127], a[172:175], v[52:55], v[112:127]
    v_cvt_pk_bf16_f32 v200, v200, v201
    ds_read_b64_tr_b16 v[38:39], v7 offset:25088
    s_waitcnt lgkmcnt(2)
    v_mfma_f32_32x32x16_bf16 v[64:79], a[48:51], v[32:35], v[64:79]
    s_add_u32 s80, s63, 0x1000
    buffer_load_dwordx4 a[144:147], v2, s[32:35], s80 offen offset:0
    ds_read_b64_tr_b16 v[48:49], v6 offset:26624
    v_cvt_pk_bf16_f32 v201, v202, v203
    v_mfma_f32_32x32x16_bf16 v[96:111], a[176:179], v[32:35], v[96:111]
    buffer_load_dwordx4 a[148:151], v2, s[32:35], s80 offen offset:1024
    ds_read_b64_tr_b16 v[50:51], v6 offset:27136
    v_cvt_pk_bf16_f32 v202, v204, v205
    s_waitcnt lgkmcnt(2)
    v_mfma_f32_32x32x16_bf16 v[80:95], a[48:51], v[36:39], v[80:95]
    buffer_load_dwordx4 a[152:155], v2, s[32:35], s80 offen offset:2048
    ds_read_b64_tr_b16 v[52:53], v7 offset:26624
    v_mfma_f32_32x32x16_bf16 v[112:127], a[176:179], v[36:39], v[112:127]
    v_cvt_pk_bf16_f32 v203, v206, v207
    ds_read_b64_tr_b16 v[54:55], v7 offset:27136
    s_waitcnt lgkmcnt(2)
    v_mfma_f32_32x32x16_bf16 v[64:79], a[52:55], v[48:51], v[64:79]
    buffer_load_dwordx4 a[156:159], v2, s[32:35], s80 offen offset:3072
    ds_read_b64_tr_b16 v[32:33], v6 offset:28672
    s_add_u32 s3, s101, 0x1000
    v_mfma_f32_32x32x16_bf16 v[96:111], a[180:183], v[48:51], v[96:111]
    ds_read_b64_tr_b16 v[34:35], v6 offset:29184
    ds_read_b64_tr_b16 v[36:37], v7 offset:28672
    s_waitcnt lgkmcnt(3)
    v_mfma_f32_32x32x16_bf16 v[80:95], a[52:55], v[52:55], v[80:95]
    s_add_u32 m0, s59, 0
    s_add_u32 s60, s65, 0
    buffer_load_dwordx4 v12, s[40:43], s60 offen offset:0 lds
    buffer_store_dwordx4 v[200:203], v2, s[32:35], s3 offen offset:0 sc1
    v_mfma_f32_32x32x16_bf16 v[112:127], a[180:183], v[52:55], v[112:127]
    ds_read_b64_tr_b16 v[38:39], v7 offset:29184
    s_waitcnt lgkmcnt(2)
    v_mfma_f32_32x32x16_bf16 v[64:79], a[56:59], v[32:35], v[64:79]
    buffer_load_dwordx4 v13, s[40:43], s60 offen offset:1024 lds
    ds_read_b64_tr_b16 v[48:49], v6 offset:30720
    v_cvt_pk_bf16_f32 v208, v208, v209
    v_mfma_f32_32x32x16_bf16 v[96:111], a[184:187], v[32:35], v[96:111]
    ds_read_b64_tr_b16 v[50:51], v6 offset:31232
    v_cvt_pk_bf16_f32 v209, v210, v211
    s_waitcnt lgkmcnt(2)
    v_mfma_f32_32x32x16_bf16 v[80:95], a[56:59], v[36:39], v[80:95]
    buffer_load_dwordx4 v14, s[40:43], s60 offen offset:2048 lds
    ds_read_b64_tr_b16 v[52:53], v7 offset:30720
    v_mfma_f32_32x32x16_bf16 v[112:127], a[184:187], v[36:39], v[112:127]
    v_cvt_pk_bf16_f32 v210, v212, v213
    ds_read_b64_tr_b16 v[54:55], v7 offset:31232
    s_waitcnt lgkmcnt(0)
    s_barrier
    v_mfma_f32_32x32x16_bf16 v[64:79], a[60:63], v[48:51], v[64:79]
    buffer_load_dwordx4 v15, s[40:43], s60 offen offset:3072 lds
    ds_read_b64_tr_b16 v[32:33], v6 offset:32768
    v_cvt_pk_bf16_f32 v211, v214, v215
    v_mfma_f32_32x32x16_bf16 v[96:111], a[188:191], v[48:51], v[96:111]
    ds_read_b64_tr_b16 v[34:35], v6 offset:33280
    s_add_u32 s3, s101, 0
    v_mfma_f32_32x32x16_bf16 v[80:95], a[60:63], v[52:55], v[80:95]
    s_add_u32 s79, s62, 0x2000
    buffer_load_dwordx4 a[32:35], v2, s[32:35], s79 offen offset:0
    ds_read_b64_tr_b16 v[36:37], v7 offset:32768
    buffer_store_dwordx4 v[208:211], v2, s[32:35], s3 offen offset:1024 sc1
    v_mfma_f32_32x32x16_bf16 v[112:127], a[188:191], v[52:55], v[112:127]
    ds_read_b64_tr_b16 v[38:39], v7 offset:33280
    s_waitcnt lgkmcnt(2)
    v_mfma_f32_32x32x16_bf16 v[64:79], a[64:67], v[32:35], v[64:79]
    buffer_load_dwordx4 a[36:39], v2, s[32:35], s79 offen offset:1024
    ds_read_b64_tr_b16 v[48:49], v6 offset:34816
    v_cvt_pk_bf16_f32 v216, v216, v217
    v_mfma_f32_32x32x16_bf16 v[96:111], a[192:195], v[32:35], v[96:111]
    buffer_load_dwordx4 a[40:43], v2, s[32:35], s79 offen offset:2048
    ds_read_b64_tr_b16 v[50:51], v6 offset:35328
    s_waitcnt lgkmcnt(2)
    v_mfma_f32_32x32x16_bf16 v[80:95], a[64:67], v[36:39], v[80:95]
    buffer_load_dwordx4 a[44:47], v2, s[32:35], s79 offen offset:3072
    ds_read_b64_tr_b16 v[52:53], v7 offset:34816
    v_cvt_pk_bf16_f32 v217, v218, v219
    v_mfma_f32_32x32x16_bf16 v[112:127], a[192:195], v[36:39], v[112:127]
    s_add_u32 s80, s63, 0x2000
    buffer_load_dwordx4 a[160:163], v2, s[32:35], s80 offen offset:0
    ds_read_b64_tr_b16 v[54:55], v7 offset:35328
    s_waitcnt lgkmcnt(2)
    v_mfma_f32_32x32x16_bf16 v[64:79], a[68:71], v[48:51], v[64:79]
    buffer_load_dwordx4 a[164:167], v2, s[32:35], s80 offen offset:1024
    ds_read_b64_tr_b16 v[32:33], v6 offset:36864
    v_cvt_pk_bf16_f32 v218, v220, v221
    v_mfma_f32_32x32x16_bf16 v[96:111], a[196:199], v[48:51], v[96:111]
    buffer_load_dwordx4 a[168:171], v2, s[32:35], s80 offen offset:2048
    ds_read_b64_tr_b16 v[34:35], v6 offset:37376
    v_cvt_pk_bf16_f32 v219, v222, v223
    s_waitcnt lgkmcnt(2)
    v_mfma_f32_32x32x16_bf16 v[80:95], a[68:71], v[52:55], v[80:95]
    ds_read_b64_tr_b16 v[36:37], v7 offset:36864
    v_mfma_f32_32x32x16_bf16 v[112:127], a[196:199], v[52:55], v[112:127]
    buffer_load_dwordx4 a[172:175], v2, s[32:35], s80 offen offset:3072
    s_add_u32 s3, s101, 0x1000
    ds_read_b64_tr_b16 v[38:39], v7 offset:37376
    s_waitcnt lgkmcnt(2)
    v_mfma_f32_32x32x16_bf16 v[64:79], a[72:75], v[32:35], v[64:79]
    ds_read_b64_tr_b16 v[48:49], v6 offset:38912
    v_mfma_f32_32x32x16_bf16 v[96:111], a[200:203], v[32:35], v[96:111]
    s_add_u32 s79, s62, 0x3000
    buffer_load_dwordx4 a[48:51], v2, s[32:35], s79 offen offset:0
    buffer_store_dwordx4 v[216:219], v2, s[32:35], s3 offen offset:1024 sc1
    ds_read_b64_tr_b16 v[50:51], v6 offset:39424
    s_waitcnt lgkmcnt(2)
    v_mfma_f32_32x32x16_bf16 v[80:95], a[72:75], v[36:39], v[80:95]
    ds_read_b64_tr_b16 v[52:53], v7 offset:38912
    v_mfma_f32_32x32x16_bf16 v[112:127], a[200:203], v[36:39], v[112:127]
    buffer_load_dwordx4 a[52:55], v2, s[32:35], s79 offen offset:1024
    v_cvt_pk_bf16_f32 v224, v224, v225
    ds_read_b64_tr_b16 v[54:55], v7 offset:39424
    s_waitcnt lgkmcnt(2)
    v_mfma_f32_32x32x16_bf16 v[64:79], a[76:79], v[48:51], v[64:79]
    ds_read_b64_tr_b16 v[32:33], v6 offset:40960
    v_cvt_pk_bf16_f32 v225, v226, v227
    v_mfma_f32_32x32x16_bf16 v[96:111], a[204:207], v[48:51], v[96:111]
    buffer_load_dwordx4 a[56:59], v2, s[32:35], s79 offen offset:2048
    ds_read_b64_tr_b16 v[34:35], v6 offset:41472
    v_cvt_pk_bf16_f32 v226, v228, v229
    s_waitcnt lgkmcnt(2)
    v_mfma_f32_32x32x16_bf16 v[80:95], a[76:79], v[52:55], v[80:95]
    ds_read_b64_tr_b16 v[36:37], v7 offset:40960
    v_mfma_f32_32x32x16_bf16 v[112:127], a[204:207], v[52:55], v[112:127]
    buffer_load_dwordx4 a[60:63], v2, s[32:35], s79 offen offset:3072
    v_cvt_pk_bf16_f32 v227, v230, v231
    ds_read_b64_tr_b16 v[38:39], v7 offset:41472
    s_waitcnt lgkmcnt(2)
    v_mfma_f32_32x32x16_bf16 v[64:79], a[80:83], v[32:35], v[64:79]
    s_add_u32 s80, s63, 0x3000
    buffer_load_dwordx4 a[176:179], v2, s[32:35], s80 offen offset:0
    ds_read_b64_tr_b16 v[48:49], v6 offset:43008
    s_add_u32 s3, s101, 0x2000
    v_mfma_f32_32x32x16_bf16 v[96:111], a[208:211], v[32:35], v[96:111]
    buffer_load_dwordx4 a[180:183], v2, s[32:35], s80 offen offset:1024
    ds_read_b64_tr_b16 v[50:51], v6 offset:43520
    buffer_store_dwordx4 v[224:227], v2, s[32:35], s3 offen offset:0 sc1
    s_waitcnt lgkmcnt(2)
    v_mfma_f32_32x32x16_bf16 v[80:95], a[80:83], v[36:39], v[80:95]
    buffer_load_dwordx4 a[184:187], v2, s[32:35], s80 offen offset:2048
    ds_read_b64_tr_b16 v[52:53], v7 offset:43008
    v_mfma_f32_32x32x16_bf16 v[112:127], a[208:211], v[36:39], v[112:127]
    v_cvt_pk_bf16_f32 v232, v232, v233
    ds_read_b64_tr_b16 v[54:55], v7 offset:43520
    s_waitcnt lgkmcnt(2)
    v_mfma_f32_32x32x16_bf16 v[64:79], a[84:87], v[48:51], v[64:79]
    buffer_load_dwordx4 a[188:191], v2, s[32:35], s80 offen offset:3072
    ds_read_b64_tr_b16 v[32:33], v6 offset:45056
    v_cvt_pk_bf16_f32 v233, v234, v235
    v_mfma_f32_32x32x16_bf16 v[96:111], a[212:215], v[48:51], v[96:111]
    ds_read_b64_tr_b16 v[34:35], v6 offset:45568
    s_waitcnt lgkmcnt(2)
    v_mfma_f32_32x32x16_bf16 v[80:95], a[84:87], v[52:55], v[80:95]
    s_add_u32 m0, s59, 0x4000
    s_add_u32 s60, s65, 0x100000
    buffer_load_dwordx4 v12, s[40:43], s60 offen offset:0 lds
    ds_read_b64_tr_b16 v[36:37], v7 offset:45056
    v_cvt_pk_bf16_f32 v234, v236, v237
    v_mfma_f32_32x32x16_bf16 v[112:127], a[212:215], v[52:55], v[112:127]
    ds_read_b64_tr_b16 v[38:39], v7 offset:45568
    s_waitcnt lgkmcnt(2)
    v_mfma_f32_32x32x16_bf16 v[64:79], a[88:91], v[32:35], v[64:79]
    buffer_load_dwordx4 v13, s[40:43], s60 offen offset:1024 lds
    ds_read_b64_tr_b16 v[48:49], v6 offset:47104
    v_cvt_pk_bf16_f32 v235, v238, v239
    v_mfma_f32_32x32x16_bf16 v[96:111], a[216:219], v[32:35], v[96:111]
    ds_read_b64_tr_b16 v[50:51], v6 offset:47616
    s_add_u32 s3, s101, 0x3000
    s_waitcnt lgkmcnt(2)
    v_mfma_f32_32x32x16_bf16 v[80:95], a[88:91], v[36:39], v[80:95]
    buffer_load_dwordx4 v14, s[40:43], s60 offen offset:2048 lds
    ds_read_b64_tr_b16 v[52:53], v7 offset:47104
    buffer_store_dwordx4 v[232:235], v2, s[32:35], s3 offen offset:0 sc1
    v_mfma_f32_32x32x16_bf16 v[112:127], a[216:219], v[36:39], v[112:127]
    ds_read_b64_tr_b16 v[54:55], v7 offset:47616
    s_waitcnt lgkmcnt(0)
    s_waitcnt vmcnt(49)
    s_barrier
    v_mfma_f32_32x32x16_bf16 v[64:79], a[92:95], v[48:51], v[64:79]
    buffer_load_dwordx4 v15, s[40:43], s60 offen offset:3072 lds
    ds_read_b64_tr_b16 v[32:33], v6 offset:49152
    v_cvt_pk_bf16_f32 v240, v240, v241
    v_mfma_f32_32x32x16_bf16 v[96:111], a[220:223], v[48:51], v[96:111]
    ds_read_b64_tr_b16 v[34:35], v6 offset:49664
    v_cvt_pk_bf16_f32 v241, v242, v243
    v_mfma_f32_32x32x16_bf16 v[80:95], a[92:95], v[52:55], v[80:95]
    s_add_u32 s79, s62, 0x4000
    buffer_load_dwordx4 a[64:67], v2, s[32:35], s79 offen offset:0
    ds_read_b64_tr_b16 v[36:37], v7 offset:49152
    v_mfma_f32_32x32x16_bf16 v[112:127], a[220:223], v[52:55], v[112:127]
    v_cvt_pk_bf16_f32 v242, v244, v245
    ds_read_b64_tr_b16 v[38:39], v7 offset:49664
    s_waitcnt lgkmcnt(2)
    v_mfma_f32_32x32x16_bf16 v[64:79], a[96:99], v[32:35], v[64:79]
    buffer_load_dwordx4 a[68:71], v2, s[32:35], s79 offen offset:1024
    ds_read_b64_tr_b16 v[48:49], v6 offset:51200
    v_cvt_pk_bf16_f32 v243, v246, v247
    v_mfma_f32_32x32x16_bf16 v[96:111], a[224:227], v[32:35], v[96:111]
    buffer_load_dwordx4 a[72:75], v2, s[32:35], s79 offen offset:2048
    ds_read_b64_tr_b16 v[50:51], v6 offset:51712
    s_waitcnt lgkmcnt(2)
    v_mfma_f32_32x32x16_bf16 v[80:95], a[96:99], v[36:39], v[80:95]
    buffer_load_dwordx4 a[76:79], v2, s[32:35], s79 offen offset:3072
    ds_read_b64_tr_b16 v[52:53], v7 offset:51200
    s_add_u32 s3, s101, 0x2000
    v_mfma_f32_32x32x16_bf16 v[112:127], a[224:227], v[36:39], v[112:127]
    s_add_u32 s80, s63, 0x4000
    buffer_load_dwordx4 a[192:195], v2, s[32:35], s80 offen offset:0
    ds_read_b64_tr_b16 v[54:55], v7 offset:51712
    s_waitcnt lgkmcnt(2)
    v_mfma_f32_32x32x16_bf16 v[64:79], a[100:103], v[48:51], v[64:79]
    buffer_load_dwordx4 a[196:199], v2, s[32:35], s80 offen offset:1024
    ds_read_b64_tr_b16 v[32:33], v6 offset:53248
    buffer_store_dwordx4 v[240:243], v2, s[32:35], s3 offen offset:1024 sc1
    v_mfma_f32_32x32x16_bf16 v[96:111], a[228:231], v[48:51], v[96:111]
    buffer_load_dwordx4 a[200:203], v2, s[32:35], s80 offen offset:2048
    ds_read_b64_tr_b16 v[34:35], v6 offset:53760
    s_waitcnt lgkmcnt(2)
    v_mfma_f32_32x32x16_bf16 v[80:95], a[100:103], v[52:55], v[80:95]
    v_cvt_pk_bf16_f32 v248, v248, v249
    ds_read_b64_tr_b16 v[36:37], v7 offset:53248
    v_mfma_f32_32x32x16_bf16 v[112:127], a[228:231], v[52:55], v[112:127]
    buffer_load_dwordx4 a[204:207], v2, s[32:35], s80 offen offset:3072
    v_cvt_pk_bf16_f32 v249, v250, v251
    ds_read_b64_tr_b16 v[38:39], v7 offset:53760
    s_waitcnt lgkmcnt(2)
    v_mfma_f32_32x32x16_bf16 v[64:79], a[104:107], v[32:35], v[64:79]
    ds_read_b64_tr_b16 v[48:49], v6 offset:55296
    v_cvt_pk_bf16_f32 v250, v252, v253
    v_mfma_f32_32x32x16_bf16 v[96:111], a[232:235], v[32:35], v[96:111]
    s_add_u32 s79, s62, 0x5000
    buffer_load_dwordx4 a[80:83], v2, s[32:35], s79 offen offset:0
    ds_read_b64_tr_b16 v[50:51], v6 offset:55808
    s_waitcnt lgkmcnt(2)
    v_mfma_f32_32x32x16_bf16 v[80:95], a[104:107], v[36:39], v[80:95]
    ds_read_b64_tr_b16 v[52:53], v7 offset:55296
    v_cvt_pk_bf16_f32 v251, v254, v255
    v_mfma_f32_32x32x16_bf16 v[112:127], a[232:235], v[36:39], v[112:127]
    buffer_load_dwordx4 a[84:87], v2, s[32:35], s79 offen offset:1024
    ds_read_b64_tr_b16 v[54:55], v7 offset:55808
    s_waitcnt lgkmcnt(2)
    v_mfma_f32_32x32x16_bf16 v[64:79], a[108:111], v[48:51], v[64:79]
    ds_read_b64_tr_b16 v[32:33], v6 offset:57344
    s_add_u32 s3, s101, 0x3000
    v_mfma_f32_32x32x16_bf16 v[96:111], a[236:239], v[48:51], v[96:111]
    buffer_load_dwordx4 a[88:91], v2, s[32:35], s79 offen offset:2048
    ds_read_b64_tr_b16 v[34:35], v6 offset:57856
    buffer_store_dwordx4 v[248:251], v2, s[32:35], s3 offen offset:1024 sc1
    s_waitcnt lgkmcnt(2)
    v_mfma_f32_32x32x16_bf16 v[80:95], a[108:111], v[52:55], v[80:95]
    ds_read_b64_tr_b16 v[36:37], v7 offset:57344
    v_mfma_f32_32x32x16_bf16 v[112:127], a[236:239], v[52:55], v[112:127]
    s_waitcnt vmcnt(62)
    buffer_load_dwordx4 a[92:95], v2, s[32:35], s79 offen offset:3072
    ds_read_b64_tr_b16 v[38:39], v7 offset:57856
    s_waitcnt lgkmcnt(2)
    v_mfma_f32_32x32x16_bf16 v[64:79], a[112:115], v[32:35], v[64:79]
    s_add_u32 s80, s63, 0x5000
    s_waitcnt vmcnt(62)
    buffer_load_dwordx4 a[208:211], v2, s[32:35], s80 offen offset:0
    ds_read_b64_tr_b16 v[48:49], v6 offset:59392
    v_mfma_f32_32x32x16_bf16 v[96:111], a[240:243], v[32:35], v[96:111]
    s_waitcnt vmcnt(62)
    buffer_load_dwordx4 a[212:215], v2, s[32:35], s80 offen offset:1024
    ds_read_b64_tr_b16 v[50:51], v6 offset:59904
    s_waitcnt lgkmcnt(2)
    v_mfma_f32_32x32x16_bf16 v[80:95], a[112:115], v[36:39], v[80:95]
    s_waitcnt vmcnt(62)
    buffer_load_dwordx4 a[216:219], v2, s[32:35], s80 offen offset:2048
    ds_read_b64_tr_b16 v[52:53], v7 offset:59392
    v_mfma_f32_32x32x16_bf16 v[112:127], a[240:243], v[36:39], v[112:127]
    ds_read_b64_tr_b16 v[54:55], v7 offset:59904
    s_waitcnt lgkmcnt(2)
    v_mfma_f32_32x32x16_bf16 v[64:79], a[116:119], v[48:51], v[64:79]
    s_waitcnt vmcnt(62)
    buffer_load_dwordx4 a[220:223], v2, s[32:35], s80 offen offset:3072
    ds_read_b64_tr_b16 v[32:33], v6 offset:61440
    v_mfma_f32_32x32x16_bf16 v[96:111], a[244:247], v[48:51], v[96:111]
    ds_read_b64_tr_b16 v[34:35], v6 offset:61952
    s_waitcnt lgkmcnt(2)
    v_mfma_f32_32x32x16_bf16 v[80:95], a[116:119], v[52:55], v[80:95]
    s_add_u32 m0, s59, 0x8000
    s_add_u32 s60, s65, 0x200000
    s_waitcnt vmcnt(62)
    buffer_load_dwordx4 v12, s[40:43], s60 offen offset:0 lds
    ds_read_b64_tr_b16 v[36:37], v7 offset:61440
    v_mfma_f32_32x32x16_bf16 v[112:127], a[244:247], v[52:55], v[112:127]
    ds_read_b64_tr_b16 v[38:39], v7 offset:61952
    s_waitcnt lgkmcnt(2)
    v_mfma_f32_32x32x16_bf16 v[64:79], a[120:123], v[32:35], v[64:79]
    s_waitcnt vmcnt(62)
    buffer_load_dwordx4 v13, s[40:43], s60 offen offset:1024 lds
    ds_read_b64_tr_b16 v[48:49], v6 offset:63488
    v_mfma_f32_32x32x16_bf16 v[96:111], a[248:251], v[32:35], v[96:111]
    ds_read_b64_tr_b16 v[50:51], v6 offset:64000
    s_waitcnt lgkmcnt(2)
    v_mfma_f32_32x32x16_bf16 v[80:95], a[120:123], v[36:39], v[80:95]
    s_waitcnt vmcnt(62)
    buffer_load_dwordx4 v14, s[40:43], s60 offen offset:2048 lds
    ds_read_b64_tr_b16 v[52:53], v7 offset:63488
    v_mfma_f32_32x32x16_bf16 v[112:127], a[248:251], v[36:39], v[112:127]
    ds_read_b64_tr_b16 v[54:55], v7 offset:64000
    s_waitcnt lgkmcnt(0)
    s_waitcnt vmcnt(45)
    s_barrier
    v_mfma_f32_32x32x16_bf16 v[64:79], a[124:127], v[48:51], v[64:79]
    buffer_load_dwordx4 v15, s[40:43], s60 offen offset:3072 lds
    ds_read_b64_tr_b16 v[32:33], v6 offset:0
    v_mfma_f32_32x32x16_bf16 v[96:111], a[252:255], v[48:51], v[96:111]
    ds_read_b64_tr_b16 v[34:35], v6 offset:512
    v_mfma_f32_32x32x16_bf16 v[80:95], a[124:127], v[52:55], v[80:95]
    s_add_u32 s79, s62, 0x6000
    buffer_load_dwordx4 a[96:99], v2, s[32:35], s79 offen offset:0
    ds_read_b64_tr_b16 v[36:37], v7 offset:0
    v_mfma_f32_32x32x16_bf16 v[112:127], a[252:255], v[52:55], v[112:127]
    ds_read_b64_tr_b16 v[38:39], v7 offset:512
    s_waitcnt lgkmcnt(2)
    v_mfma_f32_32x32x16_bf16 v[128:143], v[32:35], a[0:3], 0
    buffer_load_dwordx4 a[100:103], v2, s[32:35], s79 offen offset:1024
    ds_read_b64_tr_b16 v[48:49], v6 offset:2048
    v_cvt_pk_bf16_f32 v64, v64, v65
    v_mfma_f32_32x32x16_bf16 v[160:175], v[32:35], a[128:131], 0
    buffer_load_dwordx4 a[104:107], v2, s[32:35], s79 offen offset:2048
    ds_read_b64_tr_b16 v[50:51], v6 offset:2560
    v_cvt_pk_bf16_f32 v65, v66, v67
    s_waitcnt lgkmcnt(2)
    v_mfma_f32_32x32x16_bf16 v[144:159], v[36:39], a[0:3], 0
    buffer_load_dwordx4 a[108:111], v2, s[32:35], s79 offen offset:3072
    ds_read_b64_tr_b16 v[52:53], v7 offset:2048
    v_cvt_pk_bf16_f32 v66, v68, v69
    v_mfma_f32_32x32x16_bf16 v[176:191], v[36:39], a[128:131], 0
    s_add_u32 s80, s63, 0x6000
    buffer_load_dwordx4 a[224:227], v2, s[32:35], s80 offen offset:0
    ds_read_b64_tr_b16 v[54:55], v7 offset:2560
    v_cvt_pk_bf16_f32 v67, v70, v71
    s_waitcnt lgkmcnt(2)
    v_mfma_f32_32x32x16_bf16 v[128:143], v[48:51], a[4:7], v[128:143]
    buffer_load_dwordx4 a[228:231], v2, s[32:35], s80 offen offset:1024
    ds_read_b64_tr_b16 v[32:33], v6 offset:4096
    s_add_u32 s3, s101, 0
    v_mfma_f32_32x32x16_bf16 v[160:175], v[48:51], a[132:135], v[160:175]
    buffer_load_dwordx4 a[232:235], v2, s[32:35], s80 offen offset:2048
    ds_read_b64_tr_b16 v[34:35], v6 offset:4608
    buffer_store_dwordx4 v[64:67], v2, s[32:35], s3 offen offset:2048 sc1
    s_waitcnt lgkmcnt(2)
    v_mfma_f32_32x32x16_bf16 v[144:159], v[52:55], a[4:7], v[144:159]
    ds_read_b64_tr_b16 v[36:37], v7 offset:4096
    v_cvt_pk_bf16_f32 v72, v72, v73
    v_mfma_f32_32x32x16_bf16 v[176:191], v[52:55], a[132:135], v[176:191]
    buffer_load_dwordx4 a[236:239], v2, s[32:35], s80 offen offset:3072
    ds_read_b64_tr_b16 v[38:39], v7 offset:4608
    v_cvt_pk_bf16_f32 v73, v74, v75
    s_waitcnt lgkmcnt(2)
    v_mfma_f32_32x32x16_bf16 v[128:143], v[32:35], a[8:11], v[128:143]
    ds_read_b64_tr_b16 v[48:49], v6 offset:6144
    v_cvt_pk_bf16_f32 v74, v76, v77
    v_mfma_f32_32x32x16_bf16 v[160:175], v[32:35], a[136:139], v[160:175]
    s_add_u32 s79, s62, 0x7000
    buffer_load_dwordx4 a[112:115], v2, s[32:35], s79 offen offset:0
    ds_read_b64_tr_b16 v[50:51], v6 offset:6656
    v_cvt_pk_bf16_f32 v75, v78, v79
    ds_read_b64_tr_b16 v[52:53], v7 offset:6144
    s_waitcnt lgkmcnt(3)
    v_mfma_f32_32x32x16_bf16 v[144:159], v[36:39], a[8:11], v[144:159]
    s_add_u32 s3, s101, 0x1000
    ds_read_b64_tr_b16 v[54:55], v7 offset:6656
    v_mfma_f32_32x32x16_bf16 v[176:191], v[36:39], a[136:139], v[176:191]
    buffer_load_dwordx4 a[116:119], v2, s[32:35], s79 offen offset:1024
    buffer_store_dwordx4 v[72:75], v2, s[32:35], s3 offen offset:2048 sc1
    s_waitcnt lgkmcnt(2)
    v_mfma_f32_32x32x16_bf16 v[128:143], v[48:51], a[12:15], v[128:143]
    ds_read_b64_tr_b16 v[32:33], v6 offset:8192
    v_cvt_pk_bf16_f32 v80, v80, v81
    v_mfma_f32_32x32x16_bf16 v[160:175], v[48:51], a[140:143], v[160:175]
    buffer_load_dwordx4 a[120:123], v2, s[32:35], s79 offen offset:2048
    ds_read_b64_tr_b16 v[34:35], v6 offset:8704
    v_cvt_pk_bf16_f32 v81, v82, v83
    s_waitcnt lgkmcnt(2)
    v_mfma_f32_32x32x16_bf16 v[144:159], v[52:55], a[12:15], v[144:159]
    ds_read_b64_tr_b16 v[36:37], v7 offset:8192
    v_cvt_pk_bf16_f32 v82, v84, v85
    v_mfma_f32_32x32x16_bf16 v[176:191], v[52:55], a[140:143], v[176:191]
    buffer_load_dwordx4 a[124:127], v2, s[32:35], s79 offen offset:3072
    ds_read_b64_tr_b16 v[38:39], v7 offset:8704
    v_cvt_pk_bf16_f32 v83, v86, v87
    s_waitcnt lgkmcnt(2)
    v_mfma_f32_32x32x16_bf16 v[128:143], v[32:35], a[16:19], v[128:143]
    ds_read_b64_tr_b16 v[48:49], v6 offset:10240
    s_lshl_b32 s74, s2, 2
    s_add_u32 s74, s74, s56
    s_lshl_b32 s74, s74, 13
    s_mov_b32 s44, s14
    s_mov_b32 s45, s15
    s_mov_b32 s46, 0x400000
    s_mov_b32 s47, 0x20000
    s_cmp_ge_u32 s74, s46
    s_cselect_b32 s76, s46, 0
    s_cselect_b32 s44, s22, s44
    s_cselect_b32 s45, s23, s45
    s_cselect_b32 s46, 0x1c0000, s46
    s_sub_u32 s74, s74, s76
    v_lshlrev_b32 v5, 7, v1
    buffer_load_dword v28, v5, s[44:47], s74 offen
    s_add_u32 s3, s101, 0
    v_mfma_f32_32x32x16_bf16 v[160:175], v[32:35], a[144:147], v[160:175]
    s_add_u32 s80, s63, 0x7000
    buffer_load_dwordx4 a[240:243], v2, s[32:35], s80 offen offset:0
    ds_read_b64_tr_b16 v[50:51], v6 offset:10752
    buffer_store_dwordx4 v[80:83], v2, s[32:35], s3 offen offset:3072 sc1
    s_waitcnt lgkmcnt(2)
    v_mfma_f32_32x32x16_bf16 v[144:159], v[36:39], a[16:19], v[144:159]
    ds_read_b64_tr_b16 v[52:53], v7 offset:10240
    v_cvt_pk_bf16_f32 v88, v88, v89
    v_mfma_f32_32x32x16_bf16 v[176:191], v[36:39], a[144:147], v[176:191]
    s_waitcnt vmcnt(62)
    buffer_load_dwordx4 a[244:247], v2, s[32:35], s80 offen offset:1024
    v_cvt_pk_bf16_f32 v89, v90, v91
    ds_read_b64_tr_b16 v[54:55], v7 offset:10752
    v_cvt_pk_bf16_f32 v90, v92, v93
    s_waitcnt lgkmcnt(2)
    v_mfma_f32_32x32x16_bf16 v[128:143], v[48:51], a[20:23], v[128:143]
    ds_read_b64_tr_b16 v[32:33], v6 offset:12288
    v_cvt_pk_bf16_f32 v91, v94, v95
    v_mfma_f32_32x32x16_bf16 v[160:175], v[48:51], a[148:151], v[160:175]
    s_waitcnt vmcnt(62)
    buffer_load_dwordx4 a[248:251], v2, s[32:35], s80 offen offset:2048
    ds_read_b64_tr_b16 v[34:35], v6 offset:12800
    s_add_u32 s3, s101, 0x1000
    ds_read_b64_tr_b16 v[36:37], v7 offset:12288
    s_waitcnt lgkmcnt(3)
    v_mfma_f32_32x32x16_bf16 v[144:159], v[52:55], a[20:23], v[144:159]
    s_waitcnt vmcnt(62)
    buffer_store_dwordx4 v[88:91], v2, s[32:35], s3 offen offset:3072 sc1
    v_mfma_f32_32x32x16_bf16 v[176:191], v[52:55], a[148:151], v[176:191]
    s_waitcnt vmcnt(62)
    buffer_load_dwordx4 a[252:255], v2, s[32:35], s80 offen offset:3072
    ds_read_b64_tr_b16 v[38:39], v7 offset:12800
    v_cvt_pk_bf16_f32 v96, v96, v97
    s_waitcnt lgkmcnt(2)
    v_mfma_f32_32x32x16_bf16 v[128:143], v[32:35], a[24:27], v[128:143]
    ds_read_b64_tr_b16 v[48:49], v6 offset:14336
    v_cvt_pk_bf16_f32 v97, v98, v99
    v_mfma_f32_32x32x16_bf16 v[160:175], v[32:35], a[152:155], v[160:175]
    s_add_u32 m0, s59, 0xc000
    s_add_u32 s60, s65, 0x300000
    s_waitcnt vmcnt(62)
    buffer_load_dwordx4 v12, s[40:43], s60 offen offset:0 lds
    ds_read_b64_tr_b16 v[50:51], v6 offset:14848
    v_cvt_pk_bf16_f32 v98, v100, v101
    s_waitcnt lgkmcnt(2)
    v_mfma_f32_32x32x16_bf16 v[144:159], v[36:39], a[24:27], v[144:159]
    ds_read_b64_tr_b16 v[52:53], v7 offset:14336
    v_cvt_pk_bf16_f32 v99, v102, v103
    v_mfma_f32_32x32x16_bf16 v[176:191], v[36:39], a[152:155], v[176:191]
    s_waitcnt vmcnt(62)
    buffer_load_dwordx4 v13, s[40:43], s60 offen offset:1024 lds
    ds_read_b64_tr_b16 v[54:55], v7 offset:14848
    s_add_u32 s3, s101, 0x2000
    s_waitcnt lgkmcnt(0)
    s_waitcnt vmcnt(45)
    s_barrier
    v_mfma_f32_32x32x16_bf16 v[128:143], v[48:51], a[28:31], v[128:143]
    ds_read_b64_tr_b16 v[32:33], v6 offset:16384
    buffer_store_dwordx4 v[96:99], v2, s[32:35], s3 offen offset:2048 sc1
    v_mfma_f32_32x32x16_bf16 v[160:175], v[48:51], a[156:159], v[160:175]
    buffer_load_dwordx4 v14, s[40:43], s60 offen offset:2048 lds
    ds_read_b64_tr_b16 v[34:35], v6 offset:16896
    v_cvt_pk_bf16_f32 v104, v104, v105
    v_mfma_f32_32x32x16_bf16 v[144:159], v[52:55], a[28:31], v[144:159]
    ds_read_b64_tr_b16 v[36:37], v7 offset:16384
    v_cvt_pk_bf16_f32 v105, v106, v107
    v_mfma_f32_32x32x16_bf16 v[176:191], v[52:55], a[156:159], v[176:191]
    buffer_load_dwordx4 v15, s[40:43], s60 offen offset:3072 lds
    ds_read_b64_tr_b16 v[38:39], v7 offset:16896
    v_cvt_pk_bf16_f32 v106, v108, v109
    s_waitcnt lgkmcnt(2)
    v_mfma_f32_32x32x16_bf16 v[128:143], v[32:35], a[32:35], v[128:143]
    ds_read_b64_tr_b16 v[48:49], v6 offset:18432
    v_cvt_pk_bf16_f32 v107, v110, v111
    v_mfma_f32_32x32x16_bf16 v[160:175], v[32:35], a[160:163], v[160:175]
    s_add_u32 m0, s59, 0
    s_add_u32 s60, s66, 0
    buffer_load_dwordx4 v12, s[40:43], s60 offen offset:0 lds
    ds_read_b64_tr_b16 v[50:51], v6 offset:18944
    s_add_u32 s3, s101, 0x3000
    ds_read_b64_tr_b16 v[52:53], v7 offset:18432
    s_waitcnt lgkmcnt(3)
    v_mfma_f32_32x32x16_bf16 v[144:159], v[36:39], a[32:35], v[144:159]
    buffer_store_dwordx4 v[104:107], v2, s[32:35], s3 offen offset:2048 sc1
    v_mfma_f32_32x32x16_bf16 v[176:191], v[36:39], a[160:163], v[176:191]
    buffer_load_dwordx4 v13, s[40:43], s60 offen offset:1024 lds
    ds_read_b64_tr_b16 v[54:55], v7 offset:18944
    v_cvt_pk_bf16_f32 v112, v112, v113
    s_waitcnt lgkmcnt(2)
    v_mfma_f32_32x32x16_bf16 v[128:143], v[48:51], a[36:39], v[128:143]
    ds_read_b64_tr_b16 v[32:33], v6 offset:20480
    v_cvt_pk_bf16_f32 v113, v114, v115
    v_cvt_pk_bf16_f32 v114, v116, v117
    v_mfma_f32_32x32x16_bf16 v[160:175], v[48:51], a[164:167], v[160:175]
    buffer_load_dwordx4 v14, s[40:43], s60 offen offset:2048 lds
    ds_read_b64_tr_b16 v[34:35], v6 offset:20992
    v_cvt_pk_bf16_f32 v115, v118, v119
    s_waitcnt lgkmcnt(2)
    v_mfma_f32_32x32x16_bf16 v[144:159], v[52:55], a[36:39], v[144:159]
    ds_read_b64_tr_b16 v[36:37], v7 offset:20480
    s_add_u32 s3, s101, 0x2000
    ds_read_b64_tr_b16 v[38:39], v7 offset:20992
    v_mfma_f32_32x32x16_bf16 v[176:191], v[52:55], a[164:167], v[176:191]
    buffer_load_dwordx4 v15, s[40:43], s60 offen offset:3072 lds
    buffer_store_dwordx4 v[112:115], v2, s[32:35], s3 offen offset:3072 sc1
    s_waitcnt lgkmcnt(2)
    v_mfma_f32_32x32x16_bf16 v[128:143], v[32:35], a[40:43], v[128:143]
    ds_read_b64_tr_b16 v[48:49], v6 offset:22528
    v_cvt_pk_bf16_f32 v120, v120, v121
    v_mfma_f32_32x32x16_bf16 v[160:175], v[32:35], a[168:171], v[160:175]
    ds_read_b64_tr_b16 v[50:51], v6 offset:23040
    v_cvt_pk_bf16_f32 v121, v122, v123
    s_waitcnt lgkmcnt(2)
    v_mfma_f32_32x32x16_bf16 v[144:159], v[36:39], a[40:43], v[144:159]
    ds_read_b64_tr_b16 v[52:53], v7 offset:22528
    v_cvt_pk_bf16_f32 v122, v124, v125
    v_mfma_f32_32x32x16_bf16 v[176:191], v[36:39], a[168:171], v[176:191]
    ds_read_b64_tr_b16 v[54:55], v7 offset:23040
    v_cvt_pk_bf16_f32 v123, v126, v127
    s_waitcnt lgkmcnt(2)
    v_mfma_f32_32x32x16_bf16 v[128:143], v[48:51], a[44:47], v[128:143]
    ds_read_b64_tr_b16 v[32:33], v6 offset:24576
    s_add_u32 s3, s101, 0x3000
    v_mfma_f32_32x32x16_bf16 v[160:175], v[48:51], a[172:175], v[160:175]
    ds_read_b64_tr_b16 v[34:35], v6 offset:25088
    buffer_store_dwordx4 v[120:123], v2, s[32:35], s3 offen offset:3072 sc1
    s_waitcnt lgkmcnt(2)
    v_mfma_f32_32x32x16_bf16 v[144:159], v[52:55], a[44:47], v[144:159]
    ds_read_b64_tr_b16 v[36:37], v7 offset:24576
    s_lshl_b32 s61, s57, 12
    v_mfma_f32_32x32x16_bf16 v[176:191], v[52:55], a[172:175], v[176:191]
    ds_read_b64_tr_b16 v[38:39], v7 offset:25088
    s_add_u32 s69, s67, s61
    s_waitcnt lgkmcnt(2)
    v_mfma_f32_32x32x16_bf16 v[128:143], v[32:35], a[48:51], v[128:143]
    ds_read_b64_tr_b16 v[48:49], v6 offset:26624
    s_sub_u32 s69, s69, 0x40000
    v_mfma_f32_32x32x16_bf16 v[160:175], v[32:35], a[176:179], v[160:175]
    ds_read_b64_tr_b16 v[50:51], v6 offset:27136
    s_lshl_b32 s61, s57, 12
    s_waitcnt lgkmcnt(2)
    v_mfma_f32_32x32x16_bf16 v[144:159], v[36:39], a[48:51], v[144:159]
    ds_read_b64_tr_b16 v[52:53], v7 offset:26624
    s_add_u32 s70, s68, s61
    v_mfma_f32_32x32x16_bf16 v[176:191], v[36:39], a[176:179], v[176:191]
    ds_read_b64_tr_b16 v[54:55], v7 offset:27136
    s_sub_u32 s70, s70, 0x40000
    s_waitcnt lgkmcnt(2)
    v_mfma_f32_32x32x16_bf16 v[128:143], v[48:51], a[52:55], v[128:143]
    ds_read_b64_tr_b16 v[32:33], v6 offset:28672
    s_lshl_b32 s61, s57, 19
    s_add_u32 s61, s61, 0x200000
    s_add_u32 s48, s28, s61
    s_addc_u32 s49, s29, 0
    v_mfma_f32_32x32x16_bf16 v[160:175], v[48:51], a[180:183], v[160:175]
    s_lshl_b32 s61, s58, 15
    ds_read_b64_tr_b16 v[34:35], v6 offset:29184
    s_sub_u32 s50, 0x80000, s61
    s_waitcnt lgkmcnt(2)
    v_mfma_f32_32x32x16_bf16 v[144:159], v[52:55], a[52:55], v[144:159]
    ds_read_b64_tr_b16 v[36:37], v7 offset:28672
    s_mov_b32 s51, 0x20000
    v_mfma_f32_32x32x16_bf16 v[176:191], v[52:55], a[180:183], v[176:191]
    ds_read_b64_tr_b16 v[38:39], v7 offset:29184
    s_lshl_b32 s61, s57, 19
    s_add_u32 s61, s61, 0x1200000
    s_add_u32 s52, s28, s61
    s_addc_u32 s53, s29, 0
    s_waitcnt lgkmcnt(2)
    v_mfma_f32_32x32x16_bf16 v[128:143], v[32:35], a[56:59], v[128:143]
    ds_read_b64_tr_b16 v[48:49], v6 offset:30720
    s_lshl_b32 s61, s58, 15
    v_mfma_f32_32x32x16_bf16 v[160:175], v[32:35], a[184:187], v[160:175]
    ds_read_b64_tr_b16 v[50:51], v6 offset:31232
    s_sub_u32 s54, 0x80000, s61
    s_waitcnt lgkmcnt(2)
    v_mfma_f32_32x32x16_bf16 v[144:159], v[36:39], a[56:59], v[144:159]
    ds_read_b64_tr_b16 v[52:53], v7 offset:30720
    s_mov_b32 s55, 0x20000
    v_mfma_f32_32x32x16_bf16 v[176:191], v[36:39], a[184:187], v[176:191]
    ds_read_b64_tr_b16 v[54:55], v7 offset:31232
    s_lshl_b32 s71, s56, 12
    s_waitcnt lgkmcnt(0)
    s_waitcnt vmcnt(33)
    s_waitcnt vmcnt(0)
    s_barrier
    s_cmp_lg_u32 s56, 0
    s_cbranch_scc1 L_sig_kvb
    s_mov_b64 exec, 1
    v_mov_b32 v26, 1
    buffer_atomic_add v26, off, s[96:99], s31
    s_mov_b64 exec, -1
L_sig_kvb:
    v_mfma_f32_32x32x16_bf16 v[128:143], v[48:51], a[60:63], v[128:143]
    s_add_u32 m0, s59, 0x4000
    s_add_u32 s60, s66, 0x100000
    buffer_load_dwordx4 v12, s[40:43], s60 offen offset:0 lds
    ds_read_b64_tr_b16 v[32:33], v6 offset:32768
    s_mov_b32 s72, s71
    v_mfma_f32_32x32x16_bf16 v[160:175], v[48:51], a[188:191], v[160:175]
    ds_read_b64_tr_b16 v[34:35], v6 offset:33280
    s_mov_b32 s78, 0x4b800000
    v_mfma_f32_32x32x16_bf16 v[144:159], v[52:55], a[60:63], v[144:159]
    buffer_load_dwordx4 v13, s[40:43], s60 offen offset:1024 lds
    ds_read_b64_tr_b16 v[36:37], v7 offset:32768
    v_mfma_f32_32x32x16_bf16 v[176:191], v[52:55], a[188:191], v[176:191]
    ds_read_b64_tr_b16 v[38:39], v7 offset:33280
    s_waitcnt lgkmcnt(2)
    v_mfma_f32_32x32x16_bf16 v[128:143], v[32:35], a[64:67], v[128:143]
    buffer_load_dwordx4 v14, s[40:43], s60 offen offset:2048 lds
    ds_read_b64_tr_b16 v[48:49], v6 offset:34816
    v_mfma_f32_32x32x16_bf16 v[160:175], v[32:35], a[192:195], v[160:175]
    ds_read_b64_tr_b16 v[50:51], v6 offset:35328
    s_waitcnt lgkmcnt(2)
    v_mfma_f32_32x32x16_bf16 v[144:159], v[36:39], a[64:67], v[144:159]
    buffer_load_dwordx4 v15, s[40:43], s60 offen offset:3072 lds
    ds_read_b64_tr_b16 v[52:53], v7 offset:34816
    v_mfma_f32_32x32x16_bf16 v[176:191], v[36:39], a[192:195], v[176:191]
    ds_read_b64_tr_b16 v[54:55], v7 offset:35328
    s_waitcnt lgkmcnt(2)
    v_mfma_f32_32x32x16_bf16 v[128:143], v[48:51], a[68:71], v[128:143]
    ds_read_b64_tr_b16 v[32:33], v6 offset:36864
    v_mfma_f32_32x32x16_bf16 v[160:175], v[48:51], a[196:199], v[160:175]
    ds_read_b64_tr_b16 v[34:35], v6 offset:37376
    s_waitcnt lgkmcnt(2)
    v_mfma_f32_32x32x16_bf16 v[144:159], v[52:55], a[68:71], v[144:159]
    ds_read_b64_tr_b16 v[36:37], v7 offset:36864
    v_mfma_f32_32x32x16_bf16 v[176:191], v[52:55], a[196:199], v[176:191]
    ds_read_b64_tr_b16 v[38:39], v7 offset:37376
    s_waitcnt lgkmcnt(2)
    v_mfma_f32_32x32x16_bf16 v[128:143], v[32:35], a[72:75], v[128:143]
    ds_read_b64_tr_b16 v[48:49], v6 offset:38912
    v_mfma_f32_32x32x16_bf16 v[160:175], v[32:35], a[200:203], v[160:175]
    ds_read_b64_tr_b16 v[50:51], v6 offset:39424
    s_waitcnt lgkmcnt(2)
    v_mfma_f32_32x32x16_bf16 v[144:159], v[36:39], a[72:75], v[144:159]
    ds_read_b64_tr_b16 v[52:53], v7 offset:38912
    v_mfma_f32_32x32x16_bf16 v[176:191], v[36:39], a[200:203], v[176:191]
    ds_read_b64_tr_b16 v[54:55], v7 offset:39424
    s_waitcnt lgkmcnt(2)
    v_mfma_f32_32x32x16_bf16 v[128:143], v[48:51], a[76:79], v[128:143]
    ds_read_b64_tr_b16 v[32:33], v6 offset:40960
    v_mfma_f32_32x32x16_bf16 v[160:175], v[48:51], a[204:207], v[160:175]
    ds_read_b64_tr_b16 v[34:35], v6 offset:41472
    s_waitcnt lgkmcnt(2)
    v_mfma_f32_32x32x16_bf16 v[144:159], v[52:55], a[76:79], v[144:159]
    ds_read_b64_tr_b16 v[36:37], v7 offset:40960
    v_mfma_f32_32x32x16_bf16 v[176:191], v[52:55], a[204:207], v[176:191]
    ds_read_b64_tr_b16 v[38:39], v7 offset:41472
    s_waitcnt lgkmcnt(2)
    v_mfma_f32_32x32x16_bf16 v[128:143], v[32:35], a[80:83], v[128:143]
    ds_read_b64_tr_b16 v[48:49], v6 offset:43008
    v_mfma_f32_32x32x16_bf16 v[160:175], v[32:35], a[208:211], v[160:175]
    ds_read_b64_tr_b16 v[50:51], v6 offset:43520
    s_waitcnt lgkmcnt(2)
    v_mfma_f32_32x32x16_bf16 v[144:159], v[36:39], a[80:83], v[144:159]
    ds_read_b64_tr_b16 v[52:53], v7 offset:43008
    v_mfma_f32_32x32x16_bf16 v[176:191], v[36:39], a[208:211], v[176:191]
    ds_read_b64_tr_b16 v[54:55], v7 offset:43520
    s_waitcnt lgkmcnt(2)
    v_mfma_f32_32x32x16_bf16 v[128:143], v[48:51], a[84:87], v[128:143]
    ds_read_b64_tr_b16 v[32:33], v6 offset:45056
    v_mfma_f32_32x32x16_bf16 v[160:175], v[48:51], a[212:215], v[160:175]
    ds_read_b64_tr_b16 v[34:35], v6 offset:45568
    s_waitcnt lgkmcnt(2)
    v_mfma_f32_32x32x16_bf16 v[144:159], v[52:55], a[84:87], v[144:159]
    ds_read_b64_tr_b16 v[36:37], v7 offset:45056
    v_mfma_f32_32x32x16_bf16 v[176:191], v[52:55], a[212:215], v[176:191]
    ds_read_b64_tr_b16 v[38:39], v7 offset:45568
    s_waitcnt lgkmcnt(2)
    v_mfma_f32_32x32x16_bf16 v[128:143], v[32:35], a[88:91], v[128:143]
    ds_read_b64_tr_b16 v[48:49], v6 offset:47104
    v_mfma_f32_32x32x16_bf16 v[160:175], v[32:35], a[216:219], v[160:175]
    ds_read_b64_tr_b16 v[50:51], v6 offset:47616
    s_waitcnt lgkmcnt(2)
    v_mfma_f32_32x32x16_bf16 v[144:159], v[36:39], a[88:91], v[144:159]
    ds_read_b64_tr_b16 v[52:53], v7 offset:47104
    v_mfma_f32_32x32x16_bf16 v[176:191], v[36:39], a[216:219], v[176:191]
    ds_read_b64_tr_b16 v[54:55], v7 offset:47616
    s_waitcnt lgkmcnt(0)
    s_barrier
    buffer_load_dword v27, off, s[96:99], s31 sc1
    v_mfma_f32_32x32x16_bf16 v[128:143], v[48:51], a[92:95], v[128:143]
    s_add_u32 m0, s59, 0x8000
    s_add_u32 s60, s66, 0x200000
    buffer_load_dwordx4 v12, s[40:43], s60 offen offset:0 lds
    ds_read_b64_tr_b16 v[32:33], v6 offset:49152
    v_mfma_f32_32x32x16_bf16 v[160:175], v[48:51], a[220:223], v[160:175]
    ds_read_b64_tr_b16 v[34:35], v6 offset:49664
    v_mfma_f32_32x32x16_bf16 v[144:159], v[52:55], a[92:95], v[144:159]
    buffer_load_dwordx4 v13, s[40:43], s60 offen offset:1024 lds
    ds_read_b64_tr_b16 v[36:37], v7 offset:49152
    v_mfma_f32_32x32x16_bf16 v[176:191], v[52:55], a[220:223], v[176:191]
    ds_read_b64_tr_b16 v[38:39], v7 offset:49664
    s_waitcnt lgkmcnt(2)
    v_mfma_f32_32x32x16_bf16 v[128:143], v[32:35], a[96:99], v[128:143]
    buffer_load_dwordx4 v14, s[40:43], s60 offen offset:2048 lds
    ds_read_b64_tr_b16 v[48:49], v6 offset:51200
    v_mfma_f32_32x32x16_bf16 v[160:175], v[32:35], a[224:227], v[160:175]
    ds_read_b64_tr_b16 v[50:51], v6 offset:51712
    s_waitcnt lgkmcnt(2)
    v_mfma_f32_32x32x16_bf16 v[144:159], v[36:39], a[96:99], v[144:159]
    buffer_load_dwordx4 v15, s[40:43], s60 offen offset:3072 lds
    ds_read_b64_tr_b16 v[52:53], v7 offset:51200
    v_mfma_f32_32x32x16_bf16 v[176:191], v[36:39], a[224:227], v[176:191]
    ds_read_b64_tr_b16 v[54:55], v7 offset:51712
    s_waitcnt lgkmcnt(2)
    v_mfma_f32_32x32x16_bf16 v[128:143], v[48:51], a[100:103], v[128:143]
    ds_read_b64_tr_b16 v[32:33], v6 offset:53248
    v_mfma_f32_32x32x16_bf16 v[160:175], v[48:51], a[228:231], v[160:175]
    ds_read_b64_tr_b16 v[34:35], v6 offset:53760
    s_waitcnt lgkmcnt(2)
    v_mfma_f32_32x32x16_bf16 v[144:159], v[52:55], a[100:103], v[144:159]
    ds_read_b64_tr_b16 v[36:37], v7 offset:53248
    v_mfma_f32_32x32x16_bf16 v[176:191], v[52:55], a[228:231], v[176:191]
    ds_read_b64_tr_b16 v[38:39], v7 offset:53760
    s_waitcnt lgkmcnt(2)
    v_mfma_f32_32x32x16_bf16 v[128:143], v[32:35], a[104:107], v[128:143]
    ds_read_b64_tr_b16 v[48:49], v6 offset:55296
    v_mfma_f32_32x32x16_bf16 v[160:175], v[32:35], a[232:235], v[160:175]
    ds_read_b64_tr_b16 v[50:51], v6 offset:55808
    s_waitcnt lgkmcnt(2)
    v_mfma_f32_32x32x16_bf16 v[144:159], v[36:39], a[104:107], v[144:159]
    ds_read_b64_tr_b16 v[52:53], v7 offset:55296
    v_mfma_f32_32x32x16_bf16 v[176:191], v[36:39], a[232:235], v[176:191]
    ds_read_b64_tr_b16 v[54:55], v7 offset:55808
    s_waitcnt lgkmcnt(2)
    v_mfma_f32_32x32x16_bf16 v[128:143], v[48:51], a[108:111], v[128:143]
    ds_read_b64_tr_b16 v[32:33], v6 offset:57344
    v_mfma_f32_32x32x16_bf16 v[160:175], v[48:51], a[236:239], v[160:175]
    ds_read_b64_tr_b16 v[34:35], v6 offset:57856
    s_waitcnt lgkmcnt(2)
    v_mfma_f32_32x32x16_bf16 v[144:159], v[52:55], a[108:111], v[144:159]
    ds_read_b64_tr_b16 v[36:37], v7 offset:57344
    v_mfma_f32_32x32x16_bf16 v[176:191], v[52:55], a[236:239], v[176:191]
    ds_read_b64_tr_b16 v[38:39], v7 offset:57856
    s_waitcnt lgkmcnt(2)
    v_mfma_f32_32x32x16_bf16 v[128:143], v[32:35], a[112:115], v[128:143]
    ds_read_b64_tr_b16 v[48:49], v6 offset:59392
    v_mfma_f32_32x32x16_bf16 v[160:175], v[32:35], a[240:243], v[160:175]
    ds_read_b64_tr_b16 v[50:51], v6 offset:59904
    s_waitcnt lgkmcnt(2)
    v_mfma_f32_32x32x16_bf16 v[144:159], v[36:39], a[112:115], v[144:159]
    ds_read_b64_tr_b16 v[52:53], v7 offset:59392
    v_mfma_f32_32x32x16_bf16 v[176:191], v[36:39], a[240:243], v[176:191]
    ds_read_b64_tr_b16 v[54:55], v7 offset:59904
    s_waitcnt lgkmcnt(2)
    v_mfma_f32_32x32x16_bf16 v[128:143], v[48:51], a[116:119], v[128:143]
    ds_read_b64_tr_b16 v[32:33], v6 offset:61440
    v_mfma_f32_32x32x16_bf16 v[160:175], v[48:51], a[244:247], v[160:175]
    ds_read_b64_tr_b16 v[34:35], v6 offset:61952
    s_waitcnt lgkmcnt(2)
    v_mfma_f32_32x32x16_bf16 v[144:159], v[52:55], a[116:119], v[144:159]
    ds_read_b64_tr_b16 v[36:37], v7 offset:61440
    v_mfma_f32_32x32x16_bf16 v[176:191], v[52:55], a[244:247], v[176:191]
    ds_read_b64_tr_b16 v[38:39], v7 offset:61952
    s_waitcnt lgkmcnt(2)
    v_mfma_f32_32x32x16_bf16 v[128:143], v[32:35], a[120:123], v[128:143]
    ds_read_b64_tr_b16 v[48:49], v6 offset:63488
    v_mfma_f32_32x32x16_bf16 v[160:175], v[32:35], a[248:251], v[160:175]
    ds_read_b64_tr_b16 v[50:51], v6 offset:64000
    s_waitcnt lgkmcnt(2)
    v_mfma_f32_32x32x16_bf16 v[144:159], v[36:39], a[120:123], v[144:159]
    ds_read_b64_tr_b16 v[52:53], v7 offset:63488
    v_mfma_f32_32x32x16_bf16 v[176:191], v[36:39], a[248:251], v[176:191]
    ds_read_b64_tr_b16 v[54:55], v7 offset:64000
    s_waitcnt lgkmcnt(0)
    s_barrier
    s_waitcnt vmcnt(4)
    v_readfirstlane_b32 s74, v27
    s_nop 0
    s_cmp_ge_u32 s74, 8
    s_cbranch_scc1 L_pollx_kvb
    s_mov_b32 s76, 0x10000
L_poll_kvb:
    buffer_load_dword v27, off, s[96:99], s31 sc1
    s_waitcnt vmcnt(0)
    v_readfirstlane_b32 s74, v27
    s_sub_u32 s76, s76, 1
    s_cmp_eq_u32 s76, 0
    s_cbranch_scc1 L_pollx_kvb
    s_cmp_ge_u32 s74, 8
    s_cbranch_scc1 L_pollx_kvb
    s_sleep 2
    s_branch L_poll_kvb
L_pollx_kvb:
    v_mfma_f32_32x32x16_bf16 v[128:143], v[48:51], a[124:127], v[128:143]
    s_add_u32 m0, s59, 0xc000
    s_add_u32 s60, s66, 0x300000
    buffer_load_dwordx4 v12, s[40:43], s60 offen offset:0 lds
    ds_read_b64_tr_b16 v[32:33], v6 offset:0
    v_mfma_f32_32x32x16_bf16 v[160:175], v[48:51], a[252:255], v[160:175]
    buffer_load_dwordx4 v13, s[40:43], s60 offen offset:1024 lds
    ds_read_b64_tr_b16 v[34:35], v6 offset:512
    v_mfma_f32_32x32x16_bf16 v[144:159], v[52:55], a[124:127], v[144:159]
    buffer_load_dwordx4 v14, s[40:43], s60 offen offset:2048 lds
    ds_read_b64_tr_b16 v[36:37], v7 offset:0
    v_mfma_f32_32x32x16_bf16 v[176:191], v[52:55], a[252:255], v[176:191]
    buffer_load_dwordx4 v15, s[40:43], s60 offen offset:3072 lds
    ds_read_b64_tr_b16 v[38:39], v7 offset:512
    s_waitcnt lgkmcnt(2)
    v_mfma_f32_32x32x16_bf16 v[192:207], v[32:35], a[0:3], 0
    s_lshl_b32 s61, s56, 12
    s_add_u32 m0, s61, 0
    s_add_u32 s61, s61, 0
    buffer_load_dwordx4 v2, s[48:51], s61 offen offset:0 sc1 lds
    ds_read_b64_tr_b16 v[48:49], v6 offset:2048
    v_mul_f32 v128, 0x3e0293ee, v128
    v_mfma_f32_32x32x16_bf16 v[224:239], v[32:35], a[128:131], 0
    buffer_load_dwordx4 v2, s[48:51], s61 offen offset:1024 sc1 lds
    ds_read_b64_tr_b16 v[50:51], v6 offset:2560
    v_mul_f32 v129, 0x3e0293ee, v129
    s_waitcnt lgkmcnt(2)
    v_mfma_f32_32x32x16_bf16 v[208:223], v[36:39], a[0:3], 0
    buffer_load_dwordx4 v2, s[48:51], s61 offen offset:2048 sc1 lds
    ds_read_b64_tr_b16 v[52:53], v7 offset:2048
    v_mfma_f32_32x32x16_bf16 v[240:255], v[36:39], a[128:131], 0
    buffer_load_dwordx4 v2, s[48:51], s61 offen offset:3072 sc1 lds
    v_mul_f32 v130, 0x3e0293ee, v130
    ds_read_b64_tr_b16 v[54:55], v7 offset:2560
    s_waitcnt lgkmcnt(2)
    v_mfma_f32_32x32x16_bf16 v[192:207], v[48:51], a[4:7], v[192:207]
    s_lshl_b32 s61, s56, 12
    s_add_u32 m0, s61, 0x4000
    s_add_u32 s61, s61, 0x4000
    buffer_load_dwordx4 v2, s[48:51], s61 offen offset:0 sc1 lds
    ds_read_b64_tr_b16 v[32:33], v6 offset:4096
    v_mul_f32 v131, 0x3e0293ee, v131
    v_mfma_f32_32x32x16_bf16 v[224:239], v[48:51], a[132:135], v[224:239]
    buffer_load_dwordx4 v2, s[48:51], s61 offen offset:1024 sc1 lds
    ds_read_b64_tr_b16 v[34:35], v6 offset:4608
    v_mul_f32 v132, 0x3e0293ee, v132
    s_waitcnt lgkmcnt(2)
    v_mfma_f32_32x32x16_bf16 v[208:223], v[52:55], a[4:7], v[208:223]
    buffer_load_dwordx4 v2, s[48:51], s61 offen offset:2048 sc1 lds
    ds_read_b64_tr_b16 v[36:37], v7 offset:4096
    v_mfma_f32_32x32x16_bf16 v[240:255], v[52:55], a[132:135], v[240:255]
    v_mul_f32 v133, 0x3e0293ee, v133
    ds_read_b64_tr_b16 v[38:39], v7 offset:4608
    s_waitcnt lgkmcnt(2)
    v_mfma_f32_32x32x16_bf16 v[192:207], v[32:35], a[8:11], v[192:207]
    buffer_load_dwordx4 v2, s[48:51], s61 offen offset:3072 sc1 lds
    ds_read_b64_tr_b16 v[48:49], v6 offset:6144
    v_mul_f32 v134, 0x3e0293ee, v134
    v_mfma_f32_32x32x16_bf16 v[224:239], v[32:35], a[136:139], v[224:239]
    ds_read_b64_tr_b16 v[50:51], v6 offset:6656
    v_mul_f32 v135, 0x3e0293ee, v135
    s_waitcnt lgkmcnt(2)
    v_mfma_f32_32x32x16_bf16 v[208:223], v[36:39], a[8:11], v[208:223]
    s_lshl_b32 s61, s56, 12
    s_add_u32 m0, s61, 0x10000
    s_add_u32 s61, s61, 0
    buffer_load_dwordx4 v2, s[52:55], s61 offen offset:0 sc1 lds
    ds_read_b64_tr_b16 v[52:53], v7 offset:6144
    v_mfma_f32_32x32x16_bf16 v[240:255], v[36:39], a[136:139], v[240:255]
    v_mul_f32 v136, 0x3e0293ee, v136
    ds_read_b64_tr_b16 v[54:55], v7 offset:6656
    s_waitcnt lgkmcnt(2)
    v_mfma_f32_32x32x16_bf16 v[192:207], v[48:51], a[12:15], v[192:207]
    buffer_load_dwordx4 v2, s[52:55], s61 offen offset:1024 sc1 lds
    ds_read_b64_tr_b16 v[32:33], v6 offset:8192
    v_mul_f32 v137, 0x3e0293ee, v137
    v_mfma_f32_32x32x16_bf16 v[224:239], v[48:51], a[140:143], v[224:239]
    ds_read_b64_tr_b16 v[34:35], v6 offset:8704
    v_mul_f32 v138, 0x3e0293ee, v138
    s_waitcnt lgkmcnt(2)
    v_mfma_f32_32x32x16_bf16 v[208:223], v[52:55], a[12:15], v[208:223]
    buffer_load_dwordx4 v2, s[52:55], s61 offen offset:2048 sc1 lds
    ds_read_b64_tr_b16 v[36:37], v7 offset:8192
    v_mfma_f32_32x32x16_bf16 v[240:255], v[52:55], a[140:143], v[240:255]
    v_mul_f32 v139, 0x3e0293ee, v139
    ds_read_b64_tr_b16 v[38:39], v7 offset:8704
    s_waitcnt lgkmcnt(2)
    v_mfma_f32_32x32x16_bf16 v[192:207], v[32:35], a[16:19], v[192:207]
    buffer_load_dwordx4 v2, s[52:55], s61 offen offset:3072 sc1 lds
    ds_read_b64_tr_b16 v[48:49], v6 offset:10240
    v_mul_f32 v140, 0x3e0293ee, v140
    v_mfma_f32_32x32x16_bf16 v[224:239], v[32:35], a[144:147], v[224:239]
    ds_read_b64_tr_b16 v[50:51], v6 offset:10752
    v_mul_f32 v141, 0x3e0293ee, v141
    s_waitcnt lgkmcnt(2)
    v_mfma_f32_32x32x16_bf16 v[208:223], v[36:39], a[16:19], v[208:223]
    s_lshl_b32 s61, s56, 12
    s_add_u32 m0, s61, 0x8000
    s_add_u32 s61, s61, 0x8000
    buffer_load_dwordx4 v2, s[48:51], s61 offen offset:0 sc1 lds
    ds_read_b64_tr_b16 v[52:53], v7 offset:10240
    v_mfma_f32_32x32x16_bf16 v[240:255], v[36:39], a[144:147], v[240:255]
    v_mul_f32 v142, 0x3e0293ee, v142
    ds_read_b64_tr_b16 v[54:55], v7 offset:10752
    s_waitcnt lgkmcnt(2)
    v_mfma_f32_32x32x16_bf16 v[192:207], v[48:51], a[20:23], v[192:207]
    buffer_load_dwordx4 v2, s[48:51], s61 offen offset:1024 sc1 lds
    ds_read_b64_tr_b16 v[32:33], v6 offset:12288
    v_mul_f32 v143, 0x3e0293ee, v143
    v_mfma_f32_32x32x16_bf16 v[224:239], v[48:51], a[148:151], v[224:239]
    ds_read_b64_tr_b16 v[34:35], v6 offset:12800
    v_cvt_pk_bf16_f32 v64, v128, v129
    s_waitcnt lgkmcnt(2)
    v_mfma_f32_32x32x16_bf16 v[208:223], v[52:55], a[20:23], v[208:223]
    buffer_load_dwordx4 v2, s[48:51], s61 offen offset:2048 sc1 lds
    ds_read_b64_tr_b16 v[36:37], v7 offset:12288
    v_mfma_f32_32x32x16_bf16 v[240:255], v[52:55], a[148:151], v[240:255]
    v_cvt_pk_bf16_f32 v65, v130, v131
    ds_read_b64_tr_b16 v[38:39], v7 offset:12800
    s_waitcnt lgkmcnt(2)
    v_mfma_f32_32x32x16_bf16 v[192:207], v[32:35], a[24:27], v[192:207]
    buffer_load_dwordx4 v2, s[48:51], s61 offen offset:3072 sc1 lds
    ds_read_b64_tr_b16 v[48:49], v6 offset:14336
    v_cvt_pk_bf16_f32 v66, v132, v133
    v_mfma_f32_32x32x16_bf16 v[224:239], v[32:35], a[152:155], v[224:239]
    ds_read_b64_tr_b16 v[50:51], v6 offset:14848
    v_cvt_pk_bf16_f32 v67, v134, v135
    s_waitcnt lgkmcnt(2)
    v_mfma_f32_32x32x16_bf16 v[208:223], v[36:39], a[24:27], v[208:223]
    s_lshl_b32 s61, s56, 12
    s_add_u32 m0, s61, 0x14000
    s_add_u32 s61, s61, 0x4000
    buffer_load_dwordx4 v2, s[52:55], s61 offen offset:0 sc1 lds
    ds_read_b64_tr_b16 v[52:53], v7 offset:14336
    v_mfma_f32_32x32x16_bf16 v[240:255], v[36:39], a[152:155], v[240:255]
    v_cvt_pk_bf16_f32 v72, v136, v137
    ds_read_b64_tr_b16 v[54:55], v7 offset:14848
    s_waitcnt lgkmcnt(0)
    s_barrier
    v_mfma_f32_32x32x16_bf16 v[192:207], v[48:51], a[28:31], v[192:207]
    buffer_load_dwordx4 v2, s[52:55], s61 offen offset:1024 sc1 lds
    ds_read_b64_tr_b16 v[32:33], v6 offset:16384
    v_cvt_pk_bf16_f32 v73, v138, v139
    v_mfma_f32_32x32x16_bf16 v[224:239], v[48:51], a[156:159], v[224:239]
    ds_read_b64_tr_b16 v[34:35], v6 offset:16896
    v_cvt_pk_bf16_f32 v74, v140, v141
    v_mfma_f32_32x32x16_bf16 v[208:223], v[52:55], a[28:31], v[208:223]
    buffer_load_dwordx4 v2, s[52:55], s61 offen offset:2048 sc1 lds
    ds_read_b64_tr_b16 v[36:37], v7 offset:16384
    v_mfma_f32_32x32x16_bf16 v[240:255], v[52:55], a[156:159], v[240:255]
    v_cvt_pk_bf16_f32 v75, v142, v143
    ds_read_b64_tr_b16 v[38:39], v7 offset:16896
    s_waitcnt lgkmcnt(2)
    v_mfma_f32_32x32x16_bf16 v[192:207], v[32:35], a[32:35], v[192:207]
    buffer_load_dwordx4 v2, s[52:55], s61 offen offset:3072 sc1 lds
    ds_read_b64_tr_b16 v[48:49], v6 offset:18432
    v_mul_f32 v144, 0x3e0293ee, v144
    v_mfma_f32_32x32x16_bf16 v[224:239], v[32:35], a[160:163], v[224:239]
    ds_read_b64_tr_b16 v[50:51], v6 offset:18944
    v_mul_f32 v145, 0x3e0293ee, v145
    s_waitcnt lgkmcnt(2)
    v_mfma_f32_32x32x16_bf16 v[208:223], v[36:39], a[32:35], v[208:223]
    ds_read_b64_tr_b16 v[52:53], v7 offset:18432
    v_mfma_f32_32x32x16_bf16 v[240:255], v[36:39], a[160:163], v[240:255]
    v_mul_f32 v146, 0x3e0293ee, v146
    ds_read_b64_tr_b16 v[54:55], v7 offset:18944
    s_waitcnt lgkmcnt(2)
    v_mfma_f32_32x32x16_bf16 v[192:207], v[48:51], a[36:39], v[192:207]
    ds_read_b64_tr_b16 v[32:33], v6 offset:20480
    v_mul_f32 v147, 0x3e0293ee, v147
    v_mfma_f32_32x32x16_bf16 v[224:239], v[48:51], a[164:167], v[224:239]
    ds_read_b64_tr_b16 v[34:35], v6 offset:20992
    v_mul_f32 v148, 0x3e0293ee, v148
    s_waitcnt lgkmcnt(2)
    v_mfma_f32_32x32x16_bf16 v[208:223], v[52:55], a[36:39], v[208:223]
    ds_read_b64_tr_b16 v[36:37], v7 offset:20480
    v_mfma_f32_32x32x16_bf16 v[240:255], v[52:55], a[164:167], v[240:255]
    v_mul_f32 v149, 0x3e0293ee, v149
    ds_read_b64_tr_b16 v[38:39], v7 offset:20992
    s_waitcnt lgkmcnt(2)
    v_mfma_f32_32x32x16_bf16 v[192:207], v[32:35], a[40:43], v[192:207]
    ds_read_b64_tr_b16 v[48:49], v6 offset:22528
    v_mul_f32 v150, 0x3e0293ee, v150
    v_mfma_f32_32x32x16_bf16 v[224:239], v[32:35], a[168:171], v[224:239]
    ds_read_b64_tr_b16 v[50:51], v6 offset:23040
    v_mul_f32 v151, 0x3e0293ee, v151
    s_waitcnt lgkmcnt(2)
    v_mfma_f32_32x32x16_bf16 v[208:223], v[36:39], a[40:43], v[208:223]
    ds_read_b64_tr_b16 v[52:53], v7 offset:22528
    v_mfma_f32_32x32x16_bf16 v[240:255], v[36:39], a[168:171], v[240:255]
    v_mul_f32 v152, 0x3e0293ee, v152
    ds_read_b64_tr_b16 v[54:55], v7 offset:23040
    s_waitcnt lgkmcnt(2)
    v_mfma_f32_32x32x16_bf16 v[192:207], v[48:51], a[44:47], v[192:207]
    ds_read_b64_tr_b16 v[32:33], v6 offset:24576
    v_mul_f32 v153, 0x3e0293ee, v153
    v_mfma_f32_32x32x16_bf16 v[224:239], v[48:51], a[172:175], v[224:239]
    ds_read_b64_tr_b16 v[34:35], v6 offset:25088
    v_mul_f32 v154, 0x3e0293ee, v154
    s_waitcnt lgkmcnt(2)
    v_mfma_f32_32x32x16_bf16 v[208:223], v[52:55], a[44:47], v[208:223]
    ds_read_b64_tr_b16 v[36:37], v7 offset:24576
    v_mfma_f32_32x32x16_bf16 v[240:255], v[52:55], a[172:175], v[240:255]
    v_mul_f32 v155, 0x3e0293ee, v155
    ds_read_b64_tr_b16 v[38:39], v7 offset:25088
    s_waitcnt lgkmcnt(2)
    v_mfma_f32_32x32x16_bf16 v[192:207], v[32:35], a[48:51], v[192:207]
    ds_read_b64_tr_b16 v[48:49], v6 offset:26624
    v_mul_f32 v156, 0x3e0293ee, v156
    v_mfma_f32_32x32x16_bf16 v[224:239], v[32:35], a[176:179], v[224:239]
    ds_read_b64_tr_b16 v[50:51], v6 offset:27136
    v_mul_f32 v157, 0x3e0293ee, v157
    s_waitcnt lgkmcnt(2)
    v_mfma_f32_32x32x16_bf16 v[208:223], v[36:39], a[48:51], v[208:223]
    ds_read_b64_tr_b16 v[52:53], v7 offset:26624
    v_mfma_f32_32x32x16_bf16 v[240:255], v[36:39], a[176:179], v[240:255]
    v_mul_f32 v158, 0x3e0293ee, v158
    ds_read_b64_tr_b16 v[54:55], v7 offset:27136
    s_waitcnt lgkmcnt(2)
    v_mfma_f32_32x32x16_bf16 v[192:207], v[48:51], a[52:55], v[192:207]
    ds_read_b64_tr_b16 v[32:33], v6 offset:28672
    v_mul_f32 v159, 0x3e0293ee, v159
    v_mfma_f32_32x32x16_bf16 v[224:239], v[48:51], a[180:183], v[224:239]
    ds_read_b64_tr_b16 v[34:35], v6 offset:29184
    v_cvt_pk_bf16_f32 v80, v144, v145
    s_waitcnt lgkmcnt(2)
    v_mfma_f32_32x32x16_bf16 v[208:223], v[52:55], a[52:55], v[208:223]
    ds_read_b64_tr_b16 v[36:37], v7 offset:28672
    v_mfma_f32_32x32x16_bf16 v[240:255], v[52:55], a[180:183], v[240:255]
    v_cvt_pk_bf16_f32 v81, v146, v147
    ds_read_b64_tr_b16 v[38:39], v7 offset:29184
    s_waitcnt lgkmcnt(2)
    v_mfma_f32_32x32x16_bf16 v[192:207], v[32:35], a[56:59], v[192:207]
    ds_read_b64_tr_b16 v[48:49], v6 offset:30720
    v_cvt_pk_bf16_f32 v82, v148, v149
    v_mfma_f32_32x32x16_bf16 v[224:239], v[32:35], a[184:187], v[224:239]
    ds_read_b64_tr_b16 v[50:51], v6 offset:31232
    v_cvt_pk_bf16_f32 v83, v150, v151
    s_waitcnt lgkmcnt(2)
    v_mfma_f32_32x32x16_bf16 v[208:223], v[36:39], a[56:59], v[208:223]
    ds_read_b64_tr_b16 v[52:53], v7 offset:30720
    v_mfma_f32_32x32x16_bf16 v[240:255], v[36:39], a[184:187], v[240:255]
    v_cvt_pk_bf16_f32 v88, v152, v153
    ds_read_b64_tr_b16 v[54:55], v7 offset:31232
    s_waitcnt lgkmcnt(0)
    s_waitcnt vmcnt(24)
    s_barrier
    v_mfma_f32_32x32x16_bf16 v[192:207], v[48:51], a[60:63], v[192:207]
    ds_read_b64_tr_b16 v[32:33], v6 offset:32768
    v_cvt_pk_bf16_f32 v89, v154, v155
    v_mfma_f32_32x32x16_bf16 v[224:239], v[48:51], a[188:191], v[224:239]
    ds_read_b64_tr_b16 v[34:35], v6 offset:33280
    v_cvt_pk_bf16_f32 v90, v156, v157
    v_mfma_f32_32x32x16_bf16 v[208:223], v[52:55], a[60:63], v[208:223]
    ds_read_b64_tr_b16 v[36:37], v7 offset:32768
    v_mfma_f32_32x32x16_bf16 v[240:255], v[52:55], a[188:191], v[240:255]
    v_cvt_pk_bf16_f32 v91, v158, v159
    ds_read_b64_tr_b16 v[38:39], v7 offset:33280
    s_waitcnt lgkmcnt(2)
    v_mfma_f32_32x32x16_bf16 v[192:207], v[32:35], a[64:67], v[192:207]
    ds_read_b64_tr_b16 v[48:49], v6 offset:34816
    v_mul_f32 v160, 0x3e0293ee, v160
    v_mfma_f32_32x32x16_bf16 v[224:239], v[32:35], a[192:195], v[224:239]
    ds_read_b64_tr_b16 v[50:51], v6 offset:35328
    v_mul_f32 v161, 0x3e0293ee, v161
    s_waitcnt lgkmcnt(2)
    v_mfma_f32_32x32x16_bf16 v[208:223], v[36:39], a[64:67], v[208:223]
    ds_read_b64_tr_b16 v[52:53], v7 offset:34816
    v_mfma_f32_32x32x16_bf16 v[240:255], v[36:39], a[192:195], v[240:255]
    v_mul_f32 v162, 0x3e0293ee, v162
    ds_read_b64_tr_b16 v[54:55], v7 offset:35328
    s_waitcnt lgkmcnt(2)
    v_mfma_f32_32x32x16_bf16 v[192:207], v[48:51], a[68:71], v[192:207]
    ds_read_b64_tr_b16 v[32:33], v6 offset:36864
    v_mul_f32 v163, 0x3e0293ee, v163
    v_mfma_f32_32x32x16_bf16 v[224:239], v[48:51], a[196:199], v[224:239]
    ds_read_b64_tr_b16 v[34:35], v6 offset:37376
    v_mul_f32 v164, 0x3e0293ee, v164
    s_waitcnt lgkmcnt(2)
    v_mfma_f32_32x32x16_bf16 v[208:223], v[52:55], a[68:71], v[208:223]
    ds_read_b64_tr_b16 v[36:37], v7 offset:36864
    v_mfma_f32_32x32x16_bf16 v[240:255], v[52:55], a[196:199], v[240:255]
    v_mul_f32 v165, 0x3e0293ee, v165
    ds_read_b64_tr_b16 v[38:39], v7 offset:37376
    s_waitcnt lgkmcnt(2)
    v_mfma_f32_32x32x16_bf16 v[192:207], v[32:35], a[72:75], v[192:207]
    ds_read_b64_tr_b16 v[48:49], v6 offset:38912
    v_mul_f32 v166, 0x3e0293ee, v166
    v_mfma_f32_32x32x16_bf16 v[224:239], v[32:35], a[200:203], v[224:239]
    ds_read_b64_tr_b16 v[50:51], v6 offset:39424
    v_mul_f32 v167, 0x3e0293ee, v167
    s_waitcnt lgkmcnt(2)
    v_mfma_f32_32x32x16_bf16 v[208:223], v[36:39], a[72:75], v[208:223]
    ds_read_b64_tr_b16 v[52:53], v7 offset:38912
    v_mfma_f32_32x32x16_bf16 v[240:255], v[36:39], a[200:203], v[240:255]
    v_mul_f32 v168, 0x3e0293ee, v168
    ds_read_b64_tr_b16 v[54:55], v7 offset:39424
    s_waitcnt lgkmcnt(2)
    v_mfma_f32_32x32x16_bf16 v[192:207], v[48:51], a[76:79], v[192:207]
    ds_read_b64_tr_b16 v[32:33], v6 offset:40960
    v_mul_f32 v169, 0x3e0293ee, v169
    v_mfma_f32_32x32x16_bf16 v[224:239], v[48:51], a[204:207], v[224:239]
    ds_read_b64_tr_b16 v[34:35], v6 offset:41472
    v_mul_f32 v170, 0x3e0293ee, v170
    s_waitcnt lgkmcnt(2)
    v_mfma_f32_32x32x16_bf16 v[208:223], v[52:55], a[76:79], v[208:223]
    ds_read_b64_tr_b16 v[36:37], v7 offset:40960
    v_mfma_f32_32x32x16_bf16 v[240:255], v[52:55], a[204:207], v[240:255]
    v_mul_f32 v171, 0x3e0293ee, v171
    ds_read_b64_tr_b16 v[38:39], v7 offset:41472
    s_waitcnt lgkmcnt(2)
    v_mfma_f32_32x32x16_bf16 v[192:207], v[32:35], a[80:83], v[192:207]
    ds_read_b64_tr_b16 v[48:49], v6 offset:43008
    v_mul_f32 v172, 0x3e0293ee, v172
    v_mfma_f32_32x32x16_bf16 v[224:239], v[32:35], a[208:211], v[224:239]
    ds_read_b64_tr_b16 v[50:51], v6 offset:43520
    v_mul_f32 v173, 0x3e0293ee, v173
    s_waitcnt lgkmcnt(2)
    v_mfma_f32_32x32x16_bf16 v[208:223], v[36:39], a[80:83], v[208:223]
    ds_read_b64_tr_b16 v[52:53], v7 offset:43008
    v_mfma_f32_32x32x16_bf16 v[240:255], v[36:39], a[208:211], v[240:255]
    v_mul_f32 v174, 0x3e0293ee, v174
    ds_read_b64_tr_b16 v[54:55], v7 offset:43520
    s_waitcnt lgkmcnt(2)
    v_mfma_f32_32x32x16_bf16 v[192:207], v[48:51], a[84:87], v[192:207]
    ds_read_b64_tr_b16 v[32:33], v6 offset:45056
    v_mul_f32 v175, 0x3e0293ee, v175
    v_mfma_f32_32x32x16_bf16 v[224:239], v[48:51], a[212:215], v[224:239]
    ds_read_b64_tr_b16 v[34:35], v6 offset:45568
    v_cvt_pk_bf16_f32 v96, v160, v161
    s_waitcnt lgkmcnt(2)
    v_mfma_f32_32x32x16_bf16 v[208:223], v[52:55], a[84:87], v[208:223]
    ds_read_b64_tr_b16 v[36:37], v7 offset:45056
    v_mfma_f32_32x32x16_bf16 v[240:255], v[52:55], a[212:215], v[240:255]
    v_cvt_pk_bf16_f32 v97, v162, v163
    ds_read_b64_tr_b16 v[38:39], v7 offset:45568
    s_waitcnt lgkmcnt(2)
    v_mfma_f32_32x32x16_bf16 v[192:207], v[32:35], a[88:91], v[192:207]
    ds_read_b64_tr_b16 v[48:49], v6 offset:47104
    v_cvt_pk_bf16_f32 v98, v164, v165
    v_mfma_f32_32x32x16_bf16 v[224:239], v[32:35], a[216:219], v[224:239]
    ds_read_b64_tr_b16 v[50:51], v6 offset:47616
    v_cvt_pk_bf16_f32 v99, v166, v167
    s_waitcnt lgkmcnt(2)
    v_mfma_f32_32x32x16_bf16 v[208:223], v[36:39], a[88:91], v[208:223]
    ds_read_b64_tr_b16 v[52:53], v7 offset:47104
    v_mfma_f32_32x32x16_bf16 v[240:255], v[36:39], a[216:219], v[240:255]
    v_cvt_pk_bf16_f32 v104, v168, v169
    ds_read_b64_tr_b16 v[54:55], v7 offset:47616
    s_waitcnt lgkmcnt(0)
    s_waitcnt vmcnt(20)
    s_barrier
    v_mfma_f32_32x32x16_bf16 v[192:207], v[48:51], a[92:95], v[192:207]
    s_lshl_b32 s61, s56, 12
    s_add_u32 m0, s61, 0xc000
    s_add_u32 s61, s61, 0xc000
    buffer_load_dwordx4 v2, s[48:51], s61 offen offset:0 sc1 lds
    ds_read_b64_tr_b16 v[32:33], v6 offset:49152
    v_cvt_pk_bf16_f32 v105, v170, v171
    v_mfma_f32_32x32x16_bf16 v[224:239], v[48:51], a[220:223], v[224:239]
    ds_read_b64_tr_b16 v[34:35], v6 offset:49664
    v_cvt_pk_bf16_f32 v106, v172, v173
    v_mfma_f32_32x32x16_bf16 v[208:223], v[52:55], a[92:95], v[208:223]
    buffer_load_dwordx4 v2, s[48:51], s61 offen offset:1024 sc1 lds
    ds_read_b64_tr_b16 v[36:37], v7 offset:49152
    v_mfma_f32_32x32x16_bf16 v[240:255], v[52:55], a[220:223], v[240:255]
    v_cvt_pk_bf16_f32 v107, v174, v175
    ds_read_b64_tr_b16 v[38:39], v7 offset:49664
    s_waitcnt lgkmcnt(2)
    v_mfma_f32_32x32x16_bf16 v[192:207], v[32:35], a[96:99], v[192:207]
    buffer_load_dwordx4 v2, s[48:51], s61 offen offset:2048 sc1 lds
    ds_read_b64_tr_b16 v[48:49], v6 offset:51200
    v_mul_f32 v176, 0x3e0293ee, v176
    v_mfma_f32_32x32x16_bf16 v[224:239], v[32:35], a[224:227], v[224:239]
    ds_read_b64_tr_b16 v[50:51], v6 offset:51712
    v_mul_f32 v177, 0x3e0293ee, v177
    s_waitcnt lgkmcnt(2)
    v_mfma_f32_32x32x16_bf16 v[208:223], v[36:39], a[96:99], v[208:223]
    buffer_load_dwordx4 v2, s[48:51], s61 offen offset:3072 sc1 lds
    ds_read_b64_tr_b16 v[52:53], v7 offset:51200
    v_mfma_f32_32x32x16_bf16 v[240:255], v[36:39], a[224:227], v[240:255]
    v_mul_f32 v178, 0x3e0293ee, v178
    ds_read_b64_tr_b16 v[54:55], v7 offset:51712
    s_waitcnt lgkmcnt(2)
    v_mfma_f32_32x32x16_bf16 v[192:207], v[48:51], a[100:103], v[192:207]
    s_lshl_b32 s61, s56, 12
    s_add_u32 m0, s61, 0x18000
    s_add_u32 s61, s61, 0x8000
    buffer_load_dwordx4 v2, s[52:55], s61 offen offset:0 sc1 lds
    ds_read_b64_tr_b16 v[32:33], v6 offset:53248
    v_mul_f32 v179, 0x3e0293ee, v179
    v_mfma_f32_32x32x16_bf16 v[224:239], v[48:51], a[228:231], v[224:239]
    ds_read_b64_tr_b16 v[34:35], v6 offset:53760
    v_mul_f32 v180, 0x3e0293ee, v180
    s_waitcnt lgkmcnt(2)
    v_mfma_f32_32x32x16_bf16 v[208:223], v[52:55], a[100:103], v[208:223]
    buffer_load_dwordx4 v2, s[52:55], s61 offen offset:1024 sc1 lds
    ds_read_b64_tr_b16 v[36:37], v7 offset:53248
    v_mfma_f32_32x32x16_bf16 v[240:255], v[52:55], a[228:231], v[240:255]
    v_mul_f32 v181, 0x3e0293ee, v181
    ds_read_b64_tr_b16 v[38:39], v7 offset:53760
    s_waitcnt lgkmcnt(2)
    v_mfma_f32_32x32x16_bf16 v[192:207], v[32:35], a[104:107], v[192:207]
    buffer_load_dwordx4 v2, s[52:55], s61 offen offset:2048 sc1 lds
    ds_read_b64_tr_b16 v[48:49], v6 offset:55296
    v_mul_f32 v182, 0x3e0293ee, v182
    v_mfma_f32_32x32x16_bf16 v[224:239], v[32:35], a[232:235], v[224:239]
    ds_read_b64_tr_b16 v[50:51], v6 offset:55808
    v_mul_f32 v183, 0x3e0293ee, v183
    s_waitcnt lgkmcnt(2)
    v_mfma_f32_32x32x16_bf16 v[208:223], v[36:39], a[104:107], v[208:223]
    buffer_load_dwordx4 v2, s[52:55], s61 offen offset:3072 sc1 lds
    ds_read_b64_tr_b16 v[52:53], v7 offset:55296
    v_mfma_f32_32x32x16_bf16 v[240:255], v[36:39], a[232:235], v[240:255]
    v_mul_f32 v184, 0x3e0293ee, v184
    ds_read_b64_tr_b16 v[54:55], v7 offset:55808
    s_waitcnt lgkmcnt(2)
    v_mfma_f32_32x32x16_bf16 v[192:207], v[48:51], a[108:111], v[192:207]
    ds_read_b64_tr_b16 v[32:33], v6 offset:57344
    v_mul_f32 v185, 0x3e0293ee, v185
    v_mfma_f32_32x32x16_bf16 v[224:239], v[48:51], a[236:239], v[224:239]
    ds_read_b64_tr_b16 v[34:35], v6 offset:57856
    v_mul_f32 v186, 0x3e0293ee, v186
    s_waitcnt lgkmcnt(2)
    v_mfma_f32_32x32x16_bf16 v[208:223], v[52:55], a[108:111], v[208:223]
    ds_read_b64_tr_b16 v[36:37], v7 offset:57344
    v_mfma_f32_32x32x16_bf16 v[240:255], v[52:55], a[236:239], v[240:255]
    v_mul_f32 v187, 0x3e0293ee, v187
    ds_read_b64_tr_b16 v[38:39], v7 offset:57856
    s_waitcnt lgkmcnt(2)
    v_mfma_f32_32x32x16_bf16 v[192:207], v[32:35], a[112:115], v[192:207]
    ds_read_b64_tr_b16 v[48:49], v6 offset:59392
    v_mul_f32 v188, 0x3e0293ee, v188
    v_mfma_f32_32x32x16_bf16 v[224:239], v[32:35], a[240:243], v[224:239]
    ds_read_b64_tr_b16 v[50:51], v6 offset:59904
    v_mul_f32 v189, 0x3e0293ee, v189
    s_waitcnt lgkmcnt(2)
    v_mfma_f32_32x32x16_bf16 v[208:223], v[36:39], a[112:115], v[208:223]
    ds_read_b64_tr_b16 v[52:53], v7 offset:59392
    v_mfma_f32_32x32x16_bf16 v[240:255], v[36:39], a[240:243], v[240:255]
    v_mul_f32 v190, 0x3e0293ee, v190
    ds_read_b64_tr_b16 v[54:55], v7 offset:59904
    s_waitcnt lgkmcnt(2)
    v_mfma_f32_32x32x16_bf16 v[192:207], v[48:51], a[116:119], v[192:207]
    ds_read_b64_tr_b16 v[32:33], v6 offset:61440
    v_mul_f32 v191, 0x3e0293ee, v191
    v_mfma_f32_32x32x16_bf16 v[224:239], v[48:51], a[244:247], v[224:239]
    ds_read_b64_tr_b16 v[34:35], v6 offset:61952
    v_cvt_pk_bf16_f32 v112, v176, v177
    s_waitcnt lgkmcnt(2)
    v_mfma_f32_32x32x16_bf16 v[208:223], v[52:55], a[116:119], v[208:223]
    ds_read_b64_tr_b16 v[36:37], v7 offset:61440
    v_mfma_f32_32x32x16_bf16 v[240:255], v[52:55], a[244:247], v[240:255]
    v_cvt_pk_bf16_f32 v113, v178, v179
    ds_read_b64_tr_b16 v[38:39], v7 offset:61952
    s_waitcnt lgkmcnt(2)
    v_mfma_f32_32x32x16_bf16 v[192:207], v[32:35], a[120:123], v[192:207]
    ds_read_b64_tr_b16 v[48:49], v6 offset:63488
    v_cvt_pk_bf16_f32 v114, v180, v181
    v_mfma_f32_32x32x16_bf16 v[224:239], v[32:35], a[248:251], v[224:239]
    ds_read_b64_tr_b16 v[50:51], v6 offset:64000
    v_cvt_pk_bf16_f32 v115, v182, v183
    s_waitcnt lgkmcnt(2)
    v_mfma_f32_32x32x16_bf16 v[208:223], v[36:39], a[120:123], v[208:223]
    ds_read_b64_tr_b16 v[52:53], v7 offset:63488
    v_mfma_f32_32x32x16_bf16 v[240:255], v[36:39], a[248:251], v[240:255]
    v_cvt_pk_bf16_f32 v120, v184, v185
    ds_read_b64_tr_b16 v[54:55], v7 offset:64000
    s_waitcnt lgkmcnt(2)
    v_mfma_f32_32x32x16_bf16 v[192:207], v[48:51], a[124:127], v[192:207]
    v_cvt_pk_bf16_f32 v121, v186, v187
    v_mfma_f32_32x32x16_bf16 v[224:239], v[48:51], a[252:255], v[224:239]
    v_cvt_pk_bf16_f32 v122, v188, v189
    s_waitcnt lgkmcnt(0)
    v_mfma_f32_32x32x16_bf16 v[208:223], v[52:55], a[124:127], v[208:223]
    v_mfma_f32_32x32x16_bf16 v[240:255], v[52:55], a[252:255], v[240:255]
    v_cvt_pk_bf16_f32 v123, v190, v191
    s_nop 4
    v_mul_f32 v192, 0x3e0293ee, v192
    v_mul_f32 v193, 0x3e0293ee, v193
    v_mul_f32 v194, 0x3e0293ee, v194
    v_mul_f32 v195, 0x3e0293ee, v195
    v_mul_f32 v196, 0x3e0293ee, v196
    v_mul_f32 v197, 0x3e0293ee, v197
    v_mul_f32 v198, 0x3e0293ee, v198
    v_mul_f32 v199, 0x3e0293ee, v199
    v_mul_f32 v200, 0x3e0293ee, v200
    v_mul_f32 v201, 0x3e0293ee, v201
    v_mul_f32 v202, 0x3e0293ee, v202
    v_mul_f32 v203, 0x3e0293ee, v203
    v_mul_f32 v204, 0x3e0293ee, v204
    v_mul_f32 v205, 0x3e0293ee, v205
    v_mul_f32 v206, 0x3e0293ee, v206
    v_mul_f32 v207, 0x3e0293ee, v207
    v_cvt_pk_bf16_f32 v68, v192, v193
    v_cvt_pk_bf16_f32 v69, v194, v195
    v_cvt_pk_bf16_f32 v70, v196, v197
    v_cvt_pk_bf16_f32 v71, v198, v199
    v_cvt_pk_bf16_f32 v76, v200, v201
    v_cvt_pk_bf16_f32 v77, v202, v203
    v_cvt_pk_bf16_f32 v78, v204, v205
    v_cvt_pk_bf16_f32 v79, v206, v207
    v_mul_f32 v208, 0x3e0293ee, v208
    v_mul_f32 v209, 0x3e0293ee, v209
    v_mul_f32 v210, 0x3e0293ee, v210
    v_mul_f32 v211, 0x3e0293ee, v211
    v_mul_f32 v212, 0x3e0293ee, v212
    v_mul_f32 v213, 0x3e0293ee, v213
    v_mul_f32 v214, 0x3e0293ee, v214
    v_mul_f32 v215, 0x3e0293ee, v215
    v_mul_f32 v216, 0x3e0293ee, v216
    v_mul_f32 v217, 0x3e0293ee, v217
    v_mul_f32 v218, 0x3e0293ee, v218
    v_mul_f32 v219, 0x3e0293ee, v219
    v_mul_f32 v220, 0x3e0293ee, v220
    v_mul_f32 v221, 0x3e0293ee, v221
    v_mul_f32 v222, 0x3e0293ee, v222
    v_mul_f32 v223, 0x3e0293ee, v223
    v_cvt_pk_bf16_f32 v84, v208, v209
    v_cvt_pk_bf16_f32 v85, v210, v211
    v_cvt_pk_bf16_f32 v86, v212, v213
    v_cvt_pk_bf16_f32 v87, v214, v215
    v_cvt_pk_bf16_f32 v92, v216, v217
    v_cvt_pk_bf16_f32 v93, v218, v219
    v_cvt_pk_bf16_f32 v94, v220, v221
    v_cvt_pk_bf16_f32 v95, v222, v223
    v_mul_f32 v224, 0x3e0293ee, v224
    v_mul_f32 v225, 0x3e0293ee, v225
    v_mul_f32 v226, 0x3e0293ee, v226
    v_mul_f32 v227, 0x3e0293ee, v227
    v_mul_f32 v228, 0x3e0293ee, v228
    v_mul_f32 v229, 0x3e0293ee, v229
    v_mul_f32 v230, 0x3e0293ee, v230
    v_mul_f32 v231, 0x3e0293ee, v231
    v_mul_f32 v232, 0x3e0293ee, v232
    v_mul_f32 v233, 0x3e0293ee, v233
    v_mul_f32 v234, 0x3e0293ee, v234
    v_mul_f32 v235, 0x3e0293ee, v235
    v_mul_f32 v236, 0x3e0293ee, v236
    v_mul_f32 v237, 0x3e0293ee, v237
    v_mul_f32 v238, 0x3e0293ee, v238
    v_mul_f32 v239, 0x3e0293ee, v239
    v_cvt_pk_bf16_f32 v100, v224, v225
    v_cvt_pk_bf16_f32 v101, v226, v227
    v_cvt_pk_bf16_f32 v102, v228, v229
    v_cvt_pk_bf16_f32 v103, v230, v231
    v_cvt_pk_bf16_f32 v108, v232, v233
    v_cvt_pk_bf16_f32 v109, v234, v235
    v_cvt_pk_bf16_f32 v110, v236, v237
    v_cvt_pk_bf16_f32 v111, v238, v239
    v_mul_f32 v240, 0x3e0293ee, v240
    v_mul_f32 v241, 0x3e0293ee, v241
    v_mul_f32 v242, 0x3e0293ee, v242
    v_mul_f32 v243, 0x3e0293ee, v243
    v_mul_f32 v244, 0x3e0293ee, v244
    v_mul_f32 v245, 0x3e0293ee, v245
    v_mul_f32 v246, 0x3e0293ee, v246
    v_mul_f32 v247, 0x3e0293ee, v247
    v_mul_f32 v248, 0x3e0293ee, v248
    v_mul_f32 v249, 0x3e0293ee, v249
    v_mul_f32 v250, 0x3e0293ee, v250
    v_mul_f32 v251, 0x3e0293ee, v251
    v_mul_f32 v252, 0x3e0293ee, v252
    v_mul_f32 v253, 0x3e0293ee, v253
    v_mul_f32 v254, 0x3e0293ee, v254
    v_mul_f32 v255, 0x3e0293ee, v255
    v_cvt_pk_bf16_f32 v116, v240, v241
    v_cvt_pk_bf16_f32 v117, v242, v243
    v_cvt_pk_bf16_f32 v118, v244, v245
    v_cvt_pk_bf16_f32 v119, v246, v247
    v_cvt_pk_bf16_f32 v124, v248, v249
    v_cvt_pk_bf16_f32 v125, v250, v251
    v_cvt_pk_bf16_f32 v126, v252, v253
    v_cvt_pk_bf16_f32 v127, v254, v255
    s_waitcnt vmcnt(24)
K2_ATT:
    s_nop 1
    v_and_b32 v3, 31, v1
    v_lshrrev_b32 v4, 5, v1
    v_lshlrev_b32 v4, 2, v4
    v_sub_u32 v3, v3, v4
    s_lshl_b32 s79, s81, 5
    s_lshl_b32 s80, s30, 5
    v_add_u32 v8, s79, v3
    v_add_u32 v9, s80, v3
    v_mov_b32 v17, 0xff800000
    v_mov_b32 v10, 0
    v_mov_b32 v11, 0
    v_add_u32 v6, 0x4000, v2
    v_add_u32 v7, 0x10000, v2
    s_lshl_b32 s73, s56, 12
    s_add_u32 s71, s71, 0x10000
    s_add_u32 s72, s72, 0xc000
    s_mov_b32 s75, 0
    s_and_b32 s77, s56, 1
    s_lshl_b32 s77, s77, 13
    s_lshl_b32 s79, s56, 13
    s_add_u32 s79, s79, 0x20000
    v_add_u32 v26, s79, v2
    s_barrier
    ds_read_b128 a[192:195], v2 offset:0
    ds_read_b128 a[196:199], v2 offset:1024
    ds_read_b128 a[200:203], v2 offset:2048
    ds_read_b128 a[204:207], v2 offset:3072
    ds_read_b128 a[208:211], v2 offset:4096
    ds_read_b128 a[212:215], v2 offset:5120
    ds_read_b128 a[216:219], v2 offset:6144
    ds_read_b128 a[220:223], v2 offset:7168
    ds_read_b128 a[128:131], v2 offset:8192
    ds_read_b128 a[132:135], v2 offset:9216
    ds_read_b128 a[136:139], v2 offset:10240
    ds_read_b128 a[140:143], v2 offset:11264
    ds_read_b128 a[144:147], v2 offset:12288
    ds_read_b128 a[148:151], v2 offset:13312
    ds_read_b128 a[152:155], v2 offset:14336
    s_waitcnt lgkmcnt(8)
    ds_read_b128 a[156:159], v2 offset:15360
    v_mfma_f32_32x32x16_bf16 v[128:143], a[192:195], v[64:67], 0
    v_mfma_f32_32x32x16_bf16 v[144:159], a[192:195], v[96:99], 0
    ds_write_b128 v26, v[64:67] offset:0
    v_mfma_f32_32x32x16_bf16 v[128:143], a[196:199], v[72:75], v[128:143]
    v_mfma_f32_32x32x16_bf16 v[144:159], a[196:199], v[104:107], v[144:159]
    ds_write_b128 v26, v[72:75] offset:1024
    v_mfma_f32_32x32x16_bf16 v[128:143], a[200:203], v[80:83], v[128:143]
    v_mfma_f32_32x32x16_bf16 v[144:159], a[200:203], v[112:115], v[144:159]
    ds_write_b128 v26, v[80:83] offset:2048
    v_mfma_f32_32x32x16_bf16 v[128:143], a[204:207], v[88:91], v[128:143]
    v_mfma_f32_32x32x16_bf16 v[144:159], a[204:207], v[120:123], v[144:159]
    ds_write_b128 v26, v[88:91] offset:3072
    v_mfma_f32_32x32x16_bf16 v[128:143], a[208:211], v[68:71], v[128:143]
    v_mfma_f32_32x32x16_bf16 v[144:159], a[208:211], v[100:103], v[144:159]
    ds_write_b128 v26, v[68:71] offset:4096
    v_mfma_f32_32x32x16_bf16 v[128:143], a[212:215], v[76:79], v[128:143]
    v_mfma_f32_32x32x16_bf16 v[144:159], a[212:215], v[108:111], v[144:159]
    ds_write_b128 v26, v[76:79] offset:5120
    v_mfma_f32_32x32x16_bf16 v[128:143], a[216:219], v[84:87], v[128:143]
    v_mfma_f32_32x32x16_bf16 v[144:159], a[216:219], v[116:119], v[144:159]
    s_waitcnt lgkmcnt(8)
    ds_write_b128 v26, v[84:87] offset:6144
    v_mfma_f32_32x32x16_bf16 v[128:143], a[220:223], v[92:95], v[128:143]
    v_mfma_f32_32x32x16_bf16 v[144:159], a[220:223], v[124:127], v[144:159]
    ds_write_b128 v26, v[92:95] offset:7168
    v_xor_b32 v26, 0x2000, v26
    s_nop 8
    v_max3_f32 v32, v128, v129, v130
    v_max3_f32 v32, v32, v131, v132
    v_max3_f32 v32, v32, v133, v134
    v_max3_f32 v32, v32, v135, v136
    v_max3_f32 v32, v32, v137, v138
    v_max3_f32 v32, v32, v139, v140
    v_max3_f32 v32, v32, v141, v142
    v_max_f32 v32, v32, v143
    v_mov_b32 v33, v32
    s_nop 1
    v_permlane32_swap_b32 v32, v33
    v_max_f32 v32, v32, v33
    v_sub_f32 v128, v128, v32
    v_sub_f32 v129, v129, v32
    v_sub_f32 v130, v130, v32
    v_sub_f32 v131, v131, v32
    v_sub_f32 v132, v132, v32
    v_sub_f32 v133, v133, v32
    v_sub_f32 v134, v134, v32
    v_sub_f32 v135, v135, v32
    v_sub_f32 v136, v136, v32
    v_sub_f32 v137, v137, v32
    v_sub_f32 v138, v138, v32
    v_sub_f32 v139, v139, v32
    v_sub_f32 v140, v140, v32
    v_sub_f32 v141, v141, v32
    v_sub_f32 v142, v142, v32
    v_sub_f32 v143, v143, v32
    v_sub_f32 v192, 0, v32
    v_sub_f32 v193, 0, v32
    v_sub_f32 v194, 0, v32
    v_sub_f32 v195, 0, v32
    v_sub_f32 v196, 0, v32
    v_sub_f32 v197, 0, v32
    v_sub_f32 v198, 0, v32
    v_sub_f32 v199, 0, v32
    v_sub_f32 v200, 0, v32
    v_sub_f32 v201, 0, v32
    v_sub_f32 v202, 0, v32
    v_sub_f32 v203, 0, v32
    v_sub_f32 v204, 0, v32
    v_sub_f32 v205, 0, v32
    v_sub_f32 v206, 0, v32
    v_sub_f32 v207, 0, v32
    v_cmp_ge_i32 s[40:41], v9, 0
    v_cmp_ge_i32 s[42:43], v9, 1
    v_cmp_ge_i32 s[44:45], v9, 2
    v_cmp_ge_i32 s[46:47], v9, 3
    v_cndmask_b32 v144, v17, v144, s[40:41]
    v_cndmask_b32 v145, v17, v145, s[42:43]
    v_cndmask_b32 v146, v17, v146, s[44:45]
    v_cndmask_b32 v147, v17, v147, s[46:47]
    v_cmp_ge_i32 s[40:41], v9, 8
    v_cmp_ge_i32 s[42:43], v9, 9
    v_cmp_ge_i32 s[44:45], v9, 10
    v_cmp_ge_i32 s[46:47], v9, 11
    v_cndmask_b32 v148, v17, v148, s[40:41]
    v_cndmask_b32 v149, v17, v149, s[42:43]
    v_cndmask_b32 v150, v17, v150, s[44:45]
    v_cndmask_b32 v151, v17, v151, s[46:47]
    v_cmp_ge_i32 s[40:41], v9, 16
    v_cmp_ge_i32 s[42:43], v9, 17
    v_cmp_ge_i32 s[44:45], v9, 18
    v_cmp_ge_i32 s[46:47], v9, 19
    v_cndmask_b32 v152, v17, v152, s[40:41]
    v_cndmask_b32 v153, v17, v153, s[42:43]
    v_cndmask_b32 v154, v17, v154, s[44:45]
    v_cndmask_b32 v155, v17, v155, s[46:47]
    v_cmp_ge_i32 s[40:41], v9, 24
    v_cmp_ge_i32 s[42:43], v9, 25
    v_cmp_ge_i32 s[44:45], v9, 26
    v_cmp_ge_i32 s[46:47], v9, 27
    v_cndmask_b32 v156, v17, v156, s[40:41]
    v_cndmask_b32 v157, v17, v157, s[42:43]
    v_cndmask_b32 v158, v17, v158, s[44:45]
    v_cndmask_b32 v159, v17, v159, s[46:47]
    v_max3_f32 v32, v144, v145, v146
    v_max3_f32 v32, v32, v147, v148
    v_max3_f32 v32, v32, v149, v150
    v_max3_f32 v32, v32, v151, v152
    v_max3_f32 v32, v32, v153, v154
    v_max3_f32 v32, v32, v155, v156
    v_max3_f32 v32, v32, v157, v158
    v_max_f32 v32, v32, v159
    v_mov_b32 v33, v32
    s_nop 1
    v_permlane32_swap_b32 v32, v33
    v_max_f32 v32, v32, v33
    v_sub_f32 v144, v144, v32
    v_sub_f32 v145, v145, v32
    v_sub_f32 v146, v146, v32
    v_sub_f32 v147, v147, v32
    v_sub_f32 v148, v148, v32
    v_sub_f32 v149, v149, v32
    v_sub_f32 v150, v150, v32
    v_sub_f32 v151, v151, v32
    v_sub_f32 v152, v152, v32
    v_sub_f32 v153, v153, v32
    v_sub_f32 v154, v154, v32
    v_sub_f32 v155, v155, v32
    v_sub_f32 v156, v156, v32
    v_sub_f32 v157, v157, v32
    v_sub_f32 v158, v158, v32
    v_sub_f32 v159, v159, v32
    v_sub_f32 v208, 0, v32
    v_sub_f32 v209, 0, v32
    v_sub_f32 v210, 0, v32
    v_sub_f32 v211, 0, v32
    v_sub_f32 v212, 0, v32
    v_sub_f32 v213, 0, v32
    v_sub_f32 v214, 0, v32
    v_sub_f32 v215, 0, v32
    v_sub_f32 v216, 0, v32
    v_sub_f32 v217, 0, v32
    v_sub_f32 v218, 0, v32
    v_sub_f32 v219, 0, v32
    v_sub_f32 v220, 0, v32
    v_sub_f32 v221, 0, v32
    v_sub_f32 v222, 0, v32
    v_sub_f32 v223, 0, v32
    s_waitcnt lgkmcnt(0)
    s_waitcnt vmcnt(16) lgkmcnt(0)
    s_barrier
    v_mfma_f32_32x32x16_bf16 v[160:175], a[128:131], v[64:67], v[192:207]
    v_exp_f32 v18, v128
    s_mov_b32 m0, s73
    ds_read_b128 a[192:195], v6 offset:0
    v_exp_f32 v19, v129
    v_exp_f32 v20, v130
    v_exp_f32 v21, v131
    v_add_f32 v12, v18, v19
    v_cvt_pk_bf16_f32 v224, v18, v19
    v_mfma_f32_32x32x16_bf16 v[176:191], a[128:131], v[96:99], v[208:223]
    v_exp_f32 v22, v132
    ds_read_b128 a[224:227], v7 offset:0
    v_exp_f32 v23, v133
    v_add_f32 v12, v12, v20
    v_add_f32 v12, v12, v21
    v_cvt_pk_bf16_f32 v225, v20, v21
    v_exp_f32 v18, v134
    v_exp_f32 v19, v135
    v_mfma_f32_32x32x16_bf16 v[160:175], a[132:135], v[72:75], v[160:175]
    ds_read_b128 a[196:199], v6 offset:1024
    v_add_f32 v12, v12, v22
    v_add_f32 v12, v12, v23
    v_cvt_pk_bf16_f32 v226, v22, v23
    v_exp_f32 v20, v136
    v_exp_f32 v21, v137
    v_add_f32 v12, v12, v18
    buffer_load_dwordx4 v2, s[48:51], s71 offen offset:0 sc1 lds
    v_mfma_f32_32x32x16_bf16 v[176:191], a[132:135], v[104:107], v[176:191]
    ds_read_b128 a[228:231], v7 offset:1024
    v_add_f32 v12, v12, v19
    v_cvt_pk_bf16_f32 v227, v18, v19
    v_exp_f32 v22, v138
    v_exp_f32 v23, v139
    v_add_f32 v12, v12, v20
    v_add_f32 v12, v12, v21
    ds_read_b128 a[200:203], v6 offset:2048
    v_cvt_pk_bf16_f32 v228, v20, v21
    v_mfma_f32_32x32x16_bf16 v[160:175], a[136:139], v[80:83], v[160:175]
    v_exp_f32 v18, v140
    v_exp_f32 v19, v141
    v_add_f32 v12, v12, v22
    v_add_f32 v12, v12, v23
    v_cvt_pk_bf16_f32 v229, v22, v23
    ds_read_b128 a[232:235], v7 offset:2048
    v_exp_f32 v20, v142
    v_exp_f32 v21, v143
    v_add_f32 v12, v12, v18
    v_mfma_f32_32x32x16_bf16 v[176:191], a[136:139], v[112:115], v[176:191]
    v_add_f32 v12, v12, v19
    v_cvt_pk_bf16_f32 v230, v18, v19
    v_add_f32 v12, v12, v20
    buffer_load_dwordx4 v2, s[48:51], s71 offen offset:1024 sc1 lds
    v_add_f32 v12, v12, v21
    ds_read_b128 a[204:207], v6 offset:3072
    v_cvt_pk_bf16_f32 v231, v20, v21
    v_subrev_u32 v16, s75, v9
    v_cmp_ge_i32 s[40:41], v16, 0
    v_mfma_f32_32x32x16_bf16 v[160:175], a[140:143], v[88:91], v[160:175]
    v_cmp_ge_i32 s[42:43], v16, 1
    v_exp_f32 v18, v144
    v_exp_f32 v19, v145
    ds_read_b128 a[236:239], v7 offset:3072
    v_cmp_ge_i32 s[44:45], v16, 2
    v_cmp_ge_i32 s[46:47], v16, 3
    v_exp_f32 v20, v146
    v_exp_f32 v21, v147
    v_mfma_f32_32x32x16_bf16 v[176:191], a[140:143], v[120:123], v[176:191]
    v_cndmask_b32 v18, 0, v18, s[40:41]
    v_cndmask_b32 v19, 0, v19, s[42:43]
    ds_read_b128 a[208:211], v6 offset:4096
    v_add_f32 v13, v18, v19
    v_cvt_pk_bf16_f32 v232, v18, v19
    v_cmp_ge_i32 s[40:41], v16, 8
    v_cmp_ge_i32 s[42:43], v16, 9
    v_exp_f32 v22, v148
    buffer_load_dwordx4 v2, s[48:51], s71 offen offset:2048 sc1 lds
    v_mfma_f32_32x32x16_bf16 v[160:175], a[144:147], v[68:71], v[160:175]
    v_exp_f32 v23, v149
    ds_read_b128 a[240:243], v7 offset:4096
    v_cndmask_b32 v20, 0, v20, s[44:45]
    v_cndmask_b32 v21, 0, v21, s[46:47]
    v_add_f32 v13, v13, v20
    v_add_f32 v13, v13, v21
    v_cvt_pk_bf16_f32 v233, v20, v21
    v_cmp_ge_i32 s[44:45], v16, 10
    ds_read_b128 a[212:215], v6 offset:5120
    v_cmp_ge_i32 s[46:47], v16, 11
    v_mfma_f32_32x32x16_bf16 v[176:191], a[144:147], v[100:103], v[176:191]
    v_exp_f32 v18, v150
    v_exp_f32 v19, v151
    v_cndmask_b32 v22, 0, v22, s[40:41]
    v_cndmask_b32 v23, 0, v23, s[42:43]
    v_add_f32 v13, v13, v22
    v_add_f32 v13, v13, v23
    ds_read_b128 a[244:247], v7 offset:5120
    v_cvt_pk_bf16_f32 v234, v22, v23
    v_cmp_ge_i32 s[40:41], v16, 16
    v_cmp_ge_i32 s[42:43], v16, 17
    v_mfma_f32_32x32x16_bf16 v[160:175], a[148:151], v[76:79], v[160:175]
    v_exp_f32 v20, v152
    buffer_load_dwordx4 v2, s[48:51], s71 offen offset:3072 sc1 lds
    v_exp_f32 v21, v153
    v_cndmask_b32 v18, 0, v18, s[44:45]
    ds_read_b128 a[216:219], v6 offset:6144
    v_cndmask_b32 v19, 0, v19, s[46:47]
    v_add_f32 v13, v13, v18
    v_mfma_f32_32x32x16_bf16 v[176:191], a[148:151], v[108:111], v[176:191]
    v_add_f32 v13, v13, v19
    v_cvt_pk_bf16_f32 v235, v18, v19
    v_cmp_ge_i32 s[44:45], v16, 18
    v_cmp_ge_i32 s[46:47], v16, 19
    ds_read_b128 a[248:251], v7 offset:6144
    v_exp_f32 v22, v154
    v_exp_f32 v23, v155
    v_cndmask_b32 v20, 0, v20, s[40:41]
    v_cndmask_b32 v21, 0, v21, s[42:43]
    v_add_f32 v13, v13, v20
    v_add_f32 v13, v13, v21
    v_mfma_f32_32x32x16_bf16 v[160:175], a[152:155], v[84:87], v[160:175]
    ds_read_b128 a[220:223], v6 offset:7168
    v_cvt_pk_bf16_f32 v236, v20, v21
    v_cmp_ge_i32 s[40:41], v16, 24
    v_cmp_ge_i32 s[42:43], v16, 25
    v_exp_f32 v18, v156
    s_add_u32 s71, s71, 0x4000
    v_exp_f32 v19, v157
    v_cndmask_b32 v22, 0, v22, s[44:45]
    s_waitcnt lgkmcnt(8)
    ds_read_b128 a[252:255], v7 offset:7168
    v_cndmask_b32 v23, 0, v23, s[46:47]
    v_mfma_f32_32x32x16_bf16 v[176:191], a[152:155], v[116:119], v[176:191]
    v_add_f32 v13, v13, v22
    v_add_f32 v13, v13, v23
    v_cvt_pk_bf16_f32 v237, v22, v23
    v_cmp_ge_i32 s[44:45], v16, 26
    v_cmp_ge_i32 s[46:47], v16, 27
    v_exp_f32 v20, v158
    v_exp_f32 v21, v159
    v_cndmask_b32 v18, 0, v18, s[40:41]
    v_cndmask_b32 v19, 0, v19, s[42:43]
    v_add_f32 v13, v13, v18
    v_mfma_f32_32x32x16_bf16 v[160:175], a[156:159], v[92:95], v[160:175]
    v_add_f32 v13, v13, v19
    v_cvt_pk_bf16_f32 v238, v18, v19
    v_cndmask_b32 v20, 0, v20, s[44:45]
    v_cndmask_b32 v21, 0, v21, s[46:47]
    v_add_f32 v13, v13, v20
    v_add_f32 v13, v13, v21
    v_cvt_pk_bf16_f32 v239, v20, v21
    v_max_f32 v14, v12, v13
    v_cmp_nge_f32 vcc, s78, v14
    s_mov_b32 s76, 0
    v_add_f32 v24, v10, v12
    v_add_f32 v25, v11, v13
    v_mfma_f32_32x32x16_bf16 v[176:191], a[156:159], v[124:127], v[176:191]
    s_cbranch_vccnz K2_RARE0
K2_RET_V0a:
    s_add_u32 s75, s75, 32
    v_mfma_f32_32x32x16_bf16 v[128:143], a[192:195], v[64:67], v[192:207]
    v_exp_f32 v18, v160
    s_sub_u32 s61, s73, 0x4000
    ds_read_b128 a[128:131], v6 offset:8192
    v_exp_f32 v19, v161
    v_mfma_f32_32x32x16_bf16 v[144:159], a[192:195], v[96:99], v[208:223]
    v_exp_f32 v20, v162
    v_exp_f32 v21, v163
    v_add_f32 v12, v18, v19
    ds_read_b128 a[160:163], v7 offset:8192
    v_mfma_f32_32x32x16_bf16 v[128:143], a[196:199], v[72:75], v[128:143]
    v_cvt_pk_bf16_f32 v240, v18, v19
    v_exp_f32 v22, v164
    v_exp_f32 v23, v165
    v_add_f32 v12, v12, v20
    v_mfma_f32_32x32x16_bf16 v[144:159], a[196:199], v[104:107], v[144:159]
    v_add_f32 v12, v12, v21
    ds_read_b128 a[132:135], v6 offset:9216
    v_cvt_pk_bf16_f32 v241, v20, v21
    v_exp_f32 v18, v166
    v_exp_f32 v19, v167
    v_mfma_f32_32x32x16_bf16 v[128:143], a[200:203], v[80:83], v[128:143]
    s_and_b32 s61, s61, 0xffff
    v_add_f32 v12, v12, v22
    v_add_f32 v12, v12, v23
    ds_read_b128 a[164:167], v7 offset:9216
    v_cvt_pk_bf16_f32 v242, v22, v23
    v_mfma_f32_32x32x16_bf16 v[144:159], a[200:203], v[112:115], v[144:159]
    v_exp_f32 v20, v168
    v_exp_f32 v21, v169
    v_add_f32 v12, v12, v18
    v_add_f32 v12, v12, v19
    ds_read_b128 a[136:139], v6 offset:10240
    v_mfma_f32_32x32x16_bf16 v[128:143], a[204:207], v[88:91], v[128:143]
    v_cvt_pk_bf16_f32 v243, v18, v19
    v_exp_f32 v22, v170
    v_exp_f32 v23, v171
    v_add_f32 v12, v12, v20
    v_mfma_f32_32x32x16_bf16 v[144:159], a[204:207], v[120:123], v[144:159]
    v_add_f32 v12, v12, v21
    ds_read_b128 a[168:171], v7 offset:10240
    v_cvt_pk_bf16_f32 v244, v20, v21
    s_add_u32 m0, s61, 0x10000
    v_exp_f32 v18, v172
    s_waitcnt lgkmcnt(13)
    v_mfma_f32_32x32x16_bf16 v[128:143], a[208:211], v[68:71], v[128:143]
    v_exp_f32 v19, v173
    v_add_f32 v12, v12, v22
    ds_read_b128 a[140:143], v6 offset:11264
    v_add_f32 v12, v12, v23
    v_cvt_pk_bf16_f32 v245, v22, v23
    v_mfma_f32_32x32x16_bf16 v[144:159], a[208:211], v[100:103], v[144:159]
    v_exp_f32 v20, v174
    v_exp_f32 v21, v175
    v_add_f32 v12, v12, v18
    ds_read_b128 a[172:175], v7 offset:11264
    s_waitcnt lgkmcnt(13)
    v_mfma_f32_32x32x16_bf16 v[128:143], a[212:215], v[76:79], v[128:143]
    v_add_f32 v12, v12, v19
    v_cvt_pk_bf16_f32 v246, v18, v19
    v_add_f32 v12, v12, v20
    v_add_f32 v12, v12, v21
    v_cvt_pk_bf16_f32 v247, v20, v21
    ds_read_b128 a[144:147], v6 offset:12288
    v_mfma_f32_32x32x16_bf16 v[144:159], a[212:215], v[108:111], v[144:159]
    buffer_load_dwordx4 v2, s[52:55], s72 offen offset:0 sc1 lds
    v_subrev_u32 v16, s75, v9
    v_cmp_ge_i32 s[40:41], v16, 0
    v_cmp_ge_i32 s[42:43], v16, 1
    s_waitcnt lgkmcnt(12)
    v_mfma_f32_32x32x16_bf16 v[128:143], a[216:219], v[84:87], v[128:143]
    v_exp_f32 v18, v176
    v_exp_f32 v19, v177
    ds_read_b128 a[176:179], v7 offset:12288
    v_cmp_ge_i32 s[44:45], v16, 2
    v_mfma_f32_32x32x16_bf16 v[144:159], a[216:219], v[116:119], v[144:159]
    v_cmp_ge_i32 s[46:47], v16, 3
    v_exp_f32 v20, v178
    v_exp_f32 v21, v179
    v_cndmask_b32 v18, 0, v18, s[40:41]
    s_waitcnt lgkmcnt(11)
    v_mfma_f32_32x32x16_bf16 v[128:143], a[220:223], v[92:95], v[128:143]
    ds_read_b128 a[148:151], v6 offset:13312
    v_cndmask_b32 v19, 0, v19, s[42:43]
    v_add_f32 v13, v18, v19
    v_cvt_pk_bf16_f32 v248, v18, v19
    v_cmp_ge_i32 s[40:41], v16, 8
    v_mfma_f32_32x32x16_bf16 v[144:159], a[220:223], v[124:127], v[144:159]
    buffer_load_dwordx4 v2, s[52:55], s72 offen offset:1024 sc1 lds
    ds_read_b128 a[180:183], v7 offset:13312
    v_cmp_ge_i32 s[42:43], v16, 9
    v_exp_f32 v22, v180
    v_mfma_f32_32x32x16_bf16 a[0:15], a[224:227], v[224:227], 0
    v_exp_f32 v23, v181
    v_cndmask_b32 v20, 0, v20, s[44:45]
    v_cndmask_b32 v21, 0, v21, s[46:47]
    ds_read_b128 a[152:155], v6 offset:14336
    v_mfma_f32_32x32x16_bf16 a[64:79], a[224:227], v[232:235], 0
    v_add_f32 v13, v13, v20
    v_add_f32 v13, v13, v21
    v_cvt_pk_bf16_f32 v249, v20, v21
    v_cmp_ge_i32 s[44:45], v16, 10
    v_cmp_ge_i32 s[46:47], v16, 11
    ds_read_b128 a[184:187], v7 offset:14336
    v_mfma_f32_32x32x16_bf16 a[16:31], a[228:231], v[224:227], 0
    v_exp_f32 v18, v182
    v_exp_f32 v19, v183
    v_cndmask_b32 v22, 0, v22, s[40:41]
    v_mfma_f32_32x32x16_bf16 a[80:95], a[228:231], v[232:235], 0
    buffer_load_dwordx4 v2, s[52:55], s72 offen offset:2048 sc1 lds
    v_cndmask_b32 v23, 0, v23, s[42:43]
    v_add_f32 v13, v13, v22
    s_waitcnt lgkmcnt(8)
    ds_read_b128 a[156:159], v6 offset:15360
    v_add_f32 v13, v13, v23
    v_mfma_f32_32x32x16_bf16 a[32:47], a[232:235], v[224:227], 0
    v_cvt_pk_bf16_f32 v250, v22, v23
    v_cmp_ge_i32 s[40:41], v16, 16
    v_cmp_ge_i32 s[42:43], v16, 17
    v_exp_f32 v20, v184
    ds_read_b128 a[188:191], v7 offset:15360
    v_mfma_f32_32x32x16_bf16 a[96:111], a[232:235], v[232:235], 0
    v_exp_f32 v21, v185
    v_cndmask_b32 v18, 0, v18, s[44:45]
    v_cndmask_b32 v19, 0, v19, s[46:47]
    v_add_f32 v13, v13, v18
    v_add_f32 v13, v13, v19
    v_mfma_f32_32x32x16_bf16 a[48:63], a[236:239], v[224:227], 0
    v_cvt_pk_bf16_f32 v251, v18, v19
    v_cmp_ge_i32 s[44:45], v16, 18
    buffer_load_dwordx4 v2, s[52:55], s72 offen offset:3072 sc1 lds
    v_mfma_f32_32x32x16_bf16 a[112:127], a[236:239], v[232:235], 0
    v_cmp_ge_i32 s[46:47], v16, 19
    v_exp_f32 v22, v186
    v_exp_f32 v23, v187
    v_cndmask_b32 v20, 0, v20, s[40:41]
    v_mfma_f32_32x32x16_bf16 a[0:15], a[240:243], v[228:231], a[0:15]
    v_cndmask_b32 v21, 0, v21, s[42:43]
    v_add_f32 v13, v13, v20
    v_add_f32 v13, v13, v21
    v_cvt_pk_bf16_f32 v252, v20, v21
    v_cmp_ge_i32 s[40:41], v16, 24
    v_cmp_ge_i32 s[42:43], v16, 25
    v_mfma_f32_32x32x16_bf16 a[64:79], a[240:243], v[236:239], a[64:79]
    v_exp_f32 v18, v188
    v_exp_f32 v19, v189
    v_cndmask_b32 v22, 0, v22, s[44:45]
    v_cndmask_b32 v23, 0, v23, s[46:47]
    v_mfma_f32_32x32x16_bf16 a[16:31], a[244:247], v[228:231], a[16:31]
    v_add_f32 v13, v13, v22
    v_add_f32 v13, v13, v23
    s_add_u32 s72, s72, 0x4000
    v_cvt_pk_bf16_f32 v253, v22, v23
    v_cmp_ge_i32 s[44:45], v16, 26
    v_cmp_ge_i32 s[46:47], v16, 27
    v_mfma_f32_32x32x16_bf16 a[80:95], a[244:247], v[236:239], a[80:95]
    v_exp_f32 v20, v190
    v_exp_f32 v21, v191
    v_cndmask_b32 v18, 0, v18, s[40:41]
    v_cndmask_b32 v19, 0, v19, s[42:43]
    v_add_f32 v13, v13, v18
    v_mfma_f32_32x32x16_bf16 a[32:47], a[248:251], v[228:231], a[32:47]
    v_add_f32 v13, v13, v19
    v_cvt_pk_bf16_f32 v254, v18, v19
    v_cndmask_b32 v20, 0, v20, s[44:45]
    v_cndmask_b32 v21, 0, v21, s[46:47]
    v_add_f32 v13, v13, v20
    v_add_f32 v13, v13, v21
    v_mfma_f32_32x32x16_bf16 a[96:111], a[248:251], v[236:239], a[96:111]
    v_cvt_pk_bf16_f32 v255, v20, v21
    v_max_f32 v14, v12, v13
    v_cmp_nge_f32 vcc, s78, v14
    s_mov_b32 s76, 1
    v_add_f32 v10, v24, v12
    v_add_f32 v11, v25, v13
    v_mfma_f32_32x32x16_bf16 a[48:63], a[252:255], v[228:231], a[48:63]
    v_add_u32 v7, 0x10000, v6
    v_add_u32 v6, 0x4000, v6
    v_and_b32 v6, 0xffff, v6
    s_sub_u32 s74, s74, 1
    s_add_u32 s73, s73, 0x4000
    s_and_b32 s73, s73, 0xffff
    v_mfma_f32_32x32x16_bf16 a[112:127], a[252:255], v[236:239], a[112:127]
    s_cbranch_vccnz K2_RARE1
K2_RET_V0b:
    s_add_u32 s75, s75, 32
    s_lshl_b32 s79, s58, 7
    s_add_u32 s80, s79, 0x4800800
    s_sub_u32 s79, 0x4800f80, s79
    s_waitcnt vmcnt(8)
    s_barrier
    s_cmp_lg_u32 s56, 0
    s_cbranch_scc1 L_sig_ha
    s_mov_b64 exec, 1
    v_mov_b32 v35, 1
    buffer_atomic_add v35, off, s[32:35], s79
    s_mov_b64 exec, -1
L_sig_ha:
    s_cmp_lg_u32 s56, 0
    s_cbranch_scc1 L_sig_hb
    s_mov_b64 exec, 1
    v_mov_b32 v35, 1
    buffer_atomic_add v35, off, s[32:35], s80
    s_mov_b64 exec, -1
L_sig_hb:
    s_lshl_b32 s74, s58, 1
    s_sub_u32 s74, s74, 1
    s_max_i32 s74, s74, 0
    s_cmp_eq_u32 s74, 0
    s_cbranch_scc1 K2_V1_X
K2_V1_L:
    s_waitcnt vmcnt(16) lgkmcnt(0)
    s_barrier
    v_mfma_f32_32x32x16_bf16 v[160:175], a[128:131], v[64:67], v[192:207]
    v_exp_f32 v18, v128
    s_mov_b32 m0, s73
    ds_read_b128 a[192:195], v6 offset:0
    v_mfma_f32_32x32x16_bf16 v[176:191], a[128:131], v[96:99], v[208:223]
    v_exp_f32 v19, v129
    v_exp_f32 v20, v130
    v_exp_f32 v21, v131
    v_mfma_f32_32x32x16_bf16 v[160:175], a[132:135], v[72:75], v[160:175]
    v_add_f32 v12, v18, v19
    ds_read_b128 a[224:227], v7 offset:0
    v_cvt_pk_bf16_f32 v224, v18, v19
    v_exp_f32 v22, v132
    v_mfma_f32_32x32x16_bf16 v[176:191], a[132:135], v[104:107], v[176:191]
    v_exp_f32 v23, v133
    v_add_f32 v12, v12, v20
    ds_read_b128 a[196:199], v6 offset:1024
    v_mfma_f32_32x32x16_bf16 v[160:175], a[136:139], v[80:83], v[160:175]
    v_add_f32 v12, v12, v21
    v_cvt_pk_bf16_f32 v225, v20, v21
    v_exp_f32 v18, v134
    v_exp_f32 v19, v135
    v_mfma_f32_32x32x16_bf16 v[176:191], a[136:139], v[112:115], v[176:191]
    buffer_load_dwordx4 v2, s[48:51], s71 offen offset:0 sc1 lds
    v_mfma_f32_32x32x16_bf16 v[160:175], a[140:143], v[88:91], v[160:175]
    v_add_f32 v12, v12, v22
    ds_read_b128 a[228:231], v7 offset:1024
    v_add_f32 v12, v12, v23
    v_cvt_pk_bf16_f32 v226, v22, v23
    v_mfma_f32_32x32x16_bf16 v[176:191], a[140:143], v[120:123], v[176:191]
    v_exp_f32 v20, v136
    v_exp_f32 v21, v137
    ds_read_b128 a[200:203], v6 offset:2048
    v_mfma_f32_32x32x16_bf16 v[160:175], a[144:147], v[68:71], v[160:175]
    v_add_f32 v12, v12, v18
    v_add_f32 v12, v12, v19
    v_cvt_pk_bf16_f32 v227, v18, v19
    v_exp_f32 v22, v138
    v_mfma_f32_32x32x16_bf16 v[176:191], a[144:147], v[100:103], v[176:191]
    ds_read_b128 a[232:235], v7 offset:2048
    v_exp_f32 v23, v139
    v_add_f32 v12, v12, v20
    v_add_f32 v12, v12, v21
    v_mfma_f32_32x32x16_bf16 v[160:175], a[148:151], v[76:79], v[160:175]
    v_cvt_pk_bf16_f32 v228, v20, v21
    buffer_load_dwordx4 v2, s[48:51], s71 offen offset:1024 sc1 lds
    v_mfma_f32_32x32x16_bf16 v[176:191], a[148:151], v[108:111], v[176:191]
    v_exp_f32 v18, v140
    ds_read_b128 a[204:207], v6 offset:3072
    v_exp_f32 v19, v141
    v_mfma_f32_32x32x16_bf16 v[160:175], a[152:155], v[84:87], v[160:175]
    v_add_f32 v12, v12, v22
    v_add_f32 v12, v12, v23
    v_cvt_pk_bf16_f32 v229, v22, v23
    ds_read_b128 a[236:239], v7 offset:3072
    v_mfma_f32_32x32x16_bf16 v[176:191], a[152:155], v[116:119], v[176:191]
    v_exp_f32 v20, v142
    v_exp_f32 v21, v143
    v_add_f32 v12, v12, v18
    v_mfma_f32_32x32x16_bf16 v[160:175], a[156:159], v[92:95], v[160:175]
    v_add_f32 v12, v12, v19
    v_cvt_pk_bf16_f32 v230, v18, v19
    ds_read_b128 a[208:211], v6 offset:4096
    v_add_f32 v12, v12, v20
    v_add_f32 v12, v12, v21
    v_mfma_f32_32x32x16_bf16 v[176:191], a[156:159], v[124:127], v[176:191]
    v_cvt_pk_bf16_f32 v231, v20, v21
    buffer_load_dwordx4 v2, s[48:51], s71 offen offset:2048 sc1 lds
    v_mfma_f32_32x32x16_bf16 a[0:15], a[160:163], v[240:243], a[0:15]
    v_exp_f32 v18, v144
    ds_read_b128 a[240:243], v7 offset:4096
    v_exp_f32 v19, v145
    v_mfma_f32_32x32x16_bf16 a[64:79], a[160:163], v[248:251], a[64:79]
    v_exp_f32 v20, v146
    v_exp_f32 v21, v147
    v_add_f32 v13, v18, v19
    v_mfma_f32_32x32x16_bf16 a[16:31], a[164:167], v[240:243], a[16:31]
    ds_read_b128 a[212:215], v6 offset:5120
    v_cvt_pk_bf16_f32 v232, v18, v19
    v_exp_f32 v22, v148
    v_mfma_f32_32x32x16_bf16 a[80:95], a[164:167], v[248:251], a[80:95]
    v_exp_f32 v23, v149
    v_add_f32 v13, v13, v20
    v_add_f32 v13, v13, v21
    ds_read_b128 a[244:247], v7 offset:5120
    v_mfma_f32_32x32x16_bf16 a[32:47], a[168:171], v[240:243], a[32:47]
    v_cvt_pk_bf16_f32 v233, v20, v21
    v_exp_f32 v18, v150
    v_mfma_f32_32x32x16_bf16 a[96:111], a[168:171], v[248:251], a[96:111]
    buffer_load_dwordx4 v2, s[48:51], s71 offen offset:3072 sc1 lds
    v_exp_f32 v19, v151
    v_add_f32 v13, v13, v22
    v_mfma_f32_32x32x16_bf16 a[48:63], a[172:175], v[240:243], a[48:63]
    ds_read_b128 a[216:219], v6 offset:6144
    v_add_f32 v13, v13, v23
    v_cvt_pk_bf16_f32 v234, v22, v23
    v_exp_f32 v20, v152
    v_mfma_f32_32x32x16_bf16 a[112:127], a[172:175], v[248:251], a[112:127]
    v_exp_f32 v21, v153
    ds_read_b128 a[248:251], v7 offset:6144
    v_add_f32 v13, v13, v18
    v_mfma_f32_32x32x16_bf16 a[0:15], a[176:179], v[244:247], a[0:15]
    v_add_f32 v13, v13, v19
    v_cvt_pk_bf16_f32 v235, v18, v19
    v_exp_f32 v22, v154
    v_exp_f32 v23, v155
    v_mfma_f32_32x32x16_bf16 a[64:79], a[176:179], v[252:255], a[64:79]
    ds_read_b128 a[220:223], v6 offset:7168
    v_add_f32 v13, v13, v20
    v_add_f32 v13, v13, v21
    s_add_u32 s71, s71, 0x4000
    v_mfma_f32_32x32x16_bf16 a[16:31], a[180:183], v[244:247], a[16:31]
    v_cvt_pk_bf16_f32 v236, v20, v21
    v_exp_f32 v18, v156
    s_waitcnt lgkmcnt(8)
    ds_read_b128 a[252:255], v7 offset:7168
    v_mfma_f32_32x32x16_bf16 a[80:95], a[180:183], v[252:255], a[80:95]
    v_exp_f32 v19, v157
    v_add_f32 v13, v13, v22
    v_add_f32 v13, v13, v23
    v_cvt_pk_bf16_f32 v237, v22, v23
    v_mfma_f32_32x32x16_bf16 a[32:47], a[184:187], v[244:247], a[32:47]
    v_exp_f32 v20, v158
    v_exp_f32 v21, v159
    v_add_f32 v13, v13, v18
    v_mfma_f32_32x32x16_bf16 a[96:111], a[184:187], v[252:255], a[96:111]
    v_add_f32 v13, v13, v19
    v_cvt_pk_bf16_f32 v238, v18, v19
    v_add_f32 v13, v13, v20
    v_add_f32 v13, v13, v21
    v_cvt_pk_bf16_f32 v239, v20, v21
    v_mfma_f32_32x32x16_bf16 a[48:63], a[188:191], v[244:247], a[48:63]
    v_max_f32 v14, v12, v13
    v_cmp_nge_f32 vcc, s78, v14
    s_mov_b32 s76, 2
    v_add_f32 v24, v10, v12
    v_add_f32 v25, v11, v13
    v_mfma_f32_32x32x16_bf16 a[112:127], a[188:191], v[252:255], a[112:127]
    s_cbranch_vccnz K2_RARE0
K2_RET_V1a:
    s_add_u32 s75, s75, 32
    v_mfma_f32_32x32x16_bf16 v[128:143], a[192:195], v[64:67], v[192:207]
    v_exp_f32 v18, v160
    s_sub_u32 s61, s73, 0x4000
    ds_read_b128 a[128:131], v6 offset:8192
    v_exp_f32 v19, v161
    v_mfma_f32_32x32x16_bf16 v[144:159], a[192:195], v[96:99], v[208:223]
    v_exp_f32 v20, v162
    v_exp_f32 v21, v163
    v_mfma_f32_32x32x16_bf16 v[128:143], a[196:199], v[72:75], v[128:143]
    ds_read_b128 a[160:163], v7 offset:8192
    v_add_f32 v12, v18, v19
    v_cvt_pk_bf16_f32 v240, v18, v19
    v_exp_f32 v22, v164
    v_mfma_f32_32x32x16_bf16 v[144:159], a[196:199], v[104:107], v[144:159]
    ds_read_b128 a[132:135], v6 offset:9216
    v_exp_f32 v23, v165
    v_add_f32 v12, v12, v20
    s_and_b32 s61, s61, 0xffff
    v_mfma_f32_32x32x16_bf16 v[128:143], a[200:203], v[80:83], v[128:143]
    v_add_f32 v12, v12, v21
    v_cvt_pk_bf16_f32 v241, v20, v21
    ds_read_b128 a[164:167], v7 offset:9216
    v_exp_f32 v18, v166
    v_mfma_f32_32x32x16_bf16 v[144:159], a[200:203], v[112:115], v[144:159]
    v_exp_f32 v19, v167
    v_add_f32 v12, v12, v22
    ds_read_b128 a[136:139], v6 offset:10240
    v_add_f32 v12, v12, v23
    v_mfma_f32_32x32x16_bf16 v[128:143], a[204:207], v[88:91], v[128:143]
    v_cvt_pk_bf16_f32 v242, v22, v23
    v_exp_f32 v20, v168
    ds_read_b128 a[168:171], v7 offset:10240
    v_exp_f32 v21, v169
    v_mfma_f32_32x32x16_bf16 v[144:159], a[204:207], v[120:123], v[144:159]
    s_add_u32 m0, s61, 0x10000
    v_add_f32 v12, v12, v18
    v_add_f32 v12, v12, v19
    v_cvt_pk_bf16_f32 v243, v18, v19
    s_waitcnt lgkmcnt(8)
    ds_read_b128 a[140:143], v6 offset:11264
    v_mfma_f32_32x32x16_bf16 v[128:143], a[208:211], v[68:71], v[128:143]
    v_exp_f32 v22, v170
    v_exp_f32 v23, v171
    v_add_f32 v12, v12, v20
    v_mfma_f32_32x32x16_bf16 v[144:159], a[208:211], v[100:103], v[144:159]
    ds_read_b128 a[172:175], v7 offset:11264
    v_add_f32 v12, v12, v21
    v_cvt_pk_bf16_f32 v244, v20, v21
    v_exp_f32 v18, v172
    v_mfma_f32_32x32x16_bf16 v[128:143], a[212:215], v[76:79], v[128:143]
    v_exp_f32 v19, v173
    buffer_load_dwordx4 v2, s[52:55], s72 offen offset:0 sc1 lds
    v_mfma_f32_32x32x16_bf16 v[144:159], a[212:215], v[108:111], v[144:159]
    ds_read_b128 a[144:147], v6 offset:12288
    v_add_f32 v12, v12, v22
    v_add_f32 v12, v12, v23
    v_cvt_pk_bf16_f32 v245, v22, v23
    v_mfma_f32_32x32x16_bf16 v[128:143], a[216:219], v[84:87], v[128:143]
    ds_read_b128 a[176:179], v7 offset:12288
    v_exp_f32 v20, v174
    v_exp_f32 v21, v175
    v_mfma_f32_32x32x16_bf16 v[144:159], a[216:219], v[116:119], v[144:159]
    v_add_f32 v12, v12, v18
    ds_read_b128 a[148:151], v6 offset:13312
    v_add_f32 v12, v12, v19
    v_cvt_pk_bf16_f32 v246, v18, v19
    v_add_f32 v12, v12, v20
    s_waitcnt lgkmcnt(12)
    v_mfma_f32_32x32x16_bf16 v[128:143], a[220:223], v[92:95], v[128:143]
    buffer_load_dwordx4 v2, s[52:55], s72 offen offset:1024 sc1 lds
    v_add_f32 v12, v12, v21
    v_mfma_f32_32x32x16_bf16 v[144:159], a[220:223], v[124:127], v[144:159]
    ds_read_b128 a[180:183], v7 offset:13312
    v_cvt_pk_bf16_f32 v247, v20, v21
    v_exp_f32 v18, v176
    v_exp_f32 v19, v177
    v_mfma_f32_32x32x16_bf16 a[0:15], a[224:227], v[224:227], a[0:15]
    ds_read_b128 a[152:155], v6 offset:14336
    v_exp_f32 v20, v178
    v_exp_f32 v21, v179
    v_mfma_f32_32x32x16_bf16 a[64:79], a[224:227], v[232:235], a[64:79]
    v_add_f32 v13, v18, v19
    ds_read_b128 a[184:187], v7 offset:14336
    v_cvt_pk_bf16_f32 v248, v18, v19
    v_mfma_f32_32x32x16_bf16 a[16:31], a[228:231], v[224:227], a[16:31]
    buffer_load_dwordx4 v2, s[52:55], s72 offen offset:2048 sc1 lds
    v_exp_f32 v22, v180
    v_mfma_f32_32x32x16_bf16 a[80:95], a[228:231], v[232:235], a[80:95]
    v_exp_f32 v23, v181
    v_add_f32 v13, v13, v20
    s_waitcnt lgkmcnt(8)
    ds_read_b128 a[156:159], v6 offset:15360
    v_add_f32 v13, v13, v21
    v_mfma_f32_32x32x16_bf16 a[32:47], a[232:235], v[224:227], a[32:47]
    v_cvt_pk_bf16_f32 v249, v20, v21
    v_exp_f32 v18, v182
    ds_read_b128 a[188:191], v7 offset:15360
    v_exp_f32 v19, v183
    v_mfma_f32_32x32x16_bf16 a[96:111], a[232:235], v[232:235], a[96:111]
    v_add_f32 v13, v13, v22
    v_add_f32 v13, v13, v23
    v_cvt_pk_bf16_f32 v250, v22, v23
    v_mfma_f32_32x32x16_bf16 a[48:63], a[236:239], v[224:227], a[48:63]
    buffer_load_dwordx4 v2, s[52:55], s72 offen offset:3072 sc1 lds
    v_exp_f32 v20, v184
    v_mfma_f32_32x32x16_bf16 a[112:127], a[236:239], v[232:235], a[112:127]
    v_exp_f32 v21, v185
    v_add_f32 v13, v13, v18
    v_add_f32 v13, v13, v19
    v_cvt_pk_bf16_f32 v251, v18, v19
    v_mfma_f32_32x32x16_bf16 a[0:15], a[240:243], v[228:231], a[0:15]
    v_exp_f32 v22, v186
    v_exp_f32 v23, v187
    v_add_f32 v13, v13, v20
    v_add_f32 v13, v13, v21
    v_mfma_f32_32x32x16_bf16 a[64:79], a[240:243], v[236:239], a[64:79]
    v_cvt_pk_bf16_f32 v252, v20, v21
    v_exp_f32 v18, v188
    v_exp_f32 v19, v189
    v_mfma_f32_32x32x16_bf16 a[16:31], a[244:247], v[228:231], a[16:31]
    s_add_u32 s72, s72, 0x4000
    v_add_f32 v13, v13, v22
    v_add_f32 v13, v13, v23
    v_cvt_pk_bf16_f32 v253, v22, v23
    v_mfma_f32_32x32x16_bf16 a[80:95], a[244:247], v[236:239], a[80:95]
    v_exp_f32 v20, v190
    v_exp_f32 v21, v191
    v_add_f32 v13, v13, v18
    v_add_f32 v13, v13, v19
    v_mfma_f32_32x32x16_bf16 a[32:47], a[248:251], v[228:231], a[32:47]
    v_cvt_pk_bf16_f32 v254, v18, v19
    v_add_f32 v13, v13, v20
    v_add_f32 v13, v13, v21
    v_cvt_pk_bf16_f32 v255, v20, v21
    v_max_f32 v14, v12, v13
    v_mfma_f32_32x32x16_bf16 a[96:111], a[248:251], v[236:239], a[96:111]
    v_cmp_nge_f32 vcc, s78, v14
    s_mov_b32 s76, 3
    v_add_f32 v10, v24, v12
    v_add_f32 v11, v25, v13
    v_add_u32 v7, 0x10000, v6
    v_mfma_f32_32x32x16_bf16 a[48:63], a[252:255], v[228:231], a[48:63]
    v_add_u32 v6, 0x4000, v6
    v_and_b32 v6, 0xffff, v6
    s_sub_u32 s74, s74, 1
    s_add_u32 s73, s73, 0x4000
    s_and_b32 s73, s73, 0xffff
    v_mfma_f32_32x32x16_bf16 a[112:127], a[252:255], v[236:239], a[112:127]
    s_cbranch_vccnz K2_RARE1
K2_RET_V1b:
    s_add_u32 s75, s75, 32
    s_cmp_lg_u32 s74, 0
    s_cbranch_scc1 K2_V1_L
K2_V1_X:
    s_min_u32 s74, s58, 1
    s_cmp_eq_u32 s74, 0
    s_cbranch_scc1 K2_V2_X
K2_V2_L:
    s_waitcnt vmcnt(16) lgkmcnt(0)
    s_barrier
    v_mfma_f32_32x32x16_bf16 v[160:175], a[128:131], v[64:67], v[192:207]
    v_exp_f32 v18, v128
    s_mov_b32 m0, s73
    ds_read_b128 a[192:195], v6 offset:0
    v_exp_f32 v19, v129
    v_mfma_f32_32x32x16_bf16 v[176:191], a[128:131], v[96:99], v[208:223]
    v_exp_f32 v20, v130
    v_exp_f32 v21, v131
    v_add_f32 v12, v18, v19
    v_cvt_pk_bf16_f32 v224, v18, v19
    v_mfma_f32_32x32x16_bf16 v[160:175], a[132:135], v[72:75], v[160:175]
    v_exp_f32 v22, v132
    ds_read_b128 a[224:227], v7 offset:0
    v_exp_f32 v23, v133
    v_add_f32 v12, v12, v20
    v_mfma_f32_32x32x16_bf16 v[176:191], a[132:135], v[104:107], v[176:191]
    v_add_f32 v12, v12, v21
    v_cvt_pk_bf16_f32 v225, v20, v21
    v_exp_f32 v18, v134
    v_exp_f32 v19, v135
    v_mfma_f32_32x32x16_bf16 v[160:175], a[136:139], v[80:83], v[160:175]
    ds_read_b128 a[196:199], v6 offset:1024
    v_add_f32 v12, v12, v22
    v_add_f32 v12, v12, v23
    v_cvt_pk_bf16_f32 v226, v22, v23
    v_exp_f32 v20, v136
    v_mfma_f32_32x32x16_bf16 v[176:191], a[136:139], v[112:115], v[176:191]
    v_exp_f32 v21, v137
    v_add_f32 v12, v12, v18
    buffer_load_dwordx4 v2, s[48:51], s71 offen offset:0 sc1 lds
    v_mfma_f32_32x32x16_bf16 v[160:175], a[140:143], v[88:91], v[160:175]
    ds_read_b128 a[228:231], v7 offset:1024
    v_add_f32 v12, v12, v19
    v_cvt_pk_bf16_f32 v227, v18, v19
    v_exp_f32 v22, v138
    v_mfma_f32_32x32x16_bf16 v[176:191], a[140:143], v[120:123], v[176:191]
    v_exp_f32 v23, v139
    v_add_f32 v12, v12, v20
    v_add_f32 v12, v12, v21
    ds_read_b128 a[200:203], v6 offset:2048
    v_mfma_f32_32x32x16_bf16 v[160:175], a[144:147], v[68:71], v[160:175]
    v_cvt_pk_bf16_f32 v228, v20, v21
    v_exp_f32 v18, v140
    v_exp_f32 v19, v141
    v_add_f32 v12, v12, v22
    v_mfma_f32_32x32x16_bf16 v[176:191], a[144:147], v[100:103], v[176:191]
    v_add_f32 v12, v12, v23
    v_cvt_pk_bf16_f32 v229, v22, v23
    ds_read_b128 a[232:235], v7 offset:2048
    v_exp_f32 v20, v142
    v_mfma_f32_32x32x16_bf16 v[160:175], a[148:151], v[76:79], v[160:175]
    v_exp_f32 v21, v143
    v_add_f32 v12, v12, v18
    v_add_f32 v12, v12, v19
    v_cvt_pk_bf16_f32 v230, v18, v19
    v_add_f32 v12, v12, v20
    v_mfma_f32_32x32x16_bf16 v[176:191], a[148:151], v[108:111], v[176:191]
    buffer_load_dwordx4 v2, s[48:51], s71 offen offset:1024 sc1 lds
    v_add_f32 v12, v12, v21
    ds_read_b128 a[204:207], v6 offset:3072
    v_mfma_f32_32x32x16_bf16 v[160:175], a[152:155], v[84:87], v[160:175]
    v_cvt_pk_bf16_f32 v231, v20, v21
    v_subrev_u32 v16, s75, v9
    v_cmp_ge_i32 s[40:41], v16, 0
    v_cmp_ge_i32 s[42:43], v16, 1
    v_exp_f32 v18, v144
    v_mfma_f32_32x32x16_bf16 v[176:191], a[152:155], v[116:119], v[176:191]
    v_exp_f32 v19, v145
    ds_read_b128 a[236:239], v7 offset:3072
    v_cmp_ge_i32 s[44:45], v16, 2
    v_cmp_ge_i32 s[46:47], v16, 3
    v_exp_f32 v20, v146
    v_mfma_f32_32x32x16_bf16 v[160:175], a[156:159], v[92:95], v[160:175]
    v_exp_f32 v21, v147
    v_cndmask_b32 v18, 0, v18, s[40:41]
    v_cndmask_b32 v19, 0, v19, s[42:43]
    ds_read_b128 a[208:211], v6 offset:4096
    v_mfma_f32_32x32x16_bf16 v[176:191], a[156:159], v[124:127], v[176:191]
    v_add_f32 v13, v18, v19
    v_cvt_pk_bf16_f32 v232, v18, v19
    v_cmp_ge_i32 s[40:41], v16, 8
    v_cmp_ge_i32 s[42:43], v16, 9
    v_exp_f32 v22, v148
    v_mfma_f32_32x32x16_bf16 a[0:15], a[160:163], v[240:243], a[0:15]
    buffer_load_dwordx4 v2, s[48:51], s71 offen offset:2048 sc1 lds
    v_exp_f32 v23, v149
    v_mfma_f32_32x32x16_bf16 a[64:79], a[160:163], v[248:251], a[64:79]
    ds_read_b128 a[240:243], v7 offset:4096
    v_cndmask_b32 v20, 0, v20, s[44:45]
    v_cndmask_b32 v21, 0, v21, s[46:47]
    v_add_f32 v13, v13, v20
    v_add_f32 v13, v13, v21
    v_cvt_pk_bf16_f32 v233, v20, v21
    v_mfma_f32_32x32x16_bf16 a[16:31], a[164:167], v[240:243], a[16:31]
    v_cmp_ge_i32 s[44:45], v16, 10
    ds_read_b128 a[212:215], v6 offset:5120
    v_cmp_ge_i32 s[46:47], v16, 11
    v_exp_f32 v18, v150
    v_mfma_f32_32x32x16_bf16 a[80:95], a[164:167], v[248:251], a[80:95]
    v_exp_f32 v19, v151
    v_cndmask_b32 v22, 0, v22, s[40:41]
    v_cndmask_b32 v23, 0, v23, s[42:43]
    v_add_f32 v13, v13, v22
    v_add_f32 v13, v13, v23
    v_mfma_f32_32x32x16_bf16 a[32:47], a[168:171], v[240:243], a[32:47]
    ds_read_b128 a[244:247], v7 offset:5120
    v_cvt_pk_bf16_f32 v234, v22, v23
    v_cmp_ge_i32 s[40:41], v16, 16
    v_cmp_ge_i32 s[42:43], v16, 17
    v_exp_f32 v20, v152
    v_mfma_f32_32x32x16_bf16 a[96:111], a[168:171], v[248:251], a[96:111]
    buffer_load_dwordx4 v2, s[48:51], s71 offen offset:3072 sc1 lds
    v_exp_f32 v21, v153
    v_mfma_f32_32x32x16_bf16 a[48:63], a[172:175], v[240:243], a[48:63]
    v_cndmask_b32 v18, 0, v18, s[44:45]
    ds_read_b128 a[216:219], v6 offset:6144
    v_cndmask_b32 v19, 0, v19, s[46:47]
    v_add_f32 v13, v13, v18
    v_add_f32 v13, v13, v19
    v_cvt_pk_bf16_f32 v235, v18, v19
    v_mfma_f32_32x32x16_bf16 a[112:127], a[172:175], v[248:251], a[112:127]
    v_cmp_ge_i32 s[44:45], v16, 18
    v_cmp_ge_i32 s[46:47], v16, 19
    ds_read_b128 a[248:251], v7 offset:6144
    v_exp_f32 v22, v154
    v_mfma_f32_32x32x16_bf16 a[0:15], a[176:179], v[244:247], a[0:15]
    v_exp_f32 v23, v155
    v_cndmask_b32 v20, 0, v20, s[40:41]
    v_cndmask_b32 v21, 0, v21, s[42:43]
    v_add_f32 v13, v13, v20
    v_add_f32 v13, v13, v21
    ds_read_b128 a[220:223], v6 offset:7168
    v_mfma_f32_32x32x16_bf16 a[64:79], a[176:179], v[252:255], a[64:79]
    v_cvt_pk_bf16_f32 v236, v20, v21
    v_cmp_ge_i32 s[40:41], v16, 24
    v_cmp_ge_i32 s[42:43], v16, 25
    v_exp_f32 v18, v156
    s_add_u32 s71, s71, 0x4000
    v_mfma_f32_32x32x16_bf16 a[16:31], a[180:183], v[244:247], a[16:31]
    v_exp_f32 v19, v157
    v_cndmask_b32 v22, 0, v22, s[44:45]
    s_waitcnt lgkmcnt(8)
    ds_read_b128 a[252:255], v7 offset:7168
    v_cndmask_b32 v23, 0, v23, s[46:47]
    v_add_f32 v13, v13, v22
    v_mfma_f32_32x32x16_bf16 a[80:95], a[180:183], v[252:255], a[80:95]
    v_add_f32 v13, v13, v23
    v_cvt_pk_bf16_f32 v237, v22, v23
    v_cmp_ge_i32 s[44:45], v16, 26
    v_cmp_ge_i32 s[46:47], v16, 27
    v_exp_f32 v20, v158
    v_mfma_f32_32x32x16_bf16 a[32:47], a[184:187], v[244:247], a[32:47]
    v_exp_f32 v21, v159
    v_cndmask_b32 v18, 0, v18, s[40:41]
    v_cndmask_b32 v19, 0, v19, s[42:43]
    v_add_f32 v13, v13, v18
    v_mfma_f32_32x32x16_bf16 a[96:111], a[184:187], v[252:255], a[96:111]
    v_add_f32 v13, v13, v19
    v_cvt_pk_bf16_f32 v238, v18, v19
    v_cndmask_b32 v20, 0, v20, s[44:45]
    v_cndmask_b32 v21, 0, v21, s[46:47]
    v_add_f32 v13, v13, v20
    v_add_f32 v13, v13, v21
    v_mfma_f32_32x32x16_bf16 a[48:63], a[188:191], v[244:247], a[48:63]
    v_cvt_pk_bf16_f32 v239, v20, v21
    v_max_f32 v14, v12, v13
    v_cmp_nge_f32 vcc, s78, v14
    s_mov_b32 s76, 4
    v_add_f32 v24, v10, v12
    v_add_f32 v25, v11, v13
    v_mfma_f32_32x32x16_bf16 a[112:127], a[188:191], v[252:255], a[112:127]
    s_cbranch_vccnz K2_RARE0
K2_RET_V2a:
    s_add_u32 s75, s75, 32
    v_mfma_f32_32x32x16_bf16 v[128:143], a[192:195], v[64:67], v[192:207]
    v_exp_f32 v18, v160
    s_sub_u32 s61, s73, 0x4000
    ds_read_b128 a[128:131], v6 offset:8192
    v_exp_f32 v19, v161
    v_mfma_f32_32x32x16_bf16 v[144:159], a[192:195], v[96:99], v[208:223]
    v_exp_f32 v20, v162
    v_exp_f32 v21, v163
    v_add_f32 v12, v18, v19
    ds_read_b128 a[160:163], v7 offset:8192
    v_mfma_f32_32x32x16_bf16 v[128:143], a[196:199], v[72:75], v[128:143]
    v_cvt_pk_bf16_f32 v240, v18, v19
    v_exp_f32 v22, v164
    v_exp_f32 v23, v165
    v_add_f32 v12, v12, v20
    v_mfma_f32_32x32x16_bf16 v[144:159], a[196:199], v[104:107], v[144:159]
    v_add_f32 v12, v12, v21
    ds_read_b128 a[132:135], v6 offset:9216
    v_cvt_pk_bf16_f32 v241, v20, v21
    v_exp_f32 v18, v166
    v_exp_f32 v19, v167
    v_mfma_f32_32x32x16_bf16 v[128:143], a[200:203], v[80:83], v[128:143]
    s_and_b32 s61, s61, 0xffff
    v_add_f32 v12, v12, v22
    v_add_f32 v12, v12, v23
    ds_read_b128 a[164:167], v7 offset:9216
    v_cvt_pk_bf16_f32 v242, v22, v23
    v_mfma_f32_32x32x16_bf16 v[144:159], a[200:203], v[112:115], v[144:159]
    v_exp_f32 v20, v168
    v_exp_f32 v21, v169
    v_add_f32 v12, v12, v18
    v_add_f32 v12, v12, v19
    ds_read_b128 a[136:139], v6 offset:10240
    v_mfma_f32_32x32x16_bf16 v[128:143], a[204:207], v[88:91], v[128:143]
    v_cvt_pk_bf16_f32 v243, v18, v19
    v_exp_f32 v22, v170
    v_exp_f32 v23, v171
    v_add_f32 v12, v12, v20
    v_mfma_f32_32x32x16_bf16 v[144:159], a[204:207], v[120:123], v[144:159]
    v_add_f32 v12, v12, v21
    ds_read_b128 a[168:171], v7 offset:10240
    v_cvt_pk_bf16_f32 v244, v20, v21
    s_add_u32 m0, s61, 0x10000
    v_exp_f32 v18, v172
    s_waitcnt lgkmcnt(13)
    v_mfma_f32_32x32x16_bf16 v[128:143], a[208:211], v[68:71], v[128:143]
    v_exp_f32 v19, v173
    v_add_f32 v12, v12, v22
    ds_read_b128 a[140:143], v6 offset:11264
    v_add_f32 v12, v12, v23
    v_cvt_pk_bf16_f32 v245, v22, v23
    v_mfma_f32_32x32x16_bf16 v[144:159], a[208:211], v[100:103], v[144:159]
    v_exp_f32 v20, v174
    v_exp_f32 v21, v175
    v_add_f32 v12, v12, v18
    ds_read_b128 a[172:175], v7 offset:11264
    s_waitcnt lgkmcnt(13)
    v_mfma_f32_32x32x16_bf16 v[128:143], a[212:215], v[76:79], v[128:143]
    v_add_f32 v12, v12, v19
    v_cvt_pk_bf16_f32 v246, v18, v19
    v_add_f32 v12, v12, v20
    v_add_f32 v12, v12, v21
    v_cvt_pk_bf16_f32 v247, v20, v21
    ds_read_b128 a[144:147], v6 offset:12288
    v_mfma_f32_32x32x16_bf16 v[144:159], a[212:215], v[108:111], v[144:159]
    buffer_load_dwordx4 v2, s[52:55], s72 offen offset:0 sc1 lds
    v_subrev_u32 v16, s75, v9
    v_cmp_ge_i32 s[40:41], v16, 0
    v_cmp_ge_i32 s[42:43], v16, 1
    s_waitcnt lgkmcnt(12)
    v_mfma_f32_32x32x16_bf16 v[128:143], a[216:219], v[84:87], v[128:143]
    v_exp_f32 v18, v176
    v_exp_f32 v19, v177
    ds_read_b128 a[176:179], v7 offset:12288
    v_cmp_ge_i32 s[44:45], v16, 2
    v_mfma_f32_32x32x16_bf16 v[144:159], a[216:219], v[116:119], v[144:159]
    v_cmp_ge_i32 s[46:47], v16, 3
    v_exp_f32 v20, v178
    v_exp_f32 v21, v179
    v_cndmask_b32 v18, 0, v18, s[40:41]
    s_waitcnt lgkmcnt(11)
    v_mfma_f32_32x32x16_bf16 v[128:143], a[220:223], v[92:95], v[128:143]
    ds_read_b128 a[148:151], v6 offset:13312
    v_cndmask_b32 v19, 0, v19, s[42:43]
    v_add_f32 v13, v18, v19
    v_cvt_pk_bf16_f32 v248, v18, v19
    v_cmp_ge_i32 s[40:41], v16, 8
    v_mfma_f32_32x32x16_bf16 v[144:159], a[220:223], v[124:127], v[144:159]
    buffer_load_dwordx4 v2, s[52:55], s72 offen offset:1024 sc1 lds
    ds_read_b128 a[180:183], v7 offset:13312
    v_cmp_ge_i32 s[42:43], v16, 9
    v_exp_f32 v22, v180
    v_mfma_f32_32x32x16_bf16 a[0:15], a[224:227], v[224:227], a[0:15]
    v_exp_f32 v23, v181
    v_cndmask_b32 v20, 0, v20, s[44:45]
    v_cndmask_b32 v21, 0, v21, s[46:47]
    ds_read_b128 a[152:155], v6 offset:14336
    v_mfma_f32_32x32x16_bf16 a[64:79], a[224:227], v[232:235], a[64:79]
    v_add_f32 v13, v13, v20
    v_add_f32 v13, v13, v21
    v_cvt_pk_bf16_f32 v249, v20, v21
    v_cmp_ge_i32 s[44:45], v16, 10
    v_cmp_ge_i32 s[46:47], v16, 11
    ds_read_b128 a[184:187], v7 offset:14336
    v_mfma_f32_32x32x16_bf16 a[16:31], a[228:231], v[224:227], a[16:31]
    v_exp_f32 v18, v182
    v_exp_f32 v19, v183
    v_cndmask_b32 v22, 0, v22, s[40:41]
    v_mfma_f32_32x32x16_bf16 a[80:95], a[228:231], v[232:235], a[80:95]
    buffer_load_dwordx4 v2, s[52:55], s72 offen offset:2048 sc1 lds
    v_cndmask_b32 v23, 0, v23, s[42:43]
    v_add_f32 v13, v13, v22
    s_waitcnt lgkmcnt(8)
    ds_read_b128 a[156:159], v6 offset:15360
    v_add_f32 v13, v13, v23
    v_mfma_f32_32x32x16_bf16 a[32:47], a[232:235], v[224:227], a[32:47]
    v_cvt_pk_bf16_f32 v250, v22, v23
    v_cmp_ge_i32 s[40:41], v16, 16
    v_cmp_ge_i32 s[42:43], v16, 17
    v_exp_f32 v20, v184
    ds_read_b128 a[188:191], v7 offset:15360
    v_mfma_f32_32x32x16_bf16 a[96:111], a[232:235], v[232:235], a[96:111]
    v_exp_f32 v21, v185
    v_cndmask_b32 v18, 0, v18, s[44:45]
    v_cndmask_b32 v19, 0, v19, s[46:47]
    v_add_f32 v13, v13, v18
    v_add_f32 v13, v13, v19
    v_mfma_f32_32x32x16_bf16 a[48:63], a[236:239], v[224:227], a[48:63]
    v_cvt_pk_bf16_f32 v251, v18, v19
    v_cmp_ge_i32 s[44:45], v16, 18
    buffer_load_dwordx4 v2, s[52:55], s72 offen offset:3072 sc1 lds
    v_mfma_f32_32x32x16_bf16 a[112:127], a[236:239], v[232:235], a[112:127]
    v_cmp_ge_i32 s[46:47], v16, 19
    v_exp_f32 v22, v186
    v_exp_f32 v23, v187
    v_cndmask_b32 v20, 0, v20, s[40:41]
    v_mfma_f32_32x32x16_bf16 a[0:15], a[240:243], v[228:231], a[0:15]
    v_cndmask_b32 v21, 0, v21, s[42:43]
    v_add_f32 v13, v13, v20
    v_add_f32 v13, v13, v21
    v_cvt_pk_bf16_f32 v252, v20, v21
    v_cmp_ge_i32 s[40:41], v16, 24
    v_cmp_ge_i32 s[42:43], v16, 25
    v_mfma_f32_32x32x16_bf16 a[64:79], a[240:243], v[236:239], a[64:79]
    v_exp_f32 v18, v188
    v_exp_f32 v19, v189
    v_cndmask_b32 v22, 0, v22, s[44:45]
    v_cndmask_b32 v23, 0, v23, s[46:47]
    v_mfma_f32_32x32x16_bf16 a[16:31], a[244:247], v[228:231], a[16:31]
    v_add_f32 v13, v13, v22
    v_add_f32 v13, v13, v23
    s_add_u32 s72, s72, 0x4000
    v_cvt_pk_bf16_f32 v253, v22, v23
    v_cmp_ge_i32 s[44:45], v16, 26
    v_cmp_ge_i32 s[46:47], v16, 27
    v_mfma_f32_32x32x16_bf16 a[80:95], a[244:247], v[236:239], a[80:95]
    v_exp_f32 v20, v190
    v_exp_f32 v21, v191
    v_cndmask_b32 v18, 0, v18, s[40:41]
    v_cndmask_b32 v19, 0, v19, s[42:43]
    v_add_f32 v13, v13, v18
    v_mfma_f32_32x32x16_bf16 a[32:47], a[248:251], v[228:231], a[32:47]
    v_add_f32 v13, v13, v19
    v_cvt_pk_bf16_f32 v254, v18, v19
    v_cndmask_b32 v20, 0, v20, s[44:45]
    v_cndmask_b32 v21, 0, v21, s[46:47]
    v_add_f32 v13, v13, v20
    v_add_f32 v13, v13, v21
    v_mfma_f32_32x32x16_bf16 a[96:111], a[248:251], v[236:239], a[96:111]
    v_cvt_pk_bf16_f32 v255, v20, v21
    v_max_f32 v14, v12, v13
    v_cmp_nge_f32 vcc, s78, v14
    s_mov_b32 s76, 5
    v_add_f32 v10, v24, v12
    v_add_f32 v11, v25, v13
    v_mfma_f32_32x32x16_bf16 a[48:63], a[252:255], v[228:231], a[48:63]
    v_add_u32 v7, 0x10000, v6
    v_add_u32 v6, 0x4000, v6
    v_and_b32 v6, 0xffff, v6
    s_sub_u32 s74, s74, 1
    s_add_u32 s73, s73, 0x4000
    s_and_b32 s73, s73, 0xffff
    v_mfma_f32_32x32x16_bf16 a[112:127], a[252:255], v[236:239], a[112:127]
    s_cbranch_vccnz K2_RARE1
K2_RET_V2b:
    s_add_u32 s75, s75, 32
    s_cmp_lg_u32 s74, 0
    s_cbranch_scc1 K2_V2_L
K2_V2_X:
    s_waitcnt vmcnt(16) lgkmcnt(0)
    s_barrier
    v_mfma_f32_32x32x16_bf16 v[160:175], a[128:131], v[64:67], v[192:207]
    v_exp_f32 v18, v128
    s_mov_b32 m0, s73
    ds_read_b128 a[224:227], v7 offset:0
    v_exp_f32 v19, v129
    v_mfma_f32_32x32x16_bf16 v[176:191], a[128:131], v[96:99], v[208:223]
    v_exp_f32 v20, v130
    v_exp_f32 v21, v131
    v_add_f32 v12, v18, v19
    v_mfma_f32_32x32x16_bf16 v[160:175], a[132:135], v[72:75], v[160:175]
    v_cvt_pk_bf16_f32 v224, v18, v19
    v_exp_f32 v22, v132
    v_exp_f32 v23, v133
    v_add_f32 v12, v12, v20
    v_mfma_f32_32x32x16_bf16 v[176:191], a[132:135], v[104:107], v[176:191]
    v_add_f32 v12, v12, v21
    v_cvt_pk_bf16_f32 v225, v20, v21
    v_exp_f32 v18, v134
    v_exp_f32 v19, v135
    v_mfma_f32_32x32x16_bf16 v[160:175], a[136:139], v[80:83], v[160:175]
    ds_read_b128 a[228:231], v7 offset:1024
    v_add_f32 v12, v12, v22
    v_add_f32 v12, v12, v23
    v_cvt_pk_bf16_f32 v226, v22, v23
    v_exp_f32 v20, v136
    v_mfma_f32_32x32x16_bf16 v[176:191], a[136:139], v[112:115], v[176:191]
    v_exp_f32 v21, v137
    buffer_load_dwordx4 v2, s[48:51], s71 offen offset:0 sc1 lds
    v_mfma_f32_32x32x16_bf16 v[160:175], a[140:143], v[88:91], v[160:175]
    v_add_f32 v12, v12, v18
    v_add_f32 v12, v12, v19
    v_cvt_pk_bf16_f32 v227, v18, v19
    v_exp_f32 v22, v138
    v_mfma_f32_32x32x16_bf16 v[176:191], a[140:143], v[120:123], v[176:191]
    v_exp_f32 v23, v139
    v_add_f32 v12, v12, v20
    v_add_f32 v12, v12, v21
    ds_read_b128 a[232:235], v7 offset:2048
    v_mfma_f32_32x32x16_bf16 v[160:175], a[144:147], v[68:71], v[160:175]
    v_cvt_pk_bf16_f32 v228, v20, v21
    v_exp_f32 v18, v140
    v_exp_f32 v19, v141
    v_add_f32 v12, v12, v22
    v_mfma_f32_32x32x16_bf16 v[176:191], a[144:147], v[100:103], v[176:191]
    v_add_f32 v12, v12, v23
    v_cvt_pk_bf16_f32 v229, v22, v23
    v_exp_f32 v20, v142
    v_exp_f32 v21, v143
    v_mfma_f32_32x32x16_bf16 v[160:175], a[148:151], v[76:79], v[160:175]
    v_add_f32 v12, v12, v18
    v_add_f32 v12, v12, v19
    v_cvt_pk_bf16_f32 v230, v18, v19
    v_add_f32 v12, v12, v20
    v_mfma_f32_32x32x16_bf16 v[176:191], a[148:151], v[108:111], v[176:191]
    buffer_load_dwordx4 v2, s[48:51], s71 offen offset:1024 sc1 lds
    v_add_f32 v12, v12, v21
    ds_read_b128 a[236:239], v7 offset:3072
    v_mfma_f32_32x32x16_bf16 v[160:175], a[152:155], v[84:87], v[160:175]
    v_cvt_pk_bf16_f32 v231, v20, v21
    v_subrev_u32 v16, s75, v9
    v_cmp_ge_i32 s[40:41], v16, 0
    v_cmp_ge_i32 s[42:43], v16, 1
    v_exp_f32 v18, v144
    v_mfma_f32_32x32x16_bf16 v[176:191], a[152:155], v[116:119], v[176:191]
    v_exp_f32 v19, v145
    v_cmp_ge_i32 s[44:45], v16, 2
    v_cmp_ge_i32 s[46:47], v16, 3
    v_exp_f32 v20, v146
    v_mfma_f32_32x32x16_bf16 v[160:175], a[156:159], v[92:95], v[160:175]
    v_exp_f32 v21, v147
    v_cndmask_b32 v18, 0, v18, s[40:41]
    v_cndmask_b32 v19, 0, v19, s[42:43]
    ds_read_b128 a[240:243], v7 offset:4096
    v_mfma_f32_32x32x16_bf16 v[176:191], a[156:159], v[124:127], v[176:191]
    v_add_f32 v13, v18, v19
    v_cvt_pk_bf16_f32 v232, v18, v19
    v_cmp_ge_i32 s[40:41], v16, 8
    v_cmp_ge_i32 s[42:43], v16, 9
    v_exp_f32 v22, v148
    v_mfma_f32_32x32x16_bf16 a[0:15], a[160:163], v[240:243], a[0:15]
    buffer_load_dwordx4 v2, s[48:51], s71 offen offset:2048 sc1 lds
    v_exp_f32 v23, v149
    v_mfma_f32_32x32x16_bf16 a[64:79], a[160:163], v[248:251], a[64:79]
    v_cndmask_b32 v20, 0, v20, s[44:45]
    v_cndmask_b32 v21, 0, v21, s[46:47]
    v_add_f32 v13, v13, v20
    v_add_f32 v13, v13, v21
    v_cvt_pk_bf16_f32 v233, v20, v21
    v_mfma_f32_32x32x16_bf16 a[16:31], a[164:167], v[240:243], a[16:31]
    v_cmp_ge_i32 s[44:45], v16, 10
    ds_read_b128 a[244:247], v7 offset:5120
    v_cmp_ge_i32 s[46:47], v16, 11
    v_exp_f32 v18, v150
    v_mfma_f32_32x32x16_bf16 a[80:95], a[164:167], v[248:251], a[80:95]
    v_exp_f32 v19, v151
    v_cndmask_b32 v22, 0, v22, s[40:41]
    v_cndmask_b32 v23, 0, v23, s[42:43]
    v_add_f32 v13, v13, v22
    v_add_f32 v13, v13, v23
    v_mfma_f32_32x32x16_bf16 a[32:47], a[168:171], v[240:243], a[32:47]
    v_cvt_pk_bf16_f32 v234, v22, v23
    v_cmp_ge_i32 s[40:41], v16, 16
    v_cmp_ge_i32 s[42:43], v16, 17
    v_exp_f32 v20, v152
    v_mfma_f32_32x32x16_bf16 a[96:111], a[168:171], v[248:251], a[96:111]
    v_exp_f32 v21, v153
    buffer_load_dwordx4 v2, s[48:51], s71 offen offset:3072 sc1 lds
    v_mfma_f32_32x32x16_bf16 a[48:63], a[172:175], v[240:243], a[48:63]
    v_cndmask_b32 v18, 0, v18, s[44:45]
    ds_read_b128 a[248:251], v7 offset:6144
    v_cndmask_b32 v19, 0, v19, s[46:47]
    v_add_f32 v13, v13, v18
    v_add_f32 v13, v13, v19
    v_cvt_pk_bf16_f32 v235, v18, v19
    v_mfma_f32_32x32x16_bf16 a[112:127], a[172:175], v[248:251], a[112:127]
    v_cmp_ge_i32 s[44:45], v16, 18
    v_cmp_ge_i32 s[46:47], v16, 19
    v_exp_f32 v22, v154
    v_exp_f32 v23, v155
    v_mfma_f32_32x32x16_bf16 a[0:15], a[176:179], v[244:247], a[0:15]
    v_cndmask_b32 v20, 0, v20, s[40:41]
    v_cndmask_b32 v21, 0, v21, s[42:43]
    v_add_f32 v13, v13, v20
    v_add_f32 v13, v13, v21
    ds_read_b128 a[252:255], v7 offset:7168
    v_mfma_f32_32x32x16_bf16 a[64:79], a[176:179], v[252:255], a[64:79]
    v_cvt_pk_bf16_f32 v236, v20, v21
    v_cmp_ge_i32 s[40:41], v16, 24
    v_cmp_ge_i32 s[42:43], v16, 25
    v_exp_f32 v18, v156
    v_mfma_f32_32x32x16_bf16 a[16:31], a[180:183], v[244:247], a[16:31]
    v_exp_f32 v19, v157
    s_add_u32 s71, s71, 0x4000
    v_cndmask_b32 v22, 0, v22, s[44:45]
    v_cndmask_b32 v23, 0, v23, s[46:47]
    v_add_f32 v13, v13, v22
    v_add_f32 v13, v13, v23
    v_mfma_f32_32x32x16_bf16 a[80:95], a[180:183], v[252:255], a[80:95]
    v_cvt_pk_bf16_f32 v237, v22, v23
    v_cmp_ge_i32 s[44:45], v16, 26
    v_cmp_ge_i32 s[46:47], v16, 27
    v_exp_f32 v20, v158
    v_mfma_f32_32x32x16_bf16 a[32:47], a[184:187], v[244:247], a[32:47]
    v_exp_f32 v21, v159
    v_cndmask_b32 v18, 0, v18, s[40:41]
    v_cndmask_b32 v19, 0, v19, s[42:43]
    v_add_f32 v13, v13, v18
    v_add_f32 v13, v13, v19
    v_mfma_f32_32x32x16_bf16 a[96:111], a[184:187], v[252:255], a[96:111]
    v_cvt_pk_bf16_f32 v238, v18, v19
    v_cndmask_b32 v20, 0, v20, s[44:45]
    v_cndmask_b32 v21, 0, v21, s[46:47]
    v_add_f32 v13, v13, v20
    v_add_f32 v13, v13, v21
    v_mfma_f32_32x32x16_bf16 a[48:63], a[188:191], v[244:247], a[48:63]
    v_cvt_pk_bf16_f32 v239, v20, v21
    v_max_f32 v14, v12, v13
    v_cmp_nge_f32 vcc, s78, v14
    s_mov_b32 s76, 6
    v_add_f32 v24, v10, v12
    v_add_f32 v25, v11, v13
    v_mfma_f32_32x32x16_bf16 a[112:127], a[188:191], v[252:255], a[112:127]
    s_cbranch_vccnz K2_RARE0
K2_RET_V2La:
    s_add_u32 s75, s75, 32
    s_waitcnt lgkmcnt(7)
    v_mfma_f32_32x32x16_bf16 a[0:15], a[224:227], v[224:227], a[0:15]
    v_exp_f32 v18, v160
    s_sub_u32 s61, s73, 0x4000
    v_add_u32 v27, s77, v6
    v_exp_f32 v19, v161
    v_exp_f32 v20, v162
    v_exp_f32 v21, v163
    ds_read_b128 a[128:131], v27 offset:0
    v_add_f32 v12, v18, v19
    v_cvt_pk_bf16_f32 v240, v18, v19
    v_mfma_f32_32x32x16_bf16 a[64:79], a[224:227], v[232:235], a[64:79]
    v_exp_f32 v22, v164
    ds_read_b128 a[160:163], v7 offset:8192
    v_exp_f32 v23, v165
    v_add_f32 v12, v12, v20
    v_add_f32 v12, v12, v21
    ds_read_b128 a[132:135], v27 offset:1024
    v_cvt_pk_bf16_f32 v241, v20, v21
    v_exp_f32 v18, v166
    v_exp_f32 v19, v167
    ds_read_b128 a[164:167], v7 offset:9216
    s_waitcnt lgkmcnt(10)
    v_mfma_f32_32x32x16_bf16 a[16:31], a[228:231], v[224:227], a[16:31]
    s_and_b32 s61, s61, 0xffff
    v_add_f32 v12, v12, v22
    v_add_f32 v12, v12, v23
    v_cvt_pk_bf16_f32 v242, v22, v23
    ds_read_b128 a[136:139], v27 offset:2048
    v_exp_f32 v20, v168
    v_exp_f32 v21, v169
    v_add_f32 v12, v12, v18
    ds_read_b128 a[168:171], v7 offset:10240
    v_add_f32 v12, v12, v19
    v_cvt_pk_bf16_f32 v243, v18, v19
    v_mfma_f32_32x32x16_bf16 a[80:95], a[228:231], v[232:235], a[80:95]
    v_exp_f32 v22, v170
    ds_read_b128 a[140:143], v27 offset:3072
    v_exp_f32 v23, v171
    v_add_f32 v12, v12, v20
    v_add_f32 v12, v12, v21
    ds_read_b128 a[172:175], v7 offset:11264
    v_cvt_pk_bf16_f32 v244, v20, v21
    s_add_u32 m0, s61, 0x10000
    v_exp_f32 v18, v172
    v_exp_f32 v19, v173
    s_waitcnt lgkmcnt(13)
    v_mfma_f32_32x32x16_bf16 a[32:47], a[232:235], v[224:227], a[32:47]
    ds_read_b128 a[144:147], v27 offset:4096
    v_add_f32 v12, v12, v22
    v_add_f32 v12, v12, v23
    v_cvt_pk_bf16_f32 v245, v22, v23
    ds_read_b128 a[176:179], v7 offset:12288
    v_exp_f32 v20, v174
    v_exp_f32 v21, v175
    v_add_f32 v12, v12, v18
    s_waitcnt lgkmcnt(8)
    ds_read_b128 a[148:151], v27 offset:5120
    v_add_f32 v12, v12, v19
    v_mfma_f32_32x32x16_bf16 a[96:111], a[232:235], v[232:235], a[96:111]
    v_cvt_pk_bf16_f32 v246, v18, v19
    v_add_f32 v12, v12, v20
    ds_read_b128 a[180:183], v7 offset:13312
    v_add_f32 v12, v12, v21
    v_cvt_pk_bf16_f32 v247, v20, v21
    buffer_load_dwordx4 v2, s[52:55], s72 offen offset:0 sc1 lds
    v_subrev_u32 v16, s75, v9
    v_cmp_ge_i32 s[40:41], v16, 0
    ds_read_b128 a[152:155], v27 offset:6144
    v_cmp_ge_i32 s[42:43], v16, 1
    v_mfma_f32_32x32x16_bf16 a[48:63], a[236:239], v[224:227], a[48:63]
    v_exp_f32 v18, v176
    v_exp_f32 v19, v177
    ds_read_b128 a[184:187], v7 offset:14336
    v_cmp_ge_i32 s[44:45], v16, 2
    v_cmp_ge_i32 s[46:47], v16, 3
    v_exp_f32 v20, v178
    ds_read_b128 a[156:159], v27 offset:7168
    v_exp_f32 v21, v179
    v_cndmask_b32 v18, 0, v18, s[40:41]
    v_cndmask_b32 v19, 0, v19, s[42:43]
    v_mfma_f32_32x32x16_bf16 a[112:127], a[236:239], v[232:235], a[112:127]
    ds_read_b128 a[188:191], v7 offset:15360
    v_add_f32 v13, v18, v19
    v_cvt_pk_bf16_f32 v248, v18, v19
    buffer_load_dwordx4 v2, s[52:55], s72 offen offset:1024 sc1 lds
    v_cmp_ge_i32 s[40:41], v16, 8
    ds_read_b128 v[96:99], v26 offset:0
    v_cmp_ge_i32 s[42:43], v16, 9
    v_exp_f32 v22, v180
    v_exp_f32 v23, v181
    v_mfma_f32_32x32x16_bf16 a[0:15], a[240:243], v[228:231], a[0:15]
    s_waitcnt lgkmcnt(8)
    ds_read_b128 v[104:107], v26 offset:1024
    v_cndmask_b32 v20, 0, v20, s[44:45]
    v_cndmask_b32 v21, 0, v21, s[46:47]
    v_add_f32 v13, v13, v20
    ds_read_b128 v[112:115], v26 offset:2048
    v_add_f32 v13, v13, v21
    v_cvt_pk_bf16_f32 v249, v20, v21
    v_cmp_ge_i32 s[44:45], v16, 10
    ds_read_b128 v[120:123], v26 offset:3072
    v_cmp_ge_i32 s[46:47], v16, 11
    v_exp_f32 v18, v182
    v_mfma_f32_32x32x16_bf16 a[64:79], a[240:243], v[236:239], a[64:79]
    v_exp_f32 v19, v183
    buffer_load_dwordx4 v2, s[52:55], s72 offen offset:2048 sc1 lds
    ds_read_b128 v[100:103], v26 offset:4096
    v_cndmask_b32 v22, 0, v22, s[40:41]
    v_cndmask_b32 v23, 0, v23, s[42:43]
    v_add_f32 v13, v13, v22
    ds_read_b128 v[108:111], v26 offset:5120
    v_add_f32 v13, v13, v23
    v_cvt_pk_bf16_f32 v250, v22, v23
    v_cmp_ge_i32 s[40:41], v16, 16
    v_mfma_f32_32x32x16_bf16 a[16:31], a[244:247], v[228:231], a[16:31]
    ds_read_b128 v[116:119], v26 offset:6144
    v_cmp_ge_i32 s[42:43], v16, 17
    v_exp_f32 v20, v184
    v_exp_f32 v21, v185
    ds_read_b128 v[124:127], v26 offset:7168
    v_cndmask_b32 v18, 0, v18, s[44:45]
    v_cndmask_b32 v19, 0, v19, s[46:47]
    v_add_f32 v13, v13, v18
    v_add_f32 v13, v13, v19
    v_mfma_f32_32x32x16_bf16 a[80:95], a[244:247], v[236:239], a[80:95]
    buffer_load_dwordx4 v2, s[52:55], s72 offen offset:3072 sc1 lds
    v_cvt_pk_bf16_f32 v251, v18, v19
    v_cmp_ge_i32 s[44:45], v16, 18
    v_cmp_ge_i32 s[46:47], v16, 19
    v_exp_f32 v22, v186
    v_exp_f32 v23, v187
    v_cndmask_b32 v20, 0, v20, s[40:41]
    v_cndmask_b32 v21, 0, v21, s[42:43]
    v_add_f32 v13, v13, v20
    v_add_f32 v13, v13, v21
    v_mfma_f32_32x32x16_bf16 a[32:47], a[248:251], v[228:231], a[32:47]
    v_cvt_pk_bf16_f32 v252, v20, v21
    v_cmp_ge_i32 s[40:41], v16, 24
    v_cmp_ge_i32 s[42:43], v16, 25
    v_exp_f32 v18, v188
    v_exp_f32 v19, v189
    v_cndmask_b32 v22, 0, v22, s[44:45]
    v_cndmask_b32 v23, 0, v23, s[46:47]
    v_add_f32 v13, v13, v22
    s_add_u32 s72, s72, 0x4000
    v_add_f32 v13, v13, v23
    v_cvt_pk_bf16_f32 v253, v22, v23
    v_mfma_f32_32x32x16_bf16 a[96:111], a[248:251], v[236:239], a[96:111]
    v_cmp_ge_i32 s[44:45], v16, 26
    v_cmp_ge_i32 s[46:47], v16, 27
    v_exp_f32 v20, v190
    v_exp_f32 v21, v191
    v_cndmask_b32 v18, 0, v18, s[40:41]
    v_cndmask_b32 v19, 0, v19, s[42:43]
    v_add_f32 v13, v13, v18
    v_add_f32 v13, v13, v19
    v_cvt_pk_bf16_f32 v254, v18, v19
    v_cndmask_b32 v20, 0, v20, s[44:45]
    v_cndmask_b32 v21, 0, v21, s[46:47]
    v_add_f32 v13, v13, v20
    v_mfma_f32_32x32x16_bf16 a[48:63], a[252:255], v[228:231], a[48:63]
    v_add_f32 v13, v13, v21
    v_cvt_pk_bf16_f32 v255, v20, v21
    v_max_f32 v14, v12, v13
    v_cmp_nge_f32 vcc, s78, v14
    s_mov_b32 s76, 7
    v_add_f32 v10, v24, v12
    v_add_f32 v11, v25, v13
    v_add_u32 v7, 0x10000, v6
    v_add_u32 v6, 0x4000, v6
    v_and_b32 v6, 0xffff, v6
    s_sub_u32 s74, s74, 1
    s_add_u32 s73, s73, 0x4000
    s_and_b32 s73, s73, 0xffff
    v_mfma_f32_32x32x16_bf16 a[112:127], a[252:255], v[236:239], a[112:127]
    s_cbranch_vccnz K2_RARE1
K2_RET_V2Lb:
    s_add_u32 s75, s75, 32
    s_waitcnt vmcnt(16) lgkmcnt(0)
    s_barrier
    v_add_u32 v28, 0xc000, v7
    v_and_b32 v28, 0xc000, v28
    v_lshlrev_b32 v3, 2, v1
    v_add_u32 v28, v28, v3
    s_lshl_b32 s79, s56, 8
    s_add_u32 s79, s79, 0x10000
    v_add_u32 v28, s79, v28
    ds_write_b32 v28, v192
    v_xor_b32 v28, 0x100, v28
    v_mov_b32 v32, v11
    v_mov_b32 v33, v11
    v_mov_b32 v24, v10
    s_nop 0
    v_permlane32_swap_b32 v32, v33
    v_mov_b32 v25, 0
    v_add_f32 v32, v32, v33
    v_rcp_f32 v29, v32
    v_add_u32 v6, s77, v6
    v_add_u32 v7, s77, v7
    s_lshr_b32 s79, s77, 8
    s_add_u32 s75, s75, s79
    s_lshl_b32 s79, s79, 1
    v_add_u32 v9, 32, v8
    v_subrev_u32 v9, s79, v9
    v_mfma_f32_32x32x16_bf16 a[64:79], a[160:163], v[248:251], a[64:79]
    ds_read_b128 a[192:195], v6 offset:0
    ds_read_b128 a[196:199], v6 offset:1024
    ds_read_b128 a[200:203], v6 offset:2048
    v_mfma_f32_32x32x16_bf16 a[80:95], a[164:167], v[248:251], a[80:95]
    ds_read_b128 a[204:207], v6 offset:3072
    ds_read_b128 a[208:211], v6 offset:4096
    ds_read_b128 a[212:215], v6 offset:5120
    ds_read_b128 a[216:219], v6 offset:6144
    v_mfma_f32_32x32x16_bf16 a[96:111], a[168:171], v[248:251], a[96:111]
    ds_read_b128 a[220:223], v6 offset:7168
    s_mov_b32 m0, s73
    v_mfma_f32_32x32x16_bf16 a[112:127], a[172:175], v[248:251], a[112:127]
    buffer_load_dwordx4 v2, s[48:51], s71 offen offset:0 sc1 lds
    v_mfma_f32_32x32x16_bf16 a[64:79], a[176:179], v[252:255], a[64:79]
    buffer_load_dwordx4 v2, s[48:51], s71 offen offset:1024 sc1 lds
    v_mfma_f32_32x32x16_bf16 a[80:95], a[180:183], v[252:255], a[80:95]
    buffer_load_dwordx4 v2, s[48:51], s71 offen offset:2048 sc1 lds
    v_mfma_f32_32x32x16_bf16 a[96:111], a[184:187], v[252:255], a[96:111]
    v_mfma_f32_32x32x16_bf16 a[112:127], a[188:191], v[252:255], a[112:127]
    buffer_load_dwordx4 v2, s[48:51], s71 offen offset:3072 sc1 lds
    s_add_u32 s71, s71, 0x4000
    s_waitcnt lgkmcnt(0)
    s_barrier
    ds_read_b32 v34, v28
    v_mfma_f32_32x32x16_bf16 a[0:15], a[160:163], v[240:243], a[0:15]
    s_add_u32 s73, s73, 0x4000
    v_mfma_f32_32x32x16_bf16 a[16:31], a[164:167], v[240:243], a[16:31]
    s_and_b32 s73, s73, 0xffff
    v_mfma_f32_32x32x16_bf16 a[32:47], a[168:171], v[240:243], a[32:47]
    v_add_u32 v6, 0x4000, v6
    v_mfma_f32_32x32x16_bf16 a[48:63], a[172:175], v[240:243], a[48:63]
    v_and_b32 v6, 0xffff, v6
    v_mfma_f32_32x32x16_bf16 a[0:15], a[176:179], v[244:247], a[0:15]
    s_waitcnt lgkmcnt(0)
    v_mov_b32 v208, v34
    v_mov_b32 v209, v34
    v_mov_b32 v210, v34
    v_mov_b32 v211, v34
    v_mfma_f32_32x32x16_bf16 a[16:31], a[180:183], v[244:247], a[16:31]
    v_mov_b32 v212, v34
    v_mov_b32 v213, v34
    v_mov_b32 v214, v34
    v_mov_b32 v215, v34
    v_mfma_f32_32x32x16_bf16 a[32:47], a[184:187], v[244:247], a[32:47]
    v_mov_b32 v216, v34
    v_mov_b32 v217, v34
    v_mov_b32 v218, v34
    v_mov_b32 v219, v34
    v_mfma_f32_32x32x16_bf16 a[48:63], a[188:191], v[244:247], a[48:63]
    v_mov_b32 v220, v34
    v_mov_b32 v221, v34
    v_mov_b32 v222, v34
    v_mov_b32 v223, v34
    v_mfma_f32_32x32x16_bf16 v[160:175], a[128:131], v[64:67], v[192:207]
    v_accvgpr_read_b32 v40, a64
    v_accvgpr_read_b32 v41, a65
    v_accvgpr_read_b32 v42, a66
    v_accvgpr_read_b32 v43, a67
    v_accvgpr_read_b32 v44, a68
    v_accvgpr_read_b32 v45, a69
    v_mfma_f32_32x32x16_bf16 v[160:175], a[132:135], v[72:75], v[160:175]
    v_accvgpr_read_b32 v46, a70
    v_accvgpr_read_b32 v47, a71
    v_mul_f32 v40, v40, v29
    v_mul_f32 v41, v41, v29
    v_mul_f32 v42, v42, v29
    v_mfma_f32_32x32x16_bf16 v[160:175], a[136:139], v[80:83], v[160:175]
    v_mul_f32 v43, v43, v29
    v_mul_f32 v44, v44, v29
    v_mul_f32 v45, v45, v29
    v_mul_f32 v46, v46, v29
    v_mul_f32 v47, v47, v29
    v_cvt_pk_bf16_f32 v40, v40, v41
    v_mfma_f32_32x32x16_bf16 v[160:175], a[140:143], v[88:91], v[160:175]
    v_cvt_pk_bf16_f32 v41, v42, v43
    v_cvt_pk_bf16_f32 v42, v44, v45
    v_cvt_pk_bf16_f32 v43, v46, v47
    s_add_u32 s60, s70, 0
    buffer_store_dwordx4 v[40:43], v2, s[32:35], s60 offen offset:0 sc1
    v_mfma_f32_32x32x16_bf16 v[160:175], a[144:147], v[68:71], v[160:175]
    v_accvgpr_read_b32 v48, a72
    v_accvgpr_read_b32 v49, a73
    v_accvgpr_read_b32 v50, a74
    v_accvgpr_read_b32 v51, a75
    v_accvgpr_read_b32 v52, a76
    v_mfma_f32_32x32x16_bf16 v[160:175], a[148:151], v[76:79], v[160:175]
    v_accvgpr_read_b32 v53, a77
    v_accvgpr_read_b32 v54, a78
    v_accvgpr_read_b32 v55, a79
    v_mul_f32 v48, v48, v29
    v_mul_f32 v49, v49, v29
    v_mfma_f32_32x32x16_bf16 v[160:175], a[152:155], v[84:87], v[160:175]
    v_mul_f32 v50, v50, v29
    v_mul_f32 v51, v51, v29
    v_mul_f32 v52, v52, v29
    v_mul_f32 v53, v53, v29
    v_mul_f32 v54, v54, v29
    v_mul_f32 v55, v55, v29
    v_mfma_f32_32x32x16_bf16 v[160:175], a[156:159], v[92:95], v[160:175]
    v_cvt_pk_bf16_f32 v48, v48, v49
    v_cvt_pk_bf16_f32 v49, v50, v51
    v_cvt_pk_bf16_f32 v50, v52, v53
    v_cvt_pk_bf16_f32 v51, v54, v55
    buffer_store_dwordx4 v[48:51], v2, s[32:35], s60 offen offset:1024 sc1
    v_mfma_f32_32x32x16_bf16 v[176:191], a[128:131], v[96:99], v[208:223]
    v_accvgpr_read_b32 v56, a80
    v_accvgpr_read_b32 v57, a81
    v_accvgpr_read_b32 v58, a82
    v_accvgpr_read_b32 v59, a83
    v_accvgpr_read_b32 v60, a84
    v_mfma_f32_32x32x16_bf16 v[176:191], a[132:135], v[104:107], v[176:191]
    v_accvgpr_read_b32 v61, a85
    v_accvgpr_read_b32 v62, a86
    v_accvgpr_read_b32 v63, a87
    v_mul_f32 v56, v56, v29
    v_mul_f32 v57, v57, v29
    v_mul_f32 v58, v58, v29
    v_mfma_f32_32x32x16_bf16 v[176:191], a[136:139], v[112:115], v[176:191]
    v_mul_f32 v59, v59, v29
    v_mul_f32 v60, v60, v29
    v_mul_f32 v61, v61, v29
    v_mul_f32 v62, v62, v29
    v_mul_f32 v63, v63, v29
    v_mfma_f32_32x32x16_bf16 v[176:191], a[140:143], v[120:123], v[176:191]
    v_cvt_pk_bf16_f32 v56, v56, v57
    v_cvt_pk_bf16_f32 v57, v58, v59
    v_cvt_pk_bf16_f32 v58, v60, v61
    v_cvt_pk_bf16_f32 v59, v62, v63
    buffer_store_dwordx4 v[56:59], v2, s[32:35], s60 offen offset:2048 sc1
    v_mfma_f32_32x32x16_bf16 v[176:191], a[144:147], v[100:103], v[176:191]
    v_accvgpr_read_b32 v40, a88
    v_accvgpr_read_b32 v41, a89
    v_accvgpr_read_b32 v42, a90
    v_accvgpr_read_b32 v43, a91
    v_accvgpr_read_b32 v44, a92
    v_mfma_f32_32x32x16_bf16 v[176:191], a[148:151], v[108:111], v[176:191]
    v_accvgpr_read_b32 v45, a93
    v_accvgpr_read_b32 v46, a94
    v_accvgpr_read_b32 v47, a95
    v_mul_f32 v40, v40, v29
    v_mul_f32 v41, v41, v29
    v_mul_f32 v42, v42, v29
    v_mfma_f32_32x32x16_bf16 v[176:191], a[152:155], v[116:119], v[176:191]
    v_mul_f32 v43, v43, v29
    v_mul_f32 v44, v44, v29
    v_mul_f32 v45, v45, v29
    v_mul_f32 v46, v46, v29
    v_mul_f32 v47, v47, v29
    v_mfma_f32_32x32x16_bf16 v[176:191], a[156:159], v[124:127], v[176:191]
    v_cvt_pk_bf16_f32 v40, v40, v41
    v_cvt_pk_bf16_f32 v41, v42, v43
    v_cvt_pk_bf16_f32 v42, v44, v45
    v_cvt_pk_bf16_f32 v43, v46, v47
    buffer_store_dwordx4 v[40:43], v2, s[32:35], s60 offen offset:3072 sc1
    s_waitcnt vmcnt(16) lgkmcnt(0)
    s_barrier
    v_mfma_f32_32x32x16_bf16 v[128:143], a[192:195], v[64:67], v[192:207]
    v_subrev_u32 v15, s75, v8
    s_mov_b32 m0, s73
    v_accvgpr_read_b32 v48, a96
    ds_read_b128 a[128:131], v6 offset:0
    v_accvgpr_read_b32 v49, a97
    v_cmp_ge_i32 s[40:41], v15, 0
    v_cmp_ge_i32 s[42:43], v15, 1
    v_accvgpr_read_b32 v50, a98
    v_exp_f32 v18, v160
    v_exp_f32 v19, v161
    v_accvgpr_read_b32 v51, a99
    v_cmp_ge_i32 s[44:45], v15, 2
    v_cmp_ge_i32 s[46:47], v15, 3
    v_accvgpr_read_b32 v52, a100
    ds_read_b128 a[160:163], v7 offset:0
    v_exp_f32 v20, v162
    v_accvgpr_read_b32 v53, a101
    v_exp_f32 v21, v163
    v_mfma_f32_32x32x16_bf16 v[144:159], a[192:195], v[96:99], v[208:223]
    v_cndmask_b32 v18, 0, v18, s[40:41]
    buffer_load_dwordx4 v2, s[48:51], s71 offen offset:0 sc1 lds
    v_accvgpr_read_b32 v54, a102
    v_cndmask_b32 v19, 0, v19, s[42:43]
    v_add_f32 v12, v18, v19
    v_accvgpr_read_b32 v55, a103
    v_cvt_pk_bf16_f32 v240, v18, v19
    ds_read_b128 a[132:135], v6 offset:1024
    v_mul_f32 v48, v48, v29
    v_cmp_ge_i32 s[40:41], v15, 8
    v_mul_f32 v49, v49, v29
    v_cmp_ge_i32 s[42:43], v15, 9
    v_exp_f32 v22, v164
    v_mul_f32 v50, v50, v29
    v_exp_f32 v23, v165
    v_cndmask_b32 v20, 0, v20, s[44:45]
    v_mul_f32 v51, v51, v29
    v_mfma_f32_32x32x16_bf16 v[128:143], a[196:199], v[72:75], v[128:143]
    v_cndmask_b32 v21, 0, v21, s[46:47]
    ds_read_b128 a[164:167], v7 offset:1024
    v_mul_f32 v52, v52, v29
    buffer_load_dwordx4 v2, s[48:51], s71 offen offset:1024 sc1 lds
    v_add_f32 v12, v12, v20
    v_add_f32 v12, v12, v21
    v_mul_f32 v53, v53, v29
    v_cvt_pk_bf16_f32 v241, v20, v21
    v_cmp_ge_i32 s[44:45], v15, 10
    v_mul_f32 v54, v54, v29
    v_cmp_ge_i32 s[46:47], v15, 11
    v_exp_f32 v18, v166
    v_mul_f32 v55, v55, v29
    v_exp_f32 v19, v167
    ds_read_b128 a[136:139], v6 offset:2048
    v_cvt_pk_bf16_f32 v48, v48, v49
    v_cndmask_b32 v22, 0, v22, s[40:41]
    v_mfma_f32_32x32x16_bf16 v[144:159], a[196:199], v[104:107], v[144:159]
    v_cndmask_b32 v23, 0, v23, s[42:43]
    v_cvt_pk_bf16_f32 v49, v50, v51
    v_add_f32 v12, v12, v22
    v_cvt_pk_bf16_f32 v50, v52, v53
    buffer_load_dwordx4 v2, s[48:51], s71 offen offset:2048 sc1 lds
    v_add_f32 v12, v12, v23
    v_cvt_pk_bf16_f32 v242, v22, v23
    v_cvt_pk_bf16_f32 v51, v54, v55
    v_cmp_ge_i32 s[40:41], v15, 16
    ds_read_b128 a[168:171], v7 offset:2048
    s_add_u32 s60, s70, 0x1000
    v_cmp_ge_i32 s[42:43], v15, 17
    v_exp_f32 v20, v168
    buffer_store_dwordx4 v[48:51], v2, s[32:35], s60 offen offset:0 sc1
    v_exp_f32 v21, v169
    v_cndmask_b32 v18, 0, v18, s[44:45]
    v_mfma_f32_32x32x16_bf16 v[128:143], a[200:203], v[80:83], v[128:143]
    v_accvgpr_read_b32 v56, a104
    v_cndmask_b32 v19, 0, v19, s[46:47]
    v_add_f32 v12, v12, v18
    v_accvgpr_read_b32 v57, a105
    ds_read_b128 a[140:143], v6 offset:3072
    v_add_f32 v12, v12, v19
    v_accvgpr_read_b32 v58, a106
    buffer_load_dwordx4 v2, s[48:51], s71 offen offset:3072 sc1 lds
    v_cvt_pk_bf16_f32 v243, v18, v19
    v_cmp_ge_i32 s[44:45], v15, 18
    v_accvgpr_read_b32 v59, a107
    v_cmp_ge_i32 s[46:47], v15, 19
    v_accvgpr_read_b32 v60, a108
    v_exp_f32 v22, v170
    v_exp_f32 v23, v171
    v_accvgpr_read_b32 v61, a109
    ds_read_b128 a[172:175], v7 offset:3072
    v_mfma_f32_32x32x16_bf16 v[144:159], a[200:203], v[112:115], v[144:159]
    v_cndmask_b32 v20, 0, v20, s[40:41]
    v_accvgpr_read_b32 v62, a110
    v_cndmask_b32 v21, 0, v21, s[42:43]
    v_add_f32 v12, v12, v20
    v_accvgpr_read_b32 v63, a111
    v_add_f32 v12, v12, v21
    v_cvt_pk_bf16_f32 v244, v20, v21
    v_mul_f32 v56, v56, v29
    s_add_u32 s71, s71, 0x4000
    v_cmp_ge_i32 s[40:41], v15, 24
    v_cmp_ge_i32 s[42:43], v15, 25
    v_mul_f32 v57, v57, v29
    ds_read_b128 a[144:147], v6 offset:4096
    v_exp_f32 v18, v172
    v_mul_f32 v58, v58, v29
    v_exp_f32 v19, v173
    v_cndmask_b32 v22, 0, v22, s[44:45]
    v_mul_f32 v59, v59, v29
    v_cndmask_b32 v23, 0, v23, s[46:47]
    v_add_f32 v12, v12, v22
    v_mfma_f32_32x32x16_bf16 v[128:143], a[204:207], v[88:91], v[128:143]
    v_mul_f32 v60, v60, v29
    v_add_f32 v12, v12, v23
    v_mul_f32 v61, v61, v29
    ds_read_b128 a[176:179], v7 offset:4096
    v_cvt_pk_bf16_f32 v245, v22, v23
    v_mul_f32 v62, v62, v29
    v_cmp_ge_i32 s[44:45], v15, 26
    s_sub_u32 s61, s73, 0x8000
    v_cmp_ge_i32 s[46:47], v15, 27
    v_mul_f32 v63, v63, v29
    v_exp_f32 v20, v174
    v_exp_f32 v21, v175
    v_cvt_pk_bf16_f32 v56, v56, v57
    v_cndmask_b32 v18, 0, v18, s[40:41]
    ds_read_b128 a[148:151], v6 offset:5120
    v_cvt_pk_bf16_f32 v57, v58, v59
    v_cndmask_b32 v19, 0, v19, s[42:43]
    v_add_f32 v12, v12, v18
    v_cvt_pk_bf16_f32 v58, v60, v61
    v_add_f32 v12, v12, v19
    v_mfma_f32_32x32x16_bf16 v[144:159], a[204:207], v[120:123], v[144:159]
    v_cvt_pk_bf16_f32 v246, v18, v19
    v_cvt_pk_bf16_f32 v59, v62, v63
    v_cndmask_b32 v20, 0, v20, s[44:45]
    v_cndmask_b32 v21, 0, v21, s[46:47]
    buffer_store_dwordx4 v[56:59], v2, s[32:35], s60 offen offset:1024 sc1
    s_and_b32 s61, s61, 0xffff
    ds_read_b128 a[180:183], v7 offset:5120
    v_accvgpr_read_b32 v40, a112
    v_add_f32 v12, v12, v20
    v_add_f32 v12, v12, v21
    v_accvgpr_read_b32 v41, a113
    v_cvt_pk_bf16_f32 v247, v20, v21
    v_subrev_u32 v16, s75, v9
    v_accvgpr_read_b32 v42, a114
    v_cmp_ge_i32 s[40:41], v16, 0
    v_cmp_ge_i32 s[42:43], v16, 1
    v_accvgpr_read_b32 v43, a115
    v_exp_f32 v18, v176
    ds_read_b128 a[152:155], v6 offset:6144
    v_accvgpr_read_b32 v44, a116
    v_mfma_f32_32x32x16_bf16 v[128:143], a[208:211], v[68:71], v[128:143]
    v_exp_f32 v19, v177
    v_cmp_ge_i32 s[44:45], v16, 2
    v_accvgpr_read_b32 v45, a117
    v_cmp_ge_i32 s[46:47], v16, 3
    s_add_u32 m0, s61, 0x10000
    v_exp_f32 v20, v178
    v_accvgpr_read_b32 v46, a118
    v_exp_f32 v21, v179
    v_cndmask_b32 v18, 0, v18, s[40:41]
    v_accvgpr_read_b32 v47, a119
    ds_read_b128 a[184:187], v7 offset:6144
    v_cndmask_b32 v19, 0, v19, s[42:43]
    v_mul_f32 v40, v40, v29
    v_add_f32 v13, v18, v19
    v_mul_f32 v41, v41, v29
    v_cvt_pk_bf16_f32 v248, v18, v19
    v_cmp_ge_i32 s[40:41], v16, 8
    v_mul_f32 v42, v42, v29
    v_cmp_ge_i32 s[42:43], v16, 9
    v_mfma_f32_32x32x16_bf16 v[144:159], a[208:211], v[100:103], v[144:159]
    v_exp_f32 v22, v180
    v_mul_f32 v43, v43, v29
    ds_read_b128 a[156:159], v6 offset:7168
    buffer_load_dwordx4 v2, s[52:55], s72 offen offset:0 sc1 lds
    v_exp_f32 v23, v181
    v_mul_f32 v44, v44, v29
    v_cndmask_b32 v20, 0, v20, s[44:45]
    v_cndmask_b32 v21, 0, v21, s[46:47]
    v_mul_f32 v45, v45, v29
    v_add_f32 v13, v13, v20
    v_add_f32 v13, v13, v21
    v_mul_f32 v46, v46, v29
    v_cvt_pk_bf16_f32 v249, v20, v21
    s_waitcnt lgkmcnt(8)
    ds_read_b128 a[188:191], v7 offset:7168
    v_mul_f32 v47, v47, v29
    v_cmp_ge_i32 s[44:45], v16, 10
    v_cmp_ge_i32 s[46:47], v16, 11
    v_cvt_pk_bf16_f32 v40, v40, v41
    v_mfma_f32_32x32x16_bf16 v[128:143], a[212:215], v[76:79], v[128:143]
    v_exp_f32 v18, v182
    v_cvt_pk_bf16_f32 v41, v42, v43
    v_exp_f32 v19, v183
    v_cndmask_b32 v22, 0, v22, s[40:41]
    buffer_load_dwordx4 v2, s[52:55], s72 offen offset:1024 sc1 lds
    v_cvt_pk_bf16_f32 v42, v44, v45
    v_cndmask_b32 v23, 0, v23, s[42:43]
    v_add_f32 v13, v13, v22
    v_cvt_pk_bf16_f32 v43, v46, v47
    v_add_f32 v13, v13, v23
    v_cvt_pk_bf16_f32 v250, v22, v23
    buffer_store_dwordx4 v[40:43], v2, s[32:35], s60 offen offset:2048 sc1
    v_cmp_ge_i32 s[40:41], v16, 16
    v_cmp_ge_i32 s[42:43], v16, 17
    v_accvgpr_read_b32 v48, a120
    v_mfma_f32_32x32x16_bf16 v[144:159], a[212:215], v[108:111], v[144:159]
    v_exp_f32 v20, v184
    v_exp_f32 v21, v185
    v_accvgpr_read_b32 v49, a121
    v_cndmask_b32 v18, 0, v18, s[44:45]
    v_cndmask_b32 v19, 0, v19, s[46:47]
    v_accvgpr_read_b32 v50, a122
    v_add_f32 v13, v13, v18
    buffer_load_dwordx4 v2, s[52:55], s72 offen offset:2048 sc1 lds
    v_add_f32 v13, v13, v19
    v_accvgpr_read_b32 v51, a123
    v_cvt_pk_bf16_f32 v251, v18, v19
    v_cmp_ge_i32 s[44:45], v16, 18
    v_accvgpr_read_b32 v52, a124
    v_cmp_ge_i32 s[46:47], v16, 19
    v_accvgpr_read_b32 v53, a125
    v_exp_f32 v22, v186
    v_mfma_f32_32x32x16_bf16 v[128:143], a[216:219], v[84:87], v[128:143]
    v_exp_f32 v23, v187
    v_accvgpr_read_b32 v54, a126
    v_cndmask_b32 v20, 0, v20, s[40:41]
    v_cndmask_b32 v21, 0, v21, s[42:43]
    v_accvgpr_read_b32 v55, a127
    v_add_f32 v13, v13, v20
    v_add_f32 v13, v13, v21
    v_mul_f32 v48, v48, v29
    v_cvt_pk_bf16_f32 v252, v20, v21
    v_cmp_ge_i32 s[40:41], v16, 24
    buffer_load_dwordx4 v2, s[52:55], s72 offen offset:3072 sc1 lds
    v_mul_f32 v49, v49, v29
    v_cmp_ge_i32 s[42:43], v16, 25
    v_exp_f32 v18, v188
    v_mul_f32 v50, v50, v29
    v_exp_f32 v19, v189
    v_cndmask_b32 v22, 0, v22, s[44:45]
    v_mfma_f32_32x32x16_bf16 v[144:159], a[216:219], v[116:119], v[144:159]
    v_mul_f32 v51, v51, v29
    v_cndmask_b32 v23, 0, v23, s[46:47]
    v_add_f32 v13, v13, v22
    v_mul_f32 v52, v52, v29
    v_add_f32 v13, v13, v23
    v_mul_f32 v53, v53, v29
    v_cvt_pk_bf16_f32 v253, v22, v23
    v_cmp_ge_i32 s[44:45], v16, 26
    v_mul_f32 v54, v54, v29
    v_cmp_ge_i32 s[46:47], v16, 27
    v_exp_f32 v20, v190
    s_add_u32 s72, s72, 0x4000
    v_mul_f32 v55, v55, v29
    v_exp_f32 v21, v191
    v_cndmask_b32 v18, 0, v18, s[40:41]
    v_cvt_pk_bf16_f32 v48, v48, v49
    v_cndmask_b32 v19, 0, v19, s[42:43]
    v_add_f32 v13, v13, v18
    v_cvt_pk_bf16_f32 v49, v50, v51
    v_add_f32 v13, v13, v19
    v_mfma_f32_32x32x16_bf16 v[128:143], a[220:223], v[92:95], v[128:143]
    v_cvt_pk_bf16_f32 v254, v18, v19
    v_cvt_pk_bf16_f32 v50, v52, v53
    v_cndmask_b32 v20, 0, v20, s[44:45]
    v_cndmask_b32 v21, 0, v21, s[46:47]
    v_cvt_pk_bf16_f32 v51, v54, v55
    v_add_f32 v13, v13, v20
    v_add_f32 v13, v13, v21
    buffer_store_dwordx4 v[48:51], v2, s[32:35], s60 offen offset:3072 sc1
    v_cvt_pk_bf16_f32 v255, v20, v21
    v_max_f32 v14, v12, v13
    v_cmp_nge_f32 vcc, s78, v14
    s_mov_b32 s76, 8
    v_add_f32 v10, v24, v12
    v_add_f32 v11, v25, v13
    v_add_u32 v6, 0x4000, v6
    v_and_b32 v6, 0xffff, v6
    v_add_u32 v7, 0x4000, v7
    v_and_b32 v7, 0xffff, v7
    v_or_b32 v7, 0x10000, v7
    s_add_u32 s73, s73, 0x4000
    s_and_b32 s73, s73, 0xffff
    v_mfma_f32_32x32x16_bf16 v[144:159], a[220:223], v[124:127], v[144:159]
    s_cbranch_vccnz K2_RARE1
K2_RET_P0:
    s_add_u32 s75, s75, 64
    s_waitcnt vmcnt(16) lgkmcnt(0)
    s_barrier
    v_mfma_f32_32x32x16_bf16 v[160:175], a[128:131], v[64:67], v[192:207]
    v_subrev_u32 v15, s75, v8
    s_mov_b32 m0, s73
    ds_read_b128 a[192:195], v6 offset:0
    v_cmp_ge_i32 s[40:41], v15, 0
    v_cmp_ge_i32 s[42:43], v15, 1
    v_exp_f32 v18, v128
    v_mfma_f32_32x32x16_bf16 v[176:191], a[128:131], v[96:99], v[208:223]
    v_exp_f32 v19, v129
    v_cmp_ge_i32 s[44:45], v15, 2
    v_cmp_ge_i32 s[46:47], v15, 3
    ds_read_b128 a[224:227], v7 offset:0
    v_exp_f32 v20, v130
    v_exp_f32 v21, v131
    v_mfma_f32_32x32x16_bf16 v[160:175], a[132:135], v[72:75], v[160:175]
    v_cndmask_b32 v18, 0, v18, s[40:41]
    buffer_load_dwordx4 v2, s[48:51], s71 offen offset:0 sc1 lds
    v_cndmask_b32 v19, 0, v19, s[42:43]
    v_add_f32 v12, v18, v19
    v_mfma_f32_32x32x16_bf16 v[176:191], a[132:135], v[104:107], v[176:191]
    v_cvt_pk_bf16_f32 v224, v18, v19
    ds_read_b128 a[196:199], v6 offset:1024
    v_cmp_ge_i32 s[40:41], v15, 8
    v_cmp_ge_i32 s[42:43], v15, 9
    v_exp_f32 v22, v132
    v_exp_f32 v23, v133
    v_mfma_f32_32x32x16_bf16 v[160:175], a[136:139], v[80:83], v[160:175]
    v_cndmask_b32 v20, 0, v20, s[44:45]
    v_cndmask_b32 v21, 0, v21, s[46:47]
    ds_read_b128 a[228:231], v7 offset:1024
    buffer_load_dwordx4 v2, s[48:51], s71 offen offset:1024 sc1 lds
    v_add_f32 v12, v12, v20
    v_mfma_f32_32x32x16_bf16 v[176:191], a[136:139], v[112:115], v[176:191]
    v_add_f32 v12, v12, v21
    v_cvt_pk_bf16_f32 v225, v20, v21
    v_cmp_ge_i32 s[44:45], v15, 10
    v_cmp_ge_i32 s[46:47], v15, 11
    v_exp_f32 v18, v134
    v_exp_f32 v19, v135
    v_mfma_f32_32x32x16_bf16 v[160:175], a[140:143], v[88:91], v[160:175]
    ds_read_b128 a[200:203], v6 offset:2048
    v_cndmask_b32 v22, 0, v22, s[40:41]
    v_cndmask_b32 v23, 0, v23, s[42:43]
    v_add_f32 v12, v12, v22
    v_add_f32 v12, v12, v23
    buffer_load_dwordx4 v2, s[48:51], s71 offen offset:2048 sc1 lds
    v_mfma_f32_32x32x16_bf16 v[176:191], a[140:143], v[120:123], v[176:191]
    v_cvt_pk_bf16_f32 v226, v22, v23
    v_cmp_ge_i32 s[40:41], v15, 16
    ds_read_b128 a[232:235], v7 offset:2048
    v_cmp_ge_i32 s[42:43], v15, 17
    v_exp_f32 v20, v136
    v_mfma_f32_32x32x16_bf16 v[160:175], a[144:147], v[68:71], v[160:175]
    v_exp_f32 v21, v137
    v_cndmask_b32 v18, 0, v18, s[44:45]
    v_cndmask_b32 v19, 0, v19, s[46:47]
    v_add_f32 v12, v12, v18
    ds_read_b128 a[204:207], v6 offset:3072
    v_add_f32 v12, v12, v19
    v_mfma_f32_32x32x16_bf16 v[176:191], a[144:147], v[100:103], v[176:191]
    buffer_load_dwordx4 v2, s[48:51], s71 offen offset:3072 sc1 lds
    v_cvt_pk_bf16_f32 v227, v18, v19
    v_cmp_ge_i32 s[44:45], v15, 18
    v_cmp_ge_i32 s[46:47], v15, 19
    v_exp_f32 v22, v138
    v_mfma_f32_32x32x16_bf16 v[160:175], a[148:151], v[76:79], v[160:175]
    v_exp_f32 v23, v139
    ds_read_b128 a[236:239], v7 offset:3072
    v_cndmask_b32 v20, 0, v20, s[40:41]
    v_cndmask_b32 v21, 0, v21, s[42:43]
    v_add_f32 v12, v12, v20
    v_add_f32 v12, v12, v21
    v_cvt_pk_bf16_f32 v228, v20, v21
    v_mfma_f32_32x32x16_bf16 v[176:191], a[148:151], v[108:111], v[176:191]
    v_cmp_ge_i32 s[40:41], v15, 24
    s_add_u32 s71, s71, 0x4000
    v_cmp_ge_i32 s[42:43], v15, 25
    ds_read_b128 a[208:211], v6 offset:4096
    v_exp_f32 v18, v140
    v_exp_f32 v19, v141
    v_mfma_f32_32x32x16_bf16 v[160:175], a[152:155], v[84:87], v[160:175]
    v_cndmask_b32 v22, 0, v22, s[44:45]
    v_cndmask_b32 v23, 0, v23, s[46:47]
    v_add_f32 v12, v12, v22
    v_add_f32 v12, v12, v23
    ds_read_b128 a[240:243], v7 offset:4096
    v_cvt_pk_bf16_f32 v229, v22, v23
    v_cmp_ge_i32 s[44:45], v15, 26
    v_mfma_f32_32x32x16_bf16 v[176:191], a[152:155], v[116:119], v[176:191]
    s_sub_u32 s61, s73, 0x8000
    v_cmp_ge_i32 s[46:47], v15, 27
    v_exp_f32 v20, v142
    v_exp_f32 v21, v143
    v_cndmask_b32 v18, 0, v18, s[40:41]
    ds_read_b128 a[212:215], v6 offset:5120
    v_mfma_f32_32x32x16_bf16 v[160:175], a[156:159], v[92:95], v[160:175]
    v_cndmask_b32 v19, 0, v19, s[42:43]
    v_add_f32 v12, v12, v18
    v_add_f32 v12, v12, v19
    v_cvt_pk_bf16_f32 v230, v18, v19
    v_cndmask_b32 v20, 0, v20, s[44:45]
    v_cndmask_b32 v21, 0, v21, s[46:47]
    ds_read_b128 a[244:247], v7 offset:5120
    s_and_b32 s61, s61, 0xffff
    v_mfma_f32_32x32x16_bf16 v[176:191], a[156:159], v[124:127], v[176:191]
    v_add_f32 v12, v12, v20
    v_add_f32 v12, v12, v21
    v_cvt_pk_bf16_f32 v231, v20, v21
    v_subrev_u32 v16, s75, v9
    v_cmp_ge_i32 s[40:41], v16, 0
    v_cmp_ge_i32 s[42:43], v16, 1
    v_exp_f32 v18, v144
    v_mfma_f32_32x32x16_bf16 a[0:15], a[160:163], v[240:243], a[0:15]
    ds_read_b128 a[216:219], v6 offset:6144
    v_exp_f32 v19, v145
    v_cmp_ge_i32 s[44:45], v16, 2
    v_cmp_ge_i32 s[46:47], v16, 3
    s_add_u32 m0, s61, 0x10000
    v_exp_f32 v20, v146
    v_mfma_f32_32x32x16_bf16 a[64:79], a[160:163], v[248:251], 0
    v_exp_f32 v21, v147
    v_cndmask_b32 v18, 0, v18, s[40:41]
    ds_read_b128 a[248:251], v7 offset:6144
    v_cndmask_b32 v19, 0, v19, s[42:43]
    v_add_f32 v13, v18, v19
    v_cvt_pk_bf16_f32 v232, v18, v19
    v_cmp_ge_i32 s[40:41], v16, 8
    v_mfma_f32_32x32x16_bf16 a[16:31], a[164:167], v[240:243], a[16:31]
    v_cmp_ge_i32 s[42:43], v16, 9
    v_exp_f32 v22, v148
    ds_read_b128 a[220:223], v6 offset:7168
    buffer_load_dwordx4 v2, s[52:55], s72 offen offset:0 sc1 lds
    v_mfma_f32_32x32x16_bf16 a[80:95], a[164:167], v[248:251], 0
    v_exp_f32 v23, v149
    v_cndmask_b32 v20, 0, v20, s[44:45]
    v_cndmask_b32 v21, 0, v21, s[46:47]
    v_add_f32 v13, v13, v20
    v_add_f32 v13, v13, v21
    v_cvt_pk_bf16_f32 v233, v20, v21
    v_mfma_f32_32x32x16_bf16 a[32:47], a[168:171], v[240:243], a[32:47]
    s_waitcnt lgkmcnt(8)
    ds_read_b128 a[252:255], v7 offset:7168
    v_cmp_ge_i32 s[44:45], v16, 10
    v_cmp_ge_i32 s[46:47], v16, 11
    v_exp_f32 v18, v150
    v_exp_f32 v19, v151
    v_cndmask_b32 v22, 0, v22, s[40:41]
    v_mfma_f32_32x32x16_bf16 a[96:111], a[168:171], v[248:251], 0
    buffer_load_dwordx4 v2, s[52:55], s72 offen offset:1024 sc1 lds
    v_cndmask_b32 v23, 0, v23, s[42:43]
    v_add_f32 v13, v13, v22
    v_add_f32 v13, v13, v23
    v_cvt_pk_bf16_f32 v234, v22, v23
    v_mfma_f32_32x32x16_bf16 a[48:63], a[172:175], v[240:243], a[48:63]
    v_cmp_ge_i32 s[40:41], v16, 16
    v_cmp_ge_i32 s[42:43], v16, 17
    v_exp_f32 v20, v152
    v_exp_f32 v21, v153
    v_cndmask_b32 v18, 0, v18, s[44:45]
    v_cndmask_b32 v19, 0, v19, s[46:47]
    v_mfma_f32_32x32x16_bf16 a[112:127], a[172:175], v[248:251], 0
    v_add_f32 v13, v13, v18
    buffer_load_dwordx4 v2, s[52:55], s72 offen offset:2048 sc1 lds
    v_add_f32 v13, v13, v19
    v_cvt_pk_bf16_f32 v235, v18, v19
    v_mfma_f32_32x32x16_bf16 a[0:15], a[176:179], v[244:247], a[0:15]
    v_cmp_ge_i32 s[44:45], v16, 18
    v_cmp_ge_i32 s[46:47], v16, 19
    v_exp_f32 v22, v154
    v_exp_f32 v23, v155
    v_cndmask_b32 v20, 0, v20, s[40:41]
    v_cndmask_b32 v21, 0, v21, s[42:43]
    v_mfma_f32_32x32x16_bf16 a[64:79], a[176:179], v[252:255], a[64:79]
    v_add_f32 v13, v13, v20
    v_add_f32 v13, v13, v21
    v_cvt_pk_bf16_f32 v236, v20, v21
    v_cmp_ge_i32 s[40:41], v16, 24
    buffer_load_dwordx4 v2, s[52:55], s72 offen offset:3072 sc1 lds
    v_mfma_f32_32x32x16_bf16 a[16:31], a[180:183], v[244:247], a[16:31]
    v_cmp_ge_i32 s[42:43], v16, 25
    v_exp_f32 v18, v156
    v_exp_f32 v19, v157
    v_cndmask_b32 v22, 0, v22, s[44:45]
    v_cndmask_b32 v23, 0, v23, s[46:47]
    v_add_f32 v13, v13, v22
    v_mfma_f32_32x32x16_bf16 a[80:95], a[180:183], v[252:255], a[80:95]
    v_add_f32 v13, v13, v23
    v_cvt_pk_bf16_f32 v237, v22, v23
    v_cmp_ge_i32 s[44:45], v16, 26
    v_cmp_ge_i32 s[46:47], v16, 27
    v_exp_f32 v20, v158
    s_add_u32 s72, s72, 0x4000
    v_mfma_f32_32x32x16_bf16 a[32:47], a[184:187], v[244:247], a[32:47]
    v_exp_f32 v21, v159
    v_cndmask_b32 v18, 0, v18, s[40:41]
    v_cndmask_b32 v19, 0, v19, s[42:43]
    v_add_f32 v13, v13, v18
    v_add_f32 v13, v13, v19
    v_cvt_pk_bf16_f32 v238, v18, v19
    v_cndmask_b32 v20, 0, v20, s[44:45]
    v_mfma_f32_32x32x16_bf16 a[96:111], a[184:187], v[252:255], a[96:111]
    v_cndmask_b32 v21, 0, v21, s[46:47]
    v_add_f32 v13, v13, v20
    v_add_f32 v13, v13, v21
    v_cvt_pk_bf16_f32 v239, v20, v21
    v_max_f32 v14, v12, v13
    v_cmp_nge_f32 vcc, s78, v14
    s_mov_b32 s76, 9
    v_add_f32 v24, v10, v12
    v_mfma_f32_32x32x16_bf16 a[48:63], a[188:191], v[244:247], a[48:63]
    v_add_f32 v25, v11, v13
    v_add_u32 v6, 0x4000, v6
    v_and_b32 v6, 0xffff, v6
    v_add_u32 v7, 0x4000, v7
    v_and_b32 v7, 0xffff, v7
    v_or_b32 v7, 0x10000, v7
    s_add_u32 s73, s73, 0x4000
    s_and_b32 s73, s73, 0xffff
    v_mfma_f32_32x32x16_bf16 a[112:127], a[188:191], v[252:255], a[112:127]
    s_cbranch_vccnz K2_RARE0
K2_RET_P1:
    s_add_u32 s75, s75, 64
    s_cmp_eq_u32 s58, 7
    s_cbranch_scc1 K2_DRAIN
    s_lshl_b32 s74, s58, 1
    s_sub_u32 s74, 13, s74
    s_cmp_eq_u32 s74, 0
    s_cbranch_scc1 K2_P2_X
K2_P2_L:
    s_waitcnt vmcnt(16) lgkmcnt(0)
    s_barrier
    v_mfma_f32_32x32x16_bf16 v[128:143], a[192:195], v[64:67], v[192:207]
    v_exp_f32 v18, v160
    s_mov_b32 m0, s73
    ds_read_b128 a[128:131], v6 offset:0
    v_exp_f32 v19, v161
    v_mfma_f32_32x32x16_bf16 v[144:159], a[192:195], v[96:99], v[208:223]
    v_exp_f32 v20, v162
    v_exp_f32 v21, v163
    ds_read_b128 a[160:163], v7 offset:0
    v_mfma_f32_32x32x16_bf16 v[128:143], a[196:199], v[72:75], v[128:143]
    v_add_f32 v12, v18, v19
    buffer_load_dwordx4 v2, s[48:51], s71 offen offset:0 sc1 lds
    v_cvt_pk_bf16_f32 v240, v18, v19
    v_mfma_f32_32x32x16_bf16 v[144:159], a[196:199], v[104:107], v[144:159]
    v_exp_f32 v22, v164
    ds_read_b128 a[132:135], v6 offset:1024
    v_exp_f32 v23, v165
    v_add_f32 v12, v12, v20
    v_mfma_f32_32x32x16_bf16 v[128:143], a[200:203], v[80:83], v[128:143]
    v_add_f32 v12, v12, v21
    v_cvt_pk_bf16_f32 v241, v20, v21
    buffer_load_dwordx4 v2, s[48:51], s71 offen offset:1024 sc1 lds
    v_mfma_f32_32x32x16_bf16 v[144:159], a[200:203], v[112:115], v[144:159]
    ds_read_b128 a[164:167], v7 offset:1024
    v_exp_f32 v18, v166
    v_exp_f32 v19, v167
    v_mfma_f32_32x32x16_bf16 v[128:143], a[204:207], v[88:91], v[128:143]
    v_add_f32 v12, v12, v22
    ds_read_b128 a[136:139], v6 offset:2048
    v_add_f32 v12, v12, v23
    v_cvt_pk_bf16_f32 v242, v22, v23
    v_mfma_f32_32x32x16_bf16 v[144:159], a[204:207], v[120:123], v[144:159]
    buffer_load_dwordx4 v2, s[48:51], s71 offen offset:2048 sc1 lds
    v_exp_f32 v20, v168
    ds_read_b128 a[168:171], v7 offset:2048
    v_mfma_f32_32x32x16_bf16 v[128:143], a[208:211], v[68:71], v[128:143]
    v_exp_f32 v21, v169
    v_add_f32 v12, v12, v18
    v_add_f32 v12, v12, v19
    v_cvt_pk_bf16_f32 v243, v18, v19
    v_mfma_f32_32x32x16_bf16 v[144:159], a[208:211], v[100:103], v[144:159]
    buffer_load_dwordx4 v2, s[48:51], s71 offen offset:3072 sc1 lds
    ds_read_b128 a[140:143], v6 offset:3072
    v_exp_f32 v22, v170
    v_mfma_f32_32x32x16_bf16 v[128:143], a[212:215], v[76:79], v[128:143]
    v_exp_f32 v23, v171
    v_add_f32 v12, v12, v20
    ds_read_b128 a[172:175], v7 offset:3072
    v_add_f32 v12, v12, v21
    v_mfma_f32_32x32x16_bf16 v[144:159], a[212:215], v[108:111], v[144:159]
    v_cvt_pk_bf16_f32 v244, v20, v21
    s_add_u32 s71, s71, 0x4000
    v_exp_f32 v18, v172
    v_exp_f32 v19, v173
    v_mfma_f32_32x32x16_bf16 v[128:143], a[216:219], v[84:87], v[128:143]
    ds_read_b128 a[144:147], v6 offset:4096
    v_add_f32 v12, v12, v22
    v_add_f32 v12, v12, v23
    v_cvt_pk_bf16_f32 v245, v22, v23
    ds_read_b128 a[176:179], v7 offset:4096
    s_sub_u32 s61, s73, 0x8000
    v_mfma_f32_32x32x16_bf16 v[144:159], a[216:219], v[116:119], v[144:159]
    v_exp_f32 v20, v174
    v_exp_f32 v21, v175
    v_add_f32 v12, v12, v18
    v_mfma_f32_32x32x16_bf16 v[128:143], a[220:223], v[92:95], v[128:143]
    ds_read_b128 a[148:151], v6 offset:5120
    v_add_f32 v12, v12, v19
    v_cvt_pk_bf16_f32 v246, v18, v19
    v_add_f32 v12, v12, v20
    s_and_b32 s61, s61, 0xffff
    v_add_f32 v12, v12, v21
    v_mfma_f32_32x32x16_bf16 v[144:159], a[220:223], v[124:127], v[144:159]
    ds_read_b128 a[180:183], v7 offset:5120
    v_cvt_pk_bf16_f32 v247, v20, v21
    v_exp_f32 v18, v176
    v_exp_f32 v19, v177
    v_mfma_f32_32x32x16_bf16 a[0:15], a[224:227], v[224:227], a[0:15]
    ds_read_b128 a[152:155], v6 offset:6144
    s_add_u32 m0, s61, 0x10000
    v_exp_f32 v20, v178
    v_exp_f32 v21, v179
    v_mfma_f32_32x32x16_bf16 a[64:79], a[224:227], v[232:235], a[64:79]
    v_add_f32 v13, v18, v19
    ds_read_b128 a[184:187], v7 offset:6144
    v_cvt_pk_bf16_f32 v248, v18, v19
    v_exp_f32 v22, v180
    v_mfma_f32_32x32x16_bf16 a[16:31], a[228:231], v[224:227], a[16:31]
    v_exp_f32 v23, v181
    buffer_load_dwordx4 v2, s[52:55], s72 offen offset:0 sc1 lds
    v_mfma_f32_32x32x16_bf16 a[80:95], a[228:231], v[232:235], a[80:95]
    v_add_f32 v13, v13, v20
    ds_read_b128 a[156:159], v6 offset:7168
    v_add_f32 v13, v13, v21
    v_cvt_pk_bf16_f32 v249, v20, v21
    v_exp_f32 v18, v182
    v_mfma_f32_32x32x16_bf16 a[32:47], a[232:235], v[224:227], a[32:47]
    s_waitcnt lgkmcnt(8)
    ds_read_b128 a[188:191], v7 offset:7168
    v_exp_f32 v19, v183
    buffer_load_dwordx4 v2, s[52:55], s72 offen offset:1024 sc1 lds
    v_mfma_f32_32x32x16_bf16 a[96:111], a[232:235], v[232:235], a[96:111]
    v_add_f32 v13, v13, v22
    v_add_f32 v13, v13, v23
    v_cvt_pk_bf16_f32 v250, v22, v23
    v_mfma_f32_32x32x16_bf16 a[48:63], a[236:239], v[224:227], a[48:63]
    v_exp_f32 v20, v184
    v_exp_f32 v21, v185
    v_add_f32 v13, v13, v18
    v_mfma_f32_32x32x16_bf16 a[112:127], a[236:239], v[232:235], a[112:127]
    buffer_load_dwordx4 v2, s[52:55], s72 offen offset:2048 sc1 lds
    v_add_f32 v13, v13, v19
    v_cvt_pk_bf16_f32 v251, v18, v19
    v_exp_f32 v22, v186
    v_mfma_f32_32x32x16_bf16 a[0:15], a[240:243], v[228:231], a[0:15]
    v_exp_f32 v23, v187
    v_add_f32 v13, v13, v20
    v_add_f32 v13, v13, v21
    v_cvt_pk_bf16_f32 v252, v20, v21
    v_mfma_f32_32x32x16_bf16 a[64:79], a[240:243], v[236:239], a[64:79]
    buffer_load_dwordx4 v2, s[52:55], s72 offen offset:3072 sc1 lds
    v_exp_f32 v18, v188
    v_mfma_f32_32x32x16_bf16 a[16:31], a[244:247], v[228:231], a[16:31]
    v_exp_f32 v19, v189
    v_add_f32 v13, v13, v22
    v_add_f32 v13, v13, v23
    v_cvt_pk_bf16_f32 v253, v22, v23
    v_mfma_f32_32x32x16_bf16 a[80:95], a[244:247], v[236:239], a[80:95]
    v_exp_f32 v20, v190
    v_exp_f32 v21, v191
    s_add_u32 s72, s72, 0x4000
    v_add_f32 v13, v13, v18
    v_mfma_f32_32x32x16_bf16 a[32:47], a[248:251], v[228:231], a[32:47]
    v_add_f32 v13, v13, v19
    v_cvt_pk_bf16_f32 v254, v18, v19
    v_add_f32 v13, v13, v20
    v_add_f32 v13, v13, v21
    v_cvt_pk_bf16_f32 v255, v20, v21
    v_max_f32 v14, v12, v13
    v_mfma_f32_32x32x16_bf16 a[96:111], a[248:251], v[236:239], a[96:111]
    v_cmp_nge_f32 vcc, s78, v14
    s_mov_b32 s76, 10
    v_add_f32 v10, v24, v12
    v_add_f32 v11, v25, v13
    v_add_u32 v6, 0x4000, v6
    v_mfma_f32_32x32x16_bf16 a[48:63], a[252:255], v[228:231], a[48:63]
    v_and_b32 v6, 0xffff, v6
    v_add_u32 v7, 0x4000, v7
    v_and_b32 v7, 0xffff, v7
    v_or_b32 v7, 0x10000, v7
    s_add_u32 s73, s73, 0x4000
    s_and_b32 s73, s73, 0xffff
    v_mfma_f32_32x32x16_bf16 a[112:127], a[252:255], v[236:239], a[112:127]
    s_cbranch_vccnz K2_RARE1
K2_RET_P2a:
    s_add_u32 s75, s75, 64
    s_waitcnt vmcnt(16) lgkmcnt(0)
    s_barrier
    v_mfma_f32_32x32x16_bf16 v[160:175], a[128:131], v[64:67], v[192:207]
    v_exp_f32 v18, v128
    s_mov_b32 m0, s73
    s_sub_u32 s74, s74, 1
    ds_read_b128 a[192:195], v6 offset:0
    v_mfma_f32_32x32x16_bf16 v[176:191], a[128:131], v[96:99], v[208:223]
    v_exp_f32 v19, v129
    v_exp_f32 v20, v130
    v_exp_f32 v21, v131
    v_mfma_f32_32x32x16_bf16 v[160:175], a[132:135], v[72:75], v[160:175]
    ds_read_b128 a[224:227], v7 offset:0
    buffer_load_dwordx4 v2, s[48:51], s71 offen offset:0 sc1 lds
    v_add_f32 v12, v18, v19
    v_mfma_f32_32x32x16_bf16 v[176:191], a[132:135], v[104:107], v[176:191]
    v_cvt_pk_bf16_f32 v224, v18, v19
    v_exp_f32 v22, v132
    ds_read_b128 a[196:199], v6 offset:1024
    v_exp_f32 v23, v133
    v_mfma_f32_32x32x16_bf16 v[160:175], a[136:139], v[80:83], v[160:175]
    v_add_f32 v12, v12, v20
    v_add_f32 v12, v12, v21
    buffer_load_dwordx4 v2, s[48:51], s71 offen offset:1024 sc1 lds
    v_mfma_f32_32x32x16_bf16 v[176:191], a[136:139], v[112:115], v[176:191]
    v_cvt_pk_bf16_f32 v225, v20, v21
    ds_read_b128 a[228:231], v7 offset:1024
    v_exp_f32 v18, v134
    v_exp_f32 v19, v135
    v_mfma_f32_32x32x16_bf16 v[160:175], a[140:143], v[88:91], v[160:175]
    v_add_f32 v12, v12, v22
    ds_read_b128 a[200:203], v6 offset:2048
    v_add_f32 v12, v12, v23
    v_mfma_f32_32x32x16_bf16 v[176:191], a[140:143], v[120:123], v[176:191]
    buffer_load_dwordx4 v2, s[48:51], s71 offen offset:2048 sc1 lds
    v_cvt_pk_bf16_f32 v226, v22, v23
    v_exp_f32 v20, v136
    ds_read_b128 a[232:235], v7 offset:2048
    v_mfma_f32_32x32x16_bf16 v[160:175], a[144:147], v[68:71], v[160:175]
    v_exp_f32 v21, v137
    v_add_f32 v12, v12, v18
    v_add_f32 v12, v12, v19
    v_cvt_pk_bf16_f32 v227, v18, v19
    v_mfma_f32_32x32x16_bf16 v[176:191], a[144:147], v[100:103], v[176:191]
    buffer_load_dwordx4 v2, s[48:51], s71 offen offset:3072 sc1 lds
    ds_read_b128 a[204:207], v6 offset:3072
    v_exp_f32 v22, v138
    v_mfma_f32_32x32x16_bf16 v[160:175], a[148:151], v[76:79], v[160:175]
    v_exp_f32 v23, v139
    v_add_f32 v12, v12, v20
    ds_read_b128 a[236:239], v7 offset:3072
    v_add_f32 v12, v12, v21
    v_mfma_f32_32x32x16_bf16 v[176:191], a[148:151], v[108:111], v[176:191]
    s_add_u32 s71, s71, 0x4000
    v_cvt_pk_bf16_f32 v228, v20, v21
    v_exp_f32 v18, v140
    v_exp_f32 v19, v141
    v_mfma_f32_32x32x16_bf16 v[160:175], a[152:155], v[84:87], v[160:175]
    ds_read_b128 a[208:211], v6 offset:4096
    v_add_f32 v12, v12, v22
    v_add_f32 v12, v12, v23
    v_cvt_pk_bf16_f32 v229, v22, v23
    s_sub_u32 s61, s73, 0x8000
    v_mfma_f32_32x32x16_bf16 v[176:191], a[152:155], v[116:119], v[176:191]
    ds_read_b128 a[240:243], v7 offset:4096
    v_exp_f32 v20, v142
    v_exp_f32 v21, v143
    v_add_f32 v12, v12, v18
    v_mfma_f32_32x32x16_bf16 v[160:175], a[156:159], v[92:95], v[160:175]
    ds_read_b128 a[212:215], v6 offset:5120
    v_add_f32 v12, v12, v19
    v_cvt_pk_bf16_f32 v230, v18, v19
    s_and_b32 s61, s61, 0xffff
    v_add_f32 v12, v12, v20
    v_add_f32 v12, v12, v21
    v_mfma_f32_32x32x16_bf16 v[176:191], a[156:159], v[124:127], v[176:191]
    ds_read_b128 a[244:247], v7 offset:5120
    v_cvt_pk_bf16_f32 v231, v20, v21
    v_exp_f32 v18, v144
    v_exp_f32 v19, v145
    v_mfma_f32_32x32x16_bf16 a[0:15], a[160:163], v[240:243], a[0:15]
    ds_read_b128 a[216:219], v6 offset:6144
    s_add_u32 m0, s61, 0x10000
    v_exp_f32 v20, v146
    v_exp_f32 v21, v147
    v_mfma_f32_32x32x16_bf16 a[64:79], a[160:163], v[248:251], a[64:79]
    v_add_f32 v13, v18, v19
    ds_read_b128 a[248:251], v7 offset:6144
    v_cvt_pk_bf16_f32 v232, v18, v19
    v_exp_f32 v22, v148
    v_mfma_f32_32x32x16_bf16 a[16:31], a[164:167], v[240:243], a[16:31]
    v_exp_f32 v23, v149
    buffer_load_dwordx4 v2, s[52:55], s72 offen offset:0 sc1 lds
    v_mfma_f32_32x32x16_bf16 a[80:95], a[164:167], v[248:251], a[80:95]
    v_add_f32 v13, v13, v20
    ds_read_b128 a[220:223], v6 offset:7168
    v_add_f32 v13, v13, v21
    v_cvt_pk_bf16_f32 v233, v20, v21
    v_exp_f32 v18, v150
    v_mfma_f32_32x32x16_bf16 a[32:47], a[168:171], v[240:243], a[32:47]
    s_waitcnt lgkmcnt(8)
    ds_read_b128 a[252:255], v7 offset:7168
    buffer_load_dwordx4 v2, s[52:55], s72 offen offset:1024 sc1 lds
    v_mfma_f32_32x32x16_bf16 a[96:111], a[168:171], v[248:251], a[96:111]
    v_exp_f32 v19, v151
    v_add_f32 v13, v13, v22
    v_add_f32 v13, v13, v23
    v_cvt_pk_bf16_f32 v234, v22, v23
    v_mfma_f32_32x32x16_bf16 a[48:63], a[172:175], v[240:243], a[48:63]
    v_exp_f32 v20, v152
    v_exp_f32 v21, v153
    v_add_f32 v13, v13, v18
    v_mfma_f32_32x32x16_bf16 a[112:127], a[172:175], v[248:251], a[112:127]
    buffer_load_dwordx4 v2, s[52:55], s72 offen offset:2048 sc1 lds
    v_add_f32 v13, v13, v19
    v_cvt_pk_bf16_f32 v235, v18, v19
    v_exp_f32 v22, v154
    v_mfma_f32_32x32x16_bf16 a[0:15], a[176:179], v[244:247], a[0:15]
    v_exp_f32 v23, v155
    v_add_f32 v13, v13, v20
    v_add_f32 v13, v13, v21
    v_cvt_pk_bf16_f32 v236, v20, v21
    v_mfma_f32_32x32x16_bf16 a[64:79], a[176:179], v[252:255], a[64:79]
    buffer_load_dwordx4 v2, s[52:55], s72 offen offset:3072 sc1 lds
    v_exp_f32 v18, v156
    v_mfma_f32_32x32x16_bf16 a[16:31], a[180:183], v[244:247], a[16:31]
    v_exp_f32 v19, v157
    v_add_f32 v13, v13, v22
    v_add_f32 v13, v13, v23
    v_cvt_pk_bf16_f32 v237, v22, v23
    v_mfma_f32_32x32x16_bf16 a[80:95], a[180:183], v[252:255], a[80:95]
    v_exp_f32 v20, v158
    v_exp_f32 v21, v159
    s_add_u32 s72, s72, 0x4000
    v_add_f32 v13, v13, v18
    v_mfma_f32_32x32x16_bf16 a[32:47], a[184:187], v[244:247], a[32:47]
    v_add_f32 v13, v13, v19
    v_cvt_pk_bf16_f32 v238, v18, v19
    v_add_f32 v13, v13, v20
    v_add_f32 v13, v13, v21
    v_cvt_pk_bf16_f32 v239, v20, v21
    v_max_f32 v14, v12, v13
    v_mfma_f32_32x32x16_bf16 a[96:111], a[184:187], v[252:255], a[96:111]
    v_cmp_nge_f32 vcc, s78, v14
    s_mov_b32 s76, 11
    v_add_f32 v24, v10, v12
    v_add_f32 v25, v11, v13
    v_add_u32 v6, 0x4000, v6
    v_mfma_f32_32x32x16_bf16 a[48:63], a[188:191], v[244:247], a[48:63]
    v_and_b32 v6, 0xffff, v6
    v_add_u32 v7, 0x4000, v7
    v_and_b32 v7, 0xffff, v7
    v_or_b32 v7, 0x10000, v7
    s_add_u32 s73, s73, 0x4000
    s_and_b32 s73, s73, 0xffff
    v_mfma_f32_32x32x16_bf16 a[112:127], a[188:191], v[252:255], a[112:127]
    s_cbranch_vccnz K2_RARE0
K2_RET_P2b:
    s_add_u32 s75, s75, 64
    s_cmp_lg_u32 s74, 0
    s_cbranch_scc1 K2_P2_L
K2_P2_X:
    s_waitcnt vmcnt(16) lgkmcnt(0)
    s_barrier
    v_mfma_f32_32x32x16_bf16 v[128:143], a[192:195], v[64:67], v[192:207]
    v_subrev_u32 v15, s75, v8
    s_mov_b32 m0, s73
    ds_read_b128 a[128:131], v6 offset:0
    v_cmp_ge_i32 s[40:41], v15, 0
    v_cmp_ge_i32 s[42:43], v15, 1
    v_exp_f32 v18, v160
    v_mfma_f32_32x32x16_bf16 v[144:159], a[192:195], v[96:99], v[208:223]
    v_exp_f32 v19, v161
    v_cmp_ge_i32 s[44:45], v15, 2
    v_cmp_ge_i32 s[46:47], v15, 3
    ds_read_b128 a[160:163], v7 offset:0
    v_exp_f32 v20, v162
    v_exp_f32 v21, v163
    v_mfma_f32_32x32x16_bf16 v[128:143], a[196:199], v[72:75], v[128:143]
    v_cndmask_b32 v18, 0, v18, s[40:41]
    buffer_load_dwordx4 v2, s[48:51], s71 offen offset:0 sc1 lds
    v_cndmask_b32 v19, 0, v19, s[42:43]
    v_add_f32 v12, v18, v19
    v_mfma_f32_32x32x16_bf16 v[144:159], a[196:199], v[104:107], v[144:159]
    v_cvt_pk_bf16_f32 v240, v18, v19
    ds_read_b128 a[132:135], v6 offset:1024
    v_cmp_ge_i32 s[40:41], v15, 8
    v_cmp_ge_i32 s[42:43], v15, 9
    v_exp_f32 v22, v164
    v_exp_f32 v23, v165
    v_mfma_f32_32x32x16_bf16 v[128:143], a[200:203], v[80:83], v[128:143]
    v_cndmask_b32 v20, 0, v20, s[44:45]
    v_cndmask_b32 v21, 0, v21, s[46:47]
    ds_read_b128 a[164:167], v7 offset:1024
    buffer_load_dwordx4 v2, s[48:51], s71 offen offset:1024 sc1 lds
    v_add_f32 v12, v12, v20
    v_mfma_f32_32x32x16_bf16 v[144:159], a[200:203], v[112:115], v[144:159]
    v_add_f32 v12, v12, v21
    v_cvt_pk_bf16_f32 v241, v20, v21
    v_cmp_ge_i32 s[44:45], v15, 10
    v_cmp_ge_i32 s[46:47], v15, 11
    v_exp_f32 v18, v166
    v_exp_f32 v19, v167
    v_mfma_f32_32x32x16_bf16 v[128:143], a[204:207], v[88:91], v[128:143]
    ds_read_b128 a[136:139], v6 offset:2048
    v_cndmask_b32 v22, 0, v22, s[40:41]
    v_cndmask_b32 v23, 0, v23, s[42:43]
    v_add_f32 v12, v12, v22
    v_add_f32 v12, v12, v23
    buffer_load_dwordx4 v2, s[48:51], s71 offen offset:2048 sc1 lds
    v_mfma_f32_32x32x16_bf16 v[144:159], a[204:207], v[120:123], v[144:159]
    v_cvt_pk_bf16_f32 v242, v22, v23
    v_cmp_ge_i32 s[40:41], v15, 16
    ds_read_b128 a[168:171], v7 offset:2048
    v_cmp_ge_i32 s[42:43], v15, 17
    v_exp_f32 v20, v168
    v_mfma_f32_32x32x16_bf16 v[128:143], a[208:211], v[68:71], v[128:143]
    v_exp_f32 v21, v169
    v_cndmask_b32 v18, 0, v18, s[44:45]
    v_cndmask_b32 v19, 0, v19, s[46:47]
    v_add_f32 v12, v12, v18
    ds_read_b128 a[140:143], v6 offset:3072
    v_add_f32 v12, v12, v19
    v_mfma_f32_32x32x16_bf16 v[144:159], a[208:211], v[100:103], v[144:159]
    buffer_load_dwordx4 v2, s[48:51], s71 offen offset:3072 sc1 lds
    v_cvt_pk_bf16_f32 v243, v18, v19
    v_cmp_ge_i32 s[44:45], v15, 18
    v_cmp_ge_i32 s[46:47], v15, 19
    v_exp_f32 v22, v170
    v_mfma_f32_32x32x16_bf16 v[128:143], a[212:215], v[76:79], v[128:143]
    v_exp_f32 v23, v171
    ds_read_b128 a[172:175], v7 offset:3072
    v_cndmask_b32 v20, 0, v20, s[40:41]
    v_cndmask_b32 v21, 0, v21, s[42:43]
    v_add_f32 v12, v12, v20
    v_add_f32 v12, v12, v21
    v_cvt_pk_bf16_f32 v244, v20, v21
    v_mfma_f32_32x32x16_bf16 v[144:159], a[212:215], v[108:111], v[144:159]
    v_cmp_ge_i32 s[40:41], v15, 24
    s_add_u32 s71, s71, 0x4000
    v_cmp_ge_i32 s[42:43], v15, 25
    ds_read_b128 a[144:147], v6 offset:4096
    v_exp_f32 v18, v172
    v_exp_f32 v19, v173
    v_mfma_f32_32x32x16_bf16 v[128:143], a[216:219], v[84:87], v[128:143]
    v_cndmask_b32 v22, 0, v22, s[44:45]
    v_cndmask_b32 v23, 0, v23, s[46:47]
    v_add_f32 v12, v12, v22
    v_add_f32 v12, v12, v23
    ds_read_b128 a[176:179], v7 offset:4096
    v_cvt_pk_bf16_f32 v245, v22, v23
    v_cmp_ge_i32 s[44:45], v15, 26
    v_mfma_f32_32x32x16_bf16 v[144:159], a[216:219], v[116:119], v[144:159]
    s_sub_u32 s61, s73, 0x8000
    v_cmp_ge_i32 s[46:47], v15, 27
    v_exp_f32 v20, v174
    v_exp_f32 v21, v175
    v_cndmask_b32 v18, 0, v18, s[40:41]
    ds_read_b128 a[148:151], v6 offset:5120
    v_mfma_f32_32x32x16_bf16 v[128:143], a[220:223], v[92:95], v[128:143]
    v_cndmask_b32 v19, 0, v19, s[42:43]
    v_add_f32 v12, v12, v18
    v_add_f32 v12, v12, v19
    v_cvt_pk_bf16_f32 v246, v18, v19
    v_cndmask_b32 v20, 0, v20, s[44:45]
    v_cndmask_b32 v21, 0, v21, s[46:47]
    ds_read_b128 a[180:183], v7 offset:5120
    s_and_b32 s61, s61, 0xffff
    v_mfma_f32_32x32x16_bf16 v[144:159], a[220:223], v[124:127], v[144:159]
    v_add_f32 v12, v12, v20
    v_add_f32 v12, v12, v21
    v_cvt_pk_bf16_f32 v247, v20, v21
    v_subrev_u32 v16, s75, v9
    v_cmp_ge_i32 s[40:41], v16, 0
    v_cmp_ge_i32 s[42:43], v16, 1
    v_exp_f32 v18, v176
    v_mfma_f32_32x32x16_bf16 a[0:15], a[224:227], v[224:227], a[0:15]
    ds_read_b128 a[152:155], v6 offset:6144
    v_exp_f32 v19, v177
    v_cmp_ge_i32 s[44:45], v16, 2
    v_cmp_ge_i32 s[46:47], v16, 3
    s_add_u32 m0, s61, 0x10000
    v_exp_f32 v20, v178
    v_mfma_f32_32x32x16_bf16 a[64:79], a[224:227], v[232:235], a[64:79]
    v_exp_f32 v21, v179
    v_cndmask_b32 v18, 0, v18, s[40:41]
    ds_read_b128 a[184:187], v7 offset:6144
    v_cndmask_b32 v19, 0, v19, s[42:43]
    v_add_f32 v13, v18, v19
    v_cvt_pk_bf16_f32 v248, v18, v19
    v_cmp_ge_i32 s[40:41], v16, 8
    v_mfma_f32_32x32x16_bf16 a[16:31], a[228:231], v[224:227], a[16:31]
    v_cmp_ge_i32 s[42:43], v16, 9
    v_exp_f32 v22, v180
    ds_read_b128 a[156:159], v6 offset:7168
    buffer_load_dwordx4 v2, s[52:55], s72 offen offset:0 sc1 lds
    v_mfma_f32_32x32x16_bf16 a[80:95], a[228:231], v[232:235], a[80:95]
    v_exp_f32 v23, v181
    v_cndmask_b32 v20, 0, v20, s[44:45]
    v_cndmask_b32 v21, 0, v21, s[46:47]
    v_add_f32 v13, v13, v20
    v_add_f32 v13, v13, v21
    v_cvt_pk_bf16_f32 v249, v20, v21
    v_mfma_f32_32x32x16_bf16 a[32:47], a[232:235], v[224:227], a[32:47]
    s_waitcnt lgkmcnt(8)
    ds_read_b128 a[188:191], v7 offset:7168
    v_cmp_ge_i32 s[44:45], v16, 10
    v_cmp_ge_i32 s[46:47], v16, 11
    v_exp_f32 v18, v182
    v_exp_f32 v19, v183
    v_cndmask_b32 v22, 0, v22, s[40:41]
    v_mfma_f32_32x32x16_bf16 a[96:111], a[232:235], v[232:235], a[96:111]
    buffer_load_dwordx4 v2, s[52:55], s72 offen offset:1024 sc1 lds
    v_cndmask_b32 v23, 0, v23, s[42:43]
    v_add_f32 v13, v13, v22
    v_add_f32 v13, v13, v23
    v_cvt_pk_bf16_f32 v250, v22, v23
    v_mfma_f32_32x32x16_bf16 a[48:63], a[236:239], v[224:227], a[48:63]
    v_cmp_ge_i32 s[40:41], v16, 16
    v_cmp_ge_i32 s[42:43], v16, 17
    v_exp_f32 v20, v184
    v_exp_f32 v21, v185
    v_cndmask_b32 v18, 0, v18, s[44:45]
    v_cndmask_b32 v19, 0, v19, s[46:47]
    v_mfma_f32_32x32x16_bf16 a[112:127], a[236:239], v[232:235], a[112:127]
    v_add_f32 v13, v13, v18
    buffer_load_dwordx4 v2, s[52:55], s72 offen offset:2048 sc1 lds
    v_add_f32 v13, v13, v19
    v_cvt_pk_bf16_f32 v251, v18, v19
    v_mfma_f32_32x32x16_bf16 a[0:15], a[240:243], v[228:231], a[0:15]
    v_cmp_ge_i32 s[44:45], v16, 18
    v_cmp_ge_i32 s[46:47], v16, 19
    v_exp_f32 v22, v186
    v_exp_f32 v23, v187
    v_cndmask_b32 v20, 0, v20, s[40:41]
    v_cndmask_b32 v21, 0, v21, s[42:43]
    v_mfma_f32_32x32x16_bf16 a[64:79], a[240:243], v[236:239], a[64:79]
    v_add_f32 v13, v13, v20
    v_add_f32 v13, v13, v21
    v_cvt_pk_bf16_f32 v252, v20, v21
    v_cmp_ge_i32 s[40:41], v16, 24
    buffer_load_dwordx4 v2, s[52:55], s72 offen offset:3072 sc1 lds
    v_mfma_f32_32x32x16_bf16 a[16:31], a[244:247], v[228:231], a[16:31]
    v_cmp_ge_i32 s[42:43], v16, 25
    v_exp_f32 v18, v188
    v_exp_f32 v19, v189
    v_cndmask_b32 v22, 0, v22, s[44:45]
    v_cndmask_b32 v23, 0, v23, s[46:47]
    v_add_f32 v13, v13, v22
    v_mfma_f32_32x32x16_bf16 a[80:95], a[244:247], v[236:239], a[80:95]
    v_add_f32 v13, v13, v23
    v_cvt_pk_bf16_f32 v253, v22, v23
    v_cmp_ge_i32 s[44:45], v16, 26
    v_cmp_ge_i32 s[46:47], v16, 27
    v_exp_f32 v20, v190
    s_add_u32 s72, s72, 0x4000
    v_mfma_f32_32x32x16_bf16 a[32:47], a[248:251], v[228:231], a[32:47]
    v_exp_f32 v21, v191
    v_cndmask_b32 v18, 0, v18, s[40:41]
    v_cndmask_b32 v19, 0, v19, s[42:43]
    v_add_f32 v13, v13, v18
    v_add_f32 v13, v13, v19
    v_cvt_pk_bf16_f32 v254, v18, v19
    v_cndmask_b32 v20, 0, v20, s[44:45]
    v_mfma_f32_32x32x16_bf16 a[96:111], a[248:251], v[236:239], a[96:111]
    v_cndmask_b32 v21, 0, v21, s[46:47]
    v_add_f32 v13, v13, v20
    v_add_f32 v13, v13, v21
    v_cvt_pk_bf16_f32 v255, v20, v21
    v_max_f32 v14, v12, v13
    v_cmp_nge_f32 vcc, s78, v14
    s_mov_b32 s76, 12
    v_add_f32 v10, v24, v12
    v_mfma_f32_32x32x16_bf16 a[48:63], a[252:255], v[228:231], a[48:63]
    v_add_f32 v11, v25, v13
    v_add_u32 v6, 0x4000, v6
    v_and_b32 v6, 0xffff, v6
    v_add_u32 v7, 0x4000, v7
    v_and_b32 v7, 0xffff, v7
    v_or_b32 v7, 0x10000, v7
    s_add_u32 s73, s73, 0x4000
    s_and_b32 s73, s73, 0xffff
    v_mfma_f32_32x32x16_bf16 a[112:127], a[252:255], v[236:239], a[112:127]
    s_cbranch_vccnz K2_RARE1
K2_RET_P3:
    s_add_u32 s75, s75, 64
    s_waitcnt vmcnt(16) lgkmcnt(0)
    s_barrier
    v_mfma_f32_32x32x16_bf16 a[0:15], a[160:163], v[240:243], a[0:15]
    v_subrev_u32 v15, s75, v8
    s_mov_b32 m0, s73
    ds_read_b128 a[192:195], v6 offset:0
    v_cmp_ge_i32 s[40:41], v15, 0
    v_cmp_ge_i32 s[42:43], v15, 1
    v_exp_f32 v18, v128
    v_exp_f32 v19, v129
    v_cmp_ge_i32 s[44:45], v15, 2
    v_cmp_ge_i32 s[46:47], v15, 3
    ds_read_b128 a[224:227], v7 offset:0
    v_exp_f32 v20, v130
    v_exp_f32 v21, v131
    v_mfma_f32_32x32x16_bf16 a[64:79], a[160:163], v[248:251], a[64:79]
    v_cndmask_b32 v18, 0, v18, s[40:41]
    buffer_load_dwordx4 v2, s[48:51], s71 offen offset:0 sc1 lds
    v_cndmask_b32 v19, 0, v19, s[42:43]
    v_add_f32 v12, v18, v19
    v_cvt_pk_bf16_f32 v224, v18, v19
    ds_read_b128 a[196:199], v6 offset:1024
    v_cmp_ge_i32 s[40:41], v15, 8
    v_cmp_ge_i32 s[42:43], v15, 9
    v_exp_f32 v22, v132
    v_exp_f32 v23, v133
    v_cndmask_b32 v20, 0, v20, s[44:45]
    v_mfma_f32_32x32x16_bf16 a[16:31], a[164:167], v[240:243], a[16:31]
    v_cndmask_b32 v21, 0, v21, s[46:47]
    ds_read_b128 a[228:231], v7 offset:1024
    buffer_load_dwordx4 v2, s[48:51], s71 offen offset:1024 sc1 lds
    v_add_f32 v12, v12, v20
    v_add_f32 v12, v12, v21
    v_cvt_pk_bf16_f32 v225, v20, v21
    v_cmp_ge_i32 s[44:45], v15, 10
    v_cmp_ge_i32 s[46:47], v15, 11
    v_exp_f32 v18, v134
    v_exp_f32 v19, v135
    ds_read_b128 a[200:203], v6 offset:2048
    v_mfma_f32_32x32x16_bf16 a[80:95], a[164:167], v[248:251], a[80:95]
    v_cndmask_b32 v22, 0, v22, s[40:41]
    v_cndmask_b32 v23, 0, v23, s[42:43]
    v_add_f32 v12, v12, v22
    v_add_f32 v12, v12, v23
    buffer_load_dwordx4 v2, s[48:51], s71 offen offset:2048 sc1 lds
    v_cvt_pk_bf16_f32 v226, v22, v23
    v_cmp_ge_i32 s[40:41], v15, 16
    ds_read_b128 a[232:235], v7 offset:2048
    v_cmp_ge_i32 s[42:43], v15, 17
    v_exp_f32 v20, v136
    v_exp_f32 v21, v137
    v_cndmask_b32 v18, 0, v18, s[44:45]
    v_mfma_f32_32x32x16_bf16 a[32:47], a[168:171], v[240:243], a[32:47]
    v_cndmask_b32 v19, 0, v19, s[46:47]
    v_add_f32 v12, v12, v18
    ds_read_b128 a[204:207], v6 offset:3072
    v_add_f32 v12, v12, v19
    buffer_load_dwordx4 v2, s[48:51], s71 offen offset:3072 sc1 lds
    v_cvt_pk_bf16_f32 v227, v18, v19
    v_cmp_ge_i32 s[44:45], v15, 18
    v_cmp_ge_i32 s[46:47], v15, 19
    v_exp_f32 v22, v138
    v_exp_f32 v23, v139
    ds_read_b128 a[236:239], v7 offset:3072
    v_mfma_f32_32x32x16_bf16 a[96:111], a[168:171], v[248:251], a[96:111]
    v_cndmask_b32 v20, 0, v20, s[40:41]
    v_cndmask_b32 v21, 0, v21, s[42:43]
    v_add_f32 v12, v12, v20
    v_add_f32 v12, v12, v21
    v_cvt_pk_bf16_f32 v228, v20, v21
    v_cmp_ge_i32 s[40:41], v15, 24
    s_add_u32 s71, s71, 0x4000
    v_cmp_ge_i32 s[42:43], v15, 25
    ds_read_b128 a[208:211], v6 offset:4096
    v_exp_f32 v18, v140
    v_exp_f32 v19, v141
    v_cndmask_b32 v22, 0, v22, s[44:45]
    v_cndmask_b32 v23, 0, v23, s[46:47]
    v_add_f32 v12, v12, v22
    v_mfma_f32_32x32x16_bf16 a[48:63], a[172:175], v[240:243], a[48:63]
    v_add_f32 v12, v12, v23
    ds_read_b128 a[240:243], v7 offset:4096
    v_cvt_pk_bf16_f32 v229, v22, v23
    v_cmp_ge_i32 s[44:45], v15, 26
    s_sub_u32 s61, s73, 0x8000
    v_cmp_ge_i32 s[46:47], v15, 27
    v_exp_f32 v20, v142
    v_exp_f32 v21, v143
    v_cndmask_b32 v18, 0, v18, s[40:41]
    ds_read_b128 a[212:215], v6 offset:5120
    v_cndmask_b32 v19, 0, v19, s[42:43]
    v_add_f32 v12, v12, v18
    v_add_f32 v12, v12, v19
    v_cvt_pk_bf16_f32 v230, v18, v19
    v_mfma_f32_32x32x16_bf16 a[112:127], a[172:175], v[248:251], a[112:127]
    v_cndmask_b32 v20, 0, v20, s[44:45]
    v_cndmask_b32 v21, 0, v21, s[46:47]
    ds_read_b128 a[244:247], v7 offset:5120
    s_and_b32 s61, s61, 0xffff
    v_add_f32 v12, v12, v20
    v_add_f32 v12, v12, v21
    v_cvt_pk_bf16_f32 v231, v20, v21
    v_subrev_u32 v16, s75, v9
    v_cmp_ge_i32 s[40:41], v16, 0
    v_cmp_ge_i32 s[42:43], v16, 1
    v_exp_f32 v18, v144
    ds_read_b128 a[216:219], v6 offset:6144
    v_exp_f32 v19, v145
    v_cmp_ge_i32 s[44:45], v16, 2
    v_mfma_f32_32x32x16_bf16 a[0:15], a[176:179], v[244:247], a[0:15]
    v_cmp_ge_i32 s[46:47], v16, 3
    s_add_u32 m0, s61, 0x10000
    v_exp_f32 v20, v146
    v_exp_f32 v21, v147
    v_cndmask_b32 v18, 0, v18, s[40:41]
    ds_read_b128 a[248:251], v7 offset:6144
    v_cndmask_b32 v19, 0, v19, s[42:43]
    v_add_f32 v13, v18, v19
    v_cvt_pk_bf16_f32 v232, v18, v19
    v_cmp_ge_i32 s[40:41], v16, 8
    v_cmp_ge_i32 s[42:43], v16, 9
    v_exp_f32 v22, v148
    ds_read_b128 a[220:223], v6 offset:7168
    v_mfma_f32_32x32x16_bf16 a[64:79], a[176:179], v[252:255], a[64:79]
    buffer_load_dwordx4 v2, s[52:55], s72 offen offset:0 sc1 lds
    v_exp_f32 v23, v149
    v_cndmask_b32 v20, 0, v20, s[44:45]
    v_cndmask_b32 v21, 0, v21, s[46:47]
    v_add_f32 v13, v13, v20
    v_add_f32 v13, v13, v21
    v_cvt_pk_bf16_f32 v233, v20, v21
    s_waitcnt lgkmcnt(8)
    ds_read_b128 a[252:255], v7 offset:7168
    v_cmp_ge_i32 s[44:45], v16, 10
    v_cmp_ge_i32 s[46:47], v16, 11
    v_exp_f32 v18, v150
    v_mfma_f32_32x32x16_bf16 a[16:31], a[180:183], v[244:247], a[16:31]
    v_exp_f32 v19, v151
    v_cndmask_b32 v22, 0, v22, s[40:41]
    buffer_load_dwordx4 v2, s[52:55], s72 offen offset:1024 sc1 lds
    v_cndmask_b32 v23, 0, v23, s[42:43]
    v_add_f32 v13, v13, v22
    v_add_f32 v13, v13, v23
    v_cvt_pk_bf16_f32 v234, v22, v23
    v_cmp_ge_i32 s[40:41], v16, 16
    v_cmp_ge_i32 s[42:43], v16, 17
    v_exp_f32 v20, v152
    v_exp_f32 v21, v153
    v_mfma_f32_32x32x16_bf16 a[80:95], a[180:183], v[252:255], a[80:95]
    v_cndmask_b32 v18, 0, v18, s[44:45]
    v_cndmask_b32 v19, 0, v19, s[46:47]
    v_add_f32 v13, v13, v18
    buffer_load_dwordx4 v2, s[52:55], s72 offen offset:2048 sc1 lds
    v_add_f32 v13, v13, v19
    v_cvt_pk_bf16_f32 v235, v18, v19
    v_cmp_ge_i32 s[44:45], v16, 18
    v_cmp_ge_i32 s[46:47], v16, 19
    v_exp_f32 v22, v154
    v_exp_f32 v23, v155
    v_cndmask_b32 v20, 0, v20, s[40:41]
    v_mfma_f32_32x32x16_bf16 a[32:47], a[184:187], v[244:247], a[32:47]
    v_cndmask_b32 v21, 0, v21, s[42:43]
    v_add_f32 v13, v13, v20
    v_add_f32 v13, v13, v21
    v_cvt_pk_bf16_f32 v236, v20, v21
    v_cmp_ge_i32 s[40:41], v16, 24
    buffer_load_dwordx4 v2, s[52:55], s72 offen offset:3072 sc1 lds
    v_cmp_ge_i32 s[42:43], v16, 25
    v_exp_f32 v18, v156
    v_exp_f32 v19, v157
    v_cndmask_b32 v22, 0, v22, s[44:45]
    v_cndmask_b32 v23, 0, v23, s[46:47]
    v_mfma_f32_32x32x16_bf16 a[96:111], a[184:187], v[252:255], a[96:111]
    v_add_f32 v13, v13, v22
    v_add_f32 v13, v13, v23
    v_cvt_pk_bf16_f32 v237, v22, v23
    v_cmp_ge_i32 s[44:45], v16, 26
    v_cmp_ge_i32 s[46:47], v16, 27
    v_exp_f32 v20, v158
    s_add_u32 s72, s72, 0x4000
    v_exp_f32 v21, v159
    v_cndmask_b32 v18, 0, v18, s[40:41]
    v_cndmask_b32 v19, 0, v19, s[42:43]
    v_add_f32 v13, v13, v18
    v_add_f32 v13, v13, v19
    v_cvt_pk_bf16_f32 v238, v18, v19
    v_cndmask_b32 v20, 0, v20, s[44:45]
    v_mfma_f32_32x32x16_bf16 a[48:63], a[188:191], v[244:247], a[48:63]
    v_cndmask_b32 v21, 0, v21, s[46:47]
    v_add_f32 v13, v13, v20
    v_add_f32 v13, v13, v21
    v_cvt_pk_bf16_f32 v239, v20, v21
    v_max_f32 v14, v12, v13
    v_cmp_nge_f32 vcc, s78, v14
    s_mov_b32 s76, 13
    v_add_f32 v24, v10, v12
    v_add_f32 v25, v11, v13
    v_add_u32 v6, 0x4000, v6
    v_and_b32 v6, 0xffff, v6
    v_add_u32 v7, 0x4000, v7
    v_and_b32 v7, 0xffff, v7
    v_or_b32 v7, 0x10000, v7
    s_add_u32 s73, s73, 0x4000
    s_and_b32 s73, s73, 0xffff
    v_mfma_f32_32x32x16_bf16 a[112:127], a[188:191], v[252:255], a[112:127]
    s_cbranch_vccnz K2_RARE0
K2_RET_P4:
    s_add_u32 s75, s75, 64
K2_DRAIN:
    s_waitcnt lgkmcnt(0)
    v_mfma_f32_32x32x16_bf16 a[0:15], a[224:227], v[224:227], a[0:15]
    v_mfma_f32_32x32x16_bf16 a[64:79], a[224:227], v[232:235], a[64:79]
    v_mfma_f32_32x32x16_bf16 a[16:31], a[228:231], v[224:227], a[16:31]
    v_mfma_f32_32x32x16_bf16 a[80:95], a[228:231], v[232:235], a[80:95]
    v_mfma_f32_32x32x16_bf16 a[32:47], a[232:235], v[224:227], a[32:47]
    v_mfma_f32_32x32x16_bf16 a[96:111], a[232:235], v[232:235], a[96:111]
    v_mfma_f32_32x32x16_bf16 a[48:63], a[236:239], v[224:227], a[48:63]
    v_mfma_f32_32x32x16_bf16 a[112:127], a[236:239], v[232:235], a[112:127]
    v_mfma_f32_32x32x16_bf16 a[0:15], a[240:243], v[228:231], a[0:15]
    v_mfma_f32_32x32x16_bf16 a[64:79], a[240:243], v[236:239], a[64:79]
    v_mfma_f32_32x32x16_bf16 a[16:31], a[244:247], v[228:231], a[16:31]
    v_mfma_f32_32x32x16_bf16 a[80:95], a[244:247], v[236:239], a[80:95]
    v_mfma_f32_32x32x16_bf16 a[32:47], a[248:251], v[228:231], a[32:47]
    v_mfma_f32_32x32x16_bf16 a[96:111], a[248:251], v[236:239], a[96:111]
    v_mfma_f32_32x32x16_bf16 a[48:63], a[252:255], v[228:231], a[48:63]
    v_mfma_f32_32x32x16_bf16 a[112:127], a[252:255], v[236:239], a[112:127]
    s_mul_i32 s79, s56, 0x4400
    v_add_u32 v26, s79, v2
    v_lshlrev_b32 v3, 2, v1
    v_add_u32 v28, s79, v3
    s_waitcnt vmcnt(0)
    s_barrier
    ds_write_b32 v28, v208 offset:16384
    ds_write_b32 v28, v25 offset:16640
    ds_write_b128 v26, a[64:67] offset:0
    ds_write_b128 v26, a[68:71] offset:1024
    ds_write_b128 v26, a[72:75] offset:2048
    ds_write_b128 v26, a[76:79] offset:3072
    ds_write_b128 v26, a[80:83] offset:4096
    ds_write_b128 v26, a[84:87] offset:5120
    ds_write_b128 v26, a[88:91] offset:6144
    ds_write_b128 v26, a[92:95] offset:7168
    ds_write_b128 v26, a[96:99] offset:8192
    ds_write_b128 v26, a[100:103] offset:9216
    ds_write_b128 v26, a[104:107] offset:10240
    ds_write_b128 v26, a[108:111] offset:11264
    ds_write_b128 v26, a[112:115] offset:12288
    s_waitcnt lgkmcnt(8)
    ds_write_b128 v26, a[116:119] offset:13312
    ds_write_b128 v26, a[120:123] offset:14336
    ds_write_b128 v26, a[124:127] offset:15360
    s_xor_b32 s80, s56, 1
    s_mul_i32 s79, s80, 0x4400
    v_add_u32 v26, s79, v2
    v_add_u32 v28, s79, v3
    s_waitcnt lgkmcnt(0)
    s_barrier
    ds_read_b32 v32, v28 offset:16384
    ds_read_b32 v33, v28 offset:16640
    ds_read_b128 v[128:131], v26 offset:0
    ds_read_b128 v[132:135], v26 offset:1024
    ds_read_b128 v[136:139], v26 offset:2048
    ds_read_b128 v[140:143], v26 offset:3072
    ds_read_b128 v[144:147], v26 offset:4096
    ds_read_b128 v[148:151], v26 offset:5120
    ds_read_b128 v[152:155], v26 offset:6144
    ds_read_b128 v[156:159], v26 offset:7168
    ds_read_b128 v[160:163], v26 offset:8192
    ds_read_b128 v[164:167], v26 offset:9216
    ds_read_b128 v[168:171], v26 offset:10240
    ds_read_b128 v[172:175], v26 offset:11264
    ds_read_b128 v[176:179], v26 offset:12288
    s_waitcnt lgkmcnt(8)
    ds_read_b128 v[180:183], v26 offset:13312
    ds_read_b128 v[184:187], v26 offset:14336
    ds_read_b128 v[188:191], v26 offset:15360
    v_min_f32 v34, v192, v32
    v_sub_f32 v35, v34, v192
    v_sub_f32 v36, v34, v32
    v_exp_f32 v35, v35
    v_exp_f32 v36, v36
    v_mul_f32 v37, v24, v35
    v_fmac_f32 v37, v33, v36
    v_mov_b32 v38, v37
    s_nop 1
    v_permlane32_swap_b32 v37, v38
    v_add_f32 v37, v37, v38
    v_rcp_f32 v37, v37
    s_nop 0
    v_mul_f32 v35, v35, v37
    v_mul_f32 v36, v36, v37
    v_accvgpr_read_b32 v40, a0
    v_accvgpr_read_b32 v41, a1
    v_accvgpr_read_b32 v42, a2
    v_accvgpr_read_b32 v43, a3
    v_accvgpr_read_b32 v44, a4
    v_accvgpr_read_b32 v45, a5
    v_accvgpr_read_b32 v46, a6
    v_accvgpr_read_b32 v47, a7
    v_mul_f32 v40, v40, v35
    v_mul_f32 v41, v41, v35
    v_mul_f32 v42, v42, v35
    v_mul_f32 v43, v43, v35
    v_mul_f32 v44, v44, v35
    v_mul_f32 v45, v45, v35
    v_mul_f32 v46, v46, v35
    v_mul_f32 v47, v47, v35
    v_fmac_f32 v40, v128, v36
    v_fmac_f32 v41, v129, v36
    v_fmac_f32 v42, v130, v36
    v_fmac_f32 v43, v131, v36
    v_fmac_f32 v44, v132, v36
    v_fmac_f32 v45, v133, v36
    v_fmac_f32 v46, v134, v36
    v_fmac_f32 v47, v135, v36
    v_cvt_pk_bf16_f32 v40, v40, v41
    v_cvt_pk_bf16_f32 v41, v42, v43
    v_cvt_pk_bf16_f32 v42, v44, v45
    v_cvt_pk_bf16_f32 v43, v46, v47
    s_add_u32 s60, s69, 0
    buffer_store_dwordx4 v[40:43], v2, s[32:35], s60 offen offset:0 sc1
    v_accvgpr_read_b32 v48, a8
    v_accvgpr_read_b32 v49, a9
    v_accvgpr_read_b32 v50, a10
    v_accvgpr_read_b32 v51, a11
    v_accvgpr_read_b32 v52, a12
    v_accvgpr_read_b32 v53, a13
    v_accvgpr_read_b32 v54, a14
    v_accvgpr_read_b32 v55, a15
    v_mul_f32 v48, v48, v35
    v_mul_f32 v49, v49, v35
    v_mul_f32 v50, v50, v35
    v_mul_f32 v51, v51, v35
    v_mul_f32 v52, v52, v35
    v_mul_f32 v53, v53, v35
    v_mul_f32 v54, v54, v35
    v_mul_f32 v55, v55, v35
    v_fmac_f32 v48, v136, v36
    v_fmac_f32 v49, v137, v36
    v_fmac_f32 v50, v138, v36
    v_fmac_f32 v51, v139, v36
    v_fmac_f32 v52, v140, v36
    v_fmac_f32 v53, v141, v36
    v_fmac_f32 v54, v142, v36
    v_fmac_f32 v55, v143, v36
    v_cvt_pk_bf16_f32 v48, v48, v49
    v_cvt_pk_bf16_f32 v49, v50, v51
    v_cvt_pk_bf16_f32 v50, v52, v53
    v_cvt_pk_bf16_f32 v51, v54, v55
    buffer_store_dwordx4 v[48:51], v2, s[32:35], s60 offen offset:1024 sc1
    v_accvgpr_read_b32 v56, a16
    v_accvgpr_read_b32 v57, a17
    v_accvgpr_read_b32 v58, a18
    v_accvgpr_read_b32 v59, a19
    v_accvgpr_read_b32 v60, a20
    v_accvgpr_read_b32 v61, a21
    v_accvgpr_read_b32 v62, a22
    v_accvgpr_read_b32 v63, a23
    v_mul_f32 v56, v56, v35
    v_mul_f32 v57, v57, v35
    v_mul_f32 v58, v58, v35
    v_mul_f32 v59, v59, v35
    v_mul_f32 v60, v60, v35
    v_mul_f32 v61, v61, v35
    v_mul_f32 v62, v62, v35
    v_mul_f32 v63, v63, v35
    v_fmac_f32 v56, v144, v36
    v_fmac_f32 v57, v145, v36
    v_fmac_f32 v58, v146, v36
    v_fmac_f32 v59, v147, v36
    s_waitcnt lgkmcnt(10)
    v_fmac_f32 v60, v148, v36
    v_fmac_f32 v61, v149, v36
    v_fmac_f32 v62, v150, v36
    v_fmac_f32 v63, v151, v36
    v_cvt_pk_bf16_f32 v56, v56, v57
    v_cvt_pk_bf16_f32 v57, v58, v59
    v_cvt_pk_bf16_f32 v58, v60, v61
    v_cvt_pk_bf16_f32 v59, v62, v63
    buffer_store_dwordx4 v[56:59], v2, s[32:35], s60 offen offset:2048 sc1
    v_accvgpr_read_b32 v40, a24
    v_accvgpr_read_b32 v41, a25
    v_accvgpr_read_b32 v42, a26
    v_accvgpr_read_b32 v43, a27
    v_accvgpr_read_b32 v44, a28
    v_accvgpr_read_b32 v45, a29
    v_accvgpr_read_b32 v46, a30
    v_accvgpr_read_b32 v47, a31
    v_mul_f32 v40, v40, v35
    v_mul_f32 v41, v41, v35
    v_mul_f32 v42, v42, v35
    v_mul_f32 v43, v43, v35
    v_mul_f32 v44, v44, v35
    v_mul_f32 v45, v45, v35
    v_mul_f32 v46, v46, v35
    v_mul_f32 v47, v47, v35
    s_waitcnt lgkmcnt(9)
    v_fmac_f32 v40, v152, v36
    v_fmac_f32 v41, v153, v36
    v_fmac_f32 v42, v154, v36
    v_fmac_f32 v43, v155, v36
    s_waitcnt lgkmcnt(8)
    v_fmac_f32 v44, v156, v36
    v_fmac_f32 v45, v157, v36
    v_fmac_f32 v46, v158, v36
    v_fmac_f32 v47, v159, v36
    v_cvt_pk_bf16_f32 v40, v40, v41
    v_cvt_pk_bf16_f32 v41, v42, v43
    v_cvt_pk_bf16_f32 v42, v44, v45
    v_cvt_pk_bf16_f32 v43, v46, v47
    buffer_store_dwordx4 v[40:43], v2, s[32:35], s60 offen offset:3072 sc1
    v_accvgpr_read_b32 v48, a32
    v_accvgpr_read_b32 v49, a33
    v_accvgpr_read_b32 v50, a34
    v_accvgpr_read_b32 v51, a35
    v_accvgpr_read_b32 v52, a36
    v_accvgpr_read_b32 v53, a37
    v_accvgpr_read_b32 v54, a38
    v_accvgpr_read_b32 v55, a39
    v_mul_f32 v48, v48, v35
    v_mul_f32 v49, v49, v35
    v_mul_f32 v50, v50, v35
    v_mul_f32 v51, v51, v35
    v_mul_f32 v52, v52, v35
    v_mul_f32 v53, v53, v35
    v_mul_f32 v54, v54, v35
    v_mul_f32 v55, v55, v35
    s_waitcnt lgkmcnt(7)
    v_fmac_f32 v48, v160, v36
    v_fmac_f32 v49, v161, v36
    v_fmac_f32 v50, v162, v36
    v_fmac_f32 v51, v163, v36
    s_waitcnt lgkmcnt(6)
    v_fmac_f32 v52, v164, v36
    v_fmac_f32 v53, v165, v36
    v_fmac_f32 v54, v166, v36
    v_fmac_f32 v55, v167, v36
    v_cvt_pk_bf16_f32 v48, v48, v49
    v_cvt_pk_bf16_f32 v49, v50, v51
    v_cvt_pk_bf16_f32 v50, v52, v53
    v_cvt_pk_bf16_f32 v51, v54, v55
    s_add_u32 s60, s69, 0x1000
    buffer_store_dwordx4 v[48:51], v2, s[32:35], s60 offen offset:0 sc1
    v_accvgpr_read_b32 v56, a40
    v_accvgpr_read_b32 v57, a41
    v_accvgpr_read_b32 v58, a42
    v_accvgpr_read_b32 v59, a43
    v_accvgpr_read_b32 v60, a44
    v_accvgpr_read_b32 v61, a45
    v_accvgpr_read_b32 v62, a46
    v_accvgpr_read_b32 v63, a47
    v_mul_f32 v56, v56, v35
    v_mul_f32 v57, v57, v35
    v_mul_f32 v58, v58, v35
    v_mul_f32 v59, v59, v35
    v_mul_f32 v60, v60, v35
    v_mul_f32 v61, v61, v35
    v_mul_f32 v62, v62, v35
    v_mul_f32 v63, v63, v35
    s_waitcnt lgkmcnt(5)
    v_fmac_f32 v56, v168, v36
    v_fmac_f32 v57, v169, v36
    v_fmac_f32 v58, v170, v36
    v_fmac_f32 v59, v171, v36
    s_waitcnt lgkmcnt(4)
    v_fmac_f32 v60, v172, v36
    v_fmac_f32 v61, v173, v36
    v_fmac_f32 v62, v174, v36
    v_fmac_f32 v63, v175, v36
    v_cvt_pk_bf16_f32 v56, v56, v57
    v_cvt_pk_bf16_f32 v57, v58, v59
    v_cvt_pk_bf16_f32 v58, v60, v61
    v_cvt_pk_bf16_f32 v59, v62, v63
    buffer_store_dwordx4 v[56:59], v2, s[32:35], s60 offen offset:1024 sc1
    v_accvgpr_read_b32 v40, a48
    v_accvgpr_read_b32 v41, a49
    v_accvgpr_read_b32 v42, a50
    v_accvgpr_read_b32 v43, a51
    v_accvgpr_read_b32 v44, a52
    v_accvgpr_read_b32 v45, a53
    v_accvgpr_read_b32 v46, a54
    v_accvgpr_read_b32 v47, a55
    v_mul_f32 v40, v40, v35
    v_mul_f32 v41, v41, v35
    v_mul_f32 v42, v42, v35
    v_mul_f32 v43, v43, v35
    v_mul_f32 v44, v44, v35
    v_mul_f32 v45, v45, v35
    v_mul_f32 v46, v46, v35
    v_mul_f32 v47, v47, v35
    s_waitcnt lgkmcnt(3)
    v_fmac_f32 v40, v176, v36
    v_fmac_f32 v41, v177, v36
    v_fmac_f32 v42, v178, v36
    v_fmac_f32 v43, v179, v36
    s_waitcnt lgkmcnt(2)
    v_fmac_f32 v44, v180, v36
    v_fmac_f32 v45, v181, v36
    v_fmac_f32 v46, v182, v36
    v_fmac_f32 v47, v183, v36
    v_cvt_pk_bf16_f32 v40, v40, v41
    v_cvt_pk_bf16_f32 v41, v42, v43
    v_cvt_pk_bf16_f32 v42, v44, v45
    v_cvt_pk_bf16_f32 v43, v46, v47
    buffer_store_dwordx4 v[40:43], v2, s[32:35], s60 offen offset:2048 sc1
    v_accvgpr_read_b32 v48, a56
    v_accvgpr_read_b32 v49, a57
    v_accvgpr_read_b32 v50, a58
    v_accvgpr_read_b32 v51, a59
    v_accvgpr_read_b32 v52, a60
    v_accvgpr_read_b32 v53, a61
    v_accvgpr_read_b32 v54, a62
    v_accvgpr_read_b32 v55, a63
    v_mul_f32 v48, v48, v35
    v_mul_f32 v49, v49, v35
    v_mul_f32 v50, v50, v35
    v_mul_f32 v51, v51, v35
    v_mul_f32 v52, v52, v35
    v_mul_f32 v53, v53, v35
    v_mul_f32 v54, v54, v35
    v_mul_f32 v55, v55, v35
    s_waitcnt lgkmcnt(1)
    v_fmac_f32 v48, v184, v36
    v_fmac_f32 v49, v185, v36
    v_fmac_f32 v50, v186, v36
    v_fmac_f32 v51, v187, v36
    s_waitcnt lgkmcnt(0)
    v_fmac_f32 v52, v188, v36
    v_fmac_f32 v53, v189, v36
    v_fmac_f32 v54, v190, v36
    v_fmac_f32 v55, v191, v36
    v_cvt_pk_bf16_f32 v48, v48, v49
    v_cvt_pk_bf16_f32 v49, v50, v51
    v_cvt_pk_bf16_f32 v50, v52, v53
    v_cvt_pk_bf16_f32 v51, v54, v55
    buffer_store_dwordx4 v[48:51], v2, s[32:35], s60 offen offset:3072 sc1
    s_lshl_b32 s73, s58, 7
    s_sub_u32 s72, 0x4800780, s73
    s_add_u32 s73, s73, 0x4800000
    s_barrier
    v_and_b32 v1, 63, v0
    v_lshrrev_b32 v3, 6, v0
    v_lshlrev_b32 v2, 4, v1
    v_readfirstlane_b32 s56, v3
    s_and_b32 s57, s2, 1
    s_bfe_u32 s64, s2, 0x20001
    s_lshl_b32 s64, s64, 2
    s_bfe_u32 s65, s2, 0x20003
    s_add_u32 s58, s64, s65
    s_lshr_b32 s59, s2, 5
    v_lshrrev_b32 v3, 3, v1
    v_mul_u32_u24 v3, 0x400, v3
    v_bfe_u32 v4, v1, 4, 1
    v_lshlrev_b32 v4, 2, v4
    v_xor_b32 v4, v4, v1
    v_and_b32 v4, 7, v4
    v_lshlrev_b32 v4, 4, v4
    v_add_u32 v8, v3, v4
    v_add_u32 v9, 0x1c00, v8
    v_add_u32 v10, 0x1c00, v9
    v_add_u32 v11, 0x1c00, v10
    s_lshl_b32 s64, s58, 2
    s_add_u32 s64, s64, s56
    s_mul_i32 s60, s64, 0x5c000
    s_add_u32 s60, s60, 0x2200000
    s_lshl_b32 s64, s56, 15
    s_lshl_b32 s65, s59, 7
    s_add_u32 s61, s64, s65
    s_lshl_b32 s63, s56, 12
    s_lshl_b32 s74, s58, 7
    s_add_u32 s74, s74, 0x4800000
    s_add_u32 s75, s74, 0x800
    s_mov_b32 s32, s28
    s_mov_b32 s33, s29
    s_mov_b32 s34, 0x10000000
    s_mov_b32 s35, 0x20000
    buffer_load_dword v18, off, s[32:35], s75 sc1
    s_mov_b32 s36, s14
    s_mov_b32 s37, s15
    s_mov_b32 s38, 0x400000
    s_mov_b32 s39, 0x20000
    s_mov_b32 s40, s22
    s_mov_b32 s41, s23
    s_mov_b32 s42, 0x1c0000
    s_mov_b32 s43, 0x20000
    s_cmp_eq_u32 s57, 1
    s_cbranch_scc1 K3_CONS
    s_add_u32 m0, s63, 0
    s_add_u32 s67, s61, 0
    buffer_load_dwordx4 v8, s[40:43], s67 offen offset:0 lds
    buffer_load_dwordx4 v9, s[40:43], s67 offen offset:1024 lds
    buffer_load_dwordx4 v10, s[40:43], s67 offen offset:2048 lds
    buffer_load_dwordx4 v11, s[40:43], s67 offen offset:3072 lds
    s_add_u32 m0, s63, 0x4000
    s_add_u32 s67, s61, 0x20000
    buffer_load_dwordx4 v8, s[40:43], s67 offen offset:0 lds
    buffer_load_dwordx4 v9, s[40:43], s67 offen offset:1024 lds
    buffer_load_dwordx4 v10, s[40:43], s67 offen offset:2048 lds
    buffer_load_dwordx4 v11, s[40:43], s67 offen offset:3072 lds
    v_lshrrev_b32 v3, 5, v1
    v_lshlrev_b32 v3, 9, v3
    v_bfe_u32 v4, v1, 2, 2
    v_lshlrev_b32 v4, 7, v4
    v_add_u32 v3, v3, v4
    v_bfe_u32 v4, v1, 4, 1
    v_lshlrev_b32 v4, 5, v4
    v_add_u32 v3, v3, v4
    v_and_b32 v4, 3, v1
    v_lshlrev_b32 v4, 3, v4
    v_add_u32 v3, v3, v4
    v_bfe_u32 v5, v1, 3, 1
    v_lshlrev_b32 v5, 6, v5
    v_add_u32 v6, v3, v5
    v_xor_b32 v5, 64, v5
    v_add_u32 v7, v3, v5
    v_add_u32 v12, 0x10000, v6
    v_add_u32 v13, 0x10000, v7
    s_mov_b32 s44, s4
    s_mov_b32 s45, s5
    s_mov_b32 s46, 0x200000
    s_mov_b32 s47, 0x20000
    s_mov_b32 s48, s24
    s_mov_b32 s49, s25
    s_mov_b32 s50, 0x200000
    s_mov_b32 s51, 0x20000
    s_lshl_b32 s64, s58, 3
    s_add_u32 s64, s64, s59
    s_lshl_b32 s69, s64, 2
    s_add_u32 s69, s69, s56
    s_lshl_b32 s69, s69, 13
    s_add_u32 s69, s69, 0x4000000
    s_lshl_b32 s65, s64, 7
    s_add_u32 s65, s65, 0x4801000
    s_mov_b32 s71, 0
    v_mov_b32 v15, s65
    s_lshl_b32 s64, 1, s71
    v_mov_b32 v16, s64
    s_lshl_b32 s68, s58, 2
    s_add_u32 s68, s68, s56
    s_lshl_b32 s68, s68, 15
    s_lshl_b32 s64, s59, 7
    s_add_u32 s68, s68, s64
    v_and_b32 v3, 31, v1
    v_lshlrev_b32 v3, 10, v3
    v_lshrrev_b32 v4, 5, v1
    v_lshlrev_b32 v4, 3, v4
    v_add_u32 v14, v3, v4
    s_waitcnt vmcnt(8)
    v_readfirstlane_b32 s64, v18
    s_nop 0
    s_cmp_ge_u32 s64, 32
    s_cbranch_scc1 L_pollx_h0
    s_mov_b32 s70, 0x10000
L_poll_h0:
    buffer_load_dword v18, off, s[32:35], s75 sc1
    s_waitcnt vmcnt(0)
    v_readfirstlane_b32 s64, v18
    s_sub_u32 s70, s70, 1
    s_cmp_eq_u32 s70, 0
    s_cbranch_scc1 L_pollx_h0
    s_cmp_ge_u32 s64, 32
    s_cbranch_scc1 L_pollx_h0
    s_sleep 16
    s_branch L_poll_h0
L_pollx_h0:
    s_add_u32 s66, s60, 0x40000
    buffer_load_dwordx4 a[0:3], v2, s[32:35], s66 offen offset:0
    buffer_load_dwordx4 a[4:7], v2, s[32:35], s66 offen offset:1024
    buffer_load_dwordx4 a[8:11], v2, s[32:35], s66 offen offset:2048
    buffer_load_dwordx4 a[12:15], v2, s[32:35], s66 offen offset:3072
    s_add_u32 s66, s60, 0x41000
    buffer_load_dwordx4 a[16:19], v2, s[32:35], s66 offen offset:0
    buffer_load_dwordx4 a[20:23], v2, s[32:35], s66 offen offset:1024
    buffer_load_dwordx4 a[24:27], v2, s[32:35], s66 offen offset:2048
    buffer_load_dwordx4 a[28:31], v2, s[32:35], s66 offen offset:3072
    s_add_u32 s66, s60, 0x42000
    buffer_load_dwordx4 a[32:35], v2, s[32:35], s66 offen offset:0
    buffer_load_dwordx4 a[36:39], v2, s[32:35], s66 offen offset:1024
    buffer_load_dwordx4 a[40:43], v2, s[32:35], s66 offen offset:2048
    buffer_load_dwordx4 a[44:47], v2, s[32:35], s66 offen offset:3072
    s_add_u32 s66, s60, 0x43000
    buffer_load_dwordx4 a[48:51], v2, s[32:35], s66 offen offset:0
    buffer_load_dwordx4 a[52:55], v2, s[32:35], s66 offen offset:1024
    buffer_load_dwordx4 a[56:59], v2, s[32:35], s66 offen offset:2048
    buffer_load_dwordx4 a[60:63], v2, s[32:35], s66 offen offset:3072
    s_add_u32 s66, s60, 0x44000
    buffer_load_dwordx4 a[64:67], v2, s[32:35], s66 offen offset:0
    buffer_load_dwordx4 a[68:71], v2, s[32:35], s66 offen offset:1024
    buffer_load_dwordx4 a[72:75], v2, s[32:35], s66 offen offset:2048
    buffer_load_dwordx4 a[76:79], v2, s[32:35], s66 offen offset:3072
    s_waitcnt vmcnt(24)
    s_barrier
    s_cmp_lg_u32 s56, 0
    s_cbranch_scc1 K3_SG0
    s_mov_b64 exec, 1
    v_mov_b32 v19, 1
    buffer_atomic_add v19, off, s[32:35], s72
    buffer_atomic_add v19, off, s[32:35], s73
    s_mov_b64 exec, -1
K3_SG0:
    ds_read_b64_tr_b16 v[20:21], v6 offset:0
    ds_read_b64_tr_b16 v[22:23], v6 offset:1024
    ds_read_b64_tr_b16 v[24:25], v7 offset:0
    ds_read_b64_tr_b16 v[26:27], v7 offset:1024
    s_waitcnt vmcnt(19) lgkmcnt(2)
    v_mfma_f32_32x32x16_bf16 v[96:111], v[20:23], a[0:3], 0
    ds_read_b64_tr_b16 v[28:29], v6 offset:2048
    ds_read_b64_tr_b16 v[30:31], v6 offset:3072
    s_add_u32 m0, s63, 0x8000
    s_add_u32 s67, s61, 0x40000
    buffer_load_dwordx4 v8, s[40:43], s67 offen offset:0 lds
    s_waitcnt lgkmcnt(2)
    v_mfma_f32_32x32x16_bf16 v[112:127], v[24:27], a[0:3], 0
    ds_read_b64_tr_b16 v[32:33], v7 offset:2048
    ds_read_b64_tr_b16 v[34:35], v7 offset:3072
    s_add_u32 s66, s60, 0x45000
    buffer_load_dwordx4 a[0:3], v2, s[32:35], s66 offen offset:0
    s_waitcnt vmcnt(20) lgkmcnt(2)
    v_mfma_f32_32x32x16_bf16 v[96:111], v[28:31], a[4:7], v[96:111]
    ds_read_b64_tr_b16 v[20:21], v6 offset:4096
    ds_read_b64_tr_b16 v[22:23], v6 offset:5120
    buffer_load_dwordx4 v9, s[40:43], s67 offen offset:1024 lds
    s_waitcnt lgkmcnt(2)
    v_mfma_f32_32x32x16_bf16 v[112:127], v[32:35], a[4:7], v[112:127]
    ds_read_b64_tr_b16 v[24:25], v7 offset:4096
    ds_read_b64_tr_b16 v[26:27], v7 offset:5120
    buffer_load_dwordx4 a[4:7], v2, s[32:35], s66 offen offset:1024
    s_waitcnt vmcnt(21) lgkmcnt(2)
    v_mfma_f32_32x32x16_bf16 v[96:111], v[20:23], a[8:11], v[96:111]
    ds_read_b64_tr_b16 v[28:29], v6 offset:6144
    ds_read_b64_tr_b16 v[30:31], v6 offset:7168
    buffer_load_dwordx4 v10, s[40:43], s67 offen offset:2048 lds
    s_waitcnt lgkmcnt(2)
    v_mfma_f32_32x32x16_bf16 v[112:127], v[24:27], a[8:11], v[112:127]
    ds_read_b64_tr_b16 v[32:33], v7 offset:6144
    ds_read_b64_tr_b16 v[34:35], v7 offset:7168
    buffer_load_dwordx4 a[8:11], v2, s[32:35], s66 offen offset:2048
    s_waitcnt vmcnt(22) lgkmcnt(2)
    v_mfma_f32_32x32x16_bf16 v[96:111], v[28:31], a[12:15], v[96:111]
    ds_read_b64_tr_b16 v[20:21], v6 offset:8192
    ds_read_b64_tr_b16 v[22:23], v6 offset:9216
    buffer_load_dwordx4 v11, s[40:43], s67 offen offset:3072 lds
    s_waitcnt lgkmcnt(2)
    v_mfma_f32_32x32x16_bf16 v[112:127], v[32:35], a[12:15], v[112:127]
    ds_read_b64_tr_b16 v[24:25], v7 offset:8192
    ds_read_b64_tr_b16 v[26:27], v7 offset:9216
    buffer_load_dwordx4 a[12:15], v2, s[32:35], s66 offen offset:3072
    s_waitcnt vmcnt(23) lgkmcnt(2)
    v_mfma_f32_32x32x16_bf16 v[96:111], v[20:23], a[16:19], v[96:111]
    ds_read_b64_tr_b16 v[28:29], v6 offset:10240
    ds_read_b64_tr_b16 v[30:31], v6 offset:11264
    s_add_u32 m0, s63, 0xc000
    s_add_u32 s67, s61, 0x60000
    buffer_load_dwordx4 v8, s[40:43], s67 offen offset:0 lds
    s_waitcnt lgkmcnt(2)
    v_mfma_f32_32x32x16_bf16 v[112:127], v[24:27], a[16:19], v[112:127]
    ds_read_b64_tr_b16 v[32:33], v7 offset:10240
    ds_read_b64_tr_b16 v[34:35], v7 offset:11264
    s_add_u32 s66, s60, 0x46000
    buffer_load_dwordx4 a[16:19], v2, s[32:35], s66 offen offset:0
    s_waitcnt vmcnt(24) lgkmcnt(2)
    v_mfma_f32_32x32x16_bf16 v[96:111], v[28:31], a[20:23], v[96:111]
    ds_read_b64_tr_b16 v[20:21], v6 offset:12288
    ds_read_b64_tr_b16 v[22:23], v6 offset:13312
    buffer_load_dwordx4 v9, s[40:43], s67 offen offset:1024 lds
    s_waitcnt lgkmcnt(2)
    v_mfma_f32_32x32x16_bf16 v[112:127], v[32:35], a[20:23], v[112:127]
    ds_read_b64_tr_b16 v[24:25], v7 offset:12288
    ds_read_b64_tr_b16 v[26:27], v7 offset:13312
    buffer_load_dwordx4 a[20:23], v2, s[32:35], s66 offen offset:1024
    s_waitcnt vmcnt(25) lgkmcnt(2)
    v_mfma_f32_32x32x16_bf16 v[96:111], v[20:23], a[24:27], v[96:111]
    ds_read_b64_tr_b16 v[28:29], v6 offset:14336
    ds_read_b64_tr_b16 v[30:31], v6 offset:15360
    buffer_load_dwordx4 v10, s[40:43], s67 offen offset:2048 lds
    s_waitcnt lgkmcnt(2)
    v_mfma_f32_32x32x16_bf16 v[112:127], v[24:27], a[24:27], v[112:127]
    ds_read_b64_tr_b16 v[32:33], v7 offset:14336
    ds_read_b64_tr_b16 v[34:35], v7 offset:15360
    buffer_load_dwordx4 a[24:27], v2, s[32:35], s66 offen offset:2048
    s_waitcnt lgkmcnt(0)
    s_barrier
    s_waitcnt vmcnt(26)
    v_mfma_f32_32x32x16_bf16 v[96:111], v[28:31], a[28:31], v[96:111]
    ds_read_b64_tr_b16 v[20:21], v6 offset:16384
    ds_read_b64_tr_b16 v[22:23], v6 offset:17408
    buffer_load_dwordx4 v11, s[40:43], s67 offen offset:3072 lds
    v_mfma_f32_32x32x16_bf16 v[112:127], v[32:35], a[28:31], v[112:127]
    ds_read_b64_tr_b16 v[24:25], v7 offset:16384
    ds_read_b64_tr_b16 v[26:27], v7 offset:17408
    buffer_load_dwordx4 a[28:31], v2, s[32:35], s66 offen offset:3072
    s_waitcnt vmcnt(27) lgkmcnt(2)
    v_mfma_f32_32x32x16_bf16 v[96:111], v[20:23], a[32:35], v[96:111]
    ds_read_b64_tr_b16 v[28:29], v6 offset:18432
    ds_read_b64_tr_b16 v[30:31], v6 offset:19456
    s_add_u32 m0, s63, 0x10000
    s_add_u32 s67, s61, 0x80000
    buffer_load_dwordx4 v8, s[40:43], s67 offen offset:0 lds
    s_waitcnt lgkmcnt(2)
    v_mfma_f32_32x32x16_bf16 v[112:127], v[24:27], a[32:35], v[112:127]
    ds_read_b64_tr_b16 v[32:33], v7 offset:18432
    ds_read_b64_tr_b16 v[34:35], v7 offset:19456
    s_add_u32 s66, s60, 0x47000
    buffer_load_dwordx4 a[32:35], v2, s[32:35], s66 offen offset:0
    s_waitcnt vmcnt(28) lgkmcnt(2)
    v_mfma_f32_32x32x16_bf16 v[96:111], v[28:31], a[36:39], v[96:111]
    ds_read_b64_tr_b16 v[20:21], v6 offset:20480
    ds_read_b64_tr_b16 v[22:23], v6 offset:21504
    buffer_load_dwordx4 v9, s[40:43], s67 offen offset:1024 lds
    s_waitcnt lgkmcnt(2)
    v_mfma_f32_32x32x16_bf16 v[112:127], v[32:35], a[36:39], v[112:127]
    ds_read_b64_tr_b16 v[24:25], v7 offset:20480
    ds_read_b64_tr_b16 v[26:27], v7 offset:21504
    buffer_load_dwordx4 a[36:39], v2, s[32:35], s66 offen offset:1024
    s_waitcnt vmcnt(29) lgkmcnt(2)
    v_mfma_f32_32x32x16_bf16 v[96:111], v[20:23], a[40:43], v[96:111]
    ds_read_b64_tr_b16 v[28:29], v6 offset:22528
    ds_read_b64_tr_b16 v[30:31], v6 offset:23552
    buffer_load_dwordx4 v10, s[40:43], s67 offen offset:2048 lds
    s_waitcnt lgkmcnt(2)
    v_mfma_f32_32x32x16_bf16 v[112:127], v[24:27], a[40:43], v[112:127]
    ds_read_b64_tr_b16 v[32:33], v7 offset:22528
    ds_read_b64_tr_b16 v[34:35], v7 offset:23552
    buffer_load_dwordx4 a[40:43], v2, s[32:35], s66 offen offset:2048
    s_waitcnt vmcnt(30) lgkmcnt(2)
    v_mfma_f32_32x32x16_bf16 v[96:111], v[28:31], a[44:47], v[96:111]
    ds_read_b64_tr_b16 v[20:21], v6 offset:24576
    ds_read_b64_tr_b16 v[22:23], v6 offset:25600
    buffer_load_dwordx4 v11, s[40:43], s67 offen offset:3072 lds
    s_waitcnt lgkmcnt(2)
    v_mfma_f32_32x32x16_bf16 v[112:127], v[32:35], a[44:47], v[112:127]
    ds_read_b64_tr_b16 v[24:25], v7 offset:24576
    ds_read_b64_tr_b16 v[26:27], v7 offset:25600
    buffer_load_dwordx4 a[44:47], v2, s[32:35], s66 offen offset:3072
    s_waitcnt vmcnt(31) lgkmcnt(2)
    v_mfma_f32_32x32x16_bf16 v[96:111], v[20:23], a[48:51], v[96:111]
    ds_read_b64_tr_b16 v[28:29], v6 offset:26624
    ds_read_b64_tr_b16 v[30:31], v6 offset:27648
    s_add_u32 m0, s63, 0x14000
    s_add_u32 s67, s61, 0xa0000
    buffer_load_dwordx4 v8, s[40:43], s67 offen offset:0 lds
    s_waitcnt lgkmcnt(2)
    v_mfma_f32_32x32x16_bf16 v[112:127], v[24:27], a[48:51], v[112:127]
    ds_read_b64_tr_b16 v[32:33], v7 offset:26624
    ds_read_b64_tr_b16 v[34:35], v7 offset:27648
    s_add_u32 s66, s60, 0x48000
    buffer_load_dwordx4 a[48:51], v2, s[32:35], s66 offen offset:0
    s_waitcnt vmcnt(32) lgkmcnt(2)
    v_mfma_f32_32x32x16_bf16 v[96:111], v[28:31], a[52:55], v[96:111]
    ds_read_b64_tr_b16 v[20:21], v6 offset:28672
    ds_read_b64_tr_b16 v[22:23], v6 offset:29696
    buffer_load_dwordx4 v9, s[40:43], s67 offen offset:1024 lds
    s_waitcnt lgkmcnt(2)
    v_mfma_f32_32x32x16_bf16 v[112:127], v[32:35], a[52:55], v[112:127]
    ds_read_b64_tr_b16 v[24:25], v7 offset:28672
    ds_read_b64_tr_b16 v[26:27], v7 offset:29696
    buffer_load_dwordx4 a[52:55], v2, s[32:35], s66 offen offset:1024
    s_waitcnt vmcnt(33) lgkmcnt(2)
    v_mfma_f32_32x32x16_bf16 v[96:111], v[20:23], a[56:59], v[96:111]
    ds_read_b64_tr_b16 v[28:29], v6 offset:30720
    ds_read_b64_tr_b16 v[30:31], v6 offset:31744
    buffer_load_dwordx4 v10, s[40:43], s67 offen offset:2048 lds
    s_waitcnt lgkmcnt(2)
    v_mfma_f32_32x32x16_bf16 v[112:127], v[24:27], a[56:59], v[112:127]
    ds_read_b64_tr_b16 v[32:33], v7 offset:30720
    ds_read_b64_tr_b16 v[34:35], v7 offset:31744
    buffer_load_dwordx4 a[56:59], v2, s[32:35], s66 offen offset:2048
    s_waitcnt lgkmcnt(0)
    s_waitcnt vmcnt(23)
    s_barrier
    v_mfma_f32_32x32x16_bf16 v[96:111], v[28:31], a[60:63], v[96:111]
    ds_read_b64_tr_b16 v[20:21], v6 offset:32768
    ds_read_b64_tr_b16 v[22:23], v6 offset:33792
    buffer_load_dwordx4 v11, s[40:43], s67 offen offset:3072 lds
    v_mfma_f32_32x32x16_bf16 v[112:127], v[32:35], a[60:63], v[112:127]
    ds_read_b64_tr_b16 v[24:25], v7 offset:32768
    ds_read_b64_tr_b16 v[26:27], v7 offset:33792
    buffer_load_dwordx4 a[60:63], v2, s[32:35], s66 offen offset:3072
    s_waitcnt lgkmcnt(2)
    v_mfma_f32_32x32x16_bf16 v[96:111], v[20:23], a[64:67], v[96:111]
    ds_read_b64_tr_b16 v[28:29], v6 offset:34816
    ds_read_b64_tr_b16 v[30:31], v6 offset:35840
    s_add_u32 m0, s63, 0
    s_add_u32 s67, s61, 0xc0000
    buffer_load_dwordx4 v8, s[40:43], s67 offen offset:0 lds
    s_waitcnt lgkmcnt(2)
    v_mfma_f32_32x32x16_bf16 v[112:127], v[24:27], a[64:67], v[112:127]
    ds_read_b64_tr_b16 v[32:33], v7 offset:34816
    ds_read_b64_tr_b16 v[34:35], v7 offset:35840
    s_add_u32 s66, s60, 0x49000
    buffer_load_dwordx4 a[64:67], v2, s[32:35], s66 offen offset:0
    s_waitcnt lgkmcnt(2)
    v_mfma_f32_32x32x16_bf16 v[96:111], v[28:31], a[68:71], v[96:111]
    ds_read_b64_tr_b16 v[20:21], v6 offset:36864
    ds_read_b64_tr_b16 v[22:23], v6 offset:37888
    buffer_load_dwordx4 v9, s[40:43], s67 offen offset:1024 lds
    s_waitcnt lgkmcnt(2)
    v_mfma_f32_32x32x16_bf16 v[112:127], v[32:35], a[68:71], v[112:127]
    ds_read_b64_tr_b16 v[24:25], v7 offset:36864
    ds_read_b64_tr_b16 v[26:27], v7 offset:37888
    buffer_load_dwordx4 a[68:71], v2, s[32:35], s66 offen offset:1024
    s_waitcnt lgkmcnt(2)
    v_mfma_f32_32x32x16_bf16 v[96:111], v[20:23], a[72:75], v[96:111]
    ds_read_b64_tr_b16 v[28:29], v6 offset:38912
    ds_read_b64_tr_b16 v[30:31], v6 offset:39936
    buffer_load_dwordx4 v10, s[40:43], s67 offen offset:2048 lds
    s_waitcnt lgkmcnt(2)
    v_mfma_f32_32x32x16_bf16 v[112:127], v[24:27], a[72:75], v[112:127]
    ds_read_b64_tr_b16 v[32:33], v7 offset:38912
    ds_read_b64_tr_b16 v[34:35], v7 offset:39936
    buffer_load_dwordx4 a[72:75], v2, s[32:35], s66 offen offset:2048
    s_waitcnt lgkmcnt(2)
    v_mfma_f32_32x32x16_bf16 v[96:111], v[28:31], a[76:79], v[96:111]
    ds_read_b64_tr_b16 v[20:21], v6 offset:40960
    ds_read_b64_tr_b16 v[22:23], v6 offset:41984
    s_waitcnt lgkmcnt(2)
    v_mfma_f32_32x32x16_bf16 v[112:127], v[32:35], a[76:79], v[112:127]
    ds_read_b64_tr_b16 v[24:25], v7 offset:40960
    ds_read_b64_tr_b16 v[26:27], v7 offset:41984
    buffer_load_dwordx4 a[76:79], v2, s[32:35], s66 offen offset:3072
    s_waitcnt lgkmcnt(2)
    v_mfma_f32_32x32x16_bf16 v[96:111], v[20:23], a[0:3], v[96:111]
    ds_read_b64_tr_b16 v[28:29], v6 offset:43008
    ds_read_b64_tr_b16 v[30:31], v6 offset:44032
    buffer_load_dwordx4 v11, s[40:43], s67 offen offset:3072 lds
    s_waitcnt lgkmcnt(2)
    v_mfma_f32_32x32x16_bf16 v[112:127], v[24:27], a[0:3], v[112:127]
    ds_read_b64_tr_b16 v[32:33], v7 offset:43008
    ds_read_b64_tr_b16 v[34:35], v7 offset:44032
    s_add_u32 s66, s60, 0x4a000
    buffer_load_dwordx4 a[0:3], v2, s[32:35], s66 offen offset:0
    s_waitcnt lgkmcnt(2)
    v_mfma_f32_32x32x16_bf16 v[96:111], v[28:31], a[4:7], v[96:111]
    ds_read_b64_tr_b16 v[20:21], v6 offset:45056
    ds_read_b64_tr_b16 v[22:23], v6 offset:46080
    s_waitcnt lgkmcnt(2)
    v_mfma_f32_32x32x16_bf16 v[112:127], v[32:35], a[4:7], v[112:127]
    ds_read_b64_tr_b16 v[24:25], v7 offset:45056
    ds_read_b64_tr_b16 v[26:27], v7 offset:46080
    buffer_load_dwordx4 a[4:7], v2, s[32:35], s66 offen offset:1024
    s_waitcnt lgkmcnt(2)
    v_mfma_f32_32x32x16_bf16 v[96:111], v[20:23], a[8:11], v[96:111]
    ds_read_b64_tr_b16 v[28:29], v6 offset:47104
    ds_read_b64_tr_b16 v[30:31], v6 offset:48128
    s_add_u32 m0, s63, 0x4000
    s_add_u32 s67, s61, 0
    buffer_load_dwordx4 v8, s[36:39], s67 offen offset:0 lds
    s_waitcnt lgkmcnt(2)
    v_mfma_f32_32x32x16_bf16 v[112:127], v[24:27], a[8:11], v[112:127]
    ds_read_b64_tr_b16 v[32:33], v7 offset:47104
    ds_read_b64_tr_b16 v[34:35], v7 offset:48128
    buffer_load_dwordx4 a[8:11], v2, s[32:35], s66 offen offset:2048
    s_waitcnt lgkmcnt(0)
    s_waitcnt vmcnt(29)
    s_barrier
    v_mfma_f32_32x32x16_bf16 v[96:111], v[28:31], a[12:15], v[96:111]
    ds_read_b64_tr_b16 v[20:21], v6 offset:49152
    ds_read_b64_tr_b16 v[22:23], v6 offset:50176
    buffer_load_dwordx4 v9, s[36:39], s67 offen offset:1024 lds
    v_mfma_f32_32x32x16_bf16 v[112:127], v[32:35], a[12:15], v[112:127]
    ds_read_b64_tr_b16 v[24:25], v7 offset:49152
    ds_read_b64_tr_b16 v[26:27], v7 offset:50176
    buffer_load_dwordx4 a[12:15], v2, s[32:35], s66 offen offset:3072
    s_waitcnt lgkmcnt(2)
    v_mfma_f32_32x32x16_bf16 v[96:111], v[20:23], a[16:19], v[96:111]
    ds_read_b64_tr_b16 v[28:29], v6 offset:51200
    ds_read_b64_tr_b16 v[30:31], v6 offset:52224
    buffer_load_dwordx4 v10, s[36:39], s67 offen offset:2048 lds
    s_waitcnt lgkmcnt(2)
    v_mfma_f32_32x32x16_bf16 v[112:127], v[24:27], a[16:19], v[112:127]
    ds_read_b64_tr_b16 v[32:33], v7 offset:51200
    ds_read_b64_tr_b16 v[34:35], v7 offset:52224
    s_add_u32 s66, s60, 0x4b000
    buffer_load_dwordx4 a[16:19], v2, s[32:35], s66 offen offset:0
    s_waitcnt lgkmcnt(2)
    v_mfma_f32_32x32x16_bf16 v[96:111], v[28:31], a[20:23], v[96:111]
    ds_read_b64_tr_b16 v[20:21], v6 offset:53248
    ds_read_b64_tr_b16 v[22:23], v6 offset:54272
    s_waitcnt lgkmcnt(2)
    v_mfma_f32_32x32x16_bf16 v[112:127], v[32:35], a[20:23], v[112:127]
    ds_read_b64_tr_b16 v[24:25], v7 offset:53248
    ds_read_b64_tr_b16 v[26:27], v7 offset:54272
    buffer_load_dwordx4 a[20:23], v2, s[32:35], s66 offen offset:1024
    s_waitcnt lgkmcnt(2)
    v_mfma_f32_32x32x16_bf16 v[96:111], v[20:23], a[24:27], v[96:111]
    ds_read_b64_tr_b16 v[28:29], v6 offset:55296
    ds_read_b64_tr_b16 v[30:31], v6 offset:56320
    buffer_load_dwordx4 v11, s[36:39], s67 offen offset:3072 lds
    s_waitcnt lgkmcnt(2)
    v_mfma_f32_32x32x16_bf16 v[112:127], v[24:27], a[24:27], v[112:127]
    ds_read_b64_tr_b16 v[32:33], v7 offset:55296
    ds_read_b64_tr_b16 v[34:35], v7 offset:56320
    buffer_load_dwordx4 a[24:27], v2, s[32:35], s66 offen offset:2048
    s_waitcnt vmcnt(35) lgkmcnt(2)
    v_mfma_f32_32x32x16_bf16 v[96:111], v[28:31], a[28:31], v[96:111]
    ds_read_b64_tr_b16 v[20:21], v6 offset:57344
    ds_read_b64_tr_b16 v[22:23], v6 offset:58368
    s_waitcnt lgkmcnt(2)
    v_mfma_f32_32x32x16_bf16 v[112:127], v[32:35], a[28:31], v[112:127]
    ds_read_b64_tr_b16 v[24:25], v7 offset:57344
    ds_read_b64_tr_b16 v[26:27], v7 offset:58368
    buffer_load_dwordx4 a[28:31], v2, s[32:35], s66 offen offset:3072
    s_waitcnt vmcnt(34) lgkmcnt(2)
    v_mfma_f32_32x32x16_bf16 v[96:111], v[20:23], a[32:35], v[96:111]
    ds_read_b64_tr_b16 v[28:29], v6 offset:59392
    ds_read_b64_tr_b16 v[30:31], v6 offset:60416
    s_add_u32 m0, s63, 0x8000
    s_add_u32 s67, s61, 0x20000
    buffer_load_dwordx4 v8, s[36:39], s67 offen offset:0 lds
    s_waitcnt lgkmcnt(2)
    v_mfma_f32_32x32x16_bf16 v[112:127], v[24:27], a[32:35], v[112:127]
    ds_read_b64_tr_b16 v[32:33], v7 offset:59392
    ds_read_b64_tr_b16 v[34:35], v7 offset:60416
    s_add_u32 s66, s60, 0x4c000
    buffer_load_dwordx4 a[32:35], v2, s[32:35], s66 offen offset:0
    s_waitcnt vmcnt(34) lgkmcnt(2)
    v_mfma_f32_32x32x16_bf16 v[96:111], v[28:31], a[36:39], v[96:111]
    ds_read_b64_tr_b16 v[20:21], v6 offset:61440
    ds_read_b64_tr_b16 v[22:23], v6 offset:62464
    s_waitcnt lgkmcnt(2)
    v_mfma_f32_32x32x16_bf16 v[112:127], v[32:35], a[36:39], v[112:127]
    ds_read_b64_tr_b16 v[24:25], v7 offset:61440
    ds_read_b64_tr_b16 v[26:27], v7 offset:62464
    buffer_load_dwordx4 a[36:39], v2, s[32:35], s66 offen offset:1024
    s_waitcnt vmcnt(33) lgkmcnt(2)
    v_mfma_f32_32x32x16_bf16 v[96:111], v[20:23], a[40:43], v[96:111]
    ds_read_b64_tr_b16 v[28:29], v6 offset:63488
    ds_read_b64_tr_b16 v[30:31], v6 offset:64512
    buffer_load_dwordx4 v9, s[36:39], s67 offen offset:1024 lds
    s_waitcnt lgkmcnt(2)
    v_mfma_f32_32x32x16_bf16 v[112:127], v[24:27], a[40:43], v[112:127]
    ds_read_b64_tr_b16 v[32:33], v7 offset:63488
    ds_read_b64_tr_b16 v[34:35], v7 offset:64512
    buffer_load_dwordx4 a[40:43], v2, s[32:35], s66 offen offset:2048
    s_waitcnt lgkmcnt(0)
    s_waitcnt vmcnt(34)
    s_barrier
    s_waitcnt vmcnt(33)
    v_mfma_f32_32x32x16_bf16 v[96:111], v[28:31], a[44:47], v[96:111]
    ds_read_b64_tr_b16 v[20:21], v12 offset:0
    ds_read_b64_tr_b16 v[22:23], v12 offset:1024
    v_mfma_f32_32x32x16_bf16 v[112:127], v[32:35], a[44:47], v[112:127]
    ds_read_b64_tr_b16 v[24:25], v13 offset:0
    ds_read_b64_tr_b16 v[26:27], v13 offset:1024
    buffer_load_dwordx4 a[44:47], v2, s[32:35], s66 offen offset:3072
    s_waitcnt vmcnt(32) lgkmcnt(2)
    v_mfma_f32_32x32x16_bf16 v[96:111], v[20:23], a[48:51], v[96:111]
    ds_read_b64_tr_b16 v[28:29], v12 offset:2048
    ds_read_b64_tr_b16 v[30:31], v12 offset:3072
    buffer_load_dwordx4 v10, s[36:39], s67 offen offset:2048 lds
    s_waitcnt lgkmcnt(2)
    v_mfma_f32_32x32x16_bf16 v[112:127], v[24:27], a[48:51], v[112:127]
    ds_read_b64_tr_b16 v[32:33], v13 offset:2048
    ds_read_b64_tr_b16 v[34:35], v13 offset:3072
    s_add_u32 s66, s60, 0x4d000
    buffer_load_dwordx4 a[48:51], v2, s[32:35], s66 offen offset:0
    s_waitcnt vmcnt(32) lgkmcnt(2)
    v_mfma_f32_32x32x16_bf16 v[96:111], v[28:31], a[52:55], v[96:111]
    ds_read_b64_tr_b16 v[20:21], v12 offset:4096
    ds_read_b64_tr_b16 v[22:23], v12 offset:5120
    s_waitcnt lgkmcnt(2)
    v_mfma_f32_32x32x16_bf16 v[112:127], v[32:35], a[52:55], v[112:127]
    ds_read_b64_tr_b16 v[24:25], v13 offset:4096
    ds_read_b64_tr_b16 v[26:27], v13 offset:5120
    buffer_load_dwordx4 a[52:55], v2, s[32:35], s66 offen offset:1024
    s_waitcnt vmcnt(31) lgkmcnt(2)
    v_mfma_f32_32x32x16_bf16 v[96:111], v[20:23], a[56:59], v[96:111]
    ds_read_b64_tr_b16 v[28:29], v12 offset:6144
    ds_read_b64_tr_b16 v[30:31], v12 offset:7168
    buffer_load_dwordx4 v11, s[36:39], s67 offen offset:3072 lds
    s_waitcnt lgkmcnt(2)
    v_mfma_f32_32x32x16_bf16 v[112:127], v[24:27], a[56:59], v[112:127]
    ds_read_b64_tr_b16 v[32:33], v13 offset:6144
    ds_read_b64_tr_b16 v[34:35], v13 offset:7168
    buffer_load_dwordx4 a[56:59], v2, s[32:35], s66 offen offset:2048
    s_waitcnt vmcnt(31) lgkmcnt(2)
    v_mfma_f32_32x32x16_bf16 v[96:111], v[28:31], a[60:63], v[96:111]
    ds_read_b64_tr_b16 v[20:21], v12 offset:8192
    ds_read_b64_tr_b16 v[22:23], v12 offset:9216
    s_waitcnt lgkmcnt(2)
    v_mfma_f32_32x32x16_bf16 v[112:127], v[32:35], a[60:63], v[112:127]
    ds_read_b64_tr_b16 v[24:25], v13 offset:8192
    ds_read_b64_tr_b16 v[26:27], v13 offset:9216
    buffer_load_dwordx4 a[60:63], v2, s[32:35], s66 offen offset:3072
    buffer_load_dword v18, off, s[32:35], s74 sc1
    s_waitcnt vmcnt(31) lgkmcnt(2)
    v_mfma_f32_32x32x16_bf16 v[96:111], v[20:23], a[64:67], v[96:111]
    ds_read_b64_tr_b16 v[28:29], v12 offset:10240
    ds_read_b64_tr_b16 v[30:31], v12 offset:11264
    s_add_u32 m0, s63, 0xc000
    s_add_u32 s67, s61, 0x40000
    buffer_load_dwordx4 v8, s[36:39], s67 offen offset:0 lds
    s_waitcnt lgkmcnt(2)
    v_mfma_f32_32x32x16_bf16 v[112:127], v[24:27], a[64:67], v[112:127]
    ds_read_b64_tr_b16 v[32:33], v13 offset:10240
    ds_read_b64_tr_b16 v[34:35], v13 offset:11264
    buffer_load_dwordx4 v9, s[36:39], s67 offen offset:1024 lds
    s_waitcnt vmcnt(31) lgkmcnt(2)
    v_mfma_f32_32x32x16_bf16 v[96:111], v[28:31], a[68:71], v[96:111]
    ds_read_b64_tr_b16 v[20:21], v12 offset:12288
    ds_read_b64_tr_b16 v[22:23], v12 offset:13312
    s_waitcnt lgkmcnt(2)
    v_mfma_f32_32x32x16_bf16 v[112:127], v[32:35], a[68:71], v[112:127]
    ds_read_b64_tr_b16 v[24:25], v13 offset:12288
    ds_read_b64_tr_b16 v[26:27], v13 offset:13312
    buffer_load_dwordx4 v10, s[36:39], s67 offen offset:2048 lds
    s_waitcnt vmcnt(30) lgkmcnt(2)
    v_mfma_f32_32x32x16_bf16 v[96:111], v[20:23], a[72:75], v[96:111]
    ds_read_b64_tr_b16 v[28:29], v12 offset:14336
    ds_read_b64_tr_b16 v[30:31], v12 offset:15360
    buffer_load_dwordx4 v11, s[36:39], s67 offen offset:3072 lds
    s_waitcnt lgkmcnt(2)
    v_mfma_f32_32x32x16_bf16 v[112:127], v[24:27], a[72:75], v[112:127]
    ds_read_b64_tr_b16 v[32:33], v13 offset:14336
    ds_read_b64_tr_b16 v[34:35], v13 offset:15360
    s_waitcnt lgkmcnt(0)
    s_barrier
    s_waitcnt vmcnt(30)
    v_mfma_f32_32x32x16_bf16 v[96:111], v[28:31], a[76:79], v[96:111]
    ds_read_b64_tr_b16 v[20:21], v12 offset:16384
    ds_read_b64_tr_b16 v[22:23], v12 offset:17408
    v_mfma_f32_32x32x16_bf16 v[112:127], v[32:35], a[76:79], v[112:127]
    ds_read_b64_tr_b16 v[24:25], v13 offset:16384
    ds_read_b64_tr_b16 v[26:27], v13 offset:17408
    s_add_u32 m0, s63, 0x10000
    s_add_u32 s67, s61, 0x60000
    buffer_load_dwordx4 v8, s[36:39], s67 offen offset:0 lds
    s_waitcnt vmcnt(29) lgkmcnt(2)
    v_mfma_f32_32x32x16_bf16 v[96:111], v[20:23], a[0:3], v[96:111]
    ds_read_b64_tr_b16 v[28:29], v12 offset:18432
    ds_read_b64_tr_b16 v[30:31], v12 offset:19456
    buffer_load_dwordx4 v9, s[36:39], s67 offen offset:1024 lds
    s_waitcnt lgkmcnt(2)
    v_mfma_f32_32x32x16_bf16 v[112:127], v[24:27], a[0:3], v[112:127]
    ds_read_b64_tr_b16 v[32:33], v13 offset:18432
    ds_read_b64_tr_b16 v[34:35], v13 offset:19456
    buffer_load_dwordx4 v10, s[36:39], s67 offen offset:2048 lds
    s_waitcnt vmcnt(30) lgkmcnt(2)
    v_mfma_f32_32x32x16_bf16 v[96:111], v[28:31], a[4:7], v[96:111]
    ds_read_b64_tr_b16 v[20:21], v12 offset:20480
    ds_read_b64_tr_b16 v[22:23], v12 offset:21504
    s_waitcnt lgkmcnt(2)
    v_mfma_f32_32x32x16_bf16 v[112:127], v[32:35], a[4:7], v[112:127]
    ds_read_b64_tr_b16 v[24:25], v13 offset:20480
    ds_read_b64_tr_b16 v[26:27], v13 offset:21504
    buffer_load_dwordx4 v11, s[36:39], s67 offen offset:3072 lds
    s_waitcnt vmcnt(29) lgkmcnt(2)
    v_mfma_f32_32x32x16_bf16 v[96:111], v[20:23], a[8:11], v[96:111]
    ds_read_b64_tr_b16 v[28:29], v12 offset:22528
    ds_read_b64_tr_b16 v[30:31], v12 offset:23552
    s_waitcnt lgkmcnt(2)
    v_mfma_f32_32x32x16_bf16 v[112:127], v[24:27], a[8:11], v[112:127]
    ds_read_b64_tr_b16 v[32:33], v13 offset:22528
    ds_read_b64_tr_b16 v[34:35], v13 offset:23552
    s_waitcnt vmcnt(27) lgkmcnt(2)
    v_mfma_f32_32x32x16_bf16 v[96:111], v[28:31], a[12:15], v[96:111]
    ds_read_b64_tr_b16 v[20:21], v12 offset:24576
    ds_read_b64_tr_b16 v[22:23], v12 offset:25600
    s_waitcnt lgkmcnt(2)
    v_mfma_f32_32x32x16_bf16 v[112:127], v[32:35], a[12:15], v[112:127]
    ds_read_b64_tr_b16 v[24:25], v13 offset:24576
    ds_read_b64_tr_b16 v[26:27], v13 offset:25600
    s_waitcnt vmcnt(8)
    v_readfirstlane_b32 s64, v18
    s_nop 0
    s_cmp_ge_u32 s64, 32
    s_cbranch_scc1 L_pollx_cc0
    s_mov_b32 s70, 0x10000
L_poll_cc0:
    buffer_load_dword v18, off, s[32:35], s74 sc1
    s_waitcnt vmcnt(0)
    v_readfirstlane_b32 s64, v18
    s_sub_u32 s70, s70, 1
    s_cmp_eq_u32 s70, 0
    s_cbranch_scc1 L_pollx_cc0
    s_cmp_ge_u32 s64, 32
    s_cbranch_scc1 L_pollx_cc0
    s_sleep 16
    s_branch L_poll_cc0
L_pollx_cc0:
    s_waitcnt lgkmcnt(2)
    v_mfma_f32_32x32x16_bf16 v[96:111], v[20:23], a[16:19], v[96:111]
    ds_read_b64_tr_b16 v[28:29], v12 offset:26624
    ds_read_b64_tr_b16 v[30:31], v12 offset:27648
    s_waitcnt lgkmcnt(2)
    v_mfma_f32_32x32x16_bf16 v[112:127], v[24:27], a[16:19], v[112:127]
    ds_read_b64_tr_b16 v[32:33], v13 offset:26624
    ds_read_b64_tr_b16 v[34:35], v13 offset:27648
    s_add_u32 s66, s60, 0
    buffer_load_dwordx4 a[64:67], v2, s[32:35], s66 offen offset:0
    buffer_load_dwordx4 a[68:71], v2, s[32:35], s66 offen offset:1024
    s_waitcnt lgkmcnt(2)
    v_mfma_f32_32x32x16_bf16 v[96:111], v[28:31], a[20:23], v[96:111]
    ds_read_b64_tr_b16 v[20:21], v12 offset:28672
    ds_read_b64_tr_b16 v[22:23], v12 offset:29696
    s_waitcnt lgkmcnt(2)
    v_mfma_f32_32x32x16_bf16 v[112:127], v[32:35], a[20:23], v[112:127]
    ds_read_b64_tr_b16 v[24:25], v13 offset:28672
    ds_read_b64_tr_b16 v[26:27], v13 offset:29696
    buffer_load_dwordx4 a[72:75], v2, s[32:35], s66 offen offset:2048
    buffer_load_dwordx4 a[76:79], v2, s[32:35], s66 offen offset:3072
    s_waitcnt lgkmcnt(2)
    v_mfma_f32_32x32x16_bf16 v[96:111], v[20:23], a[24:27], v[96:111]
    ds_read_b64_tr_b16 v[28:29], v12 offset:30720
    ds_read_b64_tr_b16 v[30:31], v12 offset:31744
    s_waitcnt lgkmcnt(2)
    v_mfma_f32_32x32x16_bf16 v[112:127], v[24:27], a[24:27], v[112:127]
    ds_read_b64_tr_b16 v[32:33], v13 offset:30720
    ds_read_b64_tr_b16 v[34:35], v13 offset:31744
    s_add_u32 s66, s60, 0x1000
    buffer_load_dwordx4 a[0:3], v2, s[32:35], s66 offen offset:0
    buffer_load_dwordx4 a[4:7], v2, s[32:35], s66 offen offset:1024
    s_waitcnt lgkmcnt(0)
    s_barrier
    v_mfma_f32_32x32x16_bf16 v[96:111], v[28:31], a[28:31], v[96:111]
    ds_read_b64_tr_b16 v[20:21], v6 offset:0
    ds_read_b64_tr_b16 v[22:23], v6 offset:1024
    v_mfma_f32_32x32x16_bf16 v[112:127], v[32:35], a[28:31], v[112:127]
    ds_read_b64_tr_b16 v[24:25], v7 offset:0
    ds_read_b64_tr_b16 v[26:27], v7 offset:1024
    buffer_load_dwordx4 a[8:11], v2, s[32:35], s66 offen offset:2048
    buffer_load_dwordx4 a[12:15], v2, s[32:35], s66 offen offset:3072
    s_waitcnt lgkmcnt(2)
    v_mfma_f32_32x32x16_bf16 v[96:111], v[20:23], a[32:35], v[96:111]
    ds_read_b64_tr_b16 v[28:29], v6 offset:2048
    ds_read_b64_tr_b16 v[30:31], v6 offset:3072
    s_add_u32 m0, s63, 0x14000
    s_add_u32 s67, s61, 0x80000
    buffer_load_dwordx4 v8, s[36:39], s67 offen offset:0 lds
    s_waitcnt lgkmcnt(2)
    v_mfma_f32_32x32x16_bf16 v[112:127], v[24:27], a[32:35], v[112:127]
    ds_read_b64_tr_b16 v[32:33], v7 offset:2048
    ds_read_b64_tr_b16 v[34:35], v7 offset:3072
    s_add_u32 s66, s60, 0x2000
    buffer_load_dwordx4 a[16:19], v2, s[32:35], s66 offen offset:0
    buffer_load_dwordx4 a[20:23], v2, s[32:35], s66 offen offset:1024
    s_waitcnt lgkmcnt(2)
    v_mfma_f32_32x32x16_bf16 v[96:111], v[28:31], a[36:39], v[96:111]
    ds_read_b64_tr_b16 v[20:21], v6 offset:4096
    ds_read_b64_tr_b16 v[22:23], v6 offset:5120
    s_waitcnt lgkmcnt(2)
    v_mfma_f32_32x32x16_bf16 v[112:127], v[32:35], a[36:39], v[112:127]
    ds_read_b64_tr_b16 v[24:25], v7 offset:4096
    ds_read_b64_tr_b16 v[26:27], v7 offset:5120
    buffer_load_dwordx4 a[24:27], v2, s[32:35], s66 offen offset:2048
    buffer_load_dwordx4 a[28:31], v2, s[32:35], s66 offen offset:3072
    s_waitcnt lgkmcnt(2)
    v_mfma_f32_32x32x16_bf16 v[96:111], v[20:23], a[40:43], v[96:111]
    ds_read_b64_tr_b16 v[28:29], v6 offset:6144
    ds_read_b64_tr_b16 v[30:31], v6 offset:7168
    buffer_load_dwordx4 v9, s[36:39], s67 offen offset:1024 lds
    s_waitcnt lgkmcnt(2)
    v_mfma_f32_32x32x16_bf16 v[112:127], v[24:27], a[40:43], v[112:127]
    ds_read_b64_tr_b16 v[32:33], v7 offset:6144
    ds_read_b64_tr_b16 v[34:35], v7 offset:7168
    s_add_u32 s66, s60, 0x3000
    buffer_load_dwordx4 a[32:35], v2, s[32:35], s66 offen offset:0
    buffer_load_dwordx4 a[36:39], v2, s[32:35], s66 offen offset:1024
    s_waitcnt lgkmcnt(2)
    v_mfma_f32_32x32x16_bf16 v[96:111], v[28:31], a[44:47], v[96:111]
    ds_read_b64_tr_b16 v[20:21], v6 offset:8192
    ds_read_b64_tr_b16 v[22:23], v6 offset:9216
    s_waitcnt lgkmcnt(2)
    v_mfma_f32_32x32x16_bf16 v[112:127], v[32:35], a[44:47], v[112:127]
    ds_read_b64_tr_b16 v[24:25], v7 offset:8192
    ds_read_b64_tr_b16 v[26:27], v7 offset:9216
    buffer_load_dwordx4 a[40:43], v2, s[32:35], s66 offen offset:2048
    buffer_load_dwordx4 a[44:47], v2, s[32:35], s66 offen offset:3072
    s_waitcnt lgkmcnt(2)
    v_mfma_f32_32x32x16_bf16 v[96:111], v[20:23], a[48:51], v[96:111]
    ds_read_b64_tr_b16 v[28:29], v6 offset:10240
    ds_read_b64_tr_b16 v[30:31], v6 offset:11264
    buffer_load_dwordx4 v10, s[36:39], s67 offen offset:2048 lds
    s_waitcnt lgkmcnt(2)
    v_mfma_f32_32x32x16_bf16 v[112:127], v[24:27], a[48:51], v[112:127]
    ds_read_b64_tr_b16 v[32:33], v7 offset:10240
    ds_read_b64_tr_b16 v[34:35], v7 offset:11264
    s_add_u32 s66, s60, 0x4000
    buffer_load_dwordx4 a[48:51], v2, s[32:35], s66 offen offset:0
    s_waitcnt lgkmcnt(2)
    v_mfma_f32_32x32x16_bf16 v[96:111], v[28:31], a[52:55], v[96:111]
    ds_read_b64_tr_b16 v[20:21], v6 offset:12288
    ds_read_b64_tr_b16 v[22:23], v6 offset:13312
    s_waitcnt lgkmcnt(2)
    v_mfma_f32_32x32x16_bf16 v[112:127], v[32:35], a[52:55], v[112:127]
    ds_read_b64_tr_b16 v[24:25], v7 offset:12288
    ds_read_b64_tr_b16 v[26:27], v7 offset:13312
    buffer_load_dwordx4 a[52:55], v2, s[32:35], s66 offen offset:1024
    s_waitcnt lgkmcnt(2)
    v_mfma_f32_32x32x16_bf16 v[96:111], v[20:23], a[56:59], v[96:111]
    ds_read_b64_tr_b16 v[28:29], v6 offset:14336
    ds_read_b64_tr_b16 v[30:31], v6 offset:15360
    buffer_load_dwordx4 v11, s[36:39], s67 offen offset:3072 lds
    s_waitcnt lgkmcnt(2)
    v_mfma_f32_32x32x16_bf16 v[112:127], v[24:27], a[56:59], v[112:127]
    ds_read_b64_tr_b16 v[32:33], v7 offset:14336
    ds_read_b64_tr_b16 v[34:35], v7 offset:15360
    buffer_load_dwordx4 a[56:59], v2, s[32:35], s66 offen offset:2048
    s_waitcnt lgkmcnt(0)
    s_barrier
    v_mfma_f32_32x32x16_bf16 v[96:111], v[28:31], a[60:63], v[96:111]
    ds_read_b64_tr_b16 v[20:21], v6 offset:16384
    ds_read_b64_tr_b16 v[22:23], v6 offset:17408
    v_mfma_f32_32x32x16_bf16 v[112:127], v[32:35], a[60:63], v[112:127]
    ds_read_b64_tr_b16 v[24:25], v7 offset:16384
    ds_read_b64_tr_b16 v[26:27], v7 offset:17408
    buffer_load_dwordx4 a[60:63], v2, s[32:35], s66 offen offset:3072
    s_waitcnt vmcnt(23) lgkmcnt(2)
    v_mfma_f32_32x32x16_bf16 v[64:79], v[20:23], a[64:67], 0
    ds_read_b64_tr_b16 v[28:29], v6 offset:18432
    ds_read_b64_tr_b16 v[30:31], v6 offset:19456
    s_add_u32 m0, s63, 0
    s_add_u32 s67, s61, 0xa0000
    buffer_load_dwordx4 v8, s[36:39], s67 offen offset:0 lds
    s_waitcnt lgkmcnt(2)
    v_mfma_f32_32x32x16_bf16 v[80:95], v[24:27], a[64:67], 0
    ds_read_b64_tr_b16 v[32:33], v7 offset:18432
    ds_read_b64_tr_b16 v[34:35], v7 offset:19456
    s_add_u32 s66, s60, 0x5000
    buffer_load_dwordx4 a[64:67], v2, s[32:35], s66 offen offset:0
    s_waitcnt vmcnt(24) lgkmcnt(2)
    v_mfma_f32_32x32x16_bf16 v[64:79], v[28:31], a[68:71], v[64:79]
    ds_read_b64_tr_b16 v[20:21], v6 offset:20480
    ds_read_b64_tr_b16 v[22:23], v6 offset:21504
    s_waitcnt lgkmcnt(2)
    v_mfma_f32_32x32x16_bf16 v[80:95], v[32:35], a[68:71], v[80:95]
    ds_read_b64_tr_b16 v[24:25], v7 offset:20480
    ds_read_b64_tr_b16 v[26:27], v7 offset:21504
    buffer_load_dwordx4 a[68:71], v2, s[32:35], s66 offen offset:1024
    s_waitcnt vmcnt(24) lgkmcnt(2)
    v_mfma_f32_32x32x16_bf16 v[64:79], v[20:23], a[72:75], v[64:79]
    ds_read_b64_tr_b16 v[28:29], v6 offset:22528
    ds_read_b64_tr_b16 v[30:31], v6 offset:23552
    s_add_u32 s65, s69, 0x400000
    buffer_store_dwordx4 v[96:99], v2, s[32:35], s65 offen offset:0 sc1
    s_waitcnt lgkmcnt(2)
    v_mfma_f32_32x32x16_bf16 v[80:95], v[24:27], a[72:75], v[80:95]
    ds_read_b64_tr_b16 v[32:33], v7 offset:22528
    ds_read_b64_tr_b16 v[34:35], v7 offset:23552
    buffer_load_dwordx4 a[72:75], v2, s[32:35], s66 offen offset:2048
    s_waitcnt vmcnt(25) lgkmcnt(2)
    v_mfma_f32_32x32x16_bf16 v[64:79], v[28:31], a[76:79], v[64:79]
    ds_read_b64_tr_b16 v[20:21], v6 offset:24576
    ds_read_b64_tr_b16 v[22:23], v6 offset:25600
    buffer_store_dwordx4 v[100:103], v2, s[32:35], s65 offen offset:1024 sc1
    s_waitcnt lgkmcnt(2)
    v_mfma_f32_32x32x16_bf16 v[80:95], v[32:35], a[76:79], v[80:95]
    ds_read_b64_tr_b16 v[24:25], v7 offset:24576
    ds_read_b64_tr_b16 v[26:27], v7 offset:25600
    buffer_load_dwordx4 a[76:79], v2, s[32:35], s66 offen offset:3072
    s_waitcnt vmcnt(26) lgkmcnt(2)
    v_mfma_f32_32x32x16_bf16 v[64:79], v[20:23], a[0:3], v[64:79]
    ds_read_b64_tr_b16 v[28:29], v6 offset:26624
    ds_read_b64_tr_b16 v[30:31], v6 offset:27648
    buffer_store_dwordx4 v[104:107], v2, s[32:35], s65 offen offset:2048 sc1
    s_waitcnt lgkmcnt(2)
    v_mfma_f32_32x32x16_bf16 v[80:95], v[24:27], a[0:3], v[80:95]
    ds_read_b64_tr_b16 v[32:33], v7 offset:26624
    ds_read_b64_tr_b16 v[34:35], v7 offset:27648
    s_add_u32 s66, s60, 0x6000
    buffer_load_dwordx4 a[0:3], v2, s[32:35], s66 offen offset:0
    s_waitcnt vmcnt(27) lgkmcnt(2)
    v_mfma_f32_32x32x16_bf16 v[64:79], v[28:31], a[4:7], v[64:79]
    ds_read_b64_tr_b16 v[20:21], v6 offset:28672
    ds_read_b64_tr_b16 v[22:23], v6 offset:29696
    buffer_store_dwordx4 v[108:111], v2, s[32:35], s65 offen offset:3072 sc1
    s_waitcnt lgkmcnt(2)
    v_mfma_f32_32x32x16_bf16 v[80:95], v[32:35], a[4:7], v[80:95]
    ds_read_b64_tr_b16 v[24:25], v7 offset:28672
    ds_read_b64_tr_b16 v[26:27], v7 offset:29696
    buffer_load_dwordx4 a[4:7], v2, s[32:35], s66 offen offset:1024
    s_waitcnt vmcnt(28) lgkmcnt(2)
    v_mfma_f32_32x32x16_bf16 v[64:79], v[20:23], a[8:11], v[64:79]
    ds_read_b64_tr_b16 v[28:29], v6 offset:30720
    ds_read_b64_tr_b16 v[30:31], v6 offset:31744
    s_add_u32 s65, s69, 0x401000
    buffer_store_dwordx4 v[112:115], v2, s[32:35], s65 offen offset:0 sc1
    s_waitcnt lgkmcnt(2)
    v_mfma_f32_32x32x16_bf16 v[80:95], v[24:27], a[8:11], v[80:95]
    ds_read_b64_tr_b16 v[32:33], v7 offset:30720
    ds_read_b64_tr_b16 v[34:35], v7 offset:31744
    buffer_load_dwordx4 a[8:11], v2, s[32:35], s66 offen offset:2048
    s_waitcnt lgkmcnt(0)
    s_barrier
    s_waitcnt vmcnt(29)
    v_mfma_f32_32x32x16_bf16 v[64:79], v[28:31], a[12:15], v[64:79]
    ds_read_b64_tr_b16 v[20:21], v6 offset:32768
    ds_read_b64_tr_b16 v[22:23], v6 offset:33792
    buffer_store_dwordx4 v[116:119], v2, s[32:35], s65 offen offset:1024 sc1
    v_mfma_f32_32x32x16_bf16 v[80:95], v[32:35], a[12:15], v[80:95]
    ds_read_b64_tr_b16 v[24:25], v7 offset:32768
    ds_read_b64_tr_b16 v[26:27], v7 offset:33792
    buffer_load_dwordx4 a[12:15], v2, s[32:35], s66 offen offset:3072
    s_waitcnt vmcnt(29) lgkmcnt(2)
    v_mfma_f32_32x32x16_bf16 v[64:79], v[20:23], a[16:19], v[64:79]
    ds_read_b64_tr_b16 v[28:29], v6 offset:34816
    ds_read_b64_tr_b16 v[30:31], v6 offset:35840
    buffer_store_dwordx4 v[120:123], v2, s[32:35], s65 offen offset:2048 sc1
    s_waitcnt lgkmcnt(2)
    v_mfma_f32_32x32x16_bf16 v[80:95], v[24:27], a[16:19], v[80:95]
    ds_read_b64_tr_b16 v[32:33], v7 offset:34816
    ds_read_b64_tr_b16 v[34:35], v7 offset:35840
    s_add_u32 s66, s60, 0x7000
    buffer_load_dwordx4 a[16:19], v2, s[32:35], s66 offen offset:0
    s_waitcnt vmcnt(30) lgkmcnt(2)
    v_mfma_f32_32x32x16_bf16 v[64:79], v[28:31], a[20:23], v[64:79]
    ds_read_b64_tr_b16 v[20:21], v6 offset:36864
    ds_read_b64_tr_b16 v[22:23], v6 offset:37888
    buffer_store_dwordx4 v[124:127], v2, s[32:35], s65 offen offset:3072 sc1
    s_waitcnt lgkmcnt(2)
    v_mfma_f32_32x32x16_bf16 v[80:95], v[32:35], a[20:23], v[80:95]
    ds_read_b64_tr_b16 v[24:25], v7 offset:36864
    ds_read_b64_tr_b16 v[26:27], v7 offset:37888
    buffer_load_dwordx4 a[20:23], v2, s[32:35], s66 offen offset:1024
    s_waitcnt vmcnt(31) lgkmcnt(2)
    v_mfma_f32_32x32x16_bf16 v[64:79], v[20:23], a[24:27], v[64:79]
    ds_read_b64_tr_b16 v[28:29], v6 offset:38912
    ds_read_b64_tr_b16 v[30:31], v6 offset:39936
    buffer_load_dwordx4 v9, s[36:39], s67 offen offset:1024 lds
    s_waitcnt lgkmcnt(2)
    v_mfma_f32_32x32x16_bf16 v[80:95], v[24:27], a[24:27], v[80:95]
    ds_read_b64_tr_b16 v[32:33], v7 offset:38912
    ds_read_b64_tr_b16 v[34:35], v7 offset:39936
    buffer_load_dwordx4 a[24:27], v2, s[32:35], s66 offen offset:2048
    s_waitcnt vmcnt(32) lgkmcnt(2)
    v_mfma_f32_32x32x16_bf16 v[64:79], v[28:31], a[28:31], v[64:79]
    ds_read_b64_tr_b16 v[20:21], v6 offset:40960
    ds_read_b64_tr_b16 v[22:23], v6 offset:41984
    s_waitcnt lgkmcnt(2)
    v_mfma_f32_32x32x16_bf16 v[80:95], v[32:35], a[28:31], v[80:95]
    ds_read_b64_tr_b16 v[24:25], v7 offset:40960
    ds_read_b64_tr_b16 v[26:27], v7 offset:41984
    buffer_load_dwordx4 a[28:31], v2, s[32:35], s66 offen offset:3072
    s_waitcnt vmcnt(31) lgkmcnt(2)
    v_mfma_f32_32x32x16_bf16 v[64:79], v[20:23], a[32:35], v[64:79]
    ds_read_b64_tr_b16 v[28:29], v6 offset:43008
    ds_read_b64_tr_b16 v[30:31], v6 offset:44032
    buffer_load_dwordx4 v10, s[36:39], s67 offen offset:2048 lds
    s_waitcnt lgkmcnt(2)
    v_mfma_f32_32x32x16_bf16 v[80:95], v[24:27], a[32:35], v[80:95]
    ds_read_b64_tr_b16 v[32:33], v7 offset:43008
    ds_read_b64_tr_b16 v[34:35], v7 offset:44032
    s_add_u32 s66, s60, 0x8000
    buffer_load_dwordx4 a[32:35], v2, s[32:35], s66 offen offset:0
    s_waitcnt vmcnt(32) lgkmcnt(2)
    v_mfma_f32_32x32x16_bf16 v[64:79], v[28:31], a[36:39], v[64:79]
    ds_read_b64_tr_b16 v[20:21], v6 offset:45056
    ds_read_b64_tr_b16 v[22:23], v6 offset:46080
    s_waitcnt lgkmcnt(2)
    v_mfma_f32_32x32x16_bf16 v[80:95], v[32:35], a[36:39], v[80:95]
    ds_read_b64_tr_b16 v[24:25], v7 offset:45056
    ds_read_b64_tr_b16 v[26:27], v7 offset:46080
    buffer_load_dwordx4 a[36:39], v2, s[32:35], s66 offen offset:1024
    s_waitcnt vmcnt(32) lgkmcnt(2)
    v_mfma_f32_32x32x16_bf16 v[64:79], v[20:23], a[40:43], v[64:79]
    ds_read_b64_tr_b16 v[28:29], v6 offset:47104
    ds_read_b64_tr_b16 v[30:31], v6 offset:48128
    buffer_load_dwordx4 v11, s[36:39], s67 offen offset:3072 lds
    s_waitcnt lgkmcnt(2)
    v_mfma_f32_32x32x16_bf16 v[80:95], v[24:27], a[40:43], v[80:95]
    ds_read_b64_tr_b16 v[32:33], v7 offset:47104
    ds_read_b64_tr_b16 v[34:35], v7 offset:48128
    buffer_load_dwordx4 a[40:43], v2, s[32:35], s66 offen offset:2048
    s_waitcnt lgkmcnt(0)
    s_waitcnt vmcnt(9)
    s_barrier
    s_cmp_lg_u32 s56, 0
    s_cbranch_scc1 K3_FLd
    s_mov_b64 exec, 1
    buffer_atomic_or v16, v15, s[32:35], 0 offen offset:4
    s_mov_b64 exec, -1
K3_FLd:
    v_mfma_f32_32x32x16_bf16 v[64:79], v[28:31], a[44:47], v[64:79]
    ds_read_b64_tr_b16 v[20:21], v6 offset:49152
    ds_read_b64_tr_b16 v[22:23], v6 offset:50176
    s_add_u32 m0, s63, 0x4000
    s_add_u32 s67, s61, 0xc0000
    buffer_load_dwordx4 v8, s[36:39], s67 offen offset:0 lds
    v_mfma_f32_32x32x16_bf16 v[80:95], v[32:35], a[44:47], v[80:95]
    ds_read_b64_tr_b16 v[24:25], v7 offset:49152
    ds_read_b64_tr_b16 v[26:27], v7 offset:50176
    buffer_load_dwordx4 a[44:47], v2, s[32:35], s66 offen offset:3072
    s_waitcnt lgkmcnt(2)
    v_mfma_f32_32x32x16_bf16 v[64:79], v[20:23], a[48:51], v[64:79]
    ds_read_b64_tr_b16 v[28:29], v6 offset:51200
    ds_read_b64_tr_b16 v[30:31], v6 offset:52224
    buffer_load_dwordx4 v9, s[36:39], s67 offen offset:1024 lds
    s_waitcnt lgkmcnt(2)
    v_mfma_f32_32x32x16_bf16 v[80:95], v[24:27], a[48:51], v[80:95]
    ds_read_b64_tr_b16 v[32:33], v7 offset:51200
    ds_read_b64_tr_b16 v[34:35], v7 offset:52224
    s_add_u32 s66, s60, 0x9000
    buffer_load_dwordx4 a[48:51], v2, s[32:35], s66 offen offset:0
    s_waitcnt lgkmcnt(2)
    v_mfma_f32_32x32x16_bf16 v[64:79], v[28:31], a[52:55], v[64:79]
    ds_read_b64_tr_b16 v[20:21], v6 offset:53248
    ds_read_b64_tr_b16 v[22:23], v6 offset:54272
    s_waitcnt lgkmcnt(2)
    v_mfma_f32_32x32x16_bf16 v[80:95], v[32:35], a[52:55], v[80:95]
    ds_read_b64_tr_b16 v[24:25], v7 offset:53248
    ds_read_b64_tr_b16 v[26:27], v7 offset:54272
    buffer_load_dwordx4 a[52:55], v2, s[32:35], s66 offen offset:1024
    s_waitcnt lgkmcnt(2)
    v_mfma_f32_32x32x16_bf16 v[64:79], v[20:23], a[56:59], v[64:79]
    ds_read_b64_tr_b16 v[28:29], v6 offset:55296
    ds_read_b64_tr_b16 v[30:31], v6 offset:56320
    buffer_load_dwordx4 v10, s[36:39], s67 offen offset:2048 lds
    s_waitcnt lgkmcnt(2)
    v_mfma_f32_32x32x16_bf16 v[80:95], v[24:27], a[56:59], v[80:95]
    ds_read_b64_tr_b16 v[32:33], v7 offset:55296
    ds_read_b64_tr_b16 v[34:35], v7 offset:56320
    buffer_load_dwordx4 a[56:59], v2, s[32:35], s66 offen offset:2048
    s_waitcnt lgkmcnt(2)
    v_mfma_f32_32x32x16_bf16 v[64:79], v[28:31], a[60:63], v[64:79]
    ds_read_b64_tr_b16 v[20:21], v6 offset:57344
    ds_read_b64_tr_b16 v[22:23], v6 offset:58368
    s_waitcnt lgkmcnt(2)
    v_mfma_f32_32x32x16_bf16 v[80:95], v[32:35], a[60:63], v[80:95]
    ds_read_b64_tr_b16 v[24:25], v7 offset:57344
    ds_read_b64_tr_b16 v[26:27], v7 offset:58368
    buffer_load_dwordx4 a[60:63], v2, s[32:35], s66 offen offset:3072
    s_waitcnt lgkmcnt(2)
    v_mfma_f32_32x32x16_bf16 v[64:79], v[20:23], a[64:67], v[64:79]
    ds_read_b64_tr_b16 v[28:29], v6 offset:59392
    ds_read_b64_tr_b16 v[30:31], v6 offset:60416
    buffer_load_dwordx4 v11, s[36:39], s67 offen offset:3072 lds
    s_waitcnt lgkmcnt(2)
    v_mfma_f32_32x32x16_bf16 v[80:95], v[24:27], a[64:67], v[80:95]
    ds_read_b64_tr_b16 v[32:33], v7 offset:59392
    ds_read_b64_tr_b16 v[34:35], v7 offset:60416
    s_add_u32 s66, s60, 0xa000
    buffer_load_dwordx4 a[64:67], v2, s[32:35], s66 offen offset:0
    s_waitcnt lgkmcnt(2)
    v_mfma_f32_32x32x16_bf16 v[64:79], v[28:31], a[68:71], v[64:79]
    ds_read_b64_tr_b16 v[20:21], v6 offset:61440
    ds_read_b64_tr_b16 v[22:23], v6 offset:62464
    s_waitcnt lgkmcnt(2)
    v_mfma_f32_32x32x16_bf16 v[80:95], v[32:35], a[68:71], v[80:95]
    ds_read_b64_tr_b16 v[24:25], v7 offset:61440
    ds_read_b64_tr_b16 v[26:27], v7 offset:62464
    buffer_load_dwordx4 a[68:71], v2, s[32:35], s66 offen offset:1024
    s_waitcnt lgkmcnt(2)
    v_mfma_f32_32x32x16_bf16 v[64:79], v[20:23], a[72:75], v[64:79]
    ds_read_b64_tr_b16 v[28:29], v6 offset:63488
    ds_read_b64_tr_b16 v[30:31], v6 offset:64512
    s_add_u32 m0, s63, 0x8000
    s_add_u32 s67, s61, 0xe0000
    buffer_load_dwordx4 v8, s[36:39], s67 offen offset:0 lds
    s_waitcnt lgkmcnt(2)
    v_mfma_f32_32x32x16_bf16 v[80:95], v[24:27], a[72:75], v[80:95]
    ds_read_b64_tr_b16 v[32:33], v7 offset:63488
    ds_read_b64_tr_b16 v[34:35], v7 offset:64512
    buffer_load_dwordx4 a[72:75], v2, s[32:35], s66 offen offset:2048
    s_waitcnt lgkmcnt(0)
    s_barrier
    v_mfma_f32_32x32x16_bf16 v[64:79], v[28:31], a[76:79], v[64:79]
    ds_read_b64_tr_b16 v[20:21], v12 offset:0
    ds_read_b64_tr_b16 v[22:23], v12 offset:1024
    buffer_load_dwordx4 v9, s[36:39], s67 offen offset:1024 lds
    v_mfma_f32_32x32x16_bf16 v[80:95], v[32:35], a[76:79], v[80:95]
    ds_read_b64_tr_b16 v[24:25], v13 offset:0
    ds_read_b64_tr_b16 v[26:27], v13 offset:1024
    buffer_load_dwordx4 a[76:79], v2, s[32:35], s66 offen offset:3072
    s_waitcnt lgkmcnt(2)
    v_mfma_f32_32x32x16_bf16 v[64:79], v[20:23], a[0:3], v[64:79]
    ds_read_b64_tr_b16 v[28:29], v12 offset:2048
    ds_read_b64_tr_b16 v[30:31], v12 offset:3072
    buffer_load_dwordx4 v10, s[36:39], s67 offen offset:2048 lds
    s_waitcnt lgkmcnt(2)
    v_mfma_f32_32x32x16_bf16 v[80:95], v[24:27], a[0:3], v[80:95]
    ds_read_b64_tr_b16 v[32:33], v13 offset:2048
    ds_read_b64_tr_b16 v[34:35], v13 offset:3072
    s_add_u32 s66, s60, 0xb000
    buffer_load_dwordx4 a[0:3], v2, s[32:35], s66 offen offset:0
    s_waitcnt lgkmcnt(2)
    v_mfma_f32_32x32x16_bf16 v[64:79], v[28:31], a[4:7], v[64:79]
    ds_read_b64_tr_b16 v[20:21], v12 offset:4096
    ds_read_b64_tr_b16 v[22:23], v12 offset:5120
    s_waitcnt lgkmcnt(2)
    v_mfma_f32_32x32x16_bf16 v[80:95], v[32:35], a[4:7], v[80:95]
    ds_read_b64_tr_b16 v[24:25], v13 offset:4096
    ds_read_b64_tr_b16 v[26:27], v13 offset:5120
    buffer_load_dwordx4 a[4:7], v2, s[32:35], s66 offen offset:1024
    s_waitcnt lgkmcnt(2)
    v_mfma_f32_32x32x16_bf16 v[64:79], v[20:23], a[8:11], v[64:79]
    ds_read_b64_tr_b16 v[28:29], v12 offset:6144
    ds_read_b64_tr_b16 v[30:31], v12 offset:7168
    buffer_load_dwordx4 v11, s[36:39], s67 offen offset:3072 lds
    s_waitcnt lgkmcnt(2)
    v_mfma_f32_32x32x16_bf16 v[80:95], v[24:27], a[8:11], v[80:95]
    ds_read_b64_tr_b16 v[32:33], v13 offset:6144
    ds_read_b64_tr_b16 v[34:35], v13 offset:7168
    buffer_load_dwordx4 a[8:11], v2, s[32:35], s66 offen offset:2048
    s_waitcnt lgkmcnt(2)
    v_mfma_f32_32x32x16_bf16 v[64:79], v[28:31], a[12:15], v[64:79]
    ds_read_b64_tr_b16 v[20:21], v12 offset:8192
    ds_read_b64_tr_b16 v[22:23], v12 offset:9216
    s_waitcnt lgkmcnt(2)
    v_mfma_f32_32x32x16_bf16 v[80:95], v[32:35], a[12:15], v[80:95]
    ds_read_b64_tr_b16 v[24:25], v13 offset:8192
    ds_read_b64_tr_b16 v[26:27], v13 offset:9216
    buffer_load_dwordx4 a[12:15], v2, s[32:35], s66 offen offset:3072
    s_waitcnt lgkmcnt(2)
    v_mfma_f32_32x32x16_bf16 v[64:79], v[20:23], a[16:19], v[64:79]
    ds_read_b64_tr_b16 v[28:29], v12 offset:10240
    ds_read_b64_tr_b16 v[30:31], v12 offset:11264
    s_add_u32 m0, s63, 0xc000
    s_add_u32 s67, s61, 0x100000
    buffer_load_dwordx4 v8, s[36:39], s67 offen offset:0 lds
    s_waitcnt lgkmcnt(2)
    v_mfma_f32_32x32x16_bf16 v[80:95], v[24:27], a[16:19], v[80:95]
    ds_read_b64_tr_b16 v[32:33], v13 offset:10240
    ds_read_b64_tr_b16 v[34:35], v13 offset:11264
    s_add_u32 s66, s60, 0xc000
    buffer_load_dwordx4 a[16:19], v2, s[32:35], s66 offen offset:0
    s_waitcnt vmcnt(31) lgkmcnt(2)
    v_mfma_f32_32x32x16_bf16 v[64:79], v[28:31], a[20:23], v[64:79]
    ds_read_b64_tr_b16 v[20:21], v12 offset:12288
    ds_read_b64_tr_b16 v[22:23], v12 offset:13312
    s_waitcnt lgkmcnt(2)
    v_mfma_f32_32x32x16_bf16 v[80:95], v[32:35], a[20:23], v[80:95]
    ds_read_b64_tr_b16 v[24:25], v13 offset:12288
    ds_read_b64_tr_b16 v[26:27], v13 offset:13312
    buffer_load_dwordx4 a[20:23], v2, s[32:35], s66 offen offset:1024
    s_waitcnt vmcnt(30) lgkmcnt(2)
    v_mfma_f32_32x32x16_bf16 v[64:79], v[20:23], a[24:27], v[64:79]
    ds_read_b64_tr_b16 v[28:29], v12 offset:14336
    ds_read_b64_tr_b16 v[30:31], v12 offset:15360
    buffer_load_dwordx4 v9, s[36:39], s67 offen offset:1024 lds
    s_waitcnt lgkmcnt(2)
    v_mfma_f32_32x32x16_bf16 v[80:95], v[24:27], a[24:27], v[80:95]
    ds_read_b64_tr_b16 v[32:33], v13 offset:14336
    ds_read_b64_tr_b16 v[34:35], v13 offset:15360
    buffer_load_dwordx4 a[24:27], v2, s[32:35], s66 offen offset:2048
    s_waitcnt lgkmcnt(0)
    s_barrier
    s_waitcnt vmcnt(31)
    v_mfma_f32_32x32x16_bf16 v[64:79], v[28:31], a[28:31], v[64:79]
    ds_read_b64_tr_b16 v[20:21], v12 offset:16384
    ds_read_b64_tr_b16 v[22:23], v12 offset:17408
    v_mfma_f32_32x32x16_bf16 v[80:95], v[32:35], a[28:31], v[80:95]
    ds_read_b64_tr_b16 v[24:25], v13 offset:16384
    ds_read_b64_tr_b16 v[26:27], v13 offset:17408
    buffer_load_dwordx4 a[28:31], v2, s[32:35], s66 offen offset:3072
    s_waitcnt vmcnt(30) lgkmcnt(2)
    v_mfma_f32_32x32x16_bf16 v[64:79], v[20:23], a[32:35], v[64:79]
    ds_read_b64_tr_b16 v[28:29], v12 offset:18432
    ds_read_b64_tr_b16 v[30:31], v12 offset:19456
    buffer_load_dwordx4 v10, s[36:39], s67 offen offset:2048 lds
    s_waitcnt lgkmcnt(2)
    v_mfma_f32_32x32x16_bf16 v[80:95], v[24:27], a[32:35], v[80:95]
    ds_read_b64_tr_b16 v[32:33], v13 offset:18432
    ds_read_b64_tr_b16 v[34:35], v13 offset:19456
    s_add_u32 s66, s60, 0xd000
    buffer_load_dwordx4 a[32:35], v2, s[32:35], s66 offen offset:0
    s_waitcnt vmcnt(31) lgkmcnt(2)
    v_mfma_f32_32x32x16_bf16 v[64:79], v[28:31], a[36:39], v[64:79]
    ds_read_b64_tr_b16 v[20:21], v12 offset:20480
    ds_read_b64_tr_b16 v[22:23], v12 offset:21504
    s_waitcnt lgkmcnt(2)
    v_mfma_f32_32x32x16_bf16 v[80:95], v[32:35], a[36:39], v[80:95]
    ds_read_b64_tr_b16 v[24:25], v13 offset:20480
    ds_read_b64_tr_b16 v[26:27], v13 offset:21504
    buffer_load_dwordx4 a[36:39], v2, s[32:35], s66 offen offset:1024
    s_waitcnt vmcnt(30) lgkmcnt(2)
    v_mfma_f32_32x32x16_bf16 v[64:79], v[20:23], a[40:43], v[64:79]
    ds_read_b64_tr_b16 v[28:29], v12 offset:22528
    ds_read_b64_tr_b16 v[30:31], v12 offset:23552
    buffer_load_dwordx4 v11, s[36:39], s67 offen offset:3072 lds
    s_waitcnt lgkmcnt(2)
    v_mfma_f32_32x32x16_bf16 v[80:95], v[24:27], a[40:43], v[80:95]
    ds_read_b64_tr_b16 v[32:33], v13 offset:22528
    ds_read_b64_tr_b16 v[34:35], v13 offset:23552
    buffer_load_dwordx4 a[40:43], v2, s[32:35], s66 offen offset:2048
    s_waitcnt vmcnt(30) lgkmcnt(2)
    v_mfma_f32_32x32x16_bf16 v[64:79], v[28:31], a[44:47], v[64:79]
    ds_read_b64_tr_b16 v[20:21], v12 offset:24576
    ds_read_b64_tr_b16 v[22:23], v12 offset:25600
    s_waitcnt lgkmcnt(2)
    v_mfma_f32_32x32x16_bf16 v[80:95], v[32:35], a[44:47], v[80:95]
    ds_read_b64_tr_b16 v[24:25], v13 offset:24576
    ds_read_b64_tr_b16 v[26:27], v13 offset:25600
    buffer_load_dwordx4 a[44:47], v2, s[32:35], s66 offen offset:3072
    s_waitcnt vmcnt(29) lgkmcnt(2)
    v_mfma_f32_32x32x16_bf16 v[64:79], v[20:23], a[48:51], v[64:79]
    ds_read_b64_tr_b16 v[28:29], v12 offset:26624
    ds_read_b64_tr_b16 v[30:31], v12 offset:27648
    s_add_u32 m0, s63, 0x10000
    s_add_u32 s67, s61, 0x120000
    buffer_load_dwordx4 v8, s[36:39], s67 offen offset:0 lds
    s_waitcnt lgkmcnt(2)
    v_mfma_f32_32x32x16_bf16 v[80:95], v[24:27], a[48:51], v[80:95]
    ds_read_b64_tr_b16 v[32:33], v13 offset:26624
    ds_read_b64_tr_b16 v[34:35], v13 offset:27648
    s_add_u32 s66, s60, 0xe000
    buffer_load_dwordx4 a[48:51], v2, s[32:35], s66 offen offset:0
    s_waitcnt vmcnt(30) lgkmcnt(2)
    v_mfma_f32_32x32x16_bf16 v[64:79], v[28:31], a[52:55], v[64:79]
    ds_read_b64_tr_b16 v[20:21], v12 offset:28672
    ds_read_b64_tr_b16 v[22:23], v12 offset:29696
    s_waitcnt lgkmcnt(2)
    v_mfma_f32_32x32x16_bf16 v[80:95], v[32:35], a[52:55], v[80:95]
    ds_read_b64_tr_b16 v[24:25], v13 offset:28672
    ds_read_b64_tr_b16 v[26:27], v13 offset:29696
    buffer_load_dwordx4 a[52:55], v2, s[32:35], s66 offen offset:1024
    s_waitcnt vmcnt(29) lgkmcnt(2)
    v_mfma_f32_32x32x16_bf16 v[64:79], v[20:23], a[56:59], v[64:79]
    ds_read_b64_tr_b16 v[28:29], v12 offset:30720
    ds_read_b64_tr_b16 v[30:31], v12 offset:31744
    buffer_load_dwordx4 v9, s[36:39], s67 offen offset:1024 lds
    s_waitcnt lgkmcnt(2)
    v_mfma_f32_32x32x16_bf16 v[80:95], v[24:27], a[56:59], v[80:95]
    ds_read_b64_tr_b16 v[32:33], v13 offset:30720
    ds_read_b64_tr_b16 v[34:35], v13 offset:31744
    buffer_load_dwordx4 a[56:59], v2, s[32:35], s66 offen offset:2048
    s_waitcnt lgkmcnt(0)
    s_barrier
    s_waitcnt vmcnt(30)
    v_mfma_f32_32x32x16_bf16 v[64:79], v[28:31], a[60:63], v[64:79]
    ds_read_b64_tr_b16 v[20:21], v6 offset:0
    ds_read_b64_tr_b16 v[22:23], v6 offset:1024
    v_mfma_f32_32x32x16_bf16 v[80:95], v[32:35], a[60:63], v[80:95]
    ds_read_b64_tr_b16 v[24:25], v7 offset:0
    ds_read_b64_tr_b16 v[26:27], v7 offset:1024
    buffer_load_dwordx4 a[60:63], v2, s[32:35], s66 offen offset:3072
    s_waitcnt vmcnt(29) lgkmcnt(2)
    v_mfma_f32_32x32x16_bf16 v[64:79], v[20:23], a[64:67], v[64:79]
    ds_read_b64_tr_b16 v[28:29], v6 offset:2048
    ds_read_b64_tr_b16 v[30:31], v6 offset:3072
    buffer_load_dwordx4 v10, s[36:39], s67 offen offset:2048 lds
    s_waitcnt lgkmcnt(2)
    v_mfma_f32_32x32x16_bf16 v[80:95], v[24:27], a[64:67], v[80:95]
    ds_read_b64_tr_b16 v[32:33], v7 offset:2048
    ds_read_b64_tr_b16 v[34:35], v7 offset:3072
    s_add_u32 s66, s60, 0xf000
    buffer_load_dwordx4 a[64:67], v2, s[32:35], s66 offen offset:0
    s_waitcnt vmcnt(30) lgkmcnt(2)
    v_mfma_f32_32x32x16_bf16 v[64:79], v[28:31], a[68:71], v[64:79]
    ds_read_b64_tr_b16 v[20:21], v6 offset:4096
    ds_read_b64_tr_b16 v[22:23], v6 offset:5120
    s_waitcnt lgkmcnt(2)
    v_mfma_f32_32x32x16_bf16 v[80:95], v[32:35], a[68:71], v[80:95]
    ds_read_b64_tr_b16 v[24:25], v7 offset:4096
    ds_read_b64_tr_b16 v[26:27], v7 offset:5120
    buffer_load_dwordx4 a[68:71], v2, s[32:35], s66 offen offset:1024
    s_waitcnt vmcnt(29) lgkmcnt(2)
    v_mfma_f32_32x32x16_bf16 v[64:79], v[20:23], a[72:75], v[64:79]
    ds_read_b64_tr_b16 v[28:29], v6 offset:6144
    ds_read_b64_tr_b16 v[30:31], v6 offset:7168
    buffer_load_dwordx4 v11, s[36:39], s67 offen offset:3072 lds
    s_waitcnt lgkmcnt(2)
    v_mfma_f32_32x32x16_bf16 v[80:95], v[24:27], a[72:75], v[80:95]
    ds_read_b64_tr_b16 v[32:33], v7 offset:6144
    ds_read_b64_tr_b16 v[34:35], v7 offset:7168
    buffer_load_dwordx4 a[72:75], v2, s[32:35], s66 offen offset:2048
    s_waitcnt vmcnt(29) lgkmcnt(2)
    v_mfma_f32_32x32x16_bf16 v[64:79], v[28:31], a[76:79], v[64:79]
    ds_read_b64_tr_b16 v[20:21], v6 offset:8192
    ds_read_b64_tr_b16 v[22:23], v6 offset:9216
    s_waitcnt lgkmcnt(2)
    v_mfma_f32_32x32x16_bf16 v[80:95], v[32:35], a[76:79], v[80:95]
    ds_read_b64_tr_b16 v[24:25], v7 offset:8192
    ds_read_b64_tr_b16 v[26:27], v7 offset:9216
    buffer_load_dwordx4 a[76:79], v2, s[32:35], s66 offen offset:3072
    s_waitcnt vmcnt(28) lgkmcnt(2)
    v_mfma_f32_32x32x16_bf16 v[64:79], v[20:23], a[0:3], v[64:79]
    ds_read_b64_tr_b16 v[28:29], v6 offset:10240
    ds_read_b64_tr_b16 v[30:31], v6 offset:11264
    s_add_u32 m0, s63, 0x14000
    s_add_u32 s67, s61, 0x140000
    buffer_load_dwordx4 v8, s[36:39], s67 offen offset:0 lds
    s_waitcnt lgkmcnt(2)
    v_mfma_f32_32x32x16_bf16 v[80:95], v[24:27], a[0:3], v[80:95]
    ds_read_b64_tr_b16 v[32:33], v7 offset:10240
    ds_read_b64_tr_b16 v[34:35], v7 offset:11264
    s_add_u32 s66, s60, 0x10000
    buffer_load_dwordx4 a[0:3], v2, s[32:35], s66 offen offset:0
    s_waitcnt vmcnt(29) lgkmcnt(2)
    v_mfma_f32_32x32x16_bf16 v[64:79], v[28:31], a[4:7], v[64:79]
    ds_read_b64_tr_b16 v[20:21], v6 offset:12288
    ds_read_b64_tr_b16 v[22:23], v6 offset:13312
    s_waitcnt lgkmcnt(2)
    v_mfma_f32_32x32x16_bf16 v[80:95], v[32:35], a[4:7], v[80:95]
    ds_read_b64_tr_b16 v[24:25], v7 offset:12288
    ds_read_b64_tr_b16 v[26:27], v7 offset:13312
    buffer_load_dwordx4 a[4:7], v2, s[32:35], s66 offen offset:1024
    s_waitcnt vmcnt(28) lgkmcnt(2)
    v_mfma_f32_32x32x16_bf16 v[64:79], v[20:23], a[8:11], v[64:79]
    ds_read_b64_tr_b16 v[28:29], v6 offset:14336
    ds_read_b64_tr_b16 v[30:31], v6 offset:15360
    buffer_load_dwordx4 v9, s[36:39], s67 offen offset:1024 lds
    s_waitcnt lgkmcnt(2)
    v_mfma_f32_32x32x16_bf16 v[80:95], v[24:27], a[8:11], v[80:95]
    ds_read_b64_tr_b16 v[32:33], v7 offset:14336
    ds_read_b64_tr_b16 v[34:35], v7 offset:15360
    buffer_load_dwordx4 a[8:11], v2, s[32:35], s66 offen offset:2048
    s_waitcnt lgkmcnt(0)
    s_barrier
    s_waitcnt vmcnt(29)
    v_mfma_f32_32x32x16_bf16 v[64:79], v[28:31], a[12:15], v[64:79]
    ds_read_b64_tr_b16 v[20:21], v6 offset:16384
    ds_read_b64_tr_b16 v[22:23], v6 offset:17408
    v_mfma_f32_32x32x16_bf16 v[80:95], v[32:35], a[12:15], v[80:95]
    ds_read_b64_tr_b16 v[24:25], v7 offset:16384
    ds_read_b64_tr_b16 v[26:27], v7 offset:17408
    buffer_load_dwordx4 a[12:15], v2, s[32:35], s66 offen offset:3072
    s_waitcnt vmcnt(28) lgkmcnt(2)
    v_mfma_f32_32x32x16_bf16 v[64:79], v[20:23], a[16:19], v[64:79]
    ds_read_b64_tr_b16 v[28:29], v6 offset:18432
    ds_read_b64_tr_b16 v[30:31], v6 offset:19456
    buffer_load_dwordx4 v10, s[36:39], s67 offen offset:2048 lds
    s_waitcnt lgkmcnt(2)
    v_mfma_f32_32x32x16_bf16 v[80:95], v[24:27], a[16:19], v[80:95]
    ds_read_b64_tr_b16 v[32:33], v7 offset:18432
    ds_read_b64_tr_b16 v[34:35], v7 offset:19456
    s_add_u32 s66, s60, 0x11000
    buffer_load_dwordx4 a[16:19], v2, s[32:35], s66 offen offset:0
    s_waitcnt vmcnt(29) lgkmcnt(2)
    v_mfma_f32_32x32x16_bf16 v[64:79], v[28:31], a[20:23], v[64:79]
    ds_read_b64_tr_b16 v[20:21], v6 offset:20480
    ds_read_b64_tr_b16 v[22:23], v6 offset:21504
    s_waitcnt lgkmcnt(2)
    v_mfma_f32_32x32x16_bf16 v[80:95], v[32:35], a[20:23], v[80:95]
    ds_read_b64_tr_b16 v[24:25], v7 offset:20480
    ds_read_b64_tr_b16 v[26:27], v7 offset:21504
    buffer_load_dwordx4 a[20:23], v2, s[32:35], s66 offen offset:1024
    s_waitcnt vmcnt(28) lgkmcnt(2)
    v_mfma_f32_32x32x16_bf16 v[64:79], v[20:23], a[24:27], v[64:79]
    ds_read_b64_tr_b16 v[28:29], v6 offset:22528
    ds_read_b64_tr_b16 v[30:31], v6 offset:23552
    buffer_load_dwordx4 v11, s[36:39], s67 offen offset:3072 lds
    s_waitcnt lgkmcnt(2)
    v_mfma_f32_32x32x16_bf16 v[80:95], v[24:27], a[24:27], v[80:95]
    ds_read_b64_tr_b16 v[32:33], v7 offset:22528
    ds_read_b64_tr_b16 v[34:35], v7 offset:23552
    buffer_load_dwordx4 a[24:27], v2, s[32:35], s66 offen offset:2048
    s_waitcnt vmcnt(29) lgkmcnt(2)
    v_mfma_f32_32x32x16_bf16 v[64:79], v[28:31], a[28:31], v[64:79]
    ds_read_b64_tr_b16 v[20:21], v6 offset:24576
    ds_read_b64_tr_b16 v[22:23], v6 offset:25600
    s_waitcnt lgkmcnt(2)
    v_mfma_f32_32x32x16_bf16 v[80:95], v[32:35], a[28:31], v[80:95]
    ds_read_b64_tr_b16 v[24:25], v7 offset:24576
    ds_read_b64_tr_b16 v[26:27], v7 offset:25600
    buffer_load_dwordx4 a[28:31], v2, s[32:35], s66 offen offset:3072
    s_waitcnt vmcnt(28) lgkmcnt(2)
    v_mfma_f32_32x32x16_bf16 v[64:79], v[20:23], a[32:35], v[64:79]
    ds_read_b64_tr_b16 v[28:29], v6 offset:26624
    ds_read_b64_tr_b16 v[30:31], v6 offset:27648
    s_add_u32 m0, s63, 0
    s_add_u32 s67, s61, 0x160000
    buffer_load_dwordx4 v8, s[36:39], s67 offen offset:0 lds
    s_waitcnt lgkmcnt(2)
    v_mfma_f32_32x32x16_bf16 v[80:95], v[24:27], a[32:35], v[80:95]
    ds_read_b64_tr_b16 v[32:33], v7 offset:26624
    ds_read_b64_tr_b16 v[34:35], v7 offset:27648
    s_add_u32 s66, s60, 0x12000
    buffer_load_dwordx4 a[32:35], v2, s[32:35], s66 offen offset:0
    s_waitcnt vmcnt(29) lgkmcnt(2)
    v_mfma_f32_32x32x16_bf16 v[64:79], v[28:31], a[36:39], v[64:79]
    ds_read_b64_tr_b16 v[20:21], v6 offset:28672
    ds_read_b64_tr_b16 v[22:23], v6 offset:29696
    s_waitcnt lgkmcnt(2)
    v_mfma_f32_32x32x16_bf16 v[80:95], v[32:35], a[36:39], v[80:95]
    ds_read_b64_tr_b16 v[24:25], v7 offset:28672
    ds_read_b64_tr_b16 v[26:27], v7 offset:29696
    buffer_load_dwordx4 a[36:39], v2, s[32:35], s66 offen offset:1024
    s_waitcnt vmcnt(28) lgkmcnt(2)
    v_mfma_f32_32x32x16_bf16 v[64:79], v[20:23], a[40:43], v[64:79]
    ds_read_b64_tr_b16 v[28:29], v6 offset:30720
    ds_read_b64_tr_b16 v[30:31], v6 offset:31744
    buffer_load_dwordx4 v9, s[36:39], s67 offen offset:1024 lds
    s_waitcnt lgkmcnt(2)
    v_mfma_f32_32x32x16_bf16 v[80:95], v[24:27], a[40:43], v[80:95]
    ds_read_b64_tr_b16 v[32:33], v7 offset:30720
    ds_read_b64_tr_b16 v[34:35], v7 offset:31744
    buffer_load_dwordx4 a[40:43], v2, s[32:35], s66 offen offset:2048
    s_waitcnt lgkmcnt(0)
    s_barrier
    s_waitcnt vmcnt(29)
    v_mfma_f32_32x32x16_bf16 v[64:79], v[28:31], a[44:47], v[64:79]
    ds_read_b64_tr_b16 v[20:21], v6 offset:32768
    ds_read_b64_tr_b16 v[22:23], v6 offset:33792
    v_mfma_f32_32x32x16_bf16 v[80:95], v[32:35], a[44:47], v[80:95]
    ds_read_b64_tr_b16 v[24:25], v7 offset:32768
    ds_read_b64_tr_b16 v[26:27], v7 offset:33792
    buffer_load_dwordx4 a[44:47], v2, s[32:35], s66 offen offset:3072
    s_waitcnt vmcnt(28) lgkmcnt(2)
    v_mfma_f32_32x32x16_bf16 v[64:79], v[20:23], a[48:51], v[64:79]
    ds_read_b64_tr_b16 v[28:29], v6 offset:34816
    ds_read_b64_tr_b16 v[30:31], v6 offset:35840
    buffer_load_dwordx4 v10, s[36:39], s67 offen offset:2048 lds
    s_waitcnt lgkmcnt(2)
    v_mfma_f32_32x32x16_bf16 v[80:95], v[24:27], a[48:51], v[80:95]
    ds_read_b64_tr_b16 v[32:33], v7 offset:34816
    ds_read_b64_tr_b16 v[34:35], v7 offset:35840
    s_add_u32 s66, s60, 0x13000
    buffer_load_dwordx4 a[48:51], v2, s[32:35], s66 offen offset:0
    s_waitcnt vmcnt(29) lgkmcnt(2)
    v_mfma_f32_32x32x16_bf16 v[64:79], v[28:31], a[52:55], v[64:79]
    ds_read_b64_tr_b16 v[20:21], v6 offset:36864
    ds_read_b64_tr_b16 v[22:23], v6 offset:37888
    s_waitcnt lgkmcnt(2)
    v_mfma_f32_32x32x16_bf16 v[80:95], v[32:35], a[52:55], v[80:95]
    ds_read_b64_tr_b16 v[24:25], v7 offset:36864
    ds_read_b64_tr_b16 v[26:27], v7 offset:37888
    buffer_load_dwordx4 a[52:55], v2, s[32:35], s66 offen offset:1024
    s_waitcnt vmcnt(28) lgkmcnt(2)
    v_mfma_f32_32x32x16_bf16 v[64:79], v[20:23], a[56:59], v[64:79]
    ds_read_b64_tr_b16 v[28:29], v6 offset:38912
    ds_read_b64_tr_b16 v[30:31], v6 offset:39936
    buffer_load_dwordx4 v11, s[36:39], s67 offen offset:3072 lds
    s_waitcnt lgkmcnt(2)
    v_mfma_f32_32x32x16_bf16 v[80:95], v[24:27], a[56:59], v[80:95]
    ds_read_b64_tr_b16 v[32:33], v7 offset:38912
    ds_read_b64_tr_b16 v[34:35], v7 offset:39936
    buffer_load_dwordx4 a[56:59], v2, s[32:35], s66 offen offset:2048
    s_waitcnt vmcnt(29) lgkmcnt(2)
    v_mfma_f32_32x32x16_bf16 v[64:79], v[28:31], a[60:63], v[64:79]
    ds_read_b64_tr_b16 v[20:21], v6 offset:40960
    ds_read_b64_tr_b16 v[22:23], v6 offset:41984
    s_waitcnt lgkmcnt(2)
    v_mfma_f32_32x32x16_bf16 v[80:95], v[32:35], a[60:63], v[80:95]
    ds_read_b64_tr_b16 v[24:25], v7 offset:40960
    ds_read_b64_tr_b16 v[26:27], v7 offset:41984
    buffer_load_dwordx4 a[60:63], v2, s[32:35], s66 offen offset:3072
    s_waitcnt vmcnt(28) lgkmcnt(2)
    v_mfma_f32_32x32x16_bf16 v[64:79], v[20:23], a[64:67], v[64:79]
    ds_read_b64_tr_b16 v[28:29], v6 offset:43008
    ds_read_b64_tr_b16 v[30:31], v6 offset:44032
    s_add_u32 m0, s63, 0x4000
    s_add_u32 s67, s61, 0x180000
    buffer_load_dwordx4 v8, s[36:39], s67 offen offset:0 lds
    s_waitcnt lgkmcnt(2)
    v_mfma_f32_32x32x16_bf16 v[80:95], v[24:27], a[64:67], v[80:95]
    ds_read_b64_tr_b16 v[32:33], v7 offset:43008
    ds_read_b64_tr_b16 v[34:35], v7 offset:44032
    s_add_u32 s66, s60, 0x14000
    buffer_load_dwordx4 a[64:67], v2, s[32:35], s66 offen offset:0
    s_waitcnt vmcnt(29) lgkmcnt(2)
    v_mfma_f32_32x32x16_bf16 v[64:79], v[28:31], a[68:71], v[64:79]
    ds_read_b64_tr_b16 v[20:21], v6 offset:45056
    ds_read_b64_tr_b16 v[22:23], v6 offset:46080
    s_waitcnt lgkmcnt(2)
    v_mfma_f32_32x32x16_bf16 v[80:95], v[32:35], a[68:71], v[80:95]
    ds_read_b64_tr_b16 v[24:25], v7 offset:45056
    ds_read_b64_tr_b16 v[26:27], v7 offset:46080
    buffer_load_dwordx4 a[68:71], v2, s[32:35], s66 offen offset:1024
    s_waitcnt vmcnt(28) lgkmcnt(2)
    v_mfma_f32_32x32x16_bf16 v[64:79], v[20:23], a[72:75], v[64:79]
    ds_read_b64_tr_b16 v[28:29], v6 offset:47104
    ds_read_b64_tr_b16 v[30:31], v6 offset:48128
    buffer_load_dwordx4 v9, s[36:39], s67 offen offset:1024 lds
    s_waitcnt lgkmcnt(2)
    v_mfma_f32_32x32x16_bf16 v[80:95], v[24:27], a[72:75], v[80:95]
    ds_read_b64_tr_b16 v[32:33], v7 offset:47104
    ds_read_b64_tr_b16 v[34:35], v7 offset:48128
    buffer_load_dwordx4 a[72:75], v2, s[32:35], s66 offen offset:2048
    s_waitcnt lgkmcnt(0)
    s_barrier
    s_waitcnt vmcnt(29)
    v_mfma_f32_32x32x16_bf16 v[64:79], v[28:31], a[76:79], v[64:79]
    ds_read_b64_tr_b16 v[20:21], v6 offset:49152
    ds_read_b64_tr_b16 v[22:23], v6 offset:50176
    v_mfma_f32_32x32x16_bf16 v[80:95], v[32:35], a[76:79], v[80:95]
    ds_read_b64_tr_b16 v[24:25], v7 offset:49152
    ds_read_b64_tr_b16 v[26:27], v7 offset:50176
    buffer_load_dwordx4 a[76:79], v2, s[32:35], s66 offen offset:3072
    s_waitcnt vmcnt(28) lgkmcnt(2)
    v_mfma_f32_32x32x16_bf16 v[64:79], v[20:23], a[0:3], v[64:79]
    ds_read_b64_tr_b16 v[28:29], v6 offset:51200
    ds_read_b64_tr_b16 v[30:31], v6 offset:52224
    buffer_load_dwordx4 v10, s[36:39], s67 offen offset:2048 lds
    s_waitcnt lgkmcnt(2)
    v_mfma_f32_32x32x16_bf16 v[80:95], v[24:27], a[0:3], v[80:95]
    ds_read_b64_tr_b16 v[32:33], v7 offset:51200
    ds_read_b64_tr_b16 v[34:35], v7 offset:52224
    s_add_u32 s66, s60, 0x15000
    buffer_load_dwordx4 a[0:3], v2, s[32:35], s66 offen offset:0
    s_waitcnt vmcnt(29) lgkmcnt(2)
    v_mfma_f32_32x32x16_bf16 v[64:79], v[28:31], a[4:7], v[64:79]
    ds_read_b64_tr_b16 v[20:21], v6 offset:53248
    ds_read_b64_tr_b16 v[22:23], v6 offset:54272
    s_waitcnt lgkmcnt(2)
    v_mfma_f32_32x32x16_bf16 v[80:95], v[32:35], a[4:7], v[80:95]
    ds_read_b64_tr_b16 v[24:25], v7 offset:53248
    ds_read_b64_tr_b16 v[26:27], v7 offset:54272
    buffer_load_dwordx4 a[4:7], v2, s[32:35], s66 offen offset:1024
    s_waitcnt vmcnt(28) lgkmcnt(2)
    v_mfma_f32_32x32x16_bf16 v[64:79], v[20:23], a[8:11], v[64:79]
    ds_read_b64_tr_b16 v[28:29], v6 offset:55296
    ds_read_b64_tr_b16 v[30:31], v6 offset:56320
    buffer_load_dwordx4 v11, s[36:39], s67 offen offset:3072 lds
    s_waitcnt lgkmcnt(2)
    v_mfma_f32_32x32x16_bf16 v[80:95], v[24:27], a[8:11], v[80:95]
    ds_read_b64_tr_b16 v[32:33], v7 offset:55296
    ds_read_b64_tr_b16 v[34:35], v7 offset:56320
    buffer_load_dwordx4 a[8:11], v2, s[32:35], s66 offen offset:2048
    s_waitcnt vmcnt(29) lgkmcnt(2)
    v_mfma_f32_32x32x16_bf16 v[64:79], v[28:31], a[12:15], v[64:79]
    ds_read_b64_tr_b16 v[20:21], v6 offset:57344
    ds_read_b64_tr_b16 v[22:23], v6 offset:58368
    s_waitcnt lgkmcnt(2)
    v_mfma_f32_32x32x16_bf16 v[80:95], v[32:35], a[12:15], v[80:95]
    ds_read_b64_tr_b16 v[24:25], v7 offset:57344
    ds_read_b64_tr_b16 v[26:27], v7 offset:58368
    buffer_load_dwordx4 a[12:15], v2, s[32:35], s66 offen offset:3072
    s_waitcnt vmcnt(28) lgkmcnt(2)
    v_mfma_f32_32x32x16_bf16 v[64:79], v[20:23], a[16:19], v[64:79]
    ds_read_b64_tr_b16 v[28:29], v6 offset:59392
    ds_read_b64_tr_b16 v[30:31], v6 offset:60416
    s_add_u32 m0, s63, 0x8000
    s_add_u32 s67, s61, 0x1a0000
    buffer_load_dwordx4 v8, s[36:39], s67 offen offset:0 lds
    s_waitcnt lgkmcnt(2)
    v_mfma_f32_32x32x16_bf16 v[80:95], v[24:27], a[16:19], v[80:95]
    ds_read_b64_tr_b16 v[32:33], v7 offset:59392
    ds_read_b64_tr_b16 v[34:35], v7 offset:60416
    s_add_u32 s66, s60, 0x16000
    buffer_load_dwordx4 a[16:19], v2, s[32:35], s66 offen offset:0
    s_waitcnt vmcnt(29) lgkmcnt(2)
    v_mfma_f32_32x32x16_bf16 v[64:79], v[28:31], a[20:23], v[64:79]
    ds_read_b64_tr_b16 v[20:21], v6 offset:61440
    ds_read_b64_tr_b16 v[22:23], v6 offset:62464
    s_waitcnt lgkmcnt(2)
    v_mfma_f32_32x32x16_bf16 v[80:95], v[32:35], a[20:23], v[80:95]
    ds_read_b64_tr_b16 v[24:25], v7 offset:61440
    ds_read_b64_tr_b16 v[26:27], v7 offset:62464
    buffer_load_dwordx4 a[20:23], v2, s[32:35], s66 offen offset:1024
    s_waitcnt vmcnt(28) lgkmcnt(2)
    v_mfma_f32_32x32x16_bf16 v[64:79], v[20:23], a[24:27], v[64:79]
    ds_read_b64_tr_b16 v[28:29], v6 offset:63488
    ds_read_b64_tr_b16 v[30:31], v6 offset:64512
    buffer_load_dwordx4 v9, s[36:39], s67 offen offset:1024 lds
    s_waitcnt lgkmcnt(2)
    v_mfma_f32_32x32x16_bf16 v[80:95], v[24:27], a[24:27], v[80:95]
    ds_read_b64_tr_b16 v[32:33], v7 offset:63488
    ds_read_b64_tr_b16 v[34:35], v7 offset:64512
    buffer_load_dwordx4 a[24:27], v2, s[32:35], s66 offen offset:2048
    s_waitcnt lgkmcnt(0)
    s_barrier
    s_waitcnt vmcnt(29)
    v_mfma_f32_32x32x16_bf16 v[64:79], v[28:31], a[28:31], v[64:79]
    ds_read_b64_tr_b16 v[20:21], v12 offset:0
    ds_read_b64_tr_b16 v[22:23], v12 offset:1024
    v_mfma_f32_32x32x16_bf16 v[80:95], v[32:35], a[28:31], v[80:95]
    ds_read_b64_tr_b16 v[24:25], v13 offset:0
    ds_read_b64_tr_b16 v[26:27], v13 offset:1024
    buffer_load_dwordx4 a[28:31], v2, s[32:35], s66 offen offset:3072
    s_waitcnt vmcnt(28) lgkmcnt(2)
    v_mfma_f32_32x32x16_bf16 v[64:79], v[20:23], a[32:35], v[64:79]
    ds_read_b64_tr_b16 v[28:29], v12 offset:2048
    ds_read_b64_tr_b16 v[30:31], v12 offset:3072
    buffer_load_dwordx4 v10, s[36:39], s67 offen offset:2048 lds
    s_waitcnt lgkmcnt(2)
    v_mfma_f32_32x32x16_bf16 v[80:95], v[24:27], a[32:35], v[80:95]
    ds_read_b64_tr_b16 v[32:33], v13 offset:2048
    ds_read_b64_tr_b16 v[34:35], v13 offset:3072
    s_add_u32 s66, s60, 0x17000
    buffer_load_dwordx4 a[32:35], v2, s[32:35], s66 offen offset:0
    s_waitcnt vmcnt(29) lgkmcnt(2)
    v_mfma_f32_32x32x16_bf16 v[64:79], v[28:31], a[36:39], v[64:79]
    ds_read_b64_tr_b16 v[20:21], v12 offset:4096
    ds_read_b64_tr_b16 v[22:23], v12 offset:5120
    s_waitcnt lgkmcnt(2)
    v_mfma_f32_32x32x16_bf16 v[80:95], v[32:35], a[36:39], v[80:95]
    ds_read_b64_tr_b16 v[24:25], v13 offset:4096
    ds_read_b64_tr_b16 v[26:27], v13 offset:5120
    buffer_load_dwordx4 a[36:39], v2, s[32:35], s66 offen offset:1024
    s_waitcnt vmcnt(28) lgkmcnt(2)
    v_mfma_f32_32x32x16_bf16 v[64:79], v[20:23], a[40:43], v[64:79]
    ds_read_b64_tr_b16 v[28:29], v12 offset:6144
    ds_read_b64_tr_b16 v[30:31], v12 offset:7168
    buffer_load_dwordx4 v11, s[36:39], s67 offen offset:3072 lds
    s_waitcnt lgkmcnt(2)
    v_mfma_f32_32x32x16_bf16 v[80:95], v[24:27], a[40:43], v[80:95]
    ds_read_b64_tr_b16 v[32:33], v13 offset:6144
    ds_read_b64_tr_b16 v[34:35], v13 offset:7168
    buffer_load_dwordx4 a[40:43], v2, s[32:35], s66 offen offset:2048
    s_waitcnt vmcnt(29) lgkmcnt(2)
    v_mfma_f32_32x32x16_bf16 v[64:79], v[28:31], a[44:47], v[64:79]
    ds_read_b64_tr_b16 v[20:21], v12 offset:8192
    ds_read_b64_tr_b16 v[22:23], v12 offset:9216
    s_waitcnt lgkmcnt(2)
    v_mfma_f32_32x32x16_bf16 v[80:95], v[32:35], a[44:47], v[80:95]
    ds_read_b64_tr_b16 v[24:25], v13 offset:8192
    ds_read_b64_tr_b16 v[26:27], v13 offset:9216
    buffer_load_dwordx4 a[44:47], v2, s[32:35], s66 offen offset:3072
    s_waitcnt vmcnt(28) lgkmcnt(2)
    v_mfma_f32_32x32x16_bf16 v[64:79], v[20:23], a[48:51], v[64:79]
    ds_read_b64_tr_b16 v[28:29], v12 offset:10240
    ds_read_b64_tr_b16 v[30:31], v12 offset:11264
    s_add_u32 m0, s63, 0xc000
    s_add_u32 s67, s61, 0x1c0000
    buffer_load_dwordx4 v8, s[36:39], s67 offen offset:0 lds
    s_waitcnt lgkmcnt(2)
    v_mfma_f32_32x32x16_bf16 v[80:95], v[24:27], a[48:51], v[80:95]
    ds_read_b64_tr_b16 v[32:33], v13 offset:10240
    ds_read_b64_tr_b16 v[34:35], v13 offset:11264
    s_add_u32 s66, s60, 0x18000
    buffer_load_dwordx4 a[48:51], v2, s[32:35], s66 offen offset:0
    s_waitcnt vmcnt(29) lgkmcnt(2)
    v_mfma_f32_32x32x16_bf16 v[64:79], v[28:31], a[52:55], v[64:79]
    ds_read_b64_tr_b16 v[20:21], v12 offset:12288
    ds_read_b64_tr_b16 v[22:23], v12 offset:13312
    s_waitcnt lgkmcnt(2)
    v_mfma_f32_32x32x16_bf16 v[80:95], v[32:35], a[52:55], v[80:95]
    ds_read_b64_tr_b16 v[24:25], v13 offset:12288
    ds_read_b64_tr_b16 v[26:27], v13 offset:13312
    buffer_load_dwordx4 a[52:55], v2, s[32:35], s66 offen offset:1024
    s_waitcnt vmcnt(28) lgkmcnt(2)
    v_mfma_f32_32x32x16_bf16 v[64:79], v[20:23], a[56:59], v[64:79]
    ds_read_b64_tr_b16 v[28:29], v12 offset:14336
    ds_read_b64_tr_b16 v[30:31], v12 offset:15360
    buffer_load_dwordx4 v9, s[36:39], s67 offen offset:1024 lds
    s_waitcnt lgkmcnt(2)
    v_mfma_f32_32x32x16_bf16 v[80:95], v[24:27], a[56:59], v[80:95]
    ds_read_b64_tr_b16 v[32:33], v13 offset:14336
    ds_read_b64_tr_b16 v[34:35], v13 offset:15360
    buffer_load_dwordx4 a[56:59], v2, s[32:35], s66 offen offset:2048
    s_waitcnt lgkmcnt(0)
    s_barrier
    s_waitcnt vmcnt(29)
    v_mfma_f32_32x32x16_bf16 v[64:79], v[28:31], a[60:63], v[64:79]
    ds_read_b64_tr_b16 v[20:21], v12 offset:16384
    ds_read_b64_tr_b16 v[22:23], v12 offset:17408
    v_mfma_f32_32x32x16_bf16 v[80:95], v[32:35], a[60:63], v[80:95]
    ds_read_b64_tr_b16 v[24:25], v13 offset:16384
    ds_read_b64_tr_b16 v[26:27], v13 offset:17408
    buffer_load_dwordx4 a[60:63], v2, s[32:35], s66 offen offset:3072
    s_waitcnt vmcnt(28) lgkmcnt(2)
    v_mfma_f32_32x32x16_bf16 v[64:79], v[20:23], a[64:67], v[64:79]
    ds_read_b64_tr_b16 v[28:29], v12 offset:18432
    ds_read_b64_tr_b16 v[30:31], v12 offset:19456
    buffer_load_dwordx4 v10, s[36:39], s67 offen offset:2048 lds
    s_waitcnt lgkmcnt(2)
    v_mfma_f32_32x32x16_bf16 v[80:95], v[24:27], a[64:67], v[80:95]
    ds_read_b64_tr_b16 v[32:33], v13 offset:18432
    ds_read_b64_tr_b16 v[34:35], v13 offset:19456
    s_add_u32 s66, s60, 0x19000
    buffer_load_dwordx4 a[64:67], v2, s[32:35], s66 offen offset:0
    s_waitcnt vmcnt(29) lgkmcnt(2)
    v_mfma_f32_32x32x16_bf16 v[64:79], v[28:31], a[68:71], v[64:79]
    ds_read_b64_tr_b16 v[20:21], v12 offset:20480
    ds_read_b64_tr_b16 v[22:23], v12 offset:21504
    s_waitcnt lgkmcnt(2)
    v_mfma_f32_32x32x16_bf16 v[80:95], v[32:35], a[68:71], v[80:95]
    ds_read_b64_tr_b16 v[24:25], v13 offset:20480
    ds_read_b64_tr_b16 v[26:27], v13 offset:21504
    buffer_load_dwordx4 a[68:71], v2, s[32:35], s66 offen offset:1024
    s_waitcnt vmcnt(28) lgkmcnt(2)
    v_mfma_f32_32x32x16_bf16 v[64:79], v[20:23], a[72:75], v[64:79]
    ds_read_b64_tr_b16 v[28:29], v12 offset:22528
    ds_read_b64_tr_b16 v[30:31], v12 offset:23552
    buffer_load_dwordx4 v11, s[36:39], s67 offen offset:3072 lds
    s_waitcnt lgkmcnt(2)
    v_mfma_f32_32x32x16_bf16 v[80:95], v[24:27], a[72:75], v[80:95]
    ds_read_b64_tr_b16 v[32:33], v13 offset:22528
    ds_read_b64_tr_b16 v[34:35], v13 offset:23552
    buffer_load_dwordx4 a[72:75], v2, s[32:35], s66 offen offset:2048
    s_waitcnt vmcnt(29) lgkmcnt(2)
    v_mfma_f32_32x32x16_bf16 v[64:79], v[28:31], a[76:79], v[64:79]
    ds_read_b64_tr_b16 v[20:21], v12 offset:24576
    ds_read_b64_tr_b16 v[22:23], v12 offset:25600
    s_waitcnt lgkmcnt(2)
    v_mfma_f32_32x32x16_bf16 v[80:95], v[32:35], a[76:79], v[80:95]
    ds_read_b64_tr_b16 v[24:25], v13 offset:24576
    ds_read_b64_tr_b16 v[26:27], v13 offset:25600
    buffer_load_dwordx4 a[76:79], v2, s[32:35], s66 offen offset:3072
    s_waitcnt vmcnt(28) lgkmcnt(2)
    v_mfma_f32_32x32x16_bf16 v[64:79], v[20:23], a[0:3], v[64:79]
    ds_read_b64_tr_b16 v[28:29], v12 offset:26624
    ds_read_b64_tr_b16 v[30:31], v12 offset:27648
    s_waitcnt lgkmcnt(2)
    v_mfma_f32_32x32x16_bf16 v[80:95], v[24:27], a[0:3], v[80:95]
    ds_read_b64_tr_b16 v[32:33], v13 offset:26624
    ds_read_b64_tr_b16 v[34:35], v13 offset:27648
    s_add_u32 s66, s60, 0x1a000
    buffer_load_dwordx4 a[0:3], v2, s[32:35], s66 offen offset:0
    s_waitcnt vmcnt(28) lgkmcnt(2)
    v_mfma_f32_32x32x16_bf16 v[64:79], v[28:31], a[4:7], v[64:79]
    ds_read_b64_tr_b16 v[20:21], v12 offset:28672
    ds_read_b64_tr_b16 v[22:23], v12 offset:29696
    s_waitcnt lgkmcnt(2)
    v_mfma_f32_32x32x16_bf16 v[80:95], v[32:35], a[4:7], v[80:95]
    ds_read_b64_tr_b16 v[24:25], v13 offset:28672
    ds_read_b64_tr_b16 v[26:27], v13 offset:29696
    buffer_load_dwordx4 a[4:7], v2, s[32:35], s66 offen offset:1024
    s_waitcnt vmcnt(27) lgkmcnt(2)
    v_mfma_f32_32x32x16_bf16 v[64:79], v[20:23], a[8:11], v[64:79]
    ds_read_b64_tr_b16 v[28:29], v12 offset:30720
    ds_read_b64_tr_b16 v[30:31], v12 offset:31744
    s_waitcnt lgkmcnt(2)
    v_mfma_f32_32x32x16_bf16 v[80:95], v[24:27], a[8:11], v[80:95]
    ds_read_b64_tr_b16 v[32:33], v13 offset:30720
    ds_read_b64_tr_b16 v[34:35], v13 offset:31744
    buffer_load_dwordx4 a[8:11], v2, s[32:35], s66 offen offset:2048
    s_waitcnt lgkmcnt(0)
    s_barrier
    s_waitcnt vmcnt(27)
    v_mfma_f32_32x32x16_bf16 v[64:79], v[28:31], a[12:15], v[64:79]
    ds_read_b64_tr_b16 v[20:21], v6 offset:0
    ds_read_b64_tr_b16 v[22:23], v6 offset:1024
    v_mfma_f32_32x32x16_bf16 v[80:95], v[32:35], a[12:15], v[80:95]
    ds_read_b64_tr_b16 v[24:25], v7 offset:0
    ds_read_b64_tr_b16 v[26:27], v7 offset:1024
    buffer_load_dwordx4 a[12:15], v2, s[32:35], s66 offen offset:3072
    s_waitcnt vmcnt(26) lgkmcnt(2)
    v_mfma_f32_32x32x16_bf16 v[64:79], v[20:23], a[16:19], v[64:79]
    ds_read_b64_tr_b16 v[28:29], v6 offset:2048
    ds_read_b64_tr_b16 v[30:31], v6 offset:3072
    s_waitcnt lgkmcnt(2)
    v_mfma_f32_32x32x16_bf16 v[80:95], v[24:27], a[16:19], v[80:95]
    ds_read_b64_tr_b16 v[32:33], v7 offset:2048
    ds_read_b64_tr_b16 v[34:35], v7 offset:3072
    s_add_u32 s66, s60, 0x1b000
    buffer_load_dwordx4 a[16:19], v2, s[32:35], s66 offen offset:0
    s_waitcnt vmcnt(26) lgkmcnt(2)
    v_mfma_f32_32x32x16_bf16 v[64:79], v[28:31], a[20:23], v[64:79]
    ds_read_b64_tr_b16 v[20:21], v6 offset:4096
    ds_read_b64_tr_b16 v[22:23], v6 offset:5120
    s_waitcnt lgkmcnt(2)
    v_mfma_f32_32x32x16_bf16 v[80:95], v[32:35], a[20:23], v[80:95]
    ds_read_b64_tr_b16 v[24:25], v7 offset:4096
    ds_read_b64_tr_b16 v[26:27], v7 offset:5120
    buffer_load_dwordx4 a[20:23], v2, s[32:35], s66 offen offset:1024
    s_waitcnt vmcnt(25) lgkmcnt(2)
    v_mfma_f32_32x32x16_bf16 v[64:79], v[20:23], a[24:27], v[64:79]
    ds_read_b64_tr_b16 v[28:29], v6 offset:6144
    ds_read_b64_tr_b16 v[30:31], v6 offset:7168
    s_waitcnt lgkmcnt(2)
    v_mfma_f32_32x32x16_bf16 v[80:95], v[24:27], a[24:27], v[80:95]
    ds_read_b64_tr_b16 v[32:33], v7 offset:6144
    ds_read_b64_tr_b16 v[34:35], v7 offset:7168
    buffer_load_dwordx4 a[24:27], v2, s[32:35], s66 offen offset:2048
    s_waitcnt vmcnt(25) lgkmcnt(2)
    v_mfma_f32_32x32x16_bf16 v[64:79], v[28:31], a[28:31], v[64:79]
    ds_read_b64_tr_b16 v[20:21], v6 offset:8192
    ds_read_b64_tr_b16 v[22:23], v6 offset:9216
    s_waitcnt lgkmcnt(2)
    v_mfma_f32_32x32x16_bf16 v[80:95], v[32:35], a[28:31], v[80:95]
    ds_read_b64_tr_b16 v[24:25], v7 offset:8192
    ds_read_b64_tr_b16 v[26:27], v7 offset:9216
    buffer_load_dwordx4 a[28:31], v2, s[32:35], s66 offen offset:3072
    s_waitcnt vmcnt(24) lgkmcnt(2)
    v_mfma_f32_32x32x16_bf16 v[64:79], v[20:23], a[32:35], v[64:79]
    ds_read_b64_tr_b16 v[28:29], v6 offset:10240
    ds_read_b64_tr_b16 v[30:31], v6 offset:11264
    s_waitcnt lgkmcnt(2)
    v_mfma_f32_32x32x16_bf16 v[80:95], v[24:27], a[32:35], v[80:95]
    ds_read_b64_tr_b16 v[32:33], v7 offset:10240
    ds_read_b64_tr_b16 v[34:35], v7 offset:11264
    s_add_u32 s66, s60, 0x1c000
    buffer_load_dwordx4 a[32:35], v2, s[32:35], s66 offen offset:0
    s_waitcnt vmcnt(24) lgkmcnt(2)
    v_mfma_f32_32x32x16_bf16 v[64:79], v[28:31], a[36:39], v[64:79]
    ds_read_b64_tr_b16 v[20:21], v6 offset:12288
    ds_read_b64_tr_b16 v[22:23], v6 offset:13312
    s_waitcnt lgkmcnt(2)
    v_mfma_f32_32x32x16_bf16 v[80:95], v[32:35], a[36:39], v[80:95]
    ds_read_b64_tr_b16 v[24:25], v7 offset:12288
    ds_read_b64_tr_b16 v[26:27], v7 offset:13312
    buffer_load_dwordx4 a[36:39], v2, s[32:35], s66 offen offset:1024
    s_waitcnt vmcnt(23) lgkmcnt(2)
    v_mfma_f32_32x32x16_bf16 v[64:79], v[20:23], a[40:43], v[64:79]
    ds_read_b64_tr_b16 v[28:29], v6 offset:14336
    ds_read_b64_tr_b16 v[30:31], v6 offset:15360
    s_waitcnt lgkmcnt(2)
    v_mfma_f32_32x32x16_bf16 v[80:95], v[24:27], a[40:43], v[80:95]
    ds_read_b64_tr_b16 v[32:33], v7 offset:14336
    ds_read_b64_tr_b16 v[34:35], v7 offset:15360
    buffer_load_dwordx4 a[40:43], v2, s[32:35], s66 offen offset:2048
    s_waitcnt lgkmcnt(0)
    s_barrier
    s_waitcnt vmcnt(23)
    v_mfma_f32_32x32x16_bf16 v[64:79], v[28:31], a[44:47], v[64:79]
    ds_read_b64_tr_b16 v[20:21], v6 offset:16384
    ds_read_b64_tr_b16 v[22:23], v6 offset:17408
    v_mfma_f32_32x32x16_bf16 v[80:95], v[32:35], a[44:47], v[80:95]
    ds_read_b64_tr_b16 v[24:25], v7 offset:16384
    ds_read_b64_tr_b16 v[26:27], v7 offset:17408
    buffer_load_dwordx4 a[44:47], v2, s[32:35], s66 offen offset:3072
    s_waitcnt vmcnt(22) lgkmcnt(2)
    v_mfma_f32_32x32x16_bf16 v[64:79], v[20:23], a[48:51], v[64:79]
    ds_read_b64_tr_b16 v[28:29], v6 offset:18432
    ds_read_b64_tr_b16 v[30:31], v6 offset:19456
    s_waitcnt lgkmcnt(2)
    v_mfma_f32_32x32x16_bf16 v[80:95], v[24:27], a[48:51], v[80:95]
    ds_read_b64_tr_b16 v[32:33], v7 offset:18432
    ds_read_b64_tr_b16 v[34:35], v7 offset:19456
    s_add_u32 s66, s60, 0x1d000
    buffer_load_dwordx4 a[48:51], v2, s[32:35], s66 offen offset:0
    s_waitcnt vmcnt(22) lgkmcnt(2)
    v_mfma_f32_32x32x16_bf16 v[64:79], v[28:31], a[52:55], v[64:79]
    ds_read_b64_tr_b16 v[20:21], v6 offset:20480
    ds_read_b64_tr_b16 v[22:23], v6 offset:21504
    s_waitcnt lgkmcnt(2)
    v_mfma_f32_32x32x16_bf16 v[80:95], v[32:35], a[52:55], v[80:95]
    ds_read_b64_tr_b16 v[24:25], v7 offset:20480
    ds_read_b64_tr_b16 v[26:27], v7 offset:21504
    buffer_load_dwordx4 a[52:55], v2, s[32:35], s66 offen offset:1024
    s_waitcnt vmcnt(21) lgkmcnt(2)
    v_mfma_f32_32x32x16_bf16 v[64:79], v[20:23], a[56:59], v[64:79]
    ds_read_b64_tr_b16 v[28:29], v6 offset:22528
    ds_read_b64_tr_b16 v[30:31], v6 offset:23552
    s_waitcnt lgkmcnt(2)
    v_mfma_f32_32x32x16_bf16 v[80:95], v[24:27], a[56:59], v[80:95]
    ds_read_b64_tr_b16 v[32:33], v7 offset:22528
    ds_read_b64_tr_b16 v[34:35], v7 offset:23552
    buffer_load_dwordx4 a[56:59], v2, s[32:35], s66 offen offset:2048
    s_waitcnt vmcnt(21) lgkmcnt(2)
    v_mfma_f32_32x32x16_bf16 v[64:79], v[28:31], a[60:63], v[64:79]
    ds_read_b64_tr_b16 v[20:21], v6 offset:24576
    ds_read_b64_tr_b16 v[22:23], v6 offset:25600
    s_waitcnt lgkmcnt(2)
    v_mfma_f32_32x32x16_bf16 v[80:95], v[32:35], a[60:63], v[80:95]
    ds_read_b64_tr_b16 v[24:25], v7 offset:24576
    ds_read_b64_tr_b16 v[26:27], v7 offset:25600
    buffer_load_dwordx4 a[60:63], v2, s[32:35], s66 offen offset:3072
    s_waitcnt vmcnt(20) lgkmcnt(2)
    v_mfma_f32_32x32x16_bf16 v[64:79], v[20:23], a[64:67], v[64:79]
    ds_read_b64_tr_b16 v[28:29], v6 offset:26624
    ds_read_b64_tr_b16 v[30:31], v6 offset:27648
    s_waitcnt lgkmcnt(2)
    v_mfma_f32_32x32x16_bf16 v[80:95], v[24:27], a[64:67], v[80:95]
    ds_read_b64_tr_b16 v[32:33], v7 offset:26624
    ds_read_b64_tr_b16 v[34:35], v7 offset:27648
    s_waitcnt vmcnt(19) lgkmcnt(2)
    v_mfma_f32_32x32x16_bf16 v[64:79], v[28:31], a[68:71], v[64:79]
    ds_read_b64_tr_b16 v[20:21], v6 offset:28672
    ds_read_b64_tr_b16 v[22:23], v6 offset:29696
    s_waitcnt lgkmcnt(2)
    v_mfma_f32_32x32x16_bf16 v[80:95], v[32:35], a[68:71], v[80:95]
    ds_read_b64_tr_b16 v[24:25], v7 offset:28672
    ds_read_b64_tr_b16 v[26:27], v7 offset:29696
    s_waitcnt vmcnt(17) lgkmcnt(2)
    v_mfma_f32_32x32x16_bf16 v[64:79], v[20:23], a[72:75], v[64:79]
    ds_read_b64_tr_b16 v[28:29], v6 offset:30720
    ds_read_b64_tr_b16 v[30:31], v6 offset:31744
    s_waitcnt lgkmcnt(2)
    v_mfma_f32_32x32x16_bf16 v[80:95], v[24:27], a[72:75], v[80:95]
    ds_read_b64_tr_b16 v[32:33], v7 offset:30720
    ds_read_b64_tr_b16 v[34:35], v7 offset:31744
    s_waitcnt lgkmcnt(0)
    s_barrier
    s_waitcnt vmcnt(16)
    v_mfma_f32_32x32x16_bf16 v[64:79], v[28:31], a[76:79], v[64:79]
    ds_read_b64_tr_b16 v[20:21], v6 offset:32768
    ds_read_b64_tr_b16 v[22:23], v6 offset:33792
    v_mfma_f32_32x32x16_bf16 v[80:95], v[32:35], a[76:79], v[80:95]
    ds_read_b64_tr_b16 v[24:25], v7 offset:32768
    ds_read_b64_tr_b16 v[26:27], v7 offset:33792
    s_waitcnt vmcnt(15) lgkmcnt(2)
    v_mfma_f32_32x32x16_bf16 v[64:79], v[20:23], a[0:3], v[64:79]
    ds_read_b64_tr_b16 v[28:29], v6 offset:34816
    ds_read_b64_tr_b16 v[30:31], v6 offset:35840
    s_waitcnt lgkmcnt(2)
    v_mfma_f32_32x32x16_bf16 v[80:95], v[24:27], a[0:3], v[80:95]
    ds_read_b64_tr_b16 v[32:33], v7 offset:34816
    ds_read_b64_tr_b16 v[34:35], v7 offset:35840
    s_waitcnt vmcnt(14) lgkmcnt(2)
    v_mfma_f32_32x32x16_bf16 v[64:79], v[28:31], a[4:7], v[64:79]
    ds_read_b64_tr_b16 v[20:21], v6 offset:36864
    ds_read_b64_tr_b16 v[22:23], v6 offset:37888
    s_waitcnt lgkmcnt(2)
    v_mfma_f32_32x32x16_bf16 v[80:95], v[32:35], a[4:7], v[80:95]
    ds_read_b64_tr_b16 v[24:25], v7 offset:36864
    ds_read_b64_tr_b16 v[26:27], v7 offset:37888
    s_waitcnt vmcnt(13) lgkmcnt(2)
    v_mfma_f32_32x32x16_bf16 v[64:79], v[20:23], a[8:11], v[64:79]
    ds_read_b64_tr_b16 v[28:29], v6 offset:38912
    ds_read_b64_tr_b16 v[30:31], v6 offset:39936
    s_waitcnt lgkmcnt(2)
    v_mfma_f32_32x32x16_bf16 v[80:95], v[24:27], a[8:11], v[80:95]
    ds_read_b64_tr_b16 v[32:33], v7 offset:38912
    ds_read_b64_tr_b16 v[34:35], v7 offset:39936
    s_waitcnt vmcnt(12) lgkmcnt(2)
    v_mfma_f32_32x32x16_bf16 v[64:79], v[28:31], a[12:15], v[64:79]
    ds_read_b64_tr_b16 v[20:21], v6 offset:40960
    ds_read_b64_tr_b16 v[22:23], v6 offset:41984
    s_waitcnt lgkmcnt(2)
    v_mfma_f32_32x32x16_bf16 v[80:95], v[32:35], a[12:15], v[80:95]
    ds_read_b64_tr_b16 v[24:25], v7 offset:40960
    ds_read_b64_tr_b16 v[26:27], v7 offset:41984
    s_waitcnt vmcnt(11) lgkmcnt(2)
    v_mfma_f32_32x32x16_bf16 v[64:79], v[20:23], a[16:19], v[64:79]
    ds_read_b64_tr_b16 v[28:29], v6 offset:43008
    ds_read_b64_tr_b16 v[30:31], v6 offset:44032
    s_waitcnt lgkmcnt(2)
    v_mfma_f32_32x32x16_bf16 v[80:95], v[24:27], a[16:19], v[80:95]
    ds_read_b64_tr_b16 v[32:33], v7 offset:43008
    ds_read_b64_tr_b16 v[34:35], v7 offset:44032
    s_waitcnt vmcnt(10) lgkmcnt(2)
    v_mfma_f32_32x32x16_bf16 v[64:79], v[28:31], a[20:23], v[64:79]
    ds_read_b64_tr_b16 v[20:21], v6 offset:45056
    ds_read_b64_tr_b16 v[22:23], v6 offset:46080
    s_waitcnt lgkmcnt(2)
    v_mfma_f32_32x32x16_bf16 v[80:95], v[32:35], a[20:23], v[80:95]
    ds_read_b64_tr_b16 v[24:25], v7 offset:45056
    ds_read_b64_tr_b16 v[26:27], v7 offset:46080
    s_waitcnt vmcnt(9) lgkmcnt(2)
    v_mfma_f32_32x32x16_bf16 v[64:79], v[20:23], a[24:27], v[64:79]
    ds_read_b64_tr_b16 v[28:29], v6 offset:47104
    ds_read_b64_tr_b16 v[30:31], v6 offset:48128
    s_waitcnt lgkmcnt(2)
    v_mfma_f32_32x32x16_bf16 v[80:95], v[24:27], a[24:27], v[80:95]
    ds_read_b64_tr_b16 v[32:33], v7 offset:47104
    ds_read_b64_tr_b16 v[34:35], v7 offset:48128
    s_waitcnt lgkmcnt(0)
    s_barrier
    s_waitcnt vmcnt(8)
    v_mfma_f32_32x32x16_bf16 v[64:79], v[28:31], a[28:31], v[64:79]
    ds_read_b64_tr_b16 v[20:21], v6 offset:49152
    ds_read_b64_tr_b16 v[22:23], v6 offset:50176
    v_mfma_f32_32x32x16_bf16 v[80:95], v[32:35], a[28:31], v[80:95]
    ds_read_b64_tr_b16 v[24:25], v7 offset:49152
    ds_read_b64_tr_b16 v[26:27], v7 offset:50176
    s_waitcnt vmcnt(7) lgkmcnt(2)
    v_mfma_f32_32x32x16_bf16 v[64:79], v[20:23], a[32:35], v[64:79]
    ds_read_b64_tr_b16 v[28:29], v6 offset:51200
    ds_read_b64_tr_b16 v[30:31], v6 offset:52224
    s_waitcnt lgkmcnt(2)
    v_mfma_f32_32x32x16_bf16 v[80:95], v[24:27], a[32:35], v[80:95]
    ds_read_b64_tr_b16 v[32:33], v7 offset:51200
    ds_read_b64_tr_b16 v[34:35], v7 offset:52224
    s_waitcnt vmcnt(6) lgkmcnt(2)
    v_mfma_f32_32x32x16_bf16 v[64:79], v[28:31], a[36:39], v[64:79]
    ds_read_b64_tr_b16 v[20:21], v6 offset:53248
    ds_read_b64_tr_b16 v[22:23], v6 offset:54272
    s_waitcnt lgkmcnt(2)
    v_mfma_f32_32x32x16_bf16 v[80:95], v[32:35], a[36:39], v[80:95]
    ds_read_b64_tr_b16 v[24:25], v7 offset:53248
    ds_read_b64_tr_b16 v[26:27], v7 offset:54272
    s_waitcnt vmcnt(5) lgkmcnt(2)
    v_mfma_f32_32x32x16_bf16 v[64:79], v[20:23], a[40:43], v[64:79]
    ds_read_b64_tr_b16 v[28:29], v6 offset:55296
    ds_read_b64_tr_b16 v[30:31], v6 offset:56320
    s_waitcnt lgkmcnt(2)
    v_mfma_f32_32x32x16_bf16 v[80:95], v[24:27], a[40:43], v[80:95]
    ds_read_b64_tr_b16 v[32:33], v7 offset:55296
    ds_read_b64_tr_b16 v[34:35], v7 offset:56320
    s_waitcnt vmcnt(4) lgkmcnt(2)
    v_mfma_f32_32x32x16_bf16 v[64:79], v[28:31], a[44:47], v[64:79]
    ds_read_b64_tr_b16 v[20:21], v6 offset:57344
    ds_read_b64_tr_b16 v[22:23], v6 offset:58368
    s_waitcnt lgkmcnt(2)
    v_mfma_f32_32x32x16_bf16 v[80:95], v[32:35], a[44:47], v[80:95]
    ds_read_b64_tr_b16 v[24:25], v7 offset:57344
    ds_read_b64_tr_b16 v[26:27], v7 offset:58368
    s_waitcnt vmcnt(3) lgkmcnt(2)
    v_mfma_f32_32x32x16_bf16 v[64:79], v[20:23], a[48:51], v[64:79]
    ds_read_b64_tr_b16 v[28:29], v6 offset:59392
    ds_read_b64_tr_b16 v[30:31], v6 offset:60416
    s_waitcnt lgkmcnt(2)
    v_mfma_f32_32x32x16_bf16 v[80:95], v[24:27], a[48:51], v[80:95]
    ds_read_b64_tr_b16 v[32:33], v7 offset:59392
    ds_read_b64_tr_b16 v[34:35], v7 offset:60416
    s_waitcnt vmcnt(2) lgkmcnt(2)
    v_mfma_f32_32x32x16_bf16 v[64:79], v[28:31], a[52:55], v[64:79]
    ds_read_b64_tr_b16 v[20:21], v6 offset:61440
    ds_read_b64_tr_b16 v[22:23], v6 offset:62464
    s_waitcnt lgkmcnt(2)
    v_mfma_f32_32x32x16_bf16 v[80:95], v[32:35], a[52:55], v[80:95]
    ds_read_b64_tr_b16 v[24:25], v7 offset:61440
    ds_read_b64_tr_b16 v[26:27], v7 offset:62464
    s_waitcnt vmcnt(1) lgkmcnt(2)
    v_mfma_f32_32x32x16_bf16 v[64:79], v[20:23], a[56:59], v[64:79]
    ds_read_b64_tr_b16 v[28:29], v6 offset:63488
    ds_read_b64_tr_b16 v[30:31], v6 offset:64512
    s_waitcnt lgkmcnt(2)
    v_mfma_f32_32x32x16_bf16 v[80:95], v[24:27], a[56:59], v[80:95]
    ds_read_b64_tr_b16 v[32:33], v7 offset:63488
    ds_read_b64_tr_b16 v[34:35], v7 offset:64512
    s_waitcnt vmcnt(0) lgkmcnt(2)
    v_mfma_f32_32x32x16_bf16 v[64:79], v[28:31], a[60:63], v[64:79]
    s_waitcnt lgkmcnt(0)
    v_mfma_f32_32x32x16_bf16 v[80:95], v[32:35], a[60:63], v[80:95]
    s_add_u32 s65, s69, 0
    s_nop 8
    buffer_store_dwordx4 v[64:67], v2, s[32:35], s65 offen offset:0 sc1
    buffer_store_dwordx4 v[68:71], v2, s[32:35], s65 offen offset:1024 sc1
    buffer_store_dwordx4 v[72:75], v2, s[32:35], s65 offen offset:2048 sc1
    buffer_store_dwordx4 v[76:79], v2, s[32:35], s65 offen offset:3072 sc1
    s_add_u32 s65, s69, 0x1000
    buffer_store_dwordx4 v[80:83], v2, s[32:35], s65 offen offset:0 sc1
    buffer_store_dwordx4 v[84:87], v2, s[32:35], s65 offen offset:1024 sc1
    buffer_store_dwordx4 v[88:91], v2, s[32:35], s65 offen offset:2048 sc1
    buffer_store_dwordx4 v[92:95], v2, s[32:35], s65 offen offset:3072 sc1
    s_waitcnt vmcnt(0) lgkmcnt(0)
    s_barrier
    s_cmp_lg_u32 s56, 0
    s_cbranch_scc1 K3_PE
    s_mov_b64 exec, 1
    buffer_atomic_or v16, v15, s[32:35], 0 offen
    s_mov_b64 exec, -1
K3_PE:
    s_endpgm
K3_CONS:
    s_add_u32 m0, s63, 0
    s_add_u32 s67, s61, 0xe0000
    buffer_load_dwordx4 v8, s[40:43], s67 offen offset:0 lds
    buffer_load_dwordx4 v9, s[40:43], s67 offen offset:1024 lds
    buffer_load_dwordx4 v10, s[40:43], s67 offen offset:2048 lds
    buffer_load_dwordx4 v11, s[40:43], s67 offen offset:3072 lds
    s_add_u32 m0, s63, 0x4000
    s_add_u32 s67, s61, 0x100000
    buffer_load_dwordx4 v8, s[40:43], s67 offen offset:0 lds
    buffer_load_dwordx4 v9, s[40:43], s67 offen offset:1024 lds
    buffer_load_dwordx4 v10, s[40:43], s67 offen offset:2048 lds
    buffer_load_dwordx4 v11, s[40:43], s67 offen offset:3072 lds
    v_lshrrev_b32 v3, 5, v1
    v_lshlrev_b32 v3, 9, v3
    v_bfe_u32 v4, v1, 2, 2
    v_lshlrev_b32 v4, 7, v4
    v_add_u32 v3, v3, v4
    v_bfe_u32 v4, v1, 4, 1
    v_lshlrev_b32 v4, 5, v4
    v_add_u32 v3, v3, v4
    v_and_b32 v4, 3, v1
    v_lshlrev_b32 v4, 3, v4
    v_add_u32 v3, v3, v4
    v_bfe_u32 v5, v1, 3, 1
    v_lshlrev_b32 v5, 6, v5
    v_add_u32 v6, v3, v5
    v_xor_b32 v5, 64, v5
    v_add_u32 v7, v3, v5
    v_add_u32 v12, 0x10000, v6
    v_add_u32 v13, 0x10000, v7
    s_mov_b32 s44, s4
    s_mov_b32 s45, s5
    s_mov_b32 s46, 0x200000
    s_mov_b32 s47, 0x20000
    s_mov_b32 s48, s24
    s_mov_b32 s49, s25
    s_mov_b32 s50, 0x200000
    s_mov_b32 s51, 0x20000
    s_lshl_b32 s64, s58, 3
    s_add_u32 s64, s64, s59
    s_lshl_b32 s69, s64, 2
    s_add_u32 s69, s69, s56
    s_lshl_b32 s69, s69, 13
    s_add_u32 s69, s69, 0x4000000
    s_lshl_b32 s65, s64, 7
    s_add_u32 s65, s65, 0x4801000
    s_mov_b32 s71, 0
    v_mov_b32 v15, s65
    s_lshl_b32 s64, 1, s71
    v_mov_b32 v16, s64
    s_lshl_b32 s68, s58, 2
    s_add_u32 s68, s68, s56
    s_lshl_b32 s68, s68, 15
    s_lshl_b32 s64, s59, 7
    s_add_u32 s68, s68, s64
    v_and_b32 v3, 31, v1
    v_lshlrev_b32 v3, 10, v3
    v_lshrrev_b32 v4, 5, v1
    v_lshlrev_b32 v4, 3, v4
    v_add_u32 v14, v3, v4
    s_waitcnt vmcnt(8)
    v_readfirstlane_b32 s64, v18
    s_nop 0
    s_cmp_ge_u32 s64, 32
    s_cbranch_scc1 L_pollx_h1
    s_mov_b32 s70, 0x10000
L_poll_h1:
    buffer_load_dword v18, off, s[32:35], s75 sc1
    s_waitcnt vmcnt(0)
    v_readfirstlane_b32 s64, v18
    s_sub_u32 s70, s70, 1
    s_cmp_eq_u32 s70, 0
    s_cbranch_scc1 L_pollx_h1
    s_cmp_ge_u32 s64, 32
    s_cbranch_scc1 L_pollx_h1
    s_sleep 16
    s_branch L_poll_h1
L_pollx_h1:
    s_add_u32 s66, s60, 0x4e000
    buffer_load_dwordx4 a[0:3], v2, s[32:35], s66 offen offset:0
    buffer_load_dwordx4 a[4:7], v2, s[32:35], s66 offen offset:1024
    buffer_load_dwordx4 a[8:11], v2, s[32:35], s66 offen offset:2048
    buffer_load_dwordx4 a[12:15], v2, s[32:35], s66 offen offset:3072
    s_add_u32 s66, s60, 0x4f000
    buffer_load_dwordx4 a[16:19], v2, s[32:35], s66 offen offset:0
    buffer_load_dwordx4 a[20:23], v2, s[32:35], s66 offen offset:1024
    buffer_load_dwordx4 a[24:27], v2, s[32:35], s66 offen offset:2048
    buffer_load_dwordx4 a[28:31], v2, s[32:35], s66 offen offset:3072
    s_add_u32 s66, s60, 0x50000
    buffer_load_dwordx4 a[32:35], v2, s[32:35], s66 offen offset:0
    buffer_load_dwordx4 a[36:39], v2, s[32:35], s66 offen offset:1024
    buffer_load_dwordx4 a[40:43], v2, s[32:35], s66 offen offset:2048
    buffer_load_dwordx4 a[44:47], v2, s[32:35], s66 offen offset:3072
    s_add_u32 s66, s60, 0x51000
    buffer_load_dwordx4 a[48:51], v2, s[32:35], s66 offen offset:0
    buffer_load_dwordx4 a[52:55], v2, s[32:35], s66 offen offset:1024
    buffer_load_dwordx4 a[56:59], v2, s[32:35], s66 offen offset:2048
    buffer_load_dwordx4 a[60:63], v2, s[32:35], s66 offen offset:3072
    s_add_u32 s66, s60, 0x52000
    buffer_load_dwordx4 a[64:67], v2, s[32:35], s66 offen offset:0
    buffer_load_dwordx4 a[68:71], v2, s[32:35], s66 offen offset:1024
    buffer_load_dwordx4 a[72:75], v2, s[32:35], s66 offen offset:2048
    buffer_load_dwordx4 a[76:79], v2, s[32:35], s66 offen offset:3072
    s_waitcnt vmcnt(24)
    s_barrier
    s_cmp_lg_u32 s56, 0
    s_cbranch_scc1 K3_SG1
    s_mov_b64 exec, 1
    v_mov_b32 v19, 1
    buffer_atomic_add v19, off, s[32:35], s72
    buffer_atomic_add v19, off, s[32:35], s73
    s_mov_b64 exec, -1
K3_SG1:
    ds_read_b64_tr_b16 v[20:21], v6 offset:0
    ds_read_b64_tr_b16 v[22:23], v6 offset:1024
    ds_read_b64_tr_b16 v[24:25], v7 offset:0
    ds_read_b64_tr_b16 v[26:27], v7 offset:1024
    s_waitcnt vmcnt(19) lgkmcnt(2)
    v_mfma_f32_32x32x16_bf16 v[96:111], v[20:23], a[0:3], 0
    ds_read_b64_tr_b16 v[28:29], v6 offset:2048
    ds_read_b64_tr_b16 v[30:31], v6 offset:3072
    s_add_u32 m0, s63, 0x8000
    s_add_u32 s67, s61, 0x120000
    buffer_load_dwordx4 v8, s[40:43], s67 offen offset:0 lds
    s_waitcnt lgkmcnt(2)
    v_mfma_f32_32x32x16_bf16 v[112:127], v[24:27], a[0:3], 0
    ds_read_b64_tr_b16 v[32:33], v7 offset:2048
    ds_read_b64_tr_b16 v[34:35], v7 offset:3072
    s_add_u32 s66, s60, 0x53000
    buffer_load_dwordx4 a[0:3], v2, s[32:35], s66 offen offset:0
    s_waitcnt vmcnt(20) lgkmcnt(2)
    v_mfma_f32_32x32x16_bf16 v[96:111], v[28:31], a[4:7], v[96:111]
    ds_read_b64_tr_b16 v[20:21], v6 offset:4096
    ds_read_b64_tr_b16 v[22:23], v6 offset:5120
    buffer_load_dwordx4 v9, s[40:43], s67 offen offset:1024 lds
    s_waitcnt lgkmcnt(2)
    v_mfma_f32_32x32x16_bf16 v[112:127], v[32:35], a[4:7], v[112:127]
    ds_read_b64_tr_b16 v[24:25], v7 offset:4096
    ds_read_b64_tr_b16 v[26:27], v7 offset:5120
    buffer_load_dwordx4 a[4:7], v2, s[32:35], s66 offen offset:1024
    s_waitcnt vmcnt(21) lgkmcnt(2)
    v_mfma_f32_32x32x16_bf16 v[96:111], v[20:23], a[8:11], v[96:111]
    ds_read_b64_tr_b16 v[28:29], v6 offset:6144
    ds_read_b64_tr_b16 v[30:31], v6 offset:7168
    buffer_load_dwordx4 v10, s[40:43], s67 offen offset:2048 lds
    s_waitcnt lgkmcnt(2)
    v_mfma_f32_32x32x16_bf16 v[112:127], v[24:27], a[8:11], v[112:127]
    ds_read_b64_tr_b16 v[32:33], v7 offset:6144
    ds_read_b64_tr_b16 v[34:35], v7 offset:7168
    buffer_load_dwordx4 a[8:11], v2, s[32:35], s66 offen offset:2048
    s_waitcnt vmcnt(22) lgkmcnt(2)
    v_mfma_f32_32x32x16_bf16 v[96:111], v[28:31], a[12:15], v[96:111]
    ds_read_b64_tr_b16 v[20:21], v6 offset:8192
    ds_read_b64_tr_b16 v[22:23], v6 offset:9216
    buffer_load_dwordx4 v11, s[40:43], s67 offen offset:3072 lds
    s_waitcnt lgkmcnt(2)
    v_mfma_f32_32x32x16_bf16 v[112:127], v[32:35], a[12:15], v[112:127]
    ds_read_b64_tr_b16 v[24:25], v7 offset:8192
    ds_read_b64_tr_b16 v[26:27], v7 offset:9216
    buffer_load_dwordx4 a[12:15], v2, s[32:35], s66 offen offset:3072
    s_waitcnt vmcnt(23) lgkmcnt(2)
    v_mfma_f32_32x32x16_bf16 v[96:111], v[20:23], a[16:19], v[96:111]
    ds_read_b64_tr_b16 v[28:29], v6 offset:10240
    ds_read_b64_tr_b16 v[30:31], v6 offset:11264
    s_add_u32 m0, s63, 0xc000
    s_add_u32 s67, s61, 0x140000
    buffer_load_dwordx4 v8, s[40:43], s67 offen offset:0 lds
    s_waitcnt lgkmcnt(2)
    v_mfma_f32_32x32x16_bf16 v[112:127], v[24:27], a[16:19], v[112:127]
    ds_read_b64_tr_b16 v[32:33], v7 offset:10240
    ds_read_b64_tr_b16 v[34:35], v7 offset:11264
    s_add_u32 s66, s60, 0x54000
    buffer_load_dwordx4 a[16:19], v2, s[32:35], s66 offen offset:0
    s_waitcnt vmcnt(24) lgkmcnt(2)
    v_mfma_f32_32x32x16_bf16 v[96:111], v[28:31], a[20:23], v[96:111]
    ds_read_b64_tr_b16 v[20:21], v6 offset:12288
    ds_read_b64_tr_b16 v[22:23], v6 offset:13312
    buffer_load_dwordx4 v9, s[40:43], s67 offen offset:1024 lds
    s_waitcnt lgkmcnt(2)
    v_mfma_f32_32x32x16_bf16 v[112:127], v[32:35], a[20:23], v[112:127]
    ds_read_b64_tr_b16 v[24:25], v7 offset:12288
    ds_read_b64_tr_b16 v[26:27], v7 offset:13312
    buffer_load_dwordx4 a[20:23], v2, s[32:35], s66 offen offset:1024
    s_waitcnt vmcnt(25) lgkmcnt(2)
    v_mfma_f32_32x32x16_bf16 v[96:111], v[20:23], a[24:27], v[96:111]
    ds_read_b64_tr_b16 v[28:29], v6 offset:14336
    ds_read_b64_tr_b16 v[30:31], v6 offset:15360
    buffer_load_dwordx4 v10, s[40:43], s67 offen offset:2048 lds
    s_waitcnt lgkmcnt(2)
    v_mfma_f32_32x32x16_bf16 v[112:127], v[24:27], a[24:27], v[112:127]
    ds_read_b64_tr_b16 v[32:33], v7 offset:14336
    ds_read_b64_tr_b16 v[34:35], v7 offset:15360
    buffer_load_dwordx4 a[24:27], v2, s[32:35], s66 offen offset:2048
    s_waitcnt lgkmcnt(0)
    s_barrier
    s_waitcnt vmcnt(26)
    v_mfma_f32_32x32x16_bf16 v[96:111], v[28:31], a[28:31], v[96:111]
    ds_read_b64_tr_b16 v[20:21], v6 offset:16384
    ds_read_b64_tr_b16 v[22:23], v6 offset:17408
    buffer_load_dwordx4 v11, s[40:43], s67 offen offset:3072 lds
    v_mfma_f32_32x32x16_bf16 v[112:127], v[32:35], a[28:31], v[112:127]
    ds_read_b64_tr_b16 v[24:25], v7 offset:16384
    ds_read_b64_tr_b16 v[26:27], v7 offset:17408
    buffer_load_dwordx4 a[28:31], v2, s[32:35], s66 offen offset:3072
    s_waitcnt vmcnt(27) lgkmcnt(2)
    v_mfma_f32_32x32x16_bf16 v[96:111], v[20:23], a[32:35], v[96:111]
    ds_read_b64_tr_b16 v[28:29], v6 offset:18432
    ds_read_b64_tr_b16 v[30:31], v6 offset:19456
    s_add_u32 m0, s63, 0x10000
    s_add_u32 s67, s61, 0x160000
    buffer_load_dwordx4 v8, s[40:43], s67 offen offset:0 lds
    s_waitcnt lgkmcnt(2)
    v_mfma_f32_32x32x16_bf16 v[112:127], v[24:27], a[32:35], v[112:127]
    ds_read_b64_tr_b16 v[32:33], v7 offset:18432
    ds_read_b64_tr_b16 v[34:35], v7 offset:19456
    s_add_u32 s66, s60, 0x55000
    buffer_load_dwordx4 a[32:35], v2, s[32:35], s66 offen offset:0
    s_waitcnt vmcnt(28) lgkmcnt(2)
    v_mfma_f32_32x32x16_bf16 v[96:111], v[28:31], a[36:39], v[96:111]
    ds_read_b64_tr_b16 v[20:21], v6 offset:20480
    ds_read_b64_tr_b16 v[22:23], v6 offset:21504
    buffer_load_dwordx4 v9, s[40:43], s67 offen offset:1024 lds
    s_waitcnt lgkmcnt(2)
    v_mfma_f32_32x32x16_bf16 v[112:127], v[32:35], a[36:39], v[112:127]
    ds_read_b64_tr_b16 v[24:25], v7 offset:20480
    ds_read_b64_tr_b16 v[26:27], v7 offset:21504
    buffer_load_dwordx4 a[36:39], v2, s[32:35], s66 offen offset:1024
    s_waitcnt vmcnt(29) lgkmcnt(2)
    v_mfma_f32_32x32x16_bf16 v[96:111], v[20:23], a[40:43], v[96:111]
    ds_read_b64_tr_b16 v[28:29], v6 offset:22528
    ds_read_b64_tr_b16 v[30:31], v6 offset:23552
    buffer_load_dwordx4 v10, s[40:43], s67 offen offset:2048 lds
    s_waitcnt lgkmcnt(2)
    v_mfma_f32_32x32x16_bf16 v[112:127], v[24:27], a[40:43], v[112:127]
    ds_read_b64_tr_b16 v[32:33], v7 offset:22528
    ds_read_b64_tr_b16 v[34:35], v7 offset:23552
    buffer_load_dwordx4 a[40:43], v2, s[32:35], s66 offen offset:2048
    s_waitcnt vmcnt(30) lgkmcnt(2)
    v_mfma_f32_32x32x16_bf16 v[96:111], v[28:31], a[44:47], v[96:111]
    ds_read_b64_tr_b16 v[20:21], v6 offset:24576
    ds_read_b64_tr_b16 v[22:23], v6 offset:25600
    buffer_load_dwordx4 v11, s[40:43], s67 offen offset:3072 lds
    s_waitcnt lgkmcnt(2)
    v_mfma_f32_32x32x16_bf16 v[112:127], v[32:35], a[44:47], v[112:127]
    ds_read_b64_tr_b16 v[24:25], v7 offset:24576
    ds_read_b64_tr_b16 v[26:27], v7 offset:25600
    buffer_load_dwordx4 a[44:47], v2, s[32:35], s66 offen offset:3072
    s_waitcnt vmcnt(31) lgkmcnt(2)
    v_mfma_f32_32x32x16_bf16 v[96:111], v[20:23], a[48:51], v[96:111]
    ds_read_b64_tr_b16 v[28:29], v6 offset:26624
    ds_read_b64_tr_b16 v[30:31], v6 offset:27648
    s_add_u32 m0, s63, 0x14000
    s_add_u32 s67, s61, 0x180000
    buffer_load_dwordx4 v8, s[40:43], s67 offen offset:0 lds
    s_waitcnt lgkmcnt(2)
    v_mfma_f32_32x32x16_bf16 v[112:127], v[24:27], a[48:51], v[112:127]
    ds_read_b64_tr_b16 v[32:33], v7 offset:26624
    ds_read_b64_tr_b16 v[34:35], v7 offset:27648
    s_add_u32 s66, s60, 0x56000
    buffer_load_dwordx4 a[48:51], v2, s[32:35], s66 offen offset:0
    s_waitcnt vmcnt(32) lgkmcnt(2)
    v_mfma_f32_32x32x16_bf16 v[96:111], v[28:31], a[52:55], v[96:111]
    ds_read_b64_tr_b16 v[20:21], v6 offset:28672
    ds_read_b64_tr_b16 v[22:23], v6 offset:29696
    buffer_load_dwordx4 v9, s[40:43], s67 offen offset:1024 lds
    s_waitcnt lgkmcnt(2)
    v_mfma_f32_32x32x16_bf16 v[112:127], v[32:35], a[52:55], v[112:127]
    ds_read_b64_tr_b16 v[24:25], v7 offset:28672
    ds_read_b64_tr_b16 v[26:27], v7 offset:29696
    buffer_load_dwordx4 a[52:55], v2, s[32:35], s66 offen offset:1024
    s_waitcnt vmcnt(33) lgkmcnt(2)
    v_mfma_f32_32x32x16_bf16 v[96:111], v[20:23], a[56:59], v[96:111]
    ds_read_b64_tr_b16 v[28:29], v6 offset:30720
    ds_read_b64_tr_b16 v[30:31], v6 offset:31744
    buffer_load_dwordx4 v10, s[40:43], s67 offen offset:2048 lds
    s_waitcnt lgkmcnt(2)
    v_mfma_f32_32x32x16_bf16 v[112:127], v[24:27], a[56:59], v[112:127]
    ds_read_b64_tr_b16 v[32:33], v7 offset:30720
    ds_read_b64_tr_b16 v[34:35], v7 offset:31744
    buffer_load_dwordx4 a[56:59], v2, s[32:35], s66 offen offset:2048
    s_waitcnt lgkmcnt(0)
    s_waitcnt vmcnt(23)
    s_barrier
    v_mfma_f32_32x32x16_bf16 v[96:111], v[28:31], a[60:63], v[96:111]
    ds_read_b64_tr_b16 v[20:21], v6 offset:32768
    ds_read_b64_tr_b16 v[22:23], v6 offset:33792
    buffer_load_dwordx4 v11, s[40:43], s67 offen offset:3072 lds
    v_mfma_f32_32x32x16_bf16 v[112:127], v[32:35], a[60:63], v[112:127]
    ds_read_b64_tr_b16 v[24:25], v7 offset:32768
    ds_read_b64_tr_b16 v[26:27], v7 offset:33792
    buffer_load_dwordx4 a[60:63], v2, s[32:35], s66 offen offset:3072
    s_waitcnt lgkmcnt(2)
    v_mfma_f32_32x32x16_bf16 v[96:111], v[20:23], a[64:67], v[96:111]
    ds_read_b64_tr_b16 v[28:29], v6 offset:34816
    ds_read_b64_tr_b16 v[30:31], v6 offset:35840
    s_add_u32 m0, s63, 0
    s_add_u32 s67, s61, 0x1a0000
    buffer_load_dwordx4 v8, s[40:43], s67 offen offset:0 lds
    s_waitcnt lgkmcnt(2)
    v_mfma_f32_32x32x16_bf16 v[112:127], v[24:27], a[64:67], v[112:127]
    ds_read_b64_tr_b16 v[32:33], v7 offset:34816
    ds_read_b64_tr_b16 v[34:35], v7 offset:35840
    s_add_u32 s66, s60, 0x57000
    buffer_load_dwordx4 a[64:67], v2, s[32:35], s66 offen offset:0
    s_waitcnt lgkmcnt(2)
    v_mfma_f32_32x32x16_bf16 v[96:111], v[28:31], a[68:71], v[96:111]
    ds_read_b64_tr_b16 v[20:21], v6 offset:36864
    ds_read_b64_tr_b16 v[22:23], v6 offset:37888
    buffer_load_dwordx4 v9, s[40:43], s67 offen offset:1024 lds
    s_waitcnt lgkmcnt(2)
    v_mfma_f32_32x32x16_bf16 v[112:127], v[32:35], a[68:71], v[112:127]
    ds_read_b64_tr_b16 v[24:25], v7 offset:36864
    ds_read_b64_tr_b16 v[26:27], v7 offset:37888
    buffer_load_dwordx4 a[68:71], v2, s[32:35], s66 offen offset:1024
    s_waitcnt lgkmcnt(2)
    v_mfma_f32_32x32x16_bf16 v[96:111], v[20:23], a[72:75], v[96:111]
    ds_read_b64_tr_b16 v[28:29], v6 offset:38912
    ds_read_b64_tr_b16 v[30:31], v6 offset:39936
    buffer_load_dwordx4 v10, s[40:43], s67 offen offset:2048 lds
    s_waitcnt lgkmcnt(2)
    v_mfma_f32_32x32x16_bf16 v[112:127], v[24:27], a[72:75], v[112:127]
    ds_read_b64_tr_b16 v[32:33], v7 offset:38912
    ds_read_b64_tr_b16 v[34:35], v7 offset:39936
    buffer_load_dwordx4 a[72:75], v2, s[32:35], s66 offen offset:2048
    s_waitcnt lgkmcnt(2)
    v_mfma_f32_32x32x16_bf16 v[96:111], v[28:31], a[76:79], v[96:111]
    ds_read_b64_tr_b16 v[20:21], v6 offset:40960
    ds_read_b64_tr_b16 v[22:23], v6 offset:41984
    s_waitcnt lgkmcnt(2)
    v_mfma_f32_32x32x16_bf16 v[112:127], v[32:35], a[76:79], v[112:127]
    ds_read_b64_tr_b16 v[24:25], v7 offset:40960
    ds_read_b64_tr_b16 v[26:27], v7 offset:41984
    buffer_load_dwordx4 a[76:79], v2, s[32:35], s66 offen offset:3072
    s_waitcnt lgkmcnt(2)
    v_mfma_f32_32x32x16_bf16 v[96:111], v[20:23], a[0:3], v[96:111]
    ds_read_b64_tr_b16 v[28:29], v6 offset:43008
    ds_read_b64_tr_b16 v[30:31], v6 offset:44032
    buffer_load_dwordx4 v11, s[40:43], s67 offen offset:3072 lds
    s_waitcnt lgkmcnt(2)
    v_mfma_f32_32x32x16_bf16 v[112:127], v[24:27], a[0:3], v[112:127]
    ds_read_b64_tr_b16 v[32:33], v7 offset:43008
    ds_read_b64_tr_b16 v[34:35], v7 offset:44032
    s_add_u32 s66, s60, 0x58000
    buffer_load_dwordx4 a[0:3], v2, s[32:35], s66 offen offset:0
    s_waitcnt lgkmcnt(2)
    v_mfma_f32_32x32x16_bf16 v[96:111], v[28:31], a[4:7], v[96:111]
    ds_read_b64_tr_b16 v[20:21], v6 offset:45056
    ds_read_b64_tr_b16 v[22:23], v6 offset:46080
    s_waitcnt lgkmcnt(2)
    v_mfma_f32_32x32x16_bf16 v[112:127], v[32:35], a[4:7], v[112:127]
    ds_read_b64_tr_b16 v[24:25], v7 offset:45056
    ds_read_b64_tr_b16 v[26:27], v7 offset:46080
    buffer_load_dwordx4 a[4:7], v2, s[32:35], s66 offen offset:1024
    s_waitcnt lgkmcnt(2)
    v_mfma_f32_32x32x16_bf16 v[96:111], v[20:23], a[8:11], v[96:111]
    ds_read_b64_tr_b16 v[28:29], v6 offset:47104
    ds_read_b64_tr_b16 v[30:31], v6 offset:48128
    s_add_u32 m0, s63, 0x4000
    s_add_u32 s67, s61, 0x1e0000
    buffer_load_dwordx4 v8, s[36:39], s67 offen offset:0 lds
    s_waitcnt lgkmcnt(2)
    v_mfma_f32_32x32x16_bf16 v[112:127], v[24:27], a[8:11], v[112:127]
    ds_read_b64_tr_b16 v[32:33], v7 offset:47104
    ds_read_b64_tr_b16 v[34:35], v7 offset:48128
    buffer_load_dwordx4 a[8:11], v2, s[32:35], s66 offen offset:2048
    s_waitcnt lgkmcnt(0)
    s_waitcnt vmcnt(29)
    s_barrier
    v_mfma_f32_32x32x16_bf16 v[96:111], v[28:31], a[12:15], v[96:111]
    ds_read_b64_tr_b16 v[20:21], v6 offset:49152
    ds_read_b64_tr_b16 v[22:23], v6 offset:50176
    buffer_load_dwordx4 v9, s[36:39], s67 offen offset:1024 lds
    v_mfma_f32_32x32x16_bf16 v[112:127], v[32:35], a[12:15], v[112:127]
    ds_read_b64_tr_b16 v[24:25], v7 offset:49152
    ds_read_b64_tr_b16 v[26:27], v7 offset:50176
    buffer_load_dwordx4 a[12:15], v2, s[32:35], s66 offen offset:3072
    s_waitcnt lgkmcnt(2)
    v_mfma_f32_32x32x16_bf16 v[96:111], v[20:23], a[16:19], v[96:111]
    ds_read_b64_tr_b16 v[28:29], v6 offset:51200
    ds_read_b64_tr_b16 v[30:31], v6 offset:52224
    buffer_load_dwordx4 v10, s[36:39], s67 offen offset:2048 lds
    s_waitcnt lgkmcnt(2)
    v_mfma_f32_32x32x16_bf16 v[112:127], v[24:27], a[16:19], v[112:127]
    ds_read_b64_tr_b16 v[32:33], v7 offset:51200
    ds_read_b64_tr_b16 v[34:35], v7 offset:52224
    s_add_u32 s66, s60, 0x59000
    buffer_load_dwordx4 a[16:19], v2, s[32:35], s66 offen offset:0
    s_waitcnt lgkmcnt(2)
    v_mfma_f32_32x32x16_bf16 v[96:111], v[28:31], a[20:23], v[96:111]
    ds_read_b64_tr_b16 v[20:21], v6 offset:53248
    ds_read_b64_tr_b16 v[22:23], v6 offset:54272
    s_waitcnt lgkmcnt(2)
    v_mfma_f32_32x32x16_bf16 v[112:127], v[32:35], a[20:23], v[112:127]
    ds_read_b64_tr_b16 v[24:25], v7 offset:53248
    ds_read_b64_tr_b16 v[26:27], v7 offset:54272
    buffer_load_dwordx4 a[20:23], v2, s[32:35], s66 offen offset:1024
    s_waitcnt lgkmcnt(2)
    v_mfma_f32_32x32x16_bf16 v[96:111], v[20:23], a[24:27], v[96:111]
    ds_read_b64_tr_b16 v[28:29], v6 offset:55296
    ds_read_b64_tr_b16 v[30:31], v6 offset:56320
    buffer_load_dwordx4 v11, s[36:39], s67 offen offset:3072 lds
    s_waitcnt lgkmcnt(2)
    v_mfma_f32_32x32x16_bf16 v[112:127], v[24:27], a[24:27], v[112:127]
    ds_read_b64_tr_b16 v[32:33], v7 offset:55296
    ds_read_b64_tr_b16 v[34:35], v7 offset:56320
    buffer_load_dwordx4 a[24:27], v2, s[32:35], s66 offen offset:2048
    s_waitcnt vmcnt(35) lgkmcnt(2)
    v_mfma_f32_32x32x16_bf16 v[96:111], v[28:31], a[28:31], v[96:111]
    ds_read_b64_tr_b16 v[20:21], v6 offset:57344
    ds_read_b64_tr_b16 v[22:23], v6 offset:58368
    s_waitcnt lgkmcnt(2)
    v_mfma_f32_32x32x16_bf16 v[112:127], v[32:35], a[28:31], v[112:127]
    ds_read_b64_tr_b16 v[24:25], v7 offset:57344
    ds_read_b64_tr_b16 v[26:27], v7 offset:58368
    buffer_load_dwordx4 a[28:31], v2, s[32:35], s66 offen offset:3072
    s_waitcnt vmcnt(34) lgkmcnt(2)
    v_mfma_f32_32x32x16_bf16 v[96:111], v[20:23], a[32:35], v[96:111]
    ds_read_b64_tr_b16 v[28:29], v6 offset:59392
    ds_read_b64_tr_b16 v[30:31], v6 offset:60416
    s_add_u32 m0, s63, 0x8000
    s_add_u32 s67, s61, 0x200000
    buffer_load_dwordx4 v8, s[36:39], s67 offen offset:0 lds
    s_waitcnt lgkmcnt(2)
    v_mfma_f32_32x32x16_bf16 v[112:127], v[24:27], a[32:35], v[112:127]
    ds_read_b64_tr_b16 v[32:33], v7 offset:59392
    ds_read_b64_tr_b16 v[34:35], v7 offset:60416
    s_add_u32 s66, s60, 0x5a000
    buffer_load_dwordx4 a[32:35], v2, s[32:35], s66 offen offset:0
    s_waitcnt vmcnt(34) lgkmcnt(2)
    v_mfma_f32_32x32x16_bf16 v[96:111], v[28:31], a[36:39], v[96:111]
    ds_read_b64_tr_b16 v[20:21], v6 offset:61440
    ds_read_b64_tr_b16 v[22:23], v6 offset:62464
    s_waitcnt lgkmcnt(2)
    v_mfma_f32_32x32x16_bf16 v[112:127], v[32:35], a[36:39], v[112:127]
    ds_read_b64_tr_b16 v[24:25], v7 offset:61440
    ds_read_b64_tr_b16 v[26:27], v7 offset:62464
    buffer_load_dwordx4 a[36:39], v2, s[32:35], s66 offen offset:1024
    s_waitcnt vmcnt(33) lgkmcnt(2)
    v_mfma_f32_32x32x16_bf16 v[96:111], v[20:23], a[40:43], v[96:111]
    ds_read_b64_tr_b16 v[28:29], v6 offset:63488
    ds_read_b64_tr_b16 v[30:31], v6 offset:64512
    buffer_load_dwordx4 v9, s[36:39], s67 offen offset:1024 lds
    s_waitcnt lgkmcnt(2)
    v_mfma_f32_32x32x16_bf16 v[112:127], v[24:27], a[40:43], v[112:127]
    ds_read_b64_tr_b16 v[32:33], v7 offset:63488
    ds_read_b64_tr_b16 v[34:35], v7 offset:64512
    buffer_load_dwordx4 a[40:43], v2, s[32:35], s66 offen offset:2048
    s_waitcnt lgkmcnt(0)
    s_waitcnt vmcnt(34)
    s_barrier
    s_waitcnt vmcnt(33)
    v_mfma_f32_32x32x16_bf16 v[96:111], v[28:31], a[44:47], v[96:111]
    ds_read_b64_tr_b16 v[20:21], v12 offset:0
    ds_read_b64_tr_b16 v[22:23], v12 offset:1024
    v_mfma_f32_32x32x16_bf16 v[112:127], v[32:35], a[44:47], v[112:127]
    ds_read_b64_tr_b16 v[24:25], v13 offset:0
    ds_read_b64_tr_b16 v[26:27], v13 offset:1024
    buffer_load_dwordx4 a[44:47], v2, s[32:35], s66 offen offset:3072
    s_waitcnt vmcnt(32) lgkmcnt(2)
    v_mfma_f32_32x32x16_bf16 v[96:111], v[20:23], a[48:51], v[96:111]
    ds_read_b64_tr_b16 v[28:29], v12 offset:2048
    ds_read_b64_tr_b16 v[30:31], v12 offset:3072
    buffer_load_dwordx4 v10, s[36:39], s67 offen offset:2048 lds
    s_waitcnt lgkmcnt(2)
    v_mfma_f32_32x32x16_bf16 v[112:127], v[24:27], a[48:51], v[112:127]
    ds_read_b64_tr_b16 v[32:33], v13 offset:2048
    ds_read_b64_tr_b16 v[34:35], v13 offset:3072
    s_add_u32 s66, s60, 0x5b000
    buffer_load_dwordx4 a[48:51], v2, s[32:35], s66 offen offset:0
    s_waitcnt vmcnt(32) lgkmcnt(2)
    v_mfma_f32_32x32x16_bf16 v[96:111], v[28:31], a[52:55], v[96:111]
    ds_read_b64_tr_b16 v[20:21], v12 offset:4096
    ds_read_b64_tr_b16 v[22:23], v12 offset:5120
    s_waitcnt lgkmcnt(2)
    v_mfma_f32_32x32x16_bf16 v[112:127], v[32:35], a[52:55], v[112:127]
    ds_read_b64_tr_b16 v[24:25], v13 offset:4096
    ds_read_b64_tr_b16 v[26:27], v13 offset:5120
    buffer_load_dwordx4 a[52:55], v2, s[32:35], s66 offen offset:1024
    s_waitcnt vmcnt(31) lgkmcnt(2)
    v_mfma_f32_32x32x16_bf16 v[96:111], v[20:23], a[56:59], v[96:111]
    ds_read_b64_tr_b16 v[28:29], v12 offset:6144
    ds_read_b64_tr_b16 v[30:31], v12 offset:7168
    buffer_load_dwordx4 v11, s[36:39], s67 offen offset:3072 lds
    s_waitcnt lgkmcnt(2)
    v_mfma_f32_32x32x16_bf16 v[112:127], v[24:27], a[56:59], v[112:127]
    ds_read_b64_tr_b16 v[32:33], v13 offset:6144
    ds_read_b64_tr_b16 v[34:35], v13 offset:7168
    buffer_load_dwordx4 a[56:59], v2, s[32:35], s66 offen offset:2048
    s_waitcnt vmcnt(31) lgkmcnt(2)
    v_mfma_f32_32x32x16_bf16 v[96:111], v[28:31], a[60:63], v[96:111]
    ds_read_b64_tr_b16 v[20:21], v12 offset:8192
    ds_read_b64_tr_b16 v[22:23], v12 offset:9216
    s_waitcnt lgkmcnt(2)
    v_mfma_f32_32x32x16_bf16 v[112:127], v[32:35], a[60:63], v[112:127]
    ds_read_b64_tr_b16 v[24:25], v13 offset:8192
    ds_read_b64_tr_b16 v[26:27], v13 offset:9216
    buffer_load_dwordx4 a[60:63], v2, s[32:35], s66 offen offset:3072
    buffer_load_dword v18, off, s[32:35], s74 sc1
    s_waitcnt vmcnt(31) lgkmcnt(2)
    v_mfma_f32_32x32x16_bf16 v[96:111], v[20:23], a[64:67], v[96:111]
    ds_read_b64_tr_b16 v[28:29], v12 offset:10240
    ds_read_b64_tr_b16 v[30:31], v12 offset:11264
    s_add_u32 m0, s63, 0xc000
    s_add_u32 s67, s61, 0x220000
    buffer_load_dwordx4 v8, s[36:39], s67 offen offset:0 lds
    s_waitcnt lgkmcnt(2)
    v_mfma_f32_32x32x16_bf16 v[112:127], v[24:27], a[64:67], v[112:127]
    ds_read_b64_tr_b16 v[32:33], v13 offset:10240
    ds_read_b64_tr_b16 v[34:35], v13 offset:11264
    buffer_load_dwordx4 v9, s[36:39], s67 offen offset:1024 lds
    s_waitcnt vmcnt(31) lgkmcnt(2)
    v_mfma_f32_32x32x16_bf16 v[96:111], v[28:31], a[68:71], v[96:111]
    ds_read_b64_tr_b16 v[20:21], v12 offset:12288
    ds_read_b64_tr_b16 v[22:23], v12 offset:13312
    s_waitcnt lgkmcnt(2)
    v_mfma_f32_32x32x16_bf16 v[112:127], v[32:35], a[68:71], v[112:127]
    ds_read_b64_tr_b16 v[24:25], v13 offset:12288
    ds_read_b64_tr_b16 v[26:27], v13 offset:13312
    buffer_load_dwordx4 v10, s[36:39], s67 offen offset:2048 lds
    s_waitcnt vmcnt(30) lgkmcnt(2)
    v_mfma_f32_32x32x16_bf16 v[96:111], v[20:23], a[72:75], v[96:111]
    ds_read_b64_tr_b16 v[28:29], v12 offset:14336
    ds_read_b64_tr_b16 v[30:31], v12 offset:15360
    buffer_load_dwordx4 v11, s[36:39], s67 offen offset:3072 lds
    s_waitcnt lgkmcnt(2)
    v_mfma_f32_32x32x16_bf16 v[112:127], v[24:27], a[72:75], v[112:127]
    ds_read_b64_tr_b16 v[32:33], v13 offset:14336
    ds_read_b64_tr_b16 v[34:35], v13 offset:15360
    s_waitcnt lgkmcnt(0)
    s_barrier
    s_waitcnt vmcnt(30)
    v_mfma_f32_32x32x16_bf16 v[96:111], v[28:31], a[76:79], v[96:111]
    ds_read_b64_tr_b16 v[20:21], v12 offset:16384
    ds_read_b64_tr_b16 v[22:23], v12 offset:17408
    v_mfma_f32_32x32x16_bf16 v[112:127], v[32:35], a[76:79], v[112:127]
    ds_read_b64_tr_b16 v[24:25], v13 offset:16384
    ds_read_b64_tr_b16 v[26:27], v13 offset:17408
    s_add_u32 m0, s63, 0x10000
    s_add_u32 s67, s61, 0x240000
    buffer_load_dwordx4 v8, s[36:39], s67 offen offset:0 lds
    s_waitcnt vmcnt(29) lgkmcnt(2)
    v_mfma_f32_32x32x16_bf16 v[96:111], v[20:23], a[0:3], v[96:111]
    ds_read_b64_tr_b16 v[28:29], v12 offset:18432
    ds_read_b64_tr_b16 v[30:31], v12 offset:19456
    buffer_load_dwordx4 v9, s[36:39], s67 offen offset:1024 lds
    s_waitcnt lgkmcnt(2)
    v_mfma_f32_32x32x16_bf16 v[112:127], v[24:27], a[0:3], v[112:127]
    ds_read_b64_tr_b16 v[32:33], v13 offset:18432
    ds_read_b64_tr_b16 v[34:35], v13 offset:19456
    buffer_load_dwordx4 v10, s[36:39], s67 offen offset:2048 lds
    s_waitcnt vmcnt(30) lgkmcnt(2)
    v_mfma_f32_32x32x16_bf16 v[96:111], v[28:31], a[4:7], v[96:111]
    ds_read_b64_tr_b16 v[20:21], v12 offset:20480
    ds_read_b64_tr_b16 v[22:23], v12 offset:21504
    s_waitcnt lgkmcnt(2)
    v_mfma_f32_32x32x16_bf16 v[112:127], v[32:35], a[4:7], v[112:127]
    ds_read_b64_tr_b16 v[24:25], v13 offset:20480
    ds_read_b64_tr_b16 v[26:27], v13 offset:21504
    buffer_load_dwordx4 v11, s[36:39], s67 offen offset:3072 lds
    s_waitcnt vmcnt(29) lgkmcnt(2)
    v_mfma_f32_32x32x16_bf16 v[96:111], v[20:23], a[8:11], v[96:111]
    ds_read_b64_tr_b16 v[28:29], v12 offset:22528
    ds_read_b64_tr_b16 v[30:31], v12 offset:23552
    s_waitcnt lgkmcnt(2)
    v_mfma_f32_32x32x16_bf16 v[112:127], v[24:27], a[8:11], v[112:127]
    ds_read_b64_tr_b16 v[32:33], v13 offset:22528
    ds_read_b64_tr_b16 v[34:35], v13 offset:23552
    s_waitcnt vmcnt(27) lgkmcnt(2)
    v_mfma_f32_32x32x16_bf16 v[96:111], v[28:31], a[12:15], v[96:111]
    ds_read_b64_tr_b16 v[20:21], v12 offset:24576
    ds_read_b64_tr_b16 v[22:23], v12 offset:25600
    s_waitcnt lgkmcnt(2)
    v_mfma_f32_32x32x16_bf16 v[112:127], v[32:35], a[12:15], v[112:127]
    ds_read_b64_tr_b16 v[24:25], v13 offset:24576
    ds_read_b64_tr_b16 v[26:27], v13 offset:25600
    s_waitcnt vmcnt(8)
    v_readfirstlane_b32 s64, v18
    s_nop 0
    s_cmp_ge_u32 s64, 32
    s_cbranch_scc1 L_pollx_cc1
    s_mov_b32 s70, 0x10000
L_poll_cc1:
    buffer_load_dword v18, off, s[32:35], s74 sc1
    s_waitcnt vmcnt(0)
    v_readfirstlane_b32 s64, v18
    s_sub_u32 s70, s70, 1
    s_cmp_eq_u32 s70, 0
    s_cbranch_scc1 L_pollx_cc1
    s_cmp_ge_u32 s64, 32
    s_cbranch_scc1 L_pollx_cc1
    s_sleep 16
    s_branch L_poll_cc1
L_pollx_cc1:
    s_waitcnt lgkmcnt(2)
    v_mfma_f32_32x32x16_bf16 v[96:111], v[20:23], a[16:19], v[96:111]
    ds_read_b64_tr_b16 v[28:29], v12 offset:26624
    ds_read_b64_tr_b16 v[30:31], v12 offset:27648
    s_waitcnt lgkmcnt(2)
    v_mfma_f32_32x32x16_bf16 v[112:127], v[24:27], a[16:19], v[112:127]
    ds_read_b64_tr_b16 v[32:33], v13 offset:26624
    ds_read_b64_tr_b16 v[34:35], v13 offset:27648
    s_add_u32 s66, s60, 0x1e000
    buffer_load_dwordx4 a[64:67], v2, s[32:35], s66 offen offset:0
    buffer_load_dwordx4 a[68:71], v2, s[32:35], s66 offen offset:1024
    s_waitcnt lgkmcnt(2)
    v_mfma_f32_32x32x16_bf16 v[96:111], v[28:31], a[20:23], v[96:111]
    ds_read_b64_tr_b16 v[20:21], v12 offset:28672
    ds_read_b64_tr_b16 v[22:23], v12 offset:29696
    s_waitcnt lgkmcnt(2)
    v_mfma_f32_32x32x16_bf16 v[112:127], v[32:35], a[20:23], v[112:127]
    ds_read_b64_tr_b16 v[24:25], v13 offset:28672
    ds_read_b64_tr_b16 v[26:27], v13 offset:29696
    buffer_load_dwordx4 a[72:75], v2, s[32:35], s66 offen offset:2048
    buffer_load_dwordx4 a[76:79], v2, s[32:35], s66 offen offset:3072
    s_waitcnt lgkmcnt(2)
    v_mfma_f32_32x32x16_bf16 v[96:111], v[20:23], a[24:27], v[96:111]
    ds_read_b64_tr_b16 v[28:29], v12 offset:30720
    ds_read_b64_tr_b16 v[30:31], v12 offset:31744
    s_waitcnt lgkmcnt(2)
    v_mfma_f32_32x32x16_bf16 v[112:127], v[24:27], a[24:27], v[112:127]
    ds_read_b64_tr_b16 v[32:33], v13 offset:30720
    ds_read_b64_tr_b16 v[34:35], v13 offset:31744
    s_add_u32 s66, s60, 0x1f000
    buffer_load_dwordx4 a[0:3], v2, s[32:35], s66 offen offset:0
    buffer_load_dwordx4 a[4:7], v2, s[32:35], s66 offen offset:1024
    s_waitcnt lgkmcnt(0)
    s_barrier
    v_mfma_f32_32x32x16_bf16 v[96:111], v[28:31], a[28:31], v[96:111]
    ds_read_b64_tr_b16 v[20:21], v6 offset:0
    ds_read_b64_tr_b16 v[22:23], v6 offset:1024
    v_mfma_f32_32x32x16_bf16 v[112:127], v[32:35], a[28:31], v[112:127]
    ds_read_b64_tr_b16 v[24:25], v7 offset:0
    ds_read_b64_tr_b16 v[26:27], v7 offset:1024
    buffer_load_dwordx4 a[8:11], v2, s[32:35], s66 offen offset:2048
    buffer_load_dwordx4 a[12:15], v2, s[32:35], s66 offen offset:3072
    s_waitcnt lgkmcnt(2)
    v_mfma_f32_32x32x16_bf16 v[96:111], v[20:23], a[32:35], v[96:111]
    ds_read_b64_tr_b16 v[28:29], v6 offset:2048
    ds_read_b64_tr_b16 v[30:31], v6 offset:3072
    s_add_u32 m0, s63, 0x14000
    s_add_u32 s67, s61, 0x260000
    buffer_load_dwordx4 v8, s[36:39], s67 offen offset:0 lds
    s_waitcnt lgkmcnt(2)
    v_mfma_f32_32x32x16_bf16 v[112:127], v[24:27], a[32:35], v[112:127]
    ds_read_b64_tr_b16 v[32:33], v7 offset:2048
    ds_read_b64_tr_b16 v[34:35], v7 offset:3072
    s_add_u32 s66, s60, 0x20000
    buffer_load_dwordx4 a[16:19], v2, s[32:35], s66 offen offset:0
    buffer_load_dwordx4 a[20:23], v2, s[32:35], s66 offen offset:1024
    s_waitcnt lgkmcnt(2)
    v_mfma_f32_32x32x16_bf16 v[96:111], v[28:31], a[36:39], v[96:111]
    ds_read_b64_tr_b16 v[20:21], v6 offset:4096
    ds_read_b64_tr_b16 v[22:23], v6 offset:5120
    s_waitcnt lgkmcnt(2)
    v_mfma_f32_32x32x16_bf16 v[112:127], v[32:35], a[36:39], v[112:127]
    ds_read_b64_tr_b16 v[24:25], v7 offset:4096
    ds_read_b64_tr_b16 v[26:27], v7 offset:5120
    buffer_load_dwordx4 a[24:27], v2, s[32:35], s66 offen offset:2048
    buffer_load_dwordx4 a[28:31], v2, s[32:35], s66 offen offset:3072
    s_waitcnt lgkmcnt(2)
    v_mfma_f32_32x32x16_bf16 v[96:111], v[20:23], a[40:43], v[96:111]
    ds_read_b64_tr_b16 v[28:29], v6 offset:6144
    ds_read_b64_tr_b16 v[30:31], v6 offset:7168
    buffer_load_dwordx4 v9, s[36:39], s67 offen offset:1024 lds
    s_waitcnt lgkmcnt(2)
    v_mfma_f32_32x32x16_bf16 v[112:127], v[24:27], a[40:43], v[112:127]
    ds_read_b64_tr_b16 v[32:33], v7 offset:6144
    ds_read_b64_tr_b16 v[34:35], v7 offset:7168
    s_add_u32 s66, s60, 0x21000
    buffer_load_dwordx4 a[32:35], v2, s[32:35], s66 offen offset:0
    buffer_load_dwordx4 a[36:39], v2, s[32:35], s66 offen offset:1024
    s_waitcnt lgkmcnt(2)
    v_mfma_f32_32x32x16_bf16 v[96:111], v[28:31], a[44:47], v[96:111]
    ds_read_b64_tr_b16 v[20:21], v6 offset:8192
    ds_read_b64_tr_b16 v[22:23], v6 offset:9216
    s_waitcnt lgkmcnt(2)
    v_mfma_f32_32x32x16_bf16 v[112:127], v[32:35], a[44:47], v[112:127]
    ds_read_b64_tr_b16 v[24:25], v7 offset:8192
    ds_read_b64_tr_b16 v[26:27], v7 offset:9216
    buffer_load_dwordx4 a[40:43], v2, s[32:35], s66 offen offset:2048
    buffer_load_dwordx4 a[44:47], v2, s[32:35], s66 offen offset:3072
    s_waitcnt lgkmcnt(2)
    v_mfma_f32_32x32x16_bf16 v[96:111], v[20:23], a[48:51], v[96:111]
    ds_read_b64_tr_b16 v[28:29], v6 offset:10240
    ds_read_b64_tr_b16 v[30:31], v6 offset:11264
    buffer_load_dwordx4 v10, s[36:39], s67 offen offset:2048 lds
    s_waitcnt lgkmcnt(2)
    v_mfma_f32_32x32x16_bf16 v[112:127], v[24:27], a[48:51], v[112:127]
    ds_read_b64_tr_b16 v[32:33], v7 offset:10240
    ds_read_b64_tr_b16 v[34:35], v7 offset:11264
    s_add_u32 s66, s60, 0x22000
    buffer_load_dwordx4 a[48:51], v2, s[32:35], s66 offen offset:0
    s_waitcnt lgkmcnt(2)
    v_mfma_f32_32x32x16_bf16 v[96:111], v[28:31], a[52:55], v[96:111]
    ds_read_b64_tr_b16 v[20:21], v6 offset:12288
    ds_read_b64_tr_b16 v[22:23], v6 offset:13312
    s_waitcnt lgkmcnt(2)
    v_mfma_f32_32x32x16_bf16 v[112:127], v[32:35], a[52:55], v[112:127]
    ds_read_b64_tr_b16 v[24:25], v7 offset:12288
    ds_read_b64_tr_b16 v[26:27], v7 offset:13312
    buffer_load_dwordx4 a[52:55], v2, s[32:35], s66 offen offset:1024
    s_waitcnt lgkmcnt(2)
    v_mfma_f32_32x32x16_bf16 v[96:111], v[20:23], a[56:59], v[96:111]
    ds_read_b64_tr_b16 v[28:29], v6 offset:14336
    ds_read_b64_tr_b16 v[30:31], v6 offset:15360
    buffer_load_dwordx4 v11, s[36:39], s67 offen offset:3072 lds
    s_waitcnt lgkmcnt(2)
    v_mfma_f32_32x32x16_bf16 v[112:127], v[24:27], a[56:59], v[112:127]
    ds_read_b64_tr_b16 v[32:33], v7 offset:14336
    ds_read_b64_tr_b16 v[34:35], v7 offset:15360
    buffer_load_dwordx4 a[56:59], v2, s[32:35], s66 offen offset:2048
    s_waitcnt lgkmcnt(0)
    s_barrier
    v_mfma_f32_32x32x16_bf16 v[96:111], v[28:31], a[60:63], v[96:111]
    ds_read_b64_tr_b16 v[20:21], v6 offset:16384
    ds_read_b64_tr_b16 v[22:23], v6 offset:17408
    v_mfma_f32_32x32x16_bf16 v[112:127], v[32:35], a[60:63], v[112:127]
    ds_read_b64_tr_b16 v[24:25], v7 offset:16384
    ds_read_b64_tr_b16 v[26:27], v7 offset:17408
    buffer_load_dwordx4 a[60:63], v2, s[32:35], s66 offen offset:3072
    s_waitcnt vmcnt(23) lgkmcnt(2)
    v_mfma_f32_32x32x16_bf16 v[64:79], v[20:23], a[64:67], 0
    ds_read_b64_tr_b16 v[28:29], v6 offset:18432
    ds_read_b64_tr_b16 v[30:31], v6 offset:19456
    s_add_u32 m0, s63, 0
    s_add_u32 s67, s61, 0x280000
    buffer_load_dwordx4 v8, s[36:39], s67 offen offset:0 lds
    s_waitcnt lgkmcnt(2)
    v_mfma_f32_32x32x16_bf16 v[80:95], v[24:27], a[64:67], 0
    ds_read_b64_tr_b16 v[32:33], v7 offset:18432
    ds_read_b64_tr_b16 v[34:35], v7 offset:19456
    s_add_u32 s66, s60, 0x23000
    buffer_load_dwordx4 a[64:67], v2, s[32:35], s66 offen offset:0
    s_waitcnt vmcnt(24) lgkmcnt(2)
    v_mfma_f32_32x32x16_bf16 v[64:79], v[28:31], a[68:71], v[64:79]
    ds_read_b64_tr_b16 v[20:21], v6 offset:20480
    ds_read_b64_tr_b16 v[22:23], v6 offset:21504
    s_waitcnt lgkmcnt(2)
    v_mfma_f32_32x32x16_bf16 v[80:95], v[32:35], a[68:71], v[80:95]
    ds_read_b64_tr_b16 v[24:25], v7 offset:20480
    ds_read_b64_tr_b16 v[26:27], v7 offset:21504
    buffer_load_dwordx4 a[68:71], v2, s[32:35], s66 offen offset:1024
    s_waitcnt vmcnt(24) lgkmcnt(2)
    v_mfma_f32_32x32x16_bf16 v[64:79], v[20:23], a[72:75], v[64:79]
    ds_read_b64_tr_b16 v[28:29], v6 offset:22528
    ds_read_b64_tr_b16 v[30:31], v6 offset:23552
    buffer_load_dwordx4 v9, s[36:39], s67 offen offset:1024 lds
    s_waitcnt lgkmcnt(2)
    v_mfma_f32_32x32x16_bf16 v[80:95], v[24:27], a[72:75], v[80:95]
    ds_read_b64_tr_b16 v[32:33], v7 offset:22528
    ds_read_b64_tr_b16 v[34:35], v7 offset:23552
    buffer_load_dwordx4 a[72:75], v2, s[32:35], s66 offen offset:2048
    s_waitcnt vmcnt(25) lgkmcnt(2)
    v_mfma_f32_32x32x16_bf16 v[64:79], v[28:31], a[76:79], v[64:79]
    ds_read_b64_tr_b16 v[20:21], v6 offset:24576
    ds_read_b64_tr_b16 v[22:23], v6 offset:25600
    s_waitcnt lgkmcnt(2)
    v_mfma_f32_32x32x16_bf16 v[80:95], v[32:35], a[76:79], v[80:95]
    ds_read_b64_tr_b16 v[24:25], v7 offset:24576
    ds_read_b64_tr_b16 v[26:27], v7 offset:25600
    buffer_load_dwordx4 a[76:79], v2, s[32:35], s66 offen offset:3072
    s_waitcnt vmcnt(25) lgkmcnt(2)
    v_mfma_f32_32x32x16_bf16 v[64:79], v[20:23], a[0:3], v[64:79]
    ds_read_b64_tr_b16 v[28:29], v6 offset:26624
    ds_read_b64_tr_b16 v[30:31], v6 offset:27648
    buffer_load_dwordx4 v10, s[36:39], s67 offen offset:2048 lds
    s_waitcnt lgkmcnt(2)
    v_mfma_f32_32x32x16_bf16 v[80:95], v[24:27], a[0:3], v[80:95]
    ds_read_b64_tr_b16 v[32:33], v7 offset:26624
    ds_read_b64_tr_b16 v[34:35], v7 offset:27648
    s_add_u32 s66, s60, 0x24000
    buffer_load_dwordx4 a[0:3], v2, s[32:35], s66 offen offset:0
    s_waitcnt vmcnt(26) lgkmcnt(2)
    v_mfma_f32_32x32x16_bf16 v[64:79], v[28:31], a[4:7], v[64:79]
    ds_read_b64_tr_b16 v[20:21], v6 offset:28672
    ds_read_b64_tr_b16 v[22:23], v6 offset:29696
    s_waitcnt lgkmcnt(2)
    v_mfma_f32_32x32x16_bf16 v[80:95], v[32:35], a[4:7], v[80:95]
    ds_read_b64_tr_b16 v[24:25], v7 offset:28672
    ds_read_b64_tr_b16 v[26:27], v7 offset:29696
    buffer_load_dwordx4 a[4:7], v2, s[32:35], s66 offen offset:1024
    s_waitcnt vmcnt(26) lgkmcnt(2)
    v_mfma_f32_32x32x16_bf16 v[64:79], v[20:23], a[8:11], v[64:79]
    ds_read_b64_tr_b16 v[28:29], v6 offset:30720
    ds_read_b64_tr_b16 v[30:31], v6 offset:31744
    buffer_load_dwordx4 v11, s[36:39], s67 offen offset:3072 lds
    s_waitcnt lgkmcnt(2)
    v_mfma_f32_32x32x16_bf16 v[80:95], v[24:27], a[8:11], v[80:95]
    ds_read_b64_tr_b16 v[32:33], v7 offset:30720
    ds_read_b64_tr_b16 v[34:35], v7 offset:31744
    buffer_load_dwordx4 a[8:11], v2, s[32:35], s66 offen offset:2048
    s_waitcnt lgkmcnt(0)
    s_barrier
    s_waitcnt vmcnt(27)
    v_mfma_f32_32x32x16_bf16 v[64:79], v[28:31], a[12:15], v[64:79]
    ds_read_b64_tr_b16 v[20:21], v6 offset:32768
    ds_read_b64_tr_b16 v[22:23], v6 offset:33792
    v_mfma_f32_32x32x16_bf16 v[80:95], v[32:35], a[12:15], v[80:95]
    ds_read_b64_tr_b16 v[24:25], v7 offset:32768
    ds_read_b64_tr_b16 v[26:27], v7 offset:33792
    buffer_load_dwordx4 a[12:15], v2, s[32:35], s66 offen offset:3072
    s_waitcnt vmcnt(26) lgkmcnt(2)
    v_mfma_f32_32x32x16_bf16 v[64:79], v[20:23], a[16:19], v[64:79]
    ds_read_b64_tr_b16 v[28:29], v6 offset:34816
    ds_read_b64_tr_b16 v[30:31], v6 offset:35840
    s_add_u32 m0, s63, 0x4000
    s_add_u32 s67, s61, 0x2a0000
    buffer_load_dwordx4 v8, s[36:39], s67 offen offset:0 lds
    s_waitcnt lgkmcnt(2)
    v_mfma_f32_32x32x16_bf16 v[80:95], v[24:27], a[16:19], v[80:95]
    ds_read_b64_tr_b16 v[32:33], v7 offset:34816
    ds_read_b64_tr_b16 v[34:35], v7 offset:35840
    s_add_u32 s66, s60, 0x25000
    buffer_load_dwordx4 a[16:19], v2, s[32:35], s66 offen offset:0
    s_waitcnt vmcnt(27) lgkmcnt(2)
    v_mfma_f32_32x32x16_bf16 v[64:79], v[28:31], a[20:23], v[64:79]
    ds_read_b64_tr_b16 v[20:21], v6 offset:36864
    ds_read_b64_tr_b16 v[22:23], v6 offset:37888
    s_waitcnt lgkmcnt(2)
    v_mfma_f32_32x32x16_bf16 v[80:95], v[32:35], a[20:23], v[80:95]
    ds_read_b64_tr_b16 v[24:25], v7 offset:36864
    ds_read_b64_tr_b16 v[26:27], v7 offset:37888
    buffer_load_dwordx4 a[20:23], v2, s[32:35], s66 offen offset:1024
    s_waitcnt vmcnt(27) lgkmcnt(2)
    v_mfma_f32_32x32x16_bf16 v[64:79], v[20:23], a[24:27], v[64:79]
    ds_read_b64_tr_b16 v[28:29], v6 offset:38912
    ds_read_b64_tr_b16 v[30:31], v6 offset:39936
    buffer_load_dwordx4 v9, s[36:39], s67 offen offset:1024 lds
    s_waitcnt lgkmcnt(2)
    v_mfma_f32_32x32x16_bf16 v[80:95], v[24:27], a[24:27], v[80:95]
    ds_read_b64_tr_b16 v[32:33], v7 offset:38912
    ds_read_b64_tr_b16 v[34:35], v7 offset:39936
    buffer_load_dwordx4 a[24:27], v2, s[32:35], s66 offen offset:2048
    s_waitcnt vmcnt(28) lgkmcnt(2)
    v_mfma_f32_32x32x16_bf16 v[64:79], v[28:31], a[28:31], v[64:79]
    ds_read_b64_tr_b16 v[20:21], v6 offset:40960
    ds_read_b64_tr_b16 v[22:23], v6 offset:41984
    s_waitcnt lgkmcnt(2)
    v_mfma_f32_32x32x16_bf16 v[80:95], v[32:35], a[28:31], v[80:95]
    ds_read_b64_tr_b16 v[24:25], v7 offset:40960
    ds_read_b64_tr_b16 v[26:27], v7 offset:41984
    buffer_load_dwordx4 a[28:31], v2, s[32:35], s66 offen offset:3072
    s_waitcnt vmcnt(27) lgkmcnt(2)
    v_mfma_f32_32x32x16_bf16 v[64:79], v[20:23], a[32:35], v[64:79]
    ds_read_b64_tr_b16 v[28:29], v6 offset:43008
    ds_read_b64_tr_b16 v[30:31], v6 offset:44032
    buffer_load_dwordx4 v10, s[36:39], s67 offen offset:2048 lds
    s_waitcnt lgkmcnt(2)
    v_mfma_f32_32x32x16_bf16 v[80:95], v[24:27], a[32:35], v[80:95]
    ds_read_b64_tr_b16 v[32:33], v7 offset:43008
    ds_read_b64_tr_b16 v[34:35], v7 offset:44032
    s_add_u32 s66, s60, 0x26000
    buffer_load_dwordx4 a[32:35], v2, s[32:35], s66 offen offset:0
    s_waitcnt vmcnt(28) lgkmcnt(2)
    v_mfma_f32_32x32x16_bf16 v[64:79], v[28:31], a[36:39], v[64:79]
    ds_read_b64_tr_b16 v[20:21], v6 offset:45056
    ds_read_b64_tr_b16 v[22:23], v6 offset:46080
    s_waitcnt lgkmcnt(2)
    v_mfma_f32_32x32x16_bf16 v[80:95], v[32:35], a[36:39], v[80:95]
    ds_read_b64_tr_b16 v[24:25], v7 offset:45056
    ds_read_b64_tr_b16 v[26:27], v7 offset:46080
    buffer_load_dwordx4 a[36:39], v2, s[32:35], s66 offen offset:1024
    s_waitcnt vmcnt(28) lgkmcnt(2)
    v_mfma_f32_32x32x16_bf16 v[64:79], v[20:23], a[40:43], v[64:79]
    ds_read_b64_tr_b16 v[28:29], v6 offset:47104
    ds_read_b64_tr_b16 v[30:31], v6 offset:48128
    buffer_load_dwordx4 v11, s[36:39], s67 offen offset:3072 lds
    s_waitcnt lgkmcnt(2)
    v_mfma_f32_32x32x16_bf16 v[80:95], v[24:27], a[40:43], v[80:95]
    ds_read_b64_tr_b16 v[32:33], v7 offset:47104
    ds_read_b64_tr_b16 v[34:35], v7 offset:48128
    buffer_load_dwordx4 a[40:43], v2, s[32:35], s66 offen offset:2048
    s_waitcnt lgkmcnt(0)
    s_barrier
    s_waitcnt vmcnt(29)
    v_mfma_f32_32x32x16_bf16 v[64:79], v[28:31], a[44:47], v[64:79]
    ds_read_b64_tr_b16 v[20:21], v6 offset:49152
    ds_read_b64_tr_b16 v[22:23], v6 offset:50176
    v_mfma_f32_32x32x16_bf16 v[80:95], v[32:35], a[44:47], v[80:95]
    ds_read_b64_tr_b16 v[24:25], v7 offset:49152
    ds_read_b64_tr_b16 v[26:27], v7 offset:50176
    buffer_load_dwordx4 a[44:47], v2, s[32:35], s66 offen offset:3072
    s_waitcnt vmcnt(28) lgkmcnt(2)
    v_mfma_f32_32x32x16_bf16 v[64:79], v[20:23], a[48:51], v[64:79]
    ds_read_b64_tr_b16 v[28:29], v6 offset:51200
    ds_read_b64_tr_b16 v[30:31], v6 offset:52224
    s_add_u32 m0, s63, 0x8000
    s_add_u32 s67, s61, 0x2c0000
    buffer_load_dwordx4 v8, s[36:39], s67 offen offset:0 lds
    s_waitcnt lgkmcnt(2)
    v_mfma_f32_32x32x16_bf16 v[80:95], v[24:27], a[48:51], v[80:95]
    ds_read_b64_tr_b16 v[32:33], v7 offset:51200
    ds_read_b64_tr_b16 v[34:35], v7 offset:52224
    s_add_u32 s66, s60, 0x27000
    buffer_load_dwordx4 a[48:51], v2, s[32:35], s66 offen offset:0
    s_waitcnt vmcnt(29) lgkmcnt(2)
    v_mfma_f32_32x32x16_bf16 v[64:79], v[28:31], a[52:55], v[64:79]
    ds_read_b64_tr_b16 v[20:21], v6 offset:53248
    ds_read_b64_tr_b16 v[22:23], v6 offset:54272
    s_waitcnt lgkmcnt(2)
    v_mfma_f32_32x32x16_bf16 v[80:95], v[32:35], a[52:55], v[80:95]
    ds_read_b64_tr_b16 v[24:25], v7 offset:53248
    ds_read_b64_tr_b16 v[26:27], v7 offset:54272
    buffer_load_dwordx4 a[52:55], v2, s[32:35], s66 offen offset:1024
    s_waitcnt vmcnt(28) lgkmcnt(2)
    v_mfma_f32_32x32x16_bf16 v[64:79], v[20:23], a[56:59], v[64:79]
    ds_read_b64_tr_b16 v[28:29], v6 offset:55296
    ds_read_b64_tr_b16 v[30:31], v6 offset:56320
    buffer_load_dwordx4 v9, s[36:39], s67 offen offset:1024 lds
    s_waitcnt lgkmcnt(2)
    v_mfma_f32_32x32x16_bf16 v[80:95], v[24:27], a[56:59], v[80:95]
    ds_read_b64_tr_b16 v[32:33], v7 offset:55296
    ds_read_b64_tr_b16 v[34:35], v7 offset:56320
    buffer_load_dwordx4 a[56:59], v2, s[32:35], s66 offen offset:2048
    s_waitcnt vmcnt(29) lgkmcnt(2)
    v_mfma_f32_32x32x16_bf16 v[64:79], v[28:31], a[60:63], v[64:79]
    ds_read_b64_tr_b16 v[20:21], v6 offset:57344
    ds_read_b64_tr_b16 v[22:23], v6 offset:58368
    s_waitcnt lgkmcnt(2)
    v_mfma_f32_32x32x16_bf16 v[80:95], v[32:35], a[60:63], v[80:95]
    ds_read_b64_tr_b16 v[24:25], v7 offset:57344
    ds_read_b64_tr_b16 v[26:27], v7 offset:58368
    buffer_load_dwordx4 a[60:63], v2, s[32:35], s66 offen offset:3072
    s_waitcnt vmcnt(28) lgkmcnt(2)
    v_mfma_f32_32x32x16_bf16 v[64:79], v[20:23], a[64:67], v[64:79]
    ds_read_b64_tr_b16 v[28:29], v6 offset:59392
    ds_read_b64_tr_b16 v[30:31], v6 offset:60416
    buffer_load_dwordx4 v10, s[36:39], s67 offen offset:2048 lds
    s_waitcnt lgkmcnt(2)
    v_mfma_f32_32x32x16_bf16 v[80:95], v[24:27], a[64:67], v[80:95]
    ds_read_b64_tr_b16 v[32:33], v7 offset:59392
    ds_read_b64_tr_b16 v[34:35], v7 offset:60416
    s_add_u32 s66, s60, 0x28000
    buffer_load_dwordx4 a[64:67], v2, s[32:35], s66 offen offset:0
    s_waitcnt vmcnt(29) lgkmcnt(2)
    v_mfma_f32_32x32x16_bf16 v[64:79], v[28:31], a[68:71], v[64:79]
    ds_read_b64_tr_b16 v[20:21], v6 offset:61440
    ds_read_b64_tr_b16 v[22:23], v6 offset:62464
    s_waitcnt lgkmcnt(2)
    v_mfma_f32_32x32x16_bf16 v[80:95], v[32:35], a[68:71], v[80:95]
    ds_read_b64_tr_b16 v[24:25], v7 offset:61440
    ds_read_b64_tr_b16 v[26:27], v7 offset:62464
    buffer_load_dwordx4 a[68:71], v2, s[32:35], s66 offen offset:1024
    s_waitcnt vmcnt(28) lgkmcnt(2)
    v_mfma_f32_32x32x16_bf16 v[64:79], v[20:23], a[72:75], v[64:79]
    ds_read_b64_tr_b16 v[28:29], v6 offset:63488
    ds_read_b64_tr_b16 v[30:31], v6 offset:64512
    buffer_load_dwordx4 v11, s[36:39], s67 offen offset:3072 lds
    s_waitcnt lgkmcnt(2)
    v_mfma_f32_32x32x16_bf16 v[80:95], v[24:27], a[72:75], v[80:95]
    ds_read_b64_tr_b16 v[32:33], v7 offset:63488
    ds_read_b64_tr_b16 v[34:35], v7 offset:64512
    buffer_load_dwordx4 a[72:75], v2, s[32:35], s66 offen offset:2048
    s_waitcnt lgkmcnt(0)
    s_barrier
    s_waitcnt vmcnt(29)
    v_mfma_f32_32x32x16_bf16 v[64:79], v[28:31], a[76:79], v[64:79]
    ds_read_b64_tr_b16 v[20:21], v12 offset:0
    ds_read_b64_tr_b16 v[22:23], v12 offset:1024
    v_mfma_f32_32x32x16_bf16 v[80:95], v[32:35], a[76:79], v[80:95]
    ds_read_b64_tr_b16 v[24:25], v13 offset:0
    ds_read_b64_tr_b16 v[26:27], v13 offset:1024
    buffer_load_dwordx4 a[76:79], v2, s[32:35], s66 offen offset:3072
    s_waitcnt vmcnt(28) lgkmcnt(2)
    v_mfma_f32_32x32x16_bf16 v[64:79], v[20:23], a[0:3], v[64:79]
    ds_read_b64_tr_b16 v[28:29], v12 offset:2048
    ds_read_b64_tr_b16 v[30:31], v12 offset:3072
    s_add_u32 m0, s63, 0xc000
    s_add_u32 s67, s61, 0x2e0000
    buffer_load_dwordx4 v8, s[36:39], s67 offen offset:0 lds
    s_waitcnt lgkmcnt(2)
    v_mfma_f32_32x32x16_bf16 v[80:95], v[24:27], a[0:3], v[80:95]
    ds_read_b64_tr_b16 v[32:33], v13 offset:2048
    ds_read_b64_tr_b16 v[34:35], v13 offset:3072
    s_add_u32 s66, s60, 0x29000
    buffer_load_dwordx4 a[0:3], v2, s[32:35], s66 offen offset:0
    s_waitcnt vmcnt(29) lgkmcnt(2)
    v_mfma_f32_32x32x16_bf16 v[64:79], v[28:31], a[4:7], v[64:79]
    ds_read_b64_tr_b16 v[20:21], v12 offset:4096
    ds_read_b64_tr_b16 v[22:23], v12 offset:5120
    s_waitcnt lgkmcnt(2)
    v_mfma_f32_32x32x16_bf16 v[80:95], v[32:35], a[4:7], v[80:95]
    ds_read_b64_tr_b16 v[24:25], v13 offset:4096
    ds_read_b64_tr_b16 v[26:27], v13 offset:5120
    buffer_load_dwordx4 a[4:7], v2, s[32:35], s66 offen offset:1024
    s_waitcnt vmcnt(28) lgkmcnt(2)
    v_mfma_f32_32x32x16_bf16 v[64:79], v[20:23], a[8:11], v[64:79]
    ds_read_b64_tr_b16 v[28:29], v12 offset:6144
    ds_read_b64_tr_b16 v[30:31], v12 offset:7168
    buffer_load_dwordx4 v9, s[36:39], s67 offen offset:1024 lds
    s_waitcnt lgkmcnt(2)
    v_mfma_f32_32x32x16_bf16 v[80:95], v[24:27], a[8:11], v[80:95]
    ds_read_b64_tr_b16 v[32:33], v13 offset:6144
    ds_read_b64_tr_b16 v[34:35], v13 offset:7168
    buffer_load_dwordx4 a[8:11], v2, s[32:35], s66 offen offset:2048
    s_waitcnt vmcnt(29) lgkmcnt(2)
    v_mfma_f32_32x32x16_bf16 v[64:79], v[28:31], a[12:15], v[64:79]
    ds_read_b64_tr_b16 v[20:21], v12 offset:8192
    ds_read_b64_tr_b16 v[22:23], v12 offset:9216
    s_waitcnt lgkmcnt(2)
    v_mfma_f32_32x32x16_bf16 v[80:95], v[32:35], a[12:15], v[80:95]
    ds_read_b64_tr_b16 v[24:25], v13 offset:8192
    ds_read_b64_tr_b16 v[26:27], v13 offset:9216
    buffer_load_dwordx4 a[12:15], v2, s[32:35], s66 offen offset:3072
    s_waitcnt vmcnt(28) lgkmcnt(2)
    v_mfma_f32_32x32x16_bf16 v[64:79], v[20:23], a[16:19], v[64:79]
    ds_read_b64_tr_b16 v[28:29], v12 offset:10240
    ds_read_b64_tr_b16 v[30:31], v12 offset:11264
    buffer_load_dwordx4 v10, s[36:39], s67 offen offset:2048 lds
    s_waitcnt lgkmcnt(2)
    v_mfma_f32_32x32x16_bf16 v[80:95], v[24:27], a[16:19], v[80:95]
    ds_read_b64_tr_b16 v[32:33], v13 offset:10240
    ds_read_b64_tr_b16 v[34:35], v13 offset:11264
    s_add_u32 s66, s60, 0x2a000
    buffer_load_dwordx4 a[16:19], v2, s[32:35], s66 offen offset:0
    s_waitcnt vmcnt(29) lgkmcnt(2)
    v_mfma_f32_32x32x16_bf16 v[64:79], v[28:31], a[20:23], v[64:79]
    ds_read_b64_tr_b16 v[20:21], v12 offset:12288
    ds_read_b64_tr_b16 v[22:23], v12 offset:13312
    s_waitcnt lgkmcnt(2)
    v_mfma_f32_32x32x16_bf16 v[80:95], v[32:35], a[20:23], v[80:95]
    ds_read_b64_tr_b16 v[24:25], v13 offset:12288
    ds_read_b64_tr_b16 v[26:27], v13 offset:13312
    buffer_load_dwordx4 a[20:23], v2, s[32:35], s66 offen offset:1024
    s_waitcnt vmcnt(28) lgkmcnt(2)
    v_mfma_f32_32x32x16_bf16 v[64:79], v[20:23], a[24:27], v[64:79]
    ds_read_b64_tr_b16 v[28:29], v12 offset:14336
    ds_read_b64_tr_b16 v[30:31], v12 offset:15360
    buffer_load_dwordx4 v11, s[36:39], s67 offen offset:3072 lds
    s_waitcnt lgkmcnt(2)
    v_mfma_f32_32x32x16_bf16 v[80:95], v[24:27], a[24:27], v[80:95]
    ds_read_b64_tr_b16 v[32:33], v13 offset:14336
    ds_read_b64_tr_b16 v[34:35], v13 offset:15360
    buffer_load_dwordx4 a[24:27], v2, s[32:35], s66 offen offset:2048
    s_waitcnt lgkmcnt(0)
    buffer_load_dword v17, v15, s[32:35], 0 offen offset:4 sc1
    s_barrier
    s_waitcnt vmcnt(30)
    v_mfma_f32_32x32x16_bf16 v[64:79], v[28:31], a[28:31], v[64:79]
    ds_read_b64_tr_b16 v[20:21], v12 offset:16384
    ds_read_b64_tr_b16 v[22:23], v12 offset:17408
    v_mfma_f32_32x32x16_bf16 v[80:95], v[32:35], a[28:31], v[80:95]
    ds_read_b64_tr_b16 v[24:25], v13 offset:16384
    ds_read_b64_tr_b16 v[26:27], v13 offset:17408
    buffer_load_dwordx4 a[28:31], v2, s[32:35], s66 offen offset:3072
    s_waitcnt vmcnt(29) lgkmcnt(2)
    v_mfma_f32_32x32x16_bf16 v[64:79], v[20:23], a[32:35], v[64:79]
    ds_read_b64_tr_b16 v[28:29], v12 offset:18432
    ds_read_b64_tr_b16 v[30:31], v12 offset:19456
    s_add_u32 m0, s63, 0x10000
    s_add_u32 s67, s61, 0x300000
    buffer_load_dwordx4 v8, s[36:39], s67 offen offset:0 lds
    s_waitcnt lgkmcnt(2)
    v_mfma_f32_32x32x16_bf16 v[80:95], v[24:27], a[32:35], v[80:95]
    ds_read_b64_tr_b16 v[32:33], v13 offset:18432
    ds_read_b64_tr_b16 v[34:35], v13 offset:19456
    s_add_u32 s66, s60, 0x2b000
    buffer_load_dwordx4 a[32:35], v2, s[32:35], s66 offen offset:0
    s_waitcnt vmcnt(30) lgkmcnt(2)
    v_mfma_f32_32x32x16_bf16 v[64:79], v[28:31], a[36:39], v[64:79]
    ds_read_b64_tr_b16 v[20:21], v12 offset:20480
    ds_read_b64_tr_b16 v[22:23], v12 offset:21504
    s_waitcnt lgkmcnt(2)
    v_mfma_f32_32x32x16_bf16 v[80:95], v[32:35], a[36:39], v[80:95]
    ds_read_b64_tr_b16 v[24:25], v13 offset:20480
    ds_read_b64_tr_b16 v[26:27], v13 offset:21504
    buffer_load_dwordx4 a[36:39], v2, s[32:35], s66 offen offset:1024
    s_waitcnt vmcnt(29) lgkmcnt(2)
    v_mfma_f32_32x32x16_bf16 v[64:79], v[20:23], a[40:43], v[64:79]
    ds_read_b64_tr_b16 v[28:29], v12 offset:22528
    ds_read_b64_tr_b16 v[30:31], v12 offset:23552
    buffer_load_dwordx4 v9, s[36:39], s67 offen offset:1024 lds
    s_waitcnt lgkmcnt(2)
    v_mfma_f32_32x32x16_bf16 v[80:95], v[24:27], a[40:43], v[80:95]
    ds_read_b64_tr_b16 v[32:33], v13 offset:22528
    ds_read_b64_tr_b16 v[34:35], v13 offset:23552
    buffer_load_dwordx4 a[40:43], v2, s[32:35], s66 offen offset:2048
    s_waitcnt vmcnt(30) lgkmcnt(2)
    v_mfma_f32_32x32x16_bf16 v[64:79], v[28:31], a[44:47], v[64:79]
    ds_read_b64_tr_b16 v[20:21], v12 offset:24576
    ds_read_b64_tr_b16 v[22:23], v12 offset:25600
    s_waitcnt lgkmcnt(2)
    v_mfma_f32_32x32x16_bf16 v[80:95], v[32:35], a[44:47], v[80:95]
    ds_read_b64_tr_b16 v[24:25], v13 offset:24576
    ds_read_b64_tr_b16 v[26:27], v13 offset:25600
    buffer_load_dwordx4 a[44:47], v2, s[32:35], s66 offen offset:3072
    s_waitcnt vmcnt(29) lgkmcnt(2)
    v_mfma_f32_32x32x16_bf16 v[64:79], v[20:23], a[48:51], v[64:79]
    ds_read_b64_tr_b16 v[28:29], v12 offset:26624
    ds_read_b64_tr_b16 v[30:31], v12 offset:27648
    buffer_load_dwordx4 v10, s[36:39], s67 offen offset:2048 lds
    s_waitcnt lgkmcnt(2)
    v_mfma_f32_32x32x16_bf16 v[80:95], v[24:27], a[48:51], v[80:95]
    ds_read_b64_tr_b16 v[32:33], v13 offset:26624
    ds_read_b64_tr_b16 v[34:35], v13 offset:27648
    s_add_u32 s66, s60, 0x2c000
    buffer_load_dwordx4 a[48:51], v2, s[32:35], s66 offen offset:0
    s_waitcnt vmcnt(30) lgkmcnt(2)
    v_mfma_f32_32x32x16_bf16 v[64:79], v[28:31], a[52:55], v[64:79]
    ds_read_b64_tr_b16 v[20:21], v12 offset:28672
    ds_read_b64_tr_b16 v[22:23], v12 offset:29696
    s_waitcnt lgkmcnt(2)
    v_mfma_f32_32x32x16_bf16 v[80:95], v[32:35], a[52:55], v[80:95]
    ds_read_b64_tr_b16 v[24:25], v13 offset:28672
    ds_read_b64_tr_b16 v[26:27], v13 offset:29696
    buffer_load_dwordx4 a[52:55], v2, s[32:35], s66 offen offset:1024
    s_waitcnt vmcnt(29) lgkmcnt(2)
    v_mfma_f32_32x32x16_bf16 v[64:79], v[20:23], a[56:59], v[64:79]
    ds_read_b64_tr_b16 v[28:29], v12 offset:30720
    ds_read_b64_tr_b16 v[30:31], v12 offset:31744
    buffer_load_dwordx4 v11, s[36:39], s67 offen offset:3072 lds
    s_waitcnt lgkmcnt(2)
    v_mfma_f32_32x32x16_bf16 v[80:95], v[24:27], a[56:59], v[80:95]
    ds_read_b64_tr_b16 v[32:33], v13 offset:30720
    ds_read_b64_tr_b16 v[34:35], v13 offset:31744
    buffer_load_dwordx4 a[56:59], v2, s[32:35], s66 offen offset:2048
    s_waitcnt lgkmcnt(0)
    s_waitcnt vmcnt(12)
    v_readfirstlane_b32 s64, v17
    s_nop 0
    s_cmp_lg_u32 s64, 0
    s_cbranch_scc1 K3_POLLX4
    s_mov_b32 s70, 0x10000
K3_POLL4:
    buffer_load_dword v17, v15, s[32:35], 0 offen offset:4 sc1
    s_waitcnt vmcnt(0)
    v_readfirstlane_b32 s64, v17
    s_sub_u32 s70, s70, 1
    s_cmp_eq_u32 s70, 0
    s_cbranch_scc1 K3_POLLX4
    s_cmp_lg_u32 s64, 0
    s_cbranch_scc1 K3_POLLX4
    s_sleep 8
    s_branch K3_POLL4
K3_POLLX4:
    s_barrier
    v_mfma_f32_32x32x16_bf16 v[64:79], v[28:31], a[60:63], v[64:79]
    ds_read_b64_tr_b16 v[20:21], v6 offset:0
    ds_read_b64_tr_b16 v[22:23], v6 offset:1024
    s_add_u32 s65, s69, 0x400000
    buffer_load_dwordx4 v[160:163], v2, s[32:35], s65 offen offset:0 sc1
    v_mfma_f32_32x32x16_bf16 v[80:95], v[32:35], a[60:63], v[80:95]
    ds_read_b64_tr_b16 v[24:25], v7 offset:0
    ds_read_b64_tr_b16 v[26:27], v7 offset:1024
    buffer_load_dwordx4 a[60:63], v2, s[32:35], s66 offen offset:3072
    s_waitcnt lgkmcnt(2)
    v_mfma_f32_32x32x16_bf16 v[64:79], v[20:23], a[64:67], v[64:79]
    ds_read_b64_tr_b16 v[28:29], v6 offset:2048
    ds_read_b64_tr_b16 v[30:31], v6 offset:3072
    buffer_load_dwordx4 v[164:167], v2, s[32:35], s65 offen offset:1024 sc1
    s_waitcnt lgkmcnt(2)
    v_mfma_f32_32x32x16_bf16 v[80:95], v[24:27], a[64:67], v[80:95]
    ds_read_b64_tr_b16 v[32:33], v7 offset:2048
    ds_read_b64_tr_b16 v[34:35], v7 offset:3072
    s_add_u32 s66, s60, 0x2d000
    buffer_load_dwordx4 a[64:67], v2, s[32:35], s66 offen offset:0
    s_waitcnt lgkmcnt(2)
    v_mfma_f32_32x32x16_bf16 v[64:79], v[28:31], a[68:71], v[64:79]
    ds_read_b64_tr_b16 v[20:21], v6 offset:4096
    ds_read_b64_tr_b16 v[22:23], v6 offset:5120
    buffer_load_dwordx4 v[168:171], v2, s[32:35], s65 offen offset:2048 sc1
    s_waitcnt lgkmcnt(2)
    v_mfma_f32_32x32x16_bf16 v[80:95], v[32:35], a[68:71], v[80:95]
    ds_read_b64_tr_b16 v[24:25], v7 offset:4096
    ds_read_b64_tr_b16 v[26:27], v7 offset:5120
    buffer_load_dwordx4 a[68:71], v2, s[32:35], s66 offen offset:1024
    s_waitcnt lgkmcnt(2)
    v_mfma_f32_32x32x16_bf16 v[64:79], v[20:23], a[72:75], v[64:79]
    ds_read_b64_tr_b16 v[28:29], v6 offset:6144
    ds_read_b64_tr_b16 v[30:31], v6 offset:7168
    buffer_load_dwordx4 v[172:175], v2, s[32:35], s65 offen offset:3072 sc1
    s_waitcnt lgkmcnt(2)
    v_mfma_f32_32x32x16_bf16 v[80:95], v[24:27], a[72:75], v[80:95]
    ds_read_b64_tr_b16 v[32:33], v7 offset:6144
    ds_read_b64_tr_b16 v[34:35], v7 offset:7168
    buffer_load_dwordx4 a[72:75], v2, s[32:35], s66 offen offset:2048
    s_waitcnt lgkmcnt(2)
    v_mfma_f32_32x32x16_bf16 v[64:79], v[28:31], a[76:79], v[64:79]
    ds_read_b64_tr_b16 v[20:21], v6 offset:8192
    ds_read_b64_tr_b16 v[22:23], v6 offset:9216
    s_add_u32 s65, s69, 0x401000
    buffer_load_dwordx4 v[176:179], v2, s[32:35], s65 offen offset:0 sc1
    s_waitcnt lgkmcnt(2)
    v_mfma_f32_32x32x16_bf16 v[80:95], v[32:35], a[76:79], v[80:95]
    ds_read_b64_tr_b16 v[24:25], v7 offset:8192
    ds_read_b64_tr_b16 v[26:27], v7 offset:9216
    buffer_load_dwordx4 a[76:79], v2, s[32:35], s66 offen offset:3072
    s_waitcnt lgkmcnt(2)
    v_mfma_f32_32x32x16_bf16 v[64:79], v[20:23], a[0:3], v[64:79]
    ds_read_b64_tr_b16 v[28:29], v6 offset:10240
    ds_read_b64_tr_b16 v[30:31], v6 offset:11264
    buffer_load_dwordx4 v[180:183], v2, s[32:35], s65 offen offset:1024 sc1
    s_waitcnt lgkmcnt(2)
    v_mfma_f32_32x32x16_bf16 v[80:95], v[24:27], a[0:3], v[80:95]
    ds_read_b64_tr_b16 v[32:33], v7 offset:10240
    ds_read_b64_tr_b16 v[34:35], v7 offset:11264
    s_add_u32 s66, s60, 0x2e000
    buffer_load_dwordx4 a[0:3], v2, s[32:35], s66 offen offset:0
    s_waitcnt lgkmcnt(2)
    v_mfma_f32_32x32x16_bf16 v[64:79], v[28:31], a[4:7], v[64:79]
    ds_read_b64_tr_b16 v[20:21], v6 offset:12288
    ds_read_b64_tr_b16 v[22:23], v6 offset:13312
    s_waitcnt lgkmcnt(2)
    v_mfma_f32_32x32x16_bf16 v[80:95], v[32:35], a[4:7], v[80:95]
    ds_read_b64_tr_b16 v[24:25], v7 offset:12288
    ds_read_b64_tr_b16 v[26:27], v7 offset:13312
    buffer_load_dwordx4 a[4:7], v2, s[32:35], s66 offen offset:1024
    s_waitcnt lgkmcnt(2)
    v_mfma_f32_32x32x16_bf16 v[64:79], v[20:23], a[8:11], v[64:79]
    ds_read_b64_tr_b16 v[28:29], v6 offset:14336
    ds_read_b64_tr_b16 v[30:31], v6 offset:15360
    buffer_load_dwordx4 v[184:187], v2, s[32:35], s65 offen offset:2048 sc1
    s_waitcnt lgkmcnt(2)
    v_mfma_f32_32x32x16_bf16 v[80:95], v[24:27], a[8:11], v[80:95]
    ds_read_b64_tr_b16 v[32:33], v7 offset:14336
    ds_read_b64_tr_b16 v[34:35], v7 offset:15360
    buffer_load_dwordx4 a[8:11], v2, s[32:35], s66 offen offset:2048
    s_waitcnt lgkmcnt(0)
    s_barrier
    v_mfma_f32_32x32x16_bf16 v[64:79], v[28:31], a[12:15], v[64:79]
    ds_read_b64_tr_b16 v[20:21], v6 offset:16384
    ds_read_b64_tr_b16 v[22:23], v6 offset:17408
    buffer_load_dwordx4 v[188:191], v2, s[32:35], s65 offen offset:3072 sc1
    v_mfma_f32_32x32x16_bf16 v[80:95], v[32:35], a[12:15], v[80:95]
    ds_read_b64_tr_b16 v[24:25], v7 offset:16384
    ds_read_b64_tr_b16 v[26:27], v7 offset:17408
    buffer_load_dwordx4 a[12:15], v2, s[32:35], s66 offen offset:3072
    s_waitcnt lgkmcnt(2)
    v_mfma_f32_32x32x16_bf16 v[64:79], v[20:23], a[16:19], v[64:79]
    ds_read_b64_tr_b16 v[28:29], v6 offset:18432
    ds_read_b64_tr_b16 v[30:31], v6 offset:19456
    s_add_u32 m0, s63, 0x14000
    s_add_u32 s67, s61, 0x320000
    buffer_load_dwordx4 v8, s[36:39], s67 offen offset:0 lds
    s_waitcnt lgkmcnt(2)
    v_mfma_f32_32x32x16_bf16 v[80:95], v[24:27], a[16:19], v[80:95]
    ds_read_b64_tr_b16 v[32:33], v7 offset:18432
    ds_read_b64_tr_b16 v[34:35], v7 offset:19456
    s_add_u32 s66, s60, 0x2f000
    buffer_load_dwordx4 a[16:19], v2, s[32:35], s66 offen offset:0
    s_waitcnt lgkmcnt(2)
    v_mfma_f32_32x32x16_bf16 v[64:79], v[28:31], a[20:23], v[64:79]
    ds_read_b64_tr_b16 v[20:21], v6 offset:20480
    ds_read_b64_tr_b16 v[22:23], v6 offset:21504
    buffer_load_dwordx4 v9, s[36:39], s67 offen offset:1024 lds
    s_waitcnt lgkmcnt(2)
    v_mfma_f32_32x32x16_bf16 v[80:95], v[32:35], a[20:23], v[80:95]
    ds_read_b64_tr_b16 v[24:25], v7 offset:20480
    ds_read_b64_tr_b16 v[26:27], v7 offset:21504
    buffer_load_dwordx4 a[20:23], v2, s[32:35], s66 offen offset:1024
    s_waitcnt lgkmcnt(2)
    v_mfma_f32_32x32x16_bf16 v[64:79], v[20:23], a[24:27], v[64:79]
    ds_read_b64_tr_b16 v[28:29], v6 offset:22528
    ds_read_b64_tr_b16 v[30:31], v6 offset:23552
    buffer_load_dwordx4 v10, s[36:39], s67 offen offset:2048 lds
    s_waitcnt lgkmcnt(2)
    v_mfma_f32_32x32x16_bf16 v[80:95], v[24:27], a[24:27], v[80:95]
    ds_read_b64_tr_b16 v[32:33], v7 offset:22528
    ds_read_b64_tr_b16 v[34:35], v7 offset:23552
    buffer_load_dwordx4 a[24:27], v2, s[32:35], s66 offen offset:2048
    s_waitcnt vmcnt(34) lgkmcnt(2)
    v_mfma_f32_32x32x16_bf16 v[64:79], v[28:31], a[28:31], v[64:79]
    ds_read_b64_tr_b16 v[20:21], v6 offset:24576
    ds_read_b64_tr_b16 v[22:23], v6 offset:25600
    s_waitcnt lgkmcnt(2)
    v_mfma_f32_32x32x16_bf16 v[80:95], v[32:35], a[28:31], v[80:95]
    ds_read_b64_tr_b16 v[24:25], v7 offset:24576
    ds_read_b64_tr_b16 v[26:27], v7 offset:25600
    buffer_load_dwordx4 a[28:31], v2, s[32:35], s66 offen offset:3072
    s_waitcnt vmcnt(33) lgkmcnt(2)
    v_mfma_f32_32x32x16_bf16 v[64:79], v[20:23], a[32:35], v[64:79]
    ds_read_b64_tr_b16 v[28:29], v6 offset:26624
    ds_read_b64_tr_b16 v[30:31], v6 offset:27648
    buffer_load_dwordx4 v11, s[36:39], s67 offen offset:3072 lds
    s_waitcnt lgkmcnt(2)
    v_mfma_f32_32x32x16_bf16 v[80:95], v[24:27], a[32:35], v[80:95]
    ds_read_b64_tr_b16 v[32:33], v7 offset:26624
    ds_read_b64_tr_b16 v[34:35], v7 offset:27648
    s_add_u32 s66, s60, 0x30000
    buffer_load_dwordx4 a[32:35], v2, s[32:35], s66 offen offset:0
    s_waitcnt vmcnt(34) lgkmcnt(2)
    v_mfma_f32_32x32x16_bf16 v[64:79], v[28:31], a[36:39], v[64:79]
    ds_read_b64_tr_b16 v[20:21], v6 offset:28672
    ds_read_b64_tr_b16 v[22:23], v6 offset:29696
    s_waitcnt vmcnt(25)
    v_add_f32 v96, v96, v160
    v_add_f32 v97, v97, v161
    v_add_f32 v98, v98, v162
    v_add_f32 v99, v99, v163
    v_cvt_pk_bf16_f32 v52, v96, v97
    s_waitcnt lgkmcnt(2)
    v_mfma_f32_32x32x16_bf16 v[80:95], v[32:35], a[36:39], v[80:95]
    ds_read_b64_tr_b16 v[24:25], v7 offset:28672
    ds_read_b64_tr_b16 v[26:27], v7 offset:29696
    buffer_load_dwordx4 a[36:39], v2, s[32:35], s66 offen offset:1024
    s_waitcnt lgkmcnt(2)
    v_mfma_f32_32x32x16_bf16 v[64:79], v[20:23], a[40:43], v[64:79]
    ds_read_b64_tr_b16 v[28:29], v6 offset:30720
    ds_read_b64_tr_b16 v[30:31], v6 offset:31744
    v_cvt_pk_bf16_f32 v53, v98, v99
    v_lshlrev_b32 v96, 16, v52
    v_and_b32 v97, 0xffff0000, v52
    v_lshlrev_b32 v98, 16, v53
    v_and_b32 v99, 0xffff0000, v53
    s_add_u32 m0, s63, 0
    s_add_u32 s67, s61, 0x340000
    buffer_load_dwordx4 v8, s[36:39], s67 offen offset:0 lds
    s_waitcnt lgkmcnt(2)
    v_mfma_f32_32x32x16_bf16 v[80:95], v[24:27], a[40:43], v[80:95]
    ds_read_b64_tr_b16 v[32:33], v7 offset:30720
    ds_read_b64_tr_b16 v[34:35], v7 offset:31744
    buffer_load_dwordx4 a[40:43], v2, s[32:35], s66 offen offset:2048
    s_waitcnt lgkmcnt(0)
    s_barrier
    v_mfma_f32_32x32x16_bf16 v[64:79], v[28:31], a[44:47], v[64:79]
    ds_read_b64_tr_b16 v[20:21], v6 offset:32768
    ds_read_b64_tr_b16 v[22:23], v6 offset:33792
    v_mul_f32 v56, 0xbfb8aa3b, v96
    v_mul_f32 v57, 0xbfb8aa3b, v97
    v_mul_f32 v58, 0xbfb8aa3b, v98
    v_mul_f32 v59, 0xbfb8aa3b, v99
    v_exp_f32 v56, v56
    buffer_load_dwordx4 v9, s[36:39], s67 offen offset:1024 lds
    v_mfma_f32_32x32x16_bf16 v[80:95], v[32:35], a[44:47], v[80:95]
    ds_read_b64_tr_b16 v[24:25], v7 offset:32768
    ds_read_b64_tr_b16 v[26:27], v7 offset:33792
    buffer_load_dwordx4 a[44:47], v2, s[32:35], s66 offen offset:3072
    s_waitcnt lgkmcnt(2)
    v_mfma_f32_32x32x16_bf16 v[64:79], v[20:23], a[48:51], v[64:79]
    ds_read_b64_tr_b16 v[28:29], v6 offset:34816
    ds_read_b64_tr_b16 v[30:31], v6 offset:35840
    v_exp_f32 v57, v57
    v_exp_f32 v58, v58
    v_exp_f32 v59, v59
    v_add_f32 v56, 1.0, v56
    v_add_f32 v57, 1.0, v57
    buffer_load_dwordx4 v10, s[36:39], s67 offen offset:2048 lds
    s_waitcnt lgkmcnt(2)
    v_mfma_f32_32x32x16_bf16 v[80:95], v[24:27], a[48:51], v[80:95]
    ds_read_b64_tr_b16 v[32:33], v7 offset:34816
    ds_read_b64_tr_b16 v[34:35], v7 offset:35840
    s_add_u32 s66, s60, 0x31000
    buffer_load_dwordx4 a[48:51], v2, s[32:35], s66 offen offset:0
    s_waitcnt lgkmcnt(2)
    v_mfma_f32_32x32x16_bf16 v[64:79], v[28:31], a[52:55], v[64:79]
    ds_read_b64_tr_b16 v[20:21], v6 offset:36864
    ds_read_b64_tr_b16 v[22:23], v6 offset:37888
    v_add_f32 v58, 1.0, v58
    v_add_f32 v59, 1.0, v59
    v_rcp_f32 v56, v56
    v_rcp_f32 v57, v57
    v_rcp_f32 v58, v58
    s_waitcnt lgkmcnt(2)
    v_mfma_f32_32x32x16_bf16 v[80:95], v[32:35], a[52:55], v[80:95]
    ds_read_b64_tr_b16 v[24:25], v7 offset:36864
    ds_read_b64_tr_b16 v[26:27], v7 offset:37888
    buffer_load_dwordx4 a[52:55], v2, s[32:35], s66 offen offset:1024
    s_waitcnt lgkmcnt(2)
    v_mfma_f32_32x32x16_bf16 v[64:79], v[20:23], a[56:59], v[64:79]
    ds_read_b64_tr_b16 v[28:29], v6 offset:38912
    ds_read_b64_tr_b16 v[30:31], v6 offset:39936
    v_rcp_f32 v59, v59
    v_mul_f32 v96, v56, v96
    v_mul_f32 v97, v57, v97
    v_mul_f32 v98, v58, v98
    v_mul_f32 v99, v59, v99
    buffer_load_dwordx4 v11, s[36:39], s67 offen offset:3072 lds
    s_waitcnt lgkmcnt(2)
    v_mfma_f32_32x32x16_bf16 v[80:95], v[24:27], a[56:59], v[80:95]
    ds_read_b64_tr_b16 v[32:33], v7 offset:38912
    ds_read_b64_tr_b16 v[34:35], v7 offset:39936
    buffer_load_dwordx4 a[56:59], v2, s[32:35], s66 offen offset:2048
    s_waitcnt vmcnt(34) lgkmcnt(2)
    v_mfma_f32_32x32x16_bf16 v[64:79], v[28:31], a[60:63], v[64:79]
    ds_read_b64_tr_b16 v[20:21], v6 offset:40960
    ds_read_b64_tr_b16 v[22:23], v6 offset:41984
    v_cvt_pk_bf16_f32 v52, v96, v97
    v_cvt_pk_bf16_f32 v53, v98, v99
    v_lshlrev_b32 v96, 16, v52
    v_and_b32 v97, 0xffff0000, v52
    v_lshlrev_b32 v98, 16, v53
    s_waitcnt lgkmcnt(2)
    v_mfma_f32_32x32x16_bf16 v[80:95], v[32:35], a[60:63], v[80:95]
    ds_read_b64_tr_b16 v[24:25], v7 offset:40960
    ds_read_b64_tr_b16 v[26:27], v7 offset:41984
    buffer_load_dwordx4 a[60:63], v2, s[32:35], s66 offen offset:3072
    s_waitcnt vmcnt(33) lgkmcnt(2)
    v_mfma_f32_32x32x16_bf16 v[64:79], v[20:23], a[64:67], v[64:79]
    ds_read_b64_tr_b16 v[28:29], v6 offset:43008
    ds_read_b64_tr_b16 v[30:31], v6 offset:44032
    v_and_b32 v99, 0xffff0000, v53
    v_add_f32 v100, v100, v164
    v_add_f32 v101, v101, v165
    v_add_f32 v102, v102, v166
    v_add_f32 v103, v103, v167
    s_add_u32 m0, s63, 0x4000
    s_add_u32 s67, s61, 0x360000
    buffer_load_dwordx4 v8, s[36:39], s67 offen offset:0 lds
    s_waitcnt lgkmcnt(2)
    v_mfma_f32_32x32x16_bf16 v[80:95], v[24:27], a[64:67], v[80:95]
    ds_read_b64_tr_b16 v[32:33], v7 offset:43008
    ds_read_b64_tr_b16 v[34:35], v7 offset:44032
    s_add_u32 s66, s60, 0x32000
    buffer_load_dwordx4 a[64:67], v2, s[32:35], s66 offen offset:0
    s_waitcnt vmcnt(33) lgkmcnt(2)
    v_mfma_f32_32x32x16_bf16 v[64:79], v[28:31], a[68:71], v[64:79]
    ds_read_b64_tr_b16 v[20:21], v6 offset:45056
    ds_read_b64_tr_b16 v[22:23], v6 offset:46080
    v_cvt_pk_bf16_f32 v52, v100, v101
    v_cvt_pk_bf16_f32 v53, v102, v103
    v_lshlrev_b32 v100, 16, v52
    v_and_b32 v101, 0xffff0000, v52
    v_lshlrev_b32 v102, 16, v53
    s_waitcnt lgkmcnt(2)
    v_mfma_f32_32x32x16_bf16 v[80:95], v[32:35], a[68:71], v[80:95]
    ds_read_b64_tr_b16 v[24:25], v7 offset:45056
    ds_read_b64_tr_b16 v[26:27], v7 offset:46080
    buffer_load_dwordx4 a[68:71], v2, s[32:35], s66 offen offset:1024
    s_waitcnt vmcnt(32) lgkmcnt(2)
    v_mfma_f32_32x32x16_bf16 v[64:79], v[20:23], a[72:75], v[64:79]
    ds_read_b64_tr_b16 v[28:29], v6 offset:47104
    ds_read_b64_tr_b16 v[30:31], v6 offset:48128
    v_and_b32 v103, 0xffff0000, v53
    v_mul_f32 v56, 0xbfb8aa3b, v100
    v_mul_f32 v57, 0xbfb8aa3b, v101
    v_mul_f32 v58, 0xbfb8aa3b, v102
    v_mul_f32 v59, 0xbfb8aa3b, v103
    buffer_load_dwordx4 v9, s[36:39], s67 offen offset:1024 lds
    s_waitcnt lgkmcnt(2)
    v_mfma_f32_32x32x16_bf16 v[80:95], v[24:27], a[72:75], v[80:95]
    ds_read_b64_tr_b16 v[32:33], v7 offset:47104
    ds_read_b64_tr_b16 v[34:35], v7 offset:48128
    buffer_load_dwordx4 a[72:75], v2, s[32:35], s66 offen offset:2048
    s_waitcnt lgkmcnt(0)
    s_barrier
    s_waitcnt vmcnt(32)
    v_mfma_f32_32x32x16_bf16 v[64:79], v[28:31], a[76:79], v[64:79]
    ds_read_b64_tr_b16 v[20:21], v6 offset:49152
    ds_read_b64_tr_b16 v[22:23], v6 offset:50176
    v_exp_f32 v56, v56
    v_exp_f32 v57, v57
    v_exp_f32 v58, v58
    v_exp_f32 v59, v59
    v_add_f32 v56, 1.0, v56
    v_mfma_f32_32x32x16_bf16 v[80:95], v[32:35], a[76:79], v[80:95]
    ds_read_b64_tr_b16 v[24:25], v7 offset:49152
    ds_read_b64_tr_b16 v[26:27], v7 offset:50176
    buffer_load_dwordx4 a[76:79], v2, s[32:35], s66 offen offset:3072
    s_waitcnt vmcnt(31) lgkmcnt(2)
    v_mfma_f32_32x32x16_bf16 v[64:79], v[20:23], a[0:3], v[64:79]
    ds_read_b64_tr_b16 v[28:29], v6 offset:51200
    ds_read_b64_tr_b16 v[30:31], v6 offset:52224
    v_add_f32 v57, 1.0, v57
    v_add_f32 v58, 1.0, v58
    v_add_f32 v59, 1.0, v59
    v_rcp_f32 v56, v56
    v_rcp_f32 v57, v57
    buffer_load_dwordx4 v10, s[36:39], s67 offen offset:2048 lds
    s_waitcnt lgkmcnt(2)
    v_mfma_f32_32x32x16_bf16 v[80:95], v[24:27], a[0:3], v[80:95]
    ds_read_b64_tr_b16 v[32:33], v7 offset:51200
    ds_read_b64_tr_b16 v[34:35], v7 offset:52224
    s_add_u32 s66, s60, 0x33000
    buffer_load_dwordx4 a[0:3], v2, s[32:35], s66 offen offset:0
    s_waitcnt vmcnt(32) lgkmcnt(2)
    v_mfma_f32_32x32x16_bf16 v[64:79], v[28:31], a[4:7], v[64:79]
    ds_read_b64_tr_b16 v[20:21], v6 offset:53248
    ds_read_b64_tr_b16 v[22:23], v6 offset:54272
    v_rcp_f32 v58, v58
    v_rcp_f32 v59, v59
    v_mul_f32 v100, v56, v100
    v_mul_f32 v101, v57, v101
    v_mul_f32 v102, v58, v102
    s_waitcnt lgkmcnt(2)
    v_mfma_f32_32x32x16_bf16 v[80:95], v[32:35], a[4:7], v[80:95]
    ds_read_b64_tr_b16 v[24:25], v7 offset:53248
    ds_read_b64_tr_b16 v[26:27], v7 offset:54272
    buffer_load_dwordx4 a[4:7], v2, s[32:35], s66 offen offset:1024
    s_waitcnt vmcnt(31) lgkmcnt(2)
    v_mfma_f32_32x32x16_bf16 v[64:79], v[20:23], a[8:11], v[64:79]
    ds_read_b64_tr_b16 v[28:29], v6 offset:55296
    ds_read_b64_tr_b16 v[30:31], v6 offset:56320
    v_mul_f32 v103, v59, v103
    v_cvt_pk_bf16_f32 v52, v100, v101
    v_cvt_pk_bf16_f32 v53, v102, v103
    v_lshlrev_b32 v100, 16, v52
    v_and_b32 v101, 0xffff0000, v52
    buffer_load_dwordx4 v11, s[36:39], s67 offen offset:3072 lds
    s_waitcnt lgkmcnt(2)
    v_mfma_f32_32x32x16_bf16 v[80:95], v[24:27], a[8:11], v[80:95]
    ds_read_b64_tr_b16 v[32:33], v7 offset:55296
    ds_read_b64_tr_b16 v[34:35], v7 offset:56320
    buffer_load_dwordx4 a[8:11], v2, s[32:35], s66 offen offset:2048
    s_waitcnt vmcnt(31) lgkmcnt(2)
    v_mfma_f32_32x32x16_bf16 v[64:79], v[28:31], a[12:15], v[64:79]
    ds_read_b64_tr_b16 v[20:21], v6 offset:57344
    ds_read_b64_tr_b16 v[22:23], v6 offset:58368
    v_lshlrev_b32 v102, 16, v53
    v_and_b32 v103, 0xffff0000, v53
    v_add_f32 v104, v104, v168
    v_add_f32 v105, v105, v169
    v_add_f32 v106, v106, v170
    s_waitcnt lgkmcnt(2)
    v_mfma_f32_32x32x16_bf16 v[80:95], v[32:35], a[12:15], v[80:95]
    ds_read_b64_tr_b16 v[24:25], v7 offset:57344
    ds_read_b64_tr_b16 v[26:27], v7 offset:58368
    buffer_load_dwordx4 a[12:15], v2, s[32:35], s66 offen offset:3072
    s_waitcnt vmcnt(30) lgkmcnt(2)
    v_mfma_f32_32x32x16_bf16 v[64:79], v[20:23], a[16:19], v[64:79]
    ds_read_b64_tr_b16 v[28:29], v6 offset:59392
    ds_read_b64_tr_b16 v[30:31], v6 offset:60416
    v_add_f32 v107, v107, v171
    v_cvt_pk_bf16_f32 v52, v104, v105
    v_cvt_pk_bf16_f32 v53, v106, v107
    v_lshlrev_b32 v104, 16, v52
    v_and_b32 v105, 0xffff0000, v52
    s_add_u32 m0, s63, 0x8000
    s_add_u32 s67, s61, 0x380000
    buffer_load_dwordx4 v8, s[36:39], s67 offen offset:0 lds
    s_waitcnt lgkmcnt(2)
    v_mfma_f32_32x32x16_bf16 v[80:95], v[24:27], a[16:19], v[80:95]
    ds_read_b64_tr_b16 v[32:33], v7 offset:59392
    ds_read_b64_tr_b16 v[34:35], v7 offset:60416
    s_add_u32 s66, s60, 0x34000
    buffer_load_dwordx4 a[16:19], v2, s[32:35], s66 offen offset:0
    s_waitcnt vmcnt(30) lgkmcnt(2)
    v_mfma_f32_32x32x16_bf16 v[64:79], v[28:31], a[20:23], v[64:79]
    ds_read_b64_tr_b16 v[20:21], v6 offset:61440
    ds_read_b64_tr_b16 v[22:23], v6 offset:62464
    v_lshlrev_b32 v106, 16, v53
    v_and_b32 v107, 0xffff0000, v53
    v_mul_f32 v56, 0xbfb8aa3b, v104
    v_mul_f32 v57, 0xbfb8aa3b, v105
    v_mul_f32 v58, 0xbfb8aa3b, v106
    s_waitcnt lgkmcnt(2)
    v_mfma_f32_32x32x16_bf16 v[80:95], v[32:35], a[20:23], v[80:95]
    ds_read_b64_tr_b16 v[24:25], v7 offset:61440
    ds_read_b64_tr_b16 v[26:27], v7 offset:62464
    buffer_load_dwordx4 a[20:23], v2, s[32:35], s66 offen offset:1024
    s_waitcnt vmcnt(29) lgkmcnt(2)
    v_mfma_f32_32x32x16_bf16 v[64:79], v[20:23], a[24:27], v[64:79]
    ds_read_b64_tr_b16 v[28:29], v6 offset:63488
    ds_read_b64_tr_b16 v[30:31], v6 offset:64512
    v_mul_f32 v59, 0xbfb8aa3b, v107
    v_exp_f32 v56, v56
    v_exp_f32 v57, v57
    v_exp_f32 v58, v58
    v_exp_f32 v59, v59
    buffer_load_dwordx4 v9, s[36:39], s67 offen offset:1024 lds
    s_waitcnt lgkmcnt(2)
    v_mfma_f32_32x32x16_bf16 v[80:95], v[24:27], a[24:27], v[80:95]
    ds_read_b64_tr_b16 v[32:33], v7 offset:63488
    ds_read_b64_tr_b16 v[34:35], v7 offset:64512
    buffer_load_dwordx4 a[24:27], v2, s[32:35], s66 offen offset:2048
    s_waitcnt lgkmcnt(0)
    s_barrier
    s_waitcnt vmcnt(30)
    v_mfma_f32_32x32x16_bf16 v[64:79], v[28:31], a[28:31], v[64:79]
    ds_read_b64_tr_b16 v[20:21], v12 offset:0
    ds_read_b64_tr_b16 v[22:23], v12 offset:1024
    v_add_f32 v56, 1.0, v56
    v_add_f32 v57, 1.0, v57
    v_add_f32 v58, 1.0, v58
    v_add_f32 v59, 1.0, v59
    v_rcp_f32 v56, v56
    v_mfma_f32_32x32x16_bf16 v[80:95], v[32:35], a[28:31], v[80:95]
    ds_read_b64_tr_b16 v[24:25], v13 offset:0
    ds_read_b64_tr_b16 v[26:27], v13 offset:1024
    buffer_load_dwordx4 a[28:31], v2, s[32:35], s66 offen offset:3072
    s_waitcnt vmcnt(29) lgkmcnt(2)
    v_mfma_f32_32x32x16_bf16 v[64:79], v[20:23], a[32:35], v[64:79]
    ds_read_b64_tr_b16 v[28:29], v12 offset:2048
    ds_read_b64_tr_b16 v[30:31], v12 offset:3072
    v_rcp_f32 v57, v57
    v_rcp_f32 v58, v58
    v_rcp_f32 v59, v59
    v_mul_f32 v104, v56, v104
    v_mul_f32 v105, v57, v105
    buffer_load_dwordx4 v10, s[36:39], s67 offen offset:2048 lds
    s_waitcnt lgkmcnt(2)
    v_mfma_f32_32x32x16_bf16 v[80:95], v[24:27], a[32:35], v[80:95]
    ds_read_b64_tr_b16 v[32:33], v13 offset:2048
    ds_read_b64_tr_b16 v[34:35], v13 offset:3072
    s_add_u32 s66, s60, 0x35000
    buffer_load_dwordx4 a[32:35], v2, s[32:35], s66 offen offset:0
    s_waitcnt vmcnt(30) lgkmcnt(2)
    v_mfma_f32_32x32x16_bf16 v[64:79], v[28:31], a[36:39], v[64:79]
    ds_read_b64_tr_b16 v[20:21], v12 offset:4096
    ds_read_b64_tr_b16 v[22:23], v12 offset:5120
    v_mul_f32 v106, v58, v106
    v_mul_f32 v107, v59, v107
    v_cvt_pk_bf16_f32 v52, v104, v105
    v_cvt_pk_bf16_f32 v53, v106, v107
    v_lshlrev_b32 v104, 16, v52
    s_waitcnt lgkmcnt(2)
    v_mfma_f32_32x32x16_bf16 v[80:95], v[32:35], a[36:39], v[80:95]
    ds_read_b64_tr_b16 v[24:25], v13 offset:4096
    ds_read_b64_tr_b16 v[26:27], v13 offset:5120
    buffer_load_dwordx4 a[36:39], v2, s[32:35], s66 offen offset:1024
    s_waitcnt vmcnt(29) lgkmcnt(2)
    v_mfma_f32_32x32x16_bf16 v[64:79], v[20:23], a[40:43], v[64:79]
    ds_read_b64_tr_b16 v[28:29], v12 offset:6144
    ds_read_b64_tr_b16 v[30:31], v12 offset:7168
    v_and_b32 v105, 0xffff0000, v52
    v_lshlrev_b32 v106, 16, v53
    v_and_b32 v107, 0xffff0000, v53
    v_add_f32 v108, v108, v172
    v_add_f32 v109, v109, v173
    buffer_load_dwordx4 v11, s[36:39], s67 offen offset:3072 lds
    s_waitcnt lgkmcnt(2)
    v_mfma_f32_32x32x16_bf16 v[80:95], v[24:27], a[40:43], v[80:95]
    ds_read_b64_tr_b16 v[32:33], v13 offset:6144
    ds_read_b64_tr_b16 v[34:35], v13 offset:7168
    buffer_load_dwordx4 a[40:43], v2, s[32:35], s66 offen offset:2048
    s_waitcnt vmcnt(29) lgkmcnt(2)
    v_mfma_f32_32x32x16_bf16 v[64:79], v[28:31], a[44:47], v[64:79]
    ds_read_b64_tr_b16 v[20:21], v12 offset:8192
    ds_read_b64_tr_b16 v[22:23], v12 offset:9216
    v_add_f32 v110, v110, v174
    v_add_f32 v111, v111, v175
    v_cvt_pk_bf16_f32 v52, v108, v109
    v_cvt_pk_bf16_f32 v53, v110, v111
    v_lshlrev_b32 v108, 16, v52
    s_waitcnt lgkmcnt(2)
    v_mfma_f32_32x32x16_bf16 v[80:95], v[32:35], a[44:47], v[80:95]
    ds_read_b64_tr_b16 v[24:25], v13 offset:8192
    ds_read_b64_tr_b16 v[26:27], v13 offset:9216
    buffer_load_dwordx4 a[44:47], v2, s[32:35], s66 offen offset:3072
    s_waitcnt vmcnt(28) lgkmcnt(2)
    v_mfma_f32_32x32x16_bf16 v[64:79], v[20:23], a[48:51], v[64:79]
    ds_read_b64_tr_b16 v[28:29], v12 offset:10240
    ds_read_b64_tr_b16 v[30:31], v12 offset:11264
    v_and_b32 v109, 0xffff0000, v52
    v_lshlrev_b32 v110, 16, v53
    v_and_b32 v111, 0xffff0000, v53
    v_mul_f32 v56, 0xbfb8aa3b, v108
    v_mul_f32 v57, 0xbfb8aa3b, v109
    s_add_u32 m0, s63, 0xc000
    s_add_u32 s67, s61, 0x3a0000
    buffer_load_dwordx4 v8, s[36:39], s67 offen offset:0 lds
    s_waitcnt lgkmcnt(2)
    v_mfma_f32_32x32x16_bf16 v[80:95], v[24:27], a[48:51], v[80:95]
    ds_read_b64_tr_b16 v[32:33], v13 offset:10240
    ds_read_b64_tr_b16 v[34:35], v13 offset:11264
    s_add_u32 s66, s60, 0x36000
    buffer_load_dwordx4 a[48:51], v2, s[32:35], s66 offen offset:0
    s_waitcnt vmcnt(29) lgkmcnt(2)
    v_mfma_f32_32x32x16_bf16 v[64:79], v[28:31], a[52:55], v[64:79]
    ds_read_b64_tr_b16 v[20:21], v12 offset:12288
    ds_read_b64_tr_b16 v[22:23], v12 offset:13312
    v_mul_f32 v58, 0xbfb8aa3b, v110
    v_mul_f32 v59, 0xbfb8aa3b, v111
    v_exp_f32 v56, v56
    v_exp_f32 v57, v57
    v_exp_f32 v58, v58
    s_waitcnt lgkmcnt(2)
    v_mfma_f32_32x32x16_bf16 v[80:95], v[32:35], a[52:55], v[80:95]
    ds_read_b64_tr_b16 v[24:25], v13 offset:12288
    ds_read_b64_tr_b16 v[26:27], v13 offset:13312
    buffer_load_dwordx4 a[52:55], v2, s[32:35], s66 offen offset:1024
    s_waitcnt vmcnt(28) lgkmcnt(2)
    v_mfma_f32_32x32x16_bf16 v[64:79], v[20:23], a[56:59], v[64:79]
    ds_read_b64_tr_b16 v[28:29], v12 offset:14336
    ds_read_b64_tr_b16 v[30:31], v12 offset:15360
    v_exp_f32 v59, v59
    v_add_f32 v56, 1.0, v56
    v_add_f32 v57, 1.0, v57
    v_add_f32 v58, 1.0, v58
    v_add_f32 v59, 1.0, v59
    buffer_load_dwordx4 v9, s[36:39], s67 offen offset:1024 lds
    s_waitcnt lgkmcnt(2)
    v_mfma_f32_32x32x16_bf16 v[80:95], v[24:27], a[56:59], v[80:95]
    ds_read_b64_tr_b16 v[32:33], v13 offset:14336
    ds_read_b64_tr_b16 v[34:35], v13 offset:15360
    buffer_load_dwordx4 a[56:59], v2, s[32:35], s66 offen offset:2048
    s_waitcnt lgkmcnt(0)
    s_barrier
    s_waitcnt vmcnt(29)
    v_mfma_f32_32x32x16_bf16 v[64:79], v[28:31], a[60:63], v[64:79]
    ds_read_b64_tr_b16 v[20:21], v12 offset:16384
    ds_read_b64_tr_b16 v[22:23], v12 offset:17408
    v_rcp_f32 v56, v56
    v_rcp_f32 v57, v57
    v_rcp_f32 v58, v58
    v_rcp_f32 v59, v59
    v_mul_f32 v108, v56, v108
    v_mfma_f32_32x32x16_bf16 v[80:95], v[32:35], a[60:63], v[80:95]
    ds_read_b64_tr_b16 v[24:25], v13 offset:16384
    ds_read_b64_tr_b16 v[26:27], v13 offset:17408
    buffer_load_dwordx4 a[60:63], v2, s[32:35], s66 offen offset:3072
    s_waitcnt vmcnt(28) lgkmcnt(2)
    v_mfma_f32_32x32x16_bf16 v[64:79], v[20:23], a[64:67], v[64:79]
    ds_read_b64_tr_b16 v[28:29], v12 offset:18432
    ds_read_b64_tr_b16 v[30:31], v12 offset:19456
    v_mul_f32 v109, v57, v109
    v_mul_f32 v110, v58, v110
    v_mul_f32 v111, v59, v111
    v_cvt_pk_bf16_f32 v52, v108, v109
    v_cvt_pk_bf16_f32 v53, v110, v111
    buffer_load_dwordx4 v10, s[36:39], s67 offen offset:2048 lds
    s_waitcnt lgkmcnt(2)
    v_mfma_f32_32x32x16_bf16 v[80:95], v[24:27], a[64:67], v[80:95]
    ds_read_b64_tr_b16 v[32:33], v13 offset:18432
    ds_read_b64_tr_b16 v[34:35], v13 offset:19456
    s_add_u32 s66, s60, 0x37000
    buffer_load_dwordx4 a[64:67], v2, s[32:35], s66 offen offset:0
    s_waitcnt vmcnt(29) lgkmcnt(2)
    v_mfma_f32_32x32x16_bf16 v[64:79], v[28:31], a[68:71], v[64:79]
    ds_read_b64_tr_b16 v[20:21], v12 offset:20480
    ds_read_b64_tr_b16 v[22:23], v12 offset:21504
    v_lshlrev_b32 v108, 16, v52
    v_and_b32 v109, 0xffff0000, v52
    v_lshlrev_b32 v110, 16, v53
    v_and_b32 v111, 0xffff0000, v53
    v_add_f32 v112, v112, v176
    s_waitcnt lgkmcnt(2)
    v_mfma_f32_32x32x16_bf16 v[80:95], v[32:35], a[68:71], v[80:95]
    ds_read_b64_tr_b16 v[24:25], v13 offset:20480
    ds_read_b64_tr_b16 v[26:27], v13 offset:21504
    buffer_load_dwordx4 a[68:71], v2, s[32:35], s66 offen offset:1024
    s_waitcnt vmcnt(28) lgkmcnt(2)
    v_mfma_f32_32x32x16_bf16 v[64:79], v[20:23], a[72:75], v[64:79]
    ds_read_b64_tr_b16 v[28:29], v12 offset:22528
    ds_read_b64_tr_b16 v[30:31], v12 offset:23552
    v_add_f32 v113, v113, v177
    v_add_f32 v114, v114, v178
    v_add_f32 v115, v115, v179
    v_cvt_pk_bf16_f32 v52, v112, v113
    v_cvt_pk_bf16_f32 v53, v114, v115
    buffer_load_dwordx4 v11, s[36:39], s67 offen offset:3072 lds
    s_waitcnt lgkmcnt(2)
    v_mfma_f32_32x32x16_bf16 v[80:95], v[24:27], a[72:75], v[80:95]
    ds_read_b64_tr_b16 v[32:33], v13 offset:22528
    ds_read_b64_tr_b16 v[34:35], v13 offset:23552
    buffer_load_dwordx4 a[72:75], v2, s[32:35], s66 offen offset:2048
    s_waitcnt vmcnt(29) lgkmcnt(2)
    v_mfma_f32_32x32x16_bf16 v[64:79], v[28:31], a[76:79], v[64:79]
    ds_read_b64_tr_b16 v[20:21], v12 offset:24576
    ds_read_b64_tr_b16 v[22:23], v12 offset:25600
    v_lshlrev_b32 v112, 16, v52
    v_and_b32 v113, 0xffff0000, v52
    v_lshlrev_b32 v114, 16, v53
    v_and_b32 v115, 0xffff0000, v53
    v_mul_f32 v56, 0xbfb8aa3b, v112
    s_waitcnt lgkmcnt(2)
    v_mfma_f32_32x32x16_bf16 v[80:95], v[32:35], a[76:79], v[80:95]
    ds_read_b64_tr_b16 v[24:25], v13 offset:24576
    ds_read_b64_tr_b16 v[26:27], v13 offset:25600
    buffer_load_dwordx4 a[76:79], v2, s[32:35], s66 offen offset:3072
    s_waitcnt vmcnt(28) lgkmcnt(2)
    v_mfma_f32_32x32x16_bf16 v[64:79], v[20:23], a[0:3], v[64:79]
    ds_read_b64_tr_b16 v[28:29], v12 offset:26624
    ds_read_b64_tr_b16 v[30:31], v12 offset:27648
    v_mul_f32 v57, 0xbfb8aa3b, v113
    v_mul_f32 v58, 0xbfb8aa3b, v114
    v_mul_f32 v59, 0xbfb8aa3b, v115
    v_exp_f32 v56, v56
    v_exp_f32 v57, v57
    s_add_u32 m0, s63, 0x10000
    s_add_u32 s67, s61, 0x3c0000
    buffer_load_dwordx4 v8, s[36:39], s67 offen offset:0 lds
    s_waitcnt lgkmcnt(2)
    v_mfma_f32_32x32x16_bf16 v[80:95], v[24:27], a[0:3], v[80:95]
    ds_read_b64_tr_b16 v[32:33], v13 offset:26624
    ds_read_b64_tr_b16 v[34:35], v13 offset:27648
    s_add_u32 s66, s60, 0x38000
    buffer_load_dwordx4 a[0:3], v2, s[32:35], s66 offen offset:0
    s_waitcnt vmcnt(29) lgkmcnt(2)
    v_mfma_f32_32x32x16_bf16 v[64:79], v[28:31], a[4:7], v[64:79]
    ds_read_b64_tr_b16 v[20:21], v12 offset:28672
    ds_read_b64_tr_b16 v[22:23], v12 offset:29696
    v_exp_f32 v58, v58
    v_exp_f32 v59, v59
    v_add_f32 v56, 1.0, v56
    v_add_f32 v57, 1.0, v57
    v_add_f32 v58, 1.0, v58
    s_waitcnt lgkmcnt(2)
    v_mfma_f32_32x32x16_bf16 v[80:95], v[32:35], a[4:7], v[80:95]
    ds_read_b64_tr_b16 v[24:25], v13 offset:28672
    ds_read_b64_tr_b16 v[26:27], v13 offset:29696
    buffer_load_dwordx4 a[4:7], v2, s[32:35], s66 offen offset:1024
    s_waitcnt vmcnt(28) lgkmcnt(2)
    v_mfma_f32_32x32x16_bf16 v[64:79], v[20:23], a[8:11], v[64:79]
    ds_read_b64_tr_b16 v[28:29], v12 offset:30720
    ds_read_b64_tr_b16 v[30:31], v12 offset:31744
    v_add_f32 v59, 1.0, v59
    v_rcp_f32 v56, v56
    v_rcp_f32 v57, v57
    v_rcp_f32 v58, v58
    v_rcp_f32 v59, v59
    buffer_load_dwordx4 v9, s[36:39], s67 offen offset:1024 lds
    s_waitcnt lgkmcnt(2)
    v_mfma_f32_32x32x16_bf16 v[80:95], v[24:27], a[8:11], v[80:95]
    ds_read_b64_tr_b16 v[32:33], v13 offset:30720
    ds_read_b64_tr_b16 v[34:35], v13 offset:31744
    buffer_load_dwordx4 a[8:11], v2, s[32:35], s66 offen offset:2048
    s_waitcnt lgkmcnt(0)
    s_barrier
    s_waitcnt vmcnt(29)
    v_mfma_f32_32x32x16_bf16 v[64:79], v[28:31], a[12:15], v[64:79]
    ds_read_b64_tr_b16 v[20:21], v6 offset:0
    ds_read_b64_tr_b16 v[22:23], v6 offset:1024
    v_mul_f32 v112, v56, v112
    v_mul_f32 v113, v57, v113
    v_mul_f32 v114, v58, v114
    v_mul_f32 v115, v59, v115
    v_cvt_pk_bf16_f32 v52, v112, v113
    v_mfma_f32_32x32x16_bf16 v[80:95], v[32:35], a[12:15], v[80:95]
    ds_read_b64_tr_b16 v[24:25], v7 offset:0
    ds_read_b64_tr_b16 v[26:27], v7 offset:1024
    buffer_load_dwordx4 a[12:15], v2, s[32:35], s66 offen offset:3072
    s_waitcnt vmcnt(28) lgkmcnt(2)
    v_mfma_f32_32x32x16_bf16 v[64:79], v[20:23], a[16:19], v[64:79]
    ds_read_b64_tr_b16 v[28:29], v6 offset:2048
    ds_read_b64_tr_b16 v[30:31], v6 offset:3072
    v_cvt_pk_bf16_f32 v53, v114, v115
    v_lshlrev_b32 v112, 16, v52
    v_and_b32 v113, 0xffff0000, v52
    v_lshlrev_b32 v114, 16, v53
    v_and_b32 v115, 0xffff0000, v53
    buffer_load_dwordx4 v10, s[36:39], s67 offen offset:2048 lds
    s_waitcnt lgkmcnt(2)
    v_mfma_f32_32x32x16_bf16 v[80:95], v[24:27], a[16:19], v[80:95]
    ds_read_b64_tr_b16 v[32:33], v7 offset:2048
    ds_read_b64_tr_b16 v[34:35], v7 offset:3072
    s_add_u32 s66, s60, 0x39000
    buffer_load_dwordx4 a[16:19], v2, s[32:35], s66 offen offset:0
    s_waitcnt vmcnt(29) lgkmcnt(2)
    v_mfma_f32_32x32x16_bf16 v[64:79], v[28:31], a[20:23], v[64:79]
    ds_read_b64_tr_b16 v[20:21], v6 offset:4096
    ds_read_b64_tr_b16 v[22:23], v6 offset:5120
    v_add_f32 v116, v116, v180
    v_add_f32 v117, v117, v181
    v_add_f32 v118, v118, v182
    v_add_f32 v119, v119, v183
    v_cvt_pk_bf16_f32 v52, v116, v117
    s_waitcnt lgkmcnt(2)
    v_mfma_f32_32x32x16_bf16 v[80:95], v[32:35], a[20:23], v[80:95]
    ds_read_b64_tr_b16 v[24:25], v7 offset:4096
    ds_read_b64_tr_b16 v[26:27], v7 offset:5120
    buffer_load_dwordx4 a[20:23], v2, s[32:35], s66 offen offset:1024
    s_waitcnt vmcnt(28) lgkmcnt(2)
    v_mfma_f32_32x32x16_bf16 v[64:79], v[20:23], a[24:27], v[64:79]
    ds_read_b64_tr_b16 v[28:29], v6 offset:6144
    ds_read_b64_tr_b16 v[30:31], v6 offset:7168
    v_cvt_pk_bf16_f32 v53, v118, v119
    v_lshlrev_b32 v116, 16, v52
    v_and_b32 v117, 0xffff0000, v52
    v_lshlrev_b32 v118, 16, v53
    v_and_b32 v119, 0xffff0000, v53
    buffer_load_dwordx4 v11, s[36:39], s67 offen offset:3072 lds
    s_waitcnt lgkmcnt(2)
    v_mfma_f32_32x32x16_bf16 v[80:95], v[24:27], a[24:27], v[80:95]
    ds_read_b64_tr_b16 v[32:33], v7 offset:6144
    ds_read_b64_tr_b16 v[34:35], v7 offset:7168
    buffer_load_dwordx4 a[24:27], v2, s[32:35], s66 offen offset:2048
    s_waitcnt vmcnt(29) lgkmcnt(2)
    v_mfma_f32_32x32x16_bf16 v[64:79], v[28:31], a[28:31], v[64:79]
    ds_read_b64_tr_b16 v[20:21], v6 offset:8192
    ds_read_b64_tr_b16 v[22:23], v6 offset:9216
    v_mul_f32 v56, 0xbfb8aa3b, v116
    v_mul_f32 v57, 0xbfb8aa3b, v117
    v_mul_f32 v58, 0xbfb8aa3b, v118
    v_mul_f32 v59, 0xbfb8aa3b, v119
    v_exp_f32 v56, v56
    s_waitcnt lgkmcnt(2)
    v_mfma_f32_32x32x16_bf16 v[80:95], v[32:35], a[28:31], v[80:95]
    ds_read_b64_tr_b16 v[24:25], v7 offset:8192
    ds_read_b64_tr_b16 v[26:27], v7 offset:9216
    buffer_load_dwordx4 a[28:31], v2, s[32:35], s66 offen offset:3072
    s_waitcnt vmcnt(28) lgkmcnt(2)
    v_mfma_f32_32x32x16_bf16 v[64:79], v[20:23], a[32:35], v[64:79]
    ds_read_b64_tr_b16 v[28:29], v6 offset:10240
    ds_read_b64_tr_b16 v[30:31], v6 offset:11264
    v_exp_f32 v57, v57
    v_exp_f32 v58, v58
    v_exp_f32 v59, v59
    v_add_f32 v56, 1.0, v56
    v_add_f32 v57, 1.0, v57
    s_add_u32 m0, s63, 0x14000
    s_add_u32 s67, s61, 0x3e0000
    buffer_load_dwordx4 v8, s[36:39], s67 offen offset:0 lds
    s_waitcnt lgkmcnt(2)
    v_mfma_f32_32x32x16_bf16 v[80:95], v[24:27], a[32:35], v[80:95]
    ds_read_b64_tr_b16 v[32:33], v7 offset:10240
    ds_read_b64_tr_b16 v[34:35], v7 offset:11264
    s_add_u32 s66, s60, 0x3a000
    buffer_load_dwordx4 a[32:35], v2, s[32:35], s66 offen offset:0
    s_waitcnt vmcnt(29) lgkmcnt(2)
    v_mfma_f32_32x32x16_bf16 v[64:79], v[28:31], a[36:39], v[64:79]
    ds_read_b64_tr_b16 v[20:21], v6 offset:12288
    ds_read_b64_tr_b16 v[22:23], v6 offset:13312
    v_add_f32 v58, 1.0, v58
    v_add_f32 v59, 1.0, v59
    v_rcp_f32 v56, v56
    v_rcp_f32 v57, v57
    v_rcp_f32 v58, v58
    s_waitcnt lgkmcnt(2)
    v_mfma_f32_32x32x16_bf16 v[80:95], v[32:35], a[36:39], v[80:95]
    ds_read_b64_tr_b16 v[24:25], v7 offset:12288
    ds_read_b64_tr_b16 v[26:27], v7 offset:13312
    buffer_load_dwordx4 a[36:39], v2, s[32:35], s66 offen offset:1024
    s_waitcnt vmcnt(28) lgkmcnt(2)
    v_mfma_f32_32x32x16_bf16 v[64:79], v[20:23], a[40:43], v[64:79]
    ds_read_b64_tr_b16 v[28:29], v6 offset:14336
    ds_read_b64_tr_b16 v[30:31], v6 offset:15360
    v_rcp_f32 v59, v59
    v_mul_f32 v116, v56, v116
    v_mul_f32 v117, v57, v117
    v_mul_f32 v118, v58, v118
    v_mul_f32 v119, v59, v119
    buffer_load_dwordx4 v9, s[36:39], s67 offen offset:1024 lds
    s_waitcnt lgkmcnt(2)
    v_mfma_f32_32x32x16_bf16 v[80:95], v[24:27], a[40:43], v[80:95]
    ds_read_b64_tr_b16 v[32:33], v7 offset:14336
    ds_read_b64_tr_b16 v[34:35], v7 offset:15360
    buffer_load_dwordx4 a[40:43], v2, s[32:35], s66 offen offset:2048
    s_waitcnt lgkmcnt(0)
    s_barrier
    s_waitcnt vmcnt(29)
    v_mfma_f32_32x32x16_bf16 v[64:79], v[28:31], a[44:47], v[64:79]
    ds_read_b64_tr_b16 v[20:21], v6 offset:16384
    ds_read_b64_tr_b16 v[22:23], v6 offset:17408
    v_cvt_pk_bf16_f32 v52, v116, v117
    v_cvt_pk_bf16_f32 v53, v118, v119
    v_lshlrev_b32 v116, 16, v52
    v_and_b32 v117, 0xffff0000, v52
    v_lshlrev_b32 v118, 16, v53
    v_mfma_f32_32x32x16_bf16 v[80:95], v[32:35], a[44:47], v[80:95]
    ds_read_b64_tr_b16 v[24:25], v7 offset:16384
    ds_read_b64_tr_b16 v[26:27], v7 offset:17408
    buffer_load_dwordx4 a[44:47], v2, s[32:35], s66 offen offset:3072
    s_waitcnt vmcnt(28) lgkmcnt(2)
    v_mfma_f32_32x32x16_bf16 v[64:79], v[20:23], a[48:51], v[64:79]
    ds_read_b64_tr_b16 v[28:29], v6 offset:18432
    ds_read_b64_tr_b16 v[30:31], v6 offset:19456
    v_and_b32 v119, 0xffff0000, v53
    v_add_f32 v120, v120, v184
    v_add_f32 v121, v121, v185
    v_add_f32 v122, v122, v186
    v_add_f32 v123, v123, v187
    buffer_load_dwordx4 v10, s[36:39], s67 offen offset:2048 lds
    s_waitcnt lgkmcnt(2)
    v_mfma_f32_32x32x16_bf16 v[80:95], v[24:27], a[48:51], v[80:95]
    ds_read_b64_tr_b16 v[32:33], v7 offset:18432
    ds_read_b64_tr_b16 v[34:35], v7 offset:19456
    s_add_u32 s66, s60, 0x3b000
    buffer_load_dwordx4 a[48:51], v2, s[32:35], s66 offen offset:0
    s_waitcnt vmcnt(29) lgkmcnt(2)
    v_mfma_f32_32x32x16_bf16 v[64:79], v[28:31], a[52:55], v[64:79]
    ds_read_b64_tr_b16 v[20:21], v6 offset:20480
    ds_read_b64_tr_b16 v[22:23], v6 offset:21504
    v_cvt_pk_bf16_f32 v52, v120, v121
    v_cvt_pk_bf16_f32 v53, v122, v123
    v_lshlrev_b32 v120, 16, v52
    v_and_b32 v121, 0xffff0000, v52
    v_lshlrev_b32 v122, 16, v53
    s_waitcnt lgkmcnt(2)
    v_mfma_f32_32x32x16_bf16 v[80:95], v[32:35], a[52:55], v[80:95]
    ds_read_b64_tr_b16 v[24:25], v7 offset:20480
    ds_read_b64_tr_b16 v[26:27], v7 offset:21504
    buffer_load_dwordx4 a[52:55], v2, s[32:35], s66 offen offset:1024
    s_waitcnt vmcnt(28) lgkmcnt(2)
    v_mfma_f32_32x32x16_bf16 v[64:79], v[20:23], a[56:59], v[64:79]
    ds_read_b64_tr_b16 v[28:29], v6 offset:22528
    ds_read_b64_tr_b16 v[30:31], v6 offset:23552
    v_and_b32 v123, 0xffff0000, v53
    v_mul_f32 v56, 0xbfb8aa3b, v120
    v_mul_f32 v57, 0xbfb8aa3b, v121
    v_mul_f32 v58, 0xbfb8aa3b, v122
    v_mul_f32 v59, 0xbfb8aa3b, v123
    buffer_load_dwordx4 v11, s[36:39], s67 offen offset:3072 lds
    s_waitcnt lgkmcnt(2)
    v_mfma_f32_32x32x16_bf16 v[80:95], v[24:27], a[56:59], v[80:95]
    ds_read_b64_tr_b16 v[32:33], v7 offset:22528
    ds_read_b64_tr_b16 v[34:35], v7 offset:23552
    buffer_load_dwordx4 a[56:59], v2, s[32:35], s66 offen offset:2048
    s_waitcnt vmcnt(29) lgkmcnt(2)
    v_mfma_f32_32x32x16_bf16 v[64:79], v[28:31], a[60:63], v[64:79]
    ds_read_b64_tr_b16 v[20:21], v6 offset:24576
    ds_read_b64_tr_b16 v[22:23], v6 offset:25600
    v_exp_f32 v56, v56
    v_exp_f32 v57, v57
    v_exp_f32 v58, v58
    v_exp_f32 v59, v59
    v_add_f32 v56, 1.0, v56
    s_waitcnt lgkmcnt(2)
    v_mfma_f32_32x32x16_bf16 v[80:95], v[32:35], a[60:63], v[80:95]
    ds_read_b64_tr_b16 v[24:25], v7 offset:24576
    ds_read_b64_tr_b16 v[26:27], v7 offset:25600
    buffer_load_dwordx4 a[60:63], v2, s[32:35], s66 offen offset:3072
    s_waitcnt vmcnt(28) lgkmcnt(2)
    v_mfma_f32_32x32x16_bf16 v[64:79], v[20:23], a[64:67], v[64:79]
    ds_read_b64_tr_b16 v[28:29], v6 offset:26624
    ds_read_b64_tr_b16 v[30:31], v6 offset:27648
    v_add_f32 v57, 1.0, v57
    v_add_f32 v58, 1.0, v58
    v_add_f32 v59, 1.0, v59
    v_rcp_f32 v56, v56
    v_rcp_f32 v57, v57
    s_waitcnt lgkmcnt(2)
    v_mfma_f32_32x32x16_bf16 v[80:95], v[24:27], a[64:67], v[80:95]
    ds_read_b64_tr_b16 v[32:33], v7 offset:26624
    ds_read_b64_tr_b16 v[34:35], v7 offset:27648
    s_add_u32 s66, s60, 0x3c000
    buffer_load_dwordx4 a[64:67], v2, s[32:35], s66 offen offset:0
    s_waitcnt vmcnt(28) lgkmcnt(2)
    v_mfma_f32_32x32x16_bf16 v[64:79], v[28:31], a[68:71], v[64:79]
    ds_read_b64_tr_b16 v[20:21], v6 offset:28672
    ds_read_b64_tr_b16 v[22:23], v6 offset:29696
    v_rcp_f32 v58, v58
    v_rcp_f32 v59, v59
    v_mul_f32 v120, v56, v120
    v_mul_f32 v121, v57, v121
    v_mul_f32 v122, v58, v122
    s_waitcnt lgkmcnt(2)
    v_mfma_f32_32x32x16_bf16 v[80:95], v[32:35], a[68:71], v[80:95]
    ds_read_b64_tr_b16 v[24:25], v7 offset:28672
    ds_read_b64_tr_b16 v[26:27], v7 offset:29696
    buffer_load_dwordx4 a[68:71], v2, s[32:35], s66 offen offset:1024
    s_waitcnt vmcnt(27) lgkmcnt(2)
    v_mfma_f32_32x32x16_bf16 v[64:79], v[20:23], a[72:75], v[64:79]
    ds_read_b64_tr_b16 v[28:29], v6 offset:30720
    ds_read_b64_tr_b16 v[30:31], v6 offset:31744
    v_mul_f32 v123, v59, v123
    v_cvt_pk_bf16_f32 v52, v120, v121
    v_cvt_pk_bf16_f32 v53, v122, v123
    v_lshlrev_b32 v120, 16, v52
    v_and_b32 v121, 0xffff0000, v52
    s_waitcnt lgkmcnt(2)
    v_mfma_f32_32x32x16_bf16 v[80:95], v[24:27], a[72:75], v[80:95]
    ds_read_b64_tr_b16 v[32:33], v7 offset:30720
    ds_read_b64_tr_b16 v[34:35], v7 offset:31744
    buffer_load_dwordx4 a[72:75], v2, s[32:35], s66 offen offset:2048
    s_waitcnt lgkmcnt(0)
    s_barrier
    s_waitcnt vmcnt(27)
    v_mfma_f32_32x32x16_bf16 v[64:79], v[28:31], a[76:79], v[64:79]
    ds_read_b64_tr_b16 v[20:21], v6 offset:32768
    ds_read_b64_tr_b16 v[22:23], v6 offset:33792
    v_lshlrev_b32 v122, 16, v53
    v_and_b32 v123, 0xffff0000, v53
    v_add_f32 v124, v124, v188
    v_add_f32 v125, v125, v189
    v_add_f32 v126, v126, v190
    v_mfma_f32_32x32x16_bf16 v[80:95], v[32:35], a[76:79], v[80:95]
    ds_read_b64_tr_b16 v[24:25], v7 offset:32768
    ds_read_b64_tr_b16 v[26:27], v7 offset:33792
    buffer_load_dwordx4 a[76:79], v2, s[32:35], s66 offen offset:3072
    s_waitcnt vmcnt(26) lgkmcnt(2)
    v_mfma_f32_32x32x16_bf16 v[64:79], v[20:23], a[0:3], v[64:79]
    ds_read_b64_tr_b16 v[28:29], v6 offset:34816
    ds_read_b64_tr_b16 v[30:31], v6 offset:35840
    v_add_f32 v127, v127, v191
    v_cvt_pk_bf16_f32 v52, v124, v125
    v_cvt_pk_bf16_f32 v53, v126, v127
    v_lshlrev_b32 v124, 16, v52
    v_and_b32 v125, 0xffff0000, v52
    s_waitcnt lgkmcnt(2)
    v_mfma_f32_32x32x16_bf16 v[80:95], v[24:27], a[0:3], v[80:95]
    ds_read_b64_tr_b16 v[32:33], v7 offset:34816
    ds_read_b64_tr_b16 v[34:35], v7 offset:35840
    s_add_u32 s66, s60, 0x3d000
    buffer_load_dwordx4 a[0:3], v2, s[32:35], s66 offen offset:0
    s_waitcnt vmcnt(26) lgkmcnt(2)
    v_mfma_f32_32x32x16_bf16 v[64:79], v[28:31], a[4:7], v[64:79]
    ds_read_b64_tr_b16 v[20:21], v6 offset:36864
    ds_read_b64_tr_b16 v[22:23], v6 offset:37888
    v_lshlrev_b32 v126, 16, v53
    v_and_b32 v127, 0xffff0000, v53
    v_mul_f32 v56, 0xbfb8aa3b, v124
    v_mul_f32 v57, 0xbfb8aa3b, v125
    v_mul_f32 v58, 0xbfb8aa3b, v126
    s_waitcnt lgkmcnt(2)
    v_mfma_f32_32x32x16_bf16 v[80:95], v[32:35], a[4:7], v[80:95]
    ds_read_b64_tr_b16 v[24:25], v7 offset:36864
    ds_read_b64_tr_b16 v[26:27], v7 offset:37888
    buffer_load_dwordx4 a[4:7], v2, s[32:35], s66 offen offset:1024
    s_waitcnt vmcnt(25) lgkmcnt(2)
    v_mfma_f32_32x32x16_bf16 v[64:79], v[20:23], a[8:11], v[64:79]
    ds_read_b64_tr_b16 v[28:29], v6 offset:38912
    ds_read_b64_tr_b16 v[30:31], v6 offset:39936
    v_mul_f32 v59, 0xbfb8aa3b, v127
    v_exp_f32 v56, v56
    v_exp_f32 v57, v57
    v_exp_f32 v58, v58
    v_exp_f32 v59, v59
    s_waitcnt lgkmcnt(2)
    v_mfma_f32_32x32x16_bf16 v[80:95], v[24:27], a[8:11], v[80:95]
    ds_read_b64_tr_b16 v[32:33], v7 offset:38912
    ds_read_b64_tr_b16 v[34:35], v7 offset:39936
    buffer_load_dwordx4 a[8:11], v2, s[32:35], s66 offen offset:2048
    s_waitcnt vmcnt(25) lgkmcnt(2)
    v_mfma_f32_32x32x16_bf16 v[64:79], v[28:31], a[12:15], v[64:79]
    ds_read_b64_tr_b16 v[20:21], v6 offset:40960
    ds_read_b64_tr_b16 v[22:23], v6 offset:41984
    v_add_f32 v56, 1.0, v56
    v_add_f32 v57, 1.0, v57
    v_add_f32 v58, 1.0, v58
    v_add_f32 v59, 1.0, v59
    v_rcp_f32 v56, v56
    s_waitcnt lgkmcnt(2)
    v_mfma_f32_32x32x16_bf16 v[80:95], v[32:35], a[12:15], v[80:95]
    ds_read_b64_tr_b16 v[24:25], v7 offset:40960
    ds_read_b64_tr_b16 v[26:27], v7 offset:41984
    buffer_load_dwordx4 a[12:15], v2, s[32:35], s66 offen offset:3072
    s_waitcnt vmcnt(24) lgkmcnt(2)
    v_mfma_f32_32x32x16_bf16 v[64:79], v[20:23], a[16:19], v[64:79]
    ds_read_b64_tr_b16 v[28:29], v6 offset:43008
    ds_read_b64_tr_b16 v[30:31], v6 offset:44032
    v_rcp_f32 v57, v57
    v_rcp_f32 v58, v58
    v_rcp_f32 v59, v59
    v_mul_f32 v124, v56, v124
    v_mul_f32 v125, v57, v125
    s_waitcnt lgkmcnt(2)
    v_mfma_f32_32x32x16_bf16 v[80:95], v[24:27], a[16:19], v[80:95]
    ds_read_b64_tr_b16 v[32:33], v7 offset:43008
    ds_read_b64_tr_b16 v[34:35], v7 offset:44032
    s_add_u32 s66, s60, 0x3e000
    buffer_load_dwordx4 a[16:19], v2, s[32:35], s66 offen offset:0
    s_waitcnt vmcnt(24) lgkmcnt(2)
    v_mfma_f32_32x32x16_bf16 v[64:79], v[28:31], a[20:23], v[64:79]
    ds_read_b64_tr_b16 v[20:21], v6 offset:45056
    ds_read_b64_tr_b16 v[22:23], v6 offset:46080
    v_mul_f32 v126, v58, v126
    v_mul_f32 v127, v59, v127
    v_cvt_pk_bf16_f32 v52, v124, v125
    v_cvt_pk_bf16_f32 v53, v126, v127
    v_lshlrev_b32 v124, 16, v52
    s_waitcnt lgkmcnt(2)
    v_mfma_f32_32x32x16_bf16 v[80:95], v[32:35], a[20:23], v[80:95]
    ds_read_b64_tr_b16 v[24:25], v7 offset:45056
    ds_read_b64_tr_b16 v[26:27], v7 offset:46080
    buffer_load_dwordx4 a[20:23], v2, s[32:35], s66 offen offset:1024
    s_waitcnt vmcnt(23) lgkmcnt(2)
    v_mfma_f32_32x32x16_bf16 v[64:79], v[20:23], a[24:27], v[64:79]
    ds_read_b64_tr_b16 v[28:29], v6 offset:47104
    ds_read_b64_tr_b16 v[30:31], v6 offset:48128
    v_and_b32 v125, 0xffff0000, v52
    v_lshlrev_b32 v126, 16, v53
    v_and_b32 v127, 0xffff0000, v53
    s_waitcnt lgkmcnt(2)
    v_mfma_f32_32x32x16_bf16 v[80:95], v[24:27], a[24:27], v[80:95]
    ds_read_b64_tr_b16 v[32:33], v7 offset:47104
    ds_read_b64_tr_b16 v[34:35], v7 offset:48128
    buffer_load_dwordx4 a[24:27], v2, s[32:35], s66 offen offset:2048
    s_waitcnt lgkmcnt(0)
    buffer_load_dword v17, v15, s[32:35], 0 offen offset:0 sc1
    s_barrier
    s_waitcnt vmcnt(24)
    v_mfma_f32_32x32x16_bf16 v[64:79], v[28:31], a[28:31], v[64:79]
    ds_read_b64_tr_b16 v[20:21], v6 offset:49152
    ds_read_b64_tr_b16 v[22:23], v6 offset:50176
    v_mfma_f32_32x32x16_bf16 v[80:95], v[32:35], a[28:31], v[80:95]
    ds_read_b64_tr_b16 v[24:25], v7 offset:49152
    ds_read_b64_tr_b16 v[26:27], v7 offset:50176
    buffer_load_dwordx4 a[28:31], v2, s[32:35], s66 offen offset:3072
    s_waitcnt vmcnt(23) lgkmcnt(2)
    v_mfma_f32_32x32x16_bf16 v[64:79], v[20:23], a[32:35], v[64:79]
    ds_read_b64_tr_b16 v[28:29], v6 offset:51200
    ds_read_b64_tr_b16 v[30:31], v6 offset:52224
    s_waitcnt lgkmcnt(2)
    v_mfma_f32_32x32x16_bf16 v[80:95], v[24:27], a[32:35], v[80:95]
    ds_read_b64_tr_b16 v[32:33], v7 offset:51200
    ds_read_b64_tr_b16 v[34:35], v7 offset:52224
    s_add_u32 s66, s60, 0x3f000
    buffer_load_dwordx4 a[32:35], v2, s[32:35], s66 offen offset:0
    s_waitcnt vmcnt(23) lgkmcnt(2)
    v_mfma_f32_32x32x16_bf16 v[64:79], v[28:31], a[36:39], v[64:79]
    ds_read_b64_tr_b16 v[20:21], v6 offset:53248
    ds_read_b64_tr_b16 v[22:23], v6 offset:54272
    s_waitcnt lgkmcnt(2)
    v_mfma_f32_32x32x16_bf16 v[80:95], v[32:35], a[36:39], v[80:95]
    ds_read_b64_tr_b16 v[24:25], v7 offset:53248
    ds_read_b64_tr_b16 v[26:27], v7 offset:54272
    buffer_load_dwordx4 a[36:39], v2, s[32:35], s66 offen offset:1024
    s_waitcnt vmcnt(22) lgkmcnt(2)
    v_mfma_f32_32x32x16_bf16 v[64:79], v[20:23], a[40:43], v[64:79]
    ds_read_b64_tr_b16 v[28:29], v6 offset:55296
    ds_read_b64_tr_b16 v[30:31], v6 offset:56320
    s_waitcnt lgkmcnt(2)
    v_mfma_f32_32x32x16_bf16 v[80:95], v[24:27], a[40:43], v[80:95]
    ds_read_b64_tr_b16 v[32:33], v7 offset:55296
    ds_read_b64_tr_b16 v[34:35], v7 offset:56320
    buffer_load_dwordx4 a[40:43], v2, s[32:35], s66 offen offset:2048
    s_waitcnt vmcnt(22) lgkmcnt(2)
    v_mfma_f32_32x32x16_bf16 v[64:79], v[28:31], a[44:47], v[64:79]
    ds_read_b64_tr_b16 v[20:21], v6 offset:57344
    ds_read_b64_tr_b16 v[22:23], v6 offset:58368
    s_waitcnt lgkmcnt(2)
    v_mfma_f32_32x32x16_bf16 v[80:95], v[32:35], a[44:47], v[80:95]
    ds_read_b64_tr_b16 v[24:25], v7 offset:57344
    ds_read_b64_tr_b16 v[26:27], v7 offset:58368
    buffer_load_dwordx4 a[44:47], v2, s[32:35], s66 offen offset:3072
    s_waitcnt vmcnt(21) lgkmcnt(2)
    v_mfma_f32_32x32x16_bf16 v[64:79], v[20:23], a[48:51], v[64:79]
    ds_read_b64_tr_b16 v[28:29], v6 offset:59392
    ds_read_b64_tr_b16 v[30:31], v6 offset:60416
    s_waitcnt lgkmcnt(2)
    v_mfma_f32_32x32x16_bf16 v[80:95], v[24:27], a[48:51], v[80:95]
    ds_read_b64_tr_b16 v[32:33], v7 offset:59392
    ds_read_b64_tr_b16 v[34:35], v7 offset:60416
    s_waitcnt vmcnt(20) lgkmcnt(2)
    v_mfma_f32_32x32x16_bf16 v[64:79], v[28:31], a[52:55], v[64:79]
    ds_read_b64_tr_b16 v[20:21], v6 offset:61440
    ds_read_b64_tr_b16 v[22:23], v6 offset:62464
    s_waitcnt lgkmcnt(2)
    v_mfma_f32_32x32x16_bf16 v[80:95], v[32:35], a[52:55], v[80:95]
    ds_read_b64_tr_b16 v[24:25], v7 offset:61440
    ds_read_b64_tr_b16 v[26:27], v7 offset:62464
    s_waitcnt vmcnt(18) lgkmcnt(2)
    v_mfma_f32_32x32x16_bf16 v[64:79], v[20:23], a[56:59], v[64:79]
    ds_read_b64_tr_b16 v[28:29], v6 offset:63488
    ds_read_b64_tr_b16 v[30:31], v6 offset:64512
    s_waitcnt lgkmcnt(2)
    v_mfma_f32_32x32x16_bf16 v[80:95], v[24:27], a[56:59], v[80:95]
    ds_read_b64_tr_b16 v[32:33], v7 offset:63488
    ds_read_b64_tr_b16 v[34:35], v7 offset:64512
    s_waitcnt lgkmcnt(0)
    s_waitcnt vmcnt(5)
    v_readfirstlane_b32 s64, v17
    s_nop 0
    s_cmp_lg_u32 s64, 0
    s_cbranch_scc1 K3_POLLX0
    s_mov_b32 s70, 0x10000
K3_POLL0:
    buffer_load_dword v17, v15, s[32:35], 0 offen offset:0 sc1
    s_waitcnt vmcnt(0)
    v_readfirstlane_b32 s64, v17
    s_sub_u32 s70, s70, 1
    s_cmp_eq_u32 s70, 0
    s_cbranch_scc1 K3_POLLX0
    s_cmp_lg_u32 s64, 0
    s_cbranch_scc1 K3_POLLX0
    s_sleep 8
    s_branch K3_POLL0
K3_POLLX0:
    s_barrier
    v_mfma_f32_32x32x16_bf16 v[64:79], v[28:31], a[60:63], v[64:79]
    ds_read_b64_tr_b16 v[20:21], v12 offset:0
    ds_read_b64_tr_b16 v[22:23], v12 offset:1024
    s_add_u32 s65, s69, 0
    buffer_load_dwordx4 v[128:131], v2, s[32:35], s65 offen offset:0 sc1
    v_mfma_f32_32x32x16_bf16 v[80:95], v[32:35], a[60:63], v[80:95]
    ds_read_b64_tr_b16 v[24:25], v13 offset:0
    ds_read_b64_tr_b16 v[26:27], v13 offset:1024
    buffer_load_dwordx4 v[132:135], v2, s[32:35], s65 offen offset:1024 sc1
    s_waitcnt lgkmcnt(2)
    v_mfma_f32_32x32x16_bf16 v[64:79], v[20:23], a[64:67], v[64:79]
    ds_read_b64_tr_b16 v[28:29], v12 offset:2048
    ds_read_b64_tr_b16 v[30:31], v12 offset:3072
    buffer_load_dwordx4 v[136:139], v2, s[32:35], s65 offen offset:2048 sc1
    s_waitcnt lgkmcnt(2)
    v_mfma_f32_32x32x16_bf16 v[80:95], v[24:27], a[64:67], v[80:95]
    ds_read_b64_tr_b16 v[32:33], v13 offset:2048
    ds_read_b64_tr_b16 v[34:35], v13 offset:3072
    buffer_load_dwordx4 v[140:143], v2, s[32:35], s65 offen offset:3072 sc1
    s_waitcnt lgkmcnt(2)
    v_mfma_f32_32x32x16_bf16 v[64:79], v[28:31], a[68:71], v[64:79]
    ds_read_b64_tr_b16 v[20:21], v12 offset:4096
    ds_read_b64_tr_b16 v[22:23], v12 offset:5120
    s_add_u32 s65, s69, 0x1000
    buffer_load_dwordx4 v[144:147], v2, s[32:35], s65 offen offset:0 sc1
    s_waitcnt lgkmcnt(2)
    v_mfma_f32_32x32x16_bf16 v[80:95], v[32:35], a[68:71], v[80:95]
    ds_read_b64_tr_b16 v[24:25], v13 offset:4096
    ds_read_b64_tr_b16 v[26:27], v13 offset:5120
    buffer_load_dwordx4 v[148:151], v2, s[32:35], s65 offen offset:1024 sc1
    s_waitcnt lgkmcnt(2)
    v_mfma_f32_32x32x16_bf16 v[64:79], v[20:23], a[72:75], v[64:79]
    ds_read_b64_tr_b16 v[28:29], v12 offset:6144
    ds_read_b64_tr_b16 v[30:31], v12 offset:7168
    buffer_load_dwordx4 v[152:155], v2, s[32:35], s65 offen offset:2048 sc1
    s_waitcnt lgkmcnt(2)
    v_mfma_f32_32x32x16_bf16 v[80:95], v[24:27], a[72:75], v[80:95]
    ds_read_b64_tr_b16 v[32:33], v13 offset:6144
    ds_read_b64_tr_b16 v[34:35], v13 offset:7168
    buffer_load_dwordx4 v[156:159], v2, s[32:35], s65 offen offset:3072 sc1
    s_waitcnt lgkmcnt(2)
    v_mfma_f32_32x32x16_bf16 v[64:79], v[28:31], a[76:79], v[64:79]
    ds_read_b64_tr_b16 v[20:21], v12 offset:8192
    ds_read_b64_tr_b16 v[22:23], v12 offset:9216
    buffer_load_dwordx2 v[36:37], v14, s[44:47], s68 offen offset:0
    s_waitcnt lgkmcnt(2)
    v_mfma_f32_32x32x16_bf16 v[80:95], v[32:35], a[76:79], v[80:95]
    ds_read_b64_tr_b16 v[24:25], v13 offset:8192
    ds_read_b64_tr_b16 v[26:27], v13 offset:9216
    buffer_load_dwordx2 v[38:39], v14, s[44:47], s68 offen offset:16
    s_waitcnt lgkmcnt(2)
    v_mfma_f32_32x32x16_bf16 v[64:79], v[20:23], a[0:3], v[64:79]
    ds_read_b64_tr_b16 v[28:29], v12 offset:10240
    ds_read_b64_tr_b16 v[30:31], v12 offset:11264
    buffer_load_dwordx2 v[40:41], v14, s[44:47], s68 offen offset:32
    s_waitcnt lgkmcnt(2)
    v_mfma_f32_32x32x16_bf16 v[80:95], v[24:27], a[0:3], v[80:95]
    ds_read_b64_tr_b16 v[32:33], v13 offset:10240
    ds_read_b64_tr_b16 v[34:35], v13 offset:11264
    buffer_load_dwordx2 v[42:43], v14, s[44:47], s68 offen offset:48
    s_waitcnt lgkmcnt(2)
    v_mfma_f32_32x32x16_bf16 v[64:79], v[28:31], a[4:7], v[64:79]
    ds_read_b64_tr_b16 v[20:21], v12 offset:12288
    ds_read_b64_tr_b16 v[22:23], v12 offset:13312
    s_waitcnt lgkmcnt(2)
    v_mfma_f32_32x32x16_bf16 v[80:95], v[32:35], a[4:7], v[80:95]
    ds_read_b64_tr_b16 v[24:25], v13 offset:12288
    ds_read_b64_tr_b16 v[26:27], v13 offset:13312
    buffer_load_dwordx2 v[44:45], v14, s[44:47], s68 offen offset:64
    s_waitcnt lgkmcnt(2)
    v_mfma_f32_32x32x16_bf16 v[64:79], v[20:23], a[8:11], v[64:79]
    ds_read_b64_tr_b16 v[28:29], v12 offset:14336
    ds_read_b64_tr_b16 v[30:31], v12 offset:15360
    buffer_load_dwordx2 v[46:47], v14, s[44:47], s68 offen offset:80
    s_waitcnt lgkmcnt(2)
    v_mfma_f32_32x32x16_bf16 v[80:95], v[24:27], a[8:11], v[80:95]
    ds_read_b64_tr_b16 v[32:33], v13 offset:14336
    ds_read_b64_tr_b16 v[34:35], v13 offset:15360
    buffer_load_dwordx2 v[48:49], v14, s[44:47], s68 offen offset:96
    s_waitcnt lgkmcnt(0)
    s_barrier
    v_mfma_f32_32x32x16_bf16 v[64:79], v[28:31], a[12:15], v[64:79]
    ds_read_b64_tr_b16 v[20:21], v12 offset:16384
    ds_read_b64_tr_b16 v[22:23], v12 offset:17408
    v_mfma_f32_32x32x16_bf16 v[80:95], v[32:35], a[12:15], v[80:95]
    ds_read_b64_tr_b16 v[24:25], v13 offset:16384
    ds_read_b64_tr_b16 v[26:27], v13 offset:17408
    buffer_load_dwordx2 v[50:51], v14, s[44:47], s68 offen offset:112
    s_waitcnt lgkmcnt(2)
    v_mfma_f32_32x32x16_bf16 v[64:79], v[20:23], a[16:19], v[64:79]
    ds_read_b64_tr_b16 v[28:29], v12 offset:18432
    ds_read_b64_tr_b16 v[30:31], v12 offset:19456
    s_waitcnt lgkmcnt(2)
    v_mfma_f32_32x32x16_bf16 v[80:95], v[24:27], a[16:19], v[80:95]
    ds_read_b64_tr_b16 v[32:33], v13 offset:18432
    ds_read_b64_tr_b16 v[34:35], v13 offset:19456
    s_waitcnt lgkmcnt(2)
    v_mfma_f32_32x32x16_bf16 v[64:79], v[28:31], a[20:23], v[64:79]
    ds_read_b64_tr_b16 v[20:21], v12 offset:20480
    ds_read_b64_tr_b16 v[22:23], v12 offset:21504
    s_waitcnt lgkmcnt(2)
    v_mfma_f32_32x32x16_bf16 v[80:95], v[32:35], a[20:23], v[80:95]
    ds_read_b64_tr_b16 v[24:25], v13 offset:20480
    ds_read_b64_tr_b16 v[26:27], v13 offset:21504
    s_waitcnt lgkmcnt(2)
    v_mfma_f32_32x32x16_bf16 v[64:79], v[20:23], a[24:27], v[64:79]
    ds_read_b64_tr_b16 v[28:29], v12 offset:22528
    ds_read_b64_tr_b16 v[30:31], v12 offset:23552
    s_waitcnt lgkmcnt(2)
    v_mfma_f32_32x32x16_bf16 v[80:95], v[24:27], a[24:27], v[80:95]
    ds_read_b64_tr_b16 v[32:33], v13 offset:22528
    ds_read_b64_tr_b16 v[34:35], v13 offset:23552
    s_waitcnt vmcnt(20) lgkmcnt(2)
    v_mfma_f32_32x32x16_bf16 v[64:79], v[28:31], a[28:31], v[64:79]
    ds_read_b64_tr_b16 v[20:21], v12 offset:24576
    ds_read_b64_tr_b16 v[22:23], v12 offset:25600
    s_waitcnt lgkmcnt(2)
    v_mfma_f32_32x32x16_bf16 v[80:95], v[32:35], a[28:31], v[80:95]
    ds_read_b64_tr_b16 v[24:25], v13 offset:24576
    ds_read_b64_tr_b16 v[26:27], v13 offset:25600
    s_waitcnt vmcnt(19) lgkmcnt(2)
    v_mfma_f32_32x32x16_bf16 v[64:79], v[20:23], a[32:35], v[64:79]
    ds_read_b64_tr_b16 v[28:29], v12 offset:26624
    ds_read_b64_tr_b16 v[30:31], v12 offset:27648
    s_waitcnt lgkmcnt(2)
    v_mfma_f32_32x32x16_bf16 v[80:95], v[24:27], a[32:35], v[80:95]
    ds_read_b64_tr_b16 v[32:33], v13 offset:26624
    ds_read_b64_tr_b16 v[34:35], v13 offset:27648
    s_waitcnt vmcnt(18) lgkmcnt(2)
    v_mfma_f32_32x32x16_bf16 v[64:79], v[28:31], a[36:39], v[64:79]
    ds_read_b64_tr_b16 v[20:21], v12 offset:28672
    ds_read_b64_tr_b16 v[22:23], v12 offset:29696
    s_waitcnt lgkmcnt(2)
    v_mfma_f32_32x32x16_bf16 v[80:95], v[32:35], a[36:39], v[80:95]
    ds_read_b64_tr_b16 v[24:25], v13 offset:28672
    ds_read_b64_tr_b16 v[26:27], v13 offset:29696
    s_waitcnt vmcnt(17) lgkmcnt(2)
    v_mfma_f32_32x32x16_bf16 v[64:79], v[20:23], a[40:43], v[64:79]
    ds_read_b64_tr_b16 v[28:29], v12 offset:30720
    ds_read_b64_tr_b16 v[30:31], v12 offset:31744
    s_waitcnt lgkmcnt(2)
    v_mfma_f32_32x32x16_bf16 v[80:95], v[24:27], a[40:43], v[80:95]
    ds_read_b64_tr_b16 v[32:33], v13 offset:30720
    ds_read_b64_tr_b16 v[34:35], v13 offset:31744
    s_waitcnt vmcnt(16) lgkmcnt(2)
    v_mfma_f32_32x32x16_bf16 v[64:79], v[28:31], a[44:47], v[64:79]
    s_waitcnt lgkmcnt(0)
    v_mfma_f32_32x32x16_bf16 v[80:95], v[32:35], a[44:47], v[80:95]
    s_waitcnt vmcnt(15)
    s_nop 8
    v_add_f32 v64, v64, v128
    v_add_f32 v65, v65, v129
    v_add_f32 v66, v66, v130
    v_add_f32 v67, v67, v131
    v_cvt_pk_bf16_f32 v52, v64, v65
    v_cvt_pk_bf16_f32 v53, v66, v67
    v_lshlrev_b32 v64, 16, v52
    v_and_b32 v65, 0xffff0000, v52
    v_lshlrev_b32 v66, 16, v53
    v_and_b32 v67, 0xffff0000, v53
    v_mul_f32 v64, v64, v96
    v_mul_f32 v65, v65, v97
    v_mul_f32 v66, v66, v98
    v_mul_f32 v67, v67, v99
    v_cvt_pk_bf16_f32 v52, v64, v65
    v_cvt_pk_bf16_f32 v53, v66, v67
    v_lshlrev_b32 v64, 16, v52
    v_and_b32 v65, 0xffff0000, v52
    v_lshlrev_b32 v66, 16, v53
    v_and_b32 v67, 0xffff0000, v53
    s_waitcnt vmcnt(7)
    v_lshlrev_b32 v60, 16, v36
    v_and_b32 v61, 0xffff0000, v36
    v_lshlrev_b32 v62, 16, v37
    v_and_b32 v63, 0xffff0000, v37
    v_add_f32 v64, v64, v60
    v_add_f32 v65, v65, v61
    v_add_f32 v66, v66, v62
    v_add_f32 v67, v67, v63
    v_cvt_pk_bf16_f32 v128, v64, v65
    v_cvt_pk_bf16_f32 v129, v66, v67
    buffer_store_dwordx2 v[128:129], v14, s[48:51], s68 offen offset:0
    v_add_f32 v68, v68, v132
    v_add_f32 v69, v69, v133
    v_add_f32 v70, v70, v134
    v_add_f32 v71, v71, v135
    v_cvt_pk_bf16_f32 v52, v68, v69
    v_cvt_pk_bf16_f32 v53, v70, v71
    v_lshlrev_b32 v68, 16, v52
    v_and_b32 v69, 0xffff0000, v52
    v_lshlrev_b32 v70, 16, v53
    v_and_b32 v71, 0xffff0000, v53
    v_mul_f32 v68, v68, v100
    v_mul_f32 v69, v69, v101
    v_mul_f32 v70, v70, v102
    v_mul_f32 v71, v71, v103
    v_cvt_pk_bf16_f32 v52, v68, v69
    v_cvt_pk_bf16_f32 v53, v70, v71
    v_lshlrev_b32 v68, 16, v52
    v_and_b32 v69, 0xffff0000, v52
    v_lshlrev_b32 v70, 16, v53
    v_and_b32 v71, 0xffff0000, v53
    s_waitcnt vmcnt(7)
    v_lshlrev_b32 v60, 16, v38
    v_and_b32 v61, 0xffff0000, v38
    v_lshlrev_b32 v62, 16, v39
    v_and_b32 v63, 0xffff0000, v39
    v_add_f32 v68, v68, v60
    v_add_f32 v69, v69, v61
    v_add_f32 v70, v70, v62
    v_add_f32 v71, v71, v63
    v_cvt_pk_bf16_f32 v132, v68, v69
    v_cvt_pk_bf16_f32 v133, v70, v71
    buffer_store_dwordx2 v[132:133], v14, s[48:51], s68 offen offset:16
    v_add_f32 v72, v72, v136
    v_add_f32 v73, v73, v137
    v_add_f32 v74, v74, v138
    v_add_f32 v75, v75, v139
    v_cvt_pk_bf16_f32 v52, v72, v73
    v_cvt_pk_bf16_f32 v53, v74, v75
    v_lshlrev_b32 v72, 16, v52
    v_and_b32 v73, 0xffff0000, v52
    v_lshlrev_b32 v74, 16, v53
    v_and_b32 v75, 0xffff0000, v53
    v_mul_f32 v72, v72, v104
    v_mul_f32 v73, v73, v105
    v_mul_f32 v74, v74, v106
    v_mul_f32 v75, v75, v107
    v_cvt_pk_bf16_f32 v52, v72, v73
    v_cvt_pk_bf16_f32 v53, v74, v75
    v_lshlrev_b32 v72, 16, v52
    v_and_b32 v73, 0xffff0000, v52
    v_lshlrev_b32 v74, 16, v53
    v_and_b32 v75, 0xffff0000, v53
    s_waitcnt vmcnt(7)
    v_lshlrev_b32 v60, 16, v40
    v_and_b32 v61, 0xffff0000, v40
    v_lshlrev_b32 v62, 16, v41
    v_and_b32 v63, 0xffff0000, v41
    v_add_f32 v72, v72, v60
    v_add_f32 v73, v73, v61
    v_add_f32 v74, v74, v62
    v_add_f32 v75, v75, v63
    v_cvt_pk_bf16_f32 v136, v72, v73
    v_cvt_pk_bf16_f32 v137, v74, v75
    buffer_store_dwordx2 v[136:137], v14, s[48:51], s68 offen offset:32
    v_add_f32 v76, v76, v140
    v_add_f32 v77, v77, v141
    v_add_f32 v78, v78, v142
    v_add_f32 v79, v79, v143
    v_cvt_pk_bf16_f32 v52, v76, v77
    v_cvt_pk_bf16_f32 v53, v78, v79
    v_lshlrev_b32 v76, 16, v52
    v_and_b32 v77, 0xffff0000, v52
    v_lshlrev_b32 v78, 16, v53
    v_and_b32 v79, 0xffff0000, v53
    v_mul_f32 v76, v76, v108
    v_mul_f32 v77, v77, v109
    v_mul_f32 v78, v78, v110
    v_mul_f32 v79, v79, v111
    v_cvt_pk_bf16_f32 v52, v76, v77
    v_cvt_pk_bf16_f32 v53, v78, v79
    v_lshlrev_b32 v76, 16, v52
    v_and_b32 v77, 0xffff0000, v52
    v_lshlrev_b32 v78, 16, v53
    v_and_b32 v79, 0xffff0000, v53
    s_waitcnt vmcnt(7)
    v_lshlrev_b32 v60, 16, v42
    v_and_b32 v61, 0xffff0000, v42
    v_lshlrev_b32 v62, 16, v43
    v_and_b32 v63, 0xffff0000, v43
    v_add_f32 v76, v76, v60
    v_add_f32 v77, v77, v61
    v_add_f32 v78, v78, v62
    v_add_f32 v79, v79, v63
    v_cvt_pk_bf16_f32 v140, v76, v77
    v_cvt_pk_bf16_f32 v141, v78, v79
    buffer_store_dwordx2 v[140:141], v14, s[48:51], s68 offen offset:48
    v_add_f32 v80, v80, v144
    v_add_f32 v81, v81, v145
    v_add_f32 v82, v82, v146
    v_add_f32 v83, v83, v147
    v_cvt_pk_bf16_f32 v52, v80, v81
    v_cvt_pk_bf16_f32 v53, v82, v83
    v_lshlrev_b32 v80, 16, v52
    v_and_b32 v81, 0xffff0000, v52
    v_lshlrev_b32 v82, 16, v53
    v_and_b32 v83, 0xffff0000, v53
    v_mul_f32 v80, v80, v112
    v_mul_f32 v81, v81, v113
    v_mul_f32 v82, v82, v114
    v_mul_f32 v83, v83, v115
    v_cvt_pk_bf16_f32 v52, v80, v81
    v_cvt_pk_bf16_f32 v53, v82, v83
    v_lshlrev_b32 v80, 16, v52
    v_and_b32 v81, 0xffff0000, v52
    v_lshlrev_b32 v82, 16, v53
    v_and_b32 v83, 0xffff0000, v53
    s_waitcnt vmcnt(7)
    v_lshlrev_b32 v60, 16, v44
    v_and_b32 v61, 0xffff0000, v44
    v_lshlrev_b32 v62, 16, v45
    v_and_b32 v63, 0xffff0000, v45
    v_add_f32 v80, v80, v60
    v_add_f32 v81, v81, v61
    v_add_f32 v82, v82, v62
    v_add_f32 v83, v83, v63
    v_cvt_pk_bf16_f32 v144, v80, v81
    v_cvt_pk_bf16_f32 v145, v82, v83
    buffer_store_dwordx2 v[144:145], v14, s[48:51], s68 offen offset:64
    v_add_f32 v84, v84, v148
    v_add_f32 v85, v85, v149
    v_add_f32 v86, v86, v150
    v_add_f32 v87, v87, v151
    v_cvt_pk_bf16_f32 v52, v84, v85
    v_cvt_pk_bf16_f32 v53, v86, v87
    v_lshlrev_b32 v84, 16, v52
    v_and_b32 v85, 0xffff0000, v52
    v_lshlrev_b32 v86, 16, v53
    v_and_b32 v87, 0xffff0000, v53
    v_mul_f32 v84, v84, v116
    v_mul_f32 v85, v85, v117
    v_mul_f32 v86, v86, v118
    v_mul_f32 v87, v87, v119
    v_cvt_pk_bf16_f32 v52, v84, v85
    v_cvt_pk_bf16_f32 v53, v86, v87
    v_lshlrev_b32 v84, 16, v52
    v_and_b32 v85, 0xffff0000, v52
    v_lshlrev_b32 v86, 16, v53
    v_and_b32 v87, 0xffff0000, v53
    s_waitcnt vmcnt(7)
    v_lshlrev_b32 v60, 16, v46
    v_and_b32 v61, 0xffff0000, v46
    v_lshlrev_b32 v62, 16, v47
    v_and_b32 v63, 0xffff0000, v47
    v_add_f32 v84, v84, v60
    v_add_f32 v85, v85, v61
    v_add_f32 v86, v86, v62
    v_add_f32 v87, v87, v63
    v_cvt_pk_bf16_f32 v148, v84, v85
    v_cvt_pk_bf16_f32 v149, v86, v87
    buffer_store_dwordx2 v[148:149], v14, s[48:51], s68 offen offset:80
    v_add_f32 v88, v88, v152
    v_add_f32 v89, v89, v153
    v_add_f32 v90, v90, v154
    v_add_f32 v91, v91, v155
    v_cvt_pk_bf16_f32 v52, v88, v89
    v_cvt_pk_bf16_f32 v53, v90, v91
    v_lshlrev_b32 v88, 16, v52
    v_and_b32 v89, 0xffff0000, v52
    v_lshlrev_b32 v90, 16, v53
    v_and_b32 v91, 0xffff0000, v53
    v_mul_f32 v88, v88, v120
    v_mul_f32 v89, v89, v121
    v_mul_f32 v90, v90, v122
    v_mul_f32 v91, v91, v123
    v_cvt_pk_bf16_f32 v52, v88, v89
    v_cvt_pk_bf16_f32 v53, v90, v91
    v_lshlrev_b32 v88, 16, v52
    v_and_b32 v89, 0xffff0000, v52
    v_lshlrev_b32 v90, 16, v53
    v_and_b32 v91, 0xffff0000, v53
    s_waitcnt vmcnt(7)
    v_lshlrev_b32 v60, 16, v48
    v_and_b32 v61, 0xffff0000, v48
    v_lshlrev_b32 v62, 16, v49
    v_and_b32 v63, 0xffff0000, v49
    v_add_f32 v88, v88, v60
    v_add_f32 v89, v89, v61
    v_add_f32 v90, v90, v62
    v_add_f32 v91, v91, v63
    v_cvt_pk_bf16_f32 v152, v88, v89
    v_cvt_pk_bf16_f32 v153, v90, v91
    buffer_store_dwordx2 v[152:153], v14, s[48:51], s68 offen offset:96
    v_add_f32 v92, v92, v156
    v_add_f32 v93, v93, v157
    v_add_f32 v94, v94, v158
    v_add_f32 v95, v95, v159
    v_cvt_pk_bf16_f32 v52, v92, v93
    v_cvt_pk_bf16_f32 v53, v94, v95
    v_lshlrev_b32 v92, 16, v52
    v_and_b32 v93, 0xffff0000, v52
    v_lshlrev_b32 v94, 16, v53
    v_and_b32 v95, 0xffff0000, v53
    v_mul_f32 v92, v92, v124
    v_mul_f32 v93, v93, v125
    v_mul_f32 v94, v94, v126
    v_mul_f32 v95, v95, v127
    v_cvt_pk_bf16_f32 v52, v92, v93
    v_cvt_pk_bf16_f32 v53, v94, v95
    v_lshlrev_b32 v92, 16, v52
    v_and_b32 v93, 0xffff0000, v52
    v_lshlrev_b32 v94, 16, v53
    v_and_b32 v95, 0xffff0000, v53
    s_waitcnt vmcnt(7)
    v_lshlrev_b32 v60, 16, v50
    v_and_b32 v61, 0xffff0000, v50
    v_lshlrev_b32 v62, 16, v51
    v_and_b32 v63, 0xffff0000, v51
    v_add_f32 v92, v92, v60
    v_add_f32 v93, v93, v61
    v_add_f32 v94, v94, v62
    v_add_f32 v95, v95, v63
    v_cvt_pk_bf16_f32 v156, v92, v93
    v_cvt_pk_bf16_f32 v157, v94, v95
    buffer_store_dwordx2 v[156:157], v14, s[48:51], s68 offen offset:112
    s_endpgm
K2_RARE0:
    s_nop 15
    s_nop 7
    v_subrev_u32 v32, s75, v8
    v_cmp_ge_i32 s[40:41], v32, 0
    v_cmp_ge_i32 s[42:43], v32, 1
    v_cmp_ge_i32 s[44:45], v32, 2
    v_cmp_ge_i32 s[46:47], v32, 3
    v_cndmask_b32 v128, v17, v128, s[40:41]
    v_cndmask_b32 v129, v17, v129, s[42:43]
    v_cndmask_b32 v130, v17, v130, s[44:45]
    v_cndmask_b32 v131, v17, v131, s[46:47]
    v_cmp_ge_i32 s[40:41], v32, 8
    v_cmp_ge_i32 s[42:43], v32, 9
    v_cmp_ge_i32 s[44:45], v32, 10
    v_cmp_ge_i32 s[46:47], v32, 11
    v_cndmask_b32 v132, v17, v132, s[40:41]
    v_cndmask_b32 v133, v17, v133, s[42:43]
    v_cndmask_b32 v134, v17, v134, s[44:45]
    v_cndmask_b32 v135, v17, v135, s[46:47]
    v_cmp_ge_i32 s[40:41], v32, 16
    v_cmp_ge_i32 s[42:43], v32, 17
    v_cmp_ge_i32 s[44:45], v32, 18
    v_cmp_ge_i32 s[46:47], v32, 19
    v_cndmask_b32 v136, v17, v136, s[40:41]
    v_cndmask_b32 v137, v17, v137, s[42:43]
    v_cndmask_b32 v138, v17, v138, s[44:45]
    v_cndmask_b32 v139, v17, v139, s[46:47]
    v_cmp_ge_i32 s[40:41], v32, 24
    v_cmp_ge_i32 s[42:43], v32, 25
    v_cmp_ge_i32 s[44:45], v32, 26
    v_cmp_ge_i32 s[46:47], v32, 27
    v_cndmask_b32 v140, v17, v140, s[40:41]
    v_cndmask_b32 v141, v17, v141, s[42:43]
    v_cndmask_b32 v142, v17, v142, s[44:45]
    v_cndmask_b32 v143, v17, v143, s[46:47]
    v_max3_f32 v33, v128, v129, v130
    v_max3_f32 v33, v33, v131, v132
    v_max3_f32 v33, v33, v133, v134
    v_max3_f32 v33, v33, v135, v136
    v_max3_f32 v33, v33, v137, v138
    v_max3_f32 v33, v33, v139, v140
    v_max3_f32 v33, v33, v141, v142
    v_max_f32 v33, v33, v143
    v_mov_b32 v35, v33
    s_nop 1
    v_permlane32_swap_b32 v33, v35
    v_max_f32 v33, v33, v35
    v_max_f32 v33, 0, v33
    v_sub_f32 v34, 0, v33
    v_exp_f32 v34, v34
    v_sub_f32 v128, v128, v33
    v_sub_f32 v129, v129, v33
    v_sub_f32 v130, v130, v33
    v_sub_f32 v131, v131, v33
    v_sub_f32 v132, v132, v33
    v_sub_f32 v133, v133, v33
    v_sub_f32 v134, v134, v33
    v_sub_f32 v135, v135, v33
    v_sub_f32 v136, v136, v33
    v_sub_f32 v137, v137, v33
    v_sub_f32 v138, v138, v33
    v_sub_f32 v139, v139, v33
    v_sub_f32 v140, v140, v33
    v_sub_f32 v141, v141, v33
    v_sub_f32 v142, v142, v33
    v_sub_f32 v143, v143, v33
    v_mul_f32 v24, v10, v34
    v_exp_f32 v40, v128
    v_exp_f32 v41, v129
    v_exp_f32 v42, v130
    v_exp_f32 v43, v131
    v_exp_f32 v44, v132
    v_exp_f32 v45, v133
    v_exp_f32 v46, v134
    v_exp_f32 v47, v135
    v_exp_f32 v48, v136
    v_exp_f32 v49, v137
    v_exp_f32 v50, v138
    v_exp_f32 v51, v139
    v_exp_f32 v52, v140
    v_exp_f32 v53, v141
    v_exp_f32 v54, v142
    v_exp_f32 v55, v143
    v_sub_f32 v160, v160, v33
    v_sub_f32 v161, v161, v33
    v_sub_f32 v162, v162, v33
    v_sub_f32 v163, v163, v33
    v_sub_f32 v164, v164, v33
    v_sub_f32 v165, v165, v33
    v_sub_f32 v166, v166, v33
    v_sub_f32 v167, v167, v33
    v_sub_f32 v168, v168, v33
    v_sub_f32 v169, v169, v33
    v_sub_f32 v170, v170, v33
    v_sub_f32 v171, v171, v33
    v_sub_f32 v172, v172, v33
    v_sub_f32 v173, v173, v33
    v_sub_f32 v174, v174, v33
    v_sub_f32 v175, v175, v33
    v_add_f32 v24, v24, v40
    v_add_f32 v24, v24, v41
    v_add_f32 v24, v24, v42
    v_add_f32 v24, v24, v43
    v_add_f32 v24, v24, v44
    v_add_f32 v24, v24, v45
    v_add_f32 v24, v24, v46
    v_add_f32 v24, v24, v47
    v_add_f32 v24, v24, v48
    v_add_f32 v24, v24, v49
    v_add_f32 v24, v24, v50
    v_add_f32 v24, v24, v51
    v_add_f32 v24, v24, v52
    v_add_f32 v24, v24, v53
    v_add_f32 v24, v24, v54
    v_add_f32 v24, v24, v55
    v_cvt_pk_bf16_f32 v224, v40, v41
    v_cvt_pk_bf16_f32 v225, v42, v43
    v_cvt_pk_bf16_f32 v226, v44, v45
    v_cvt_pk_bf16_f32 v227, v46, v47
    v_cvt_pk_bf16_f32 v228, v48, v49
    v_cvt_pk_bf16_f32 v229, v50, v51
    v_cvt_pk_bf16_f32 v230, v52, v53
    v_cvt_pk_bf16_f32 v231, v54, v55
    v_sub_f32 v192, v192, v33
    v_sub_f32 v193, v193, v33
    v_sub_f32 v194, v194, v33
    v_sub_f32 v195, v195, v33
    v_sub_f32 v196, v196, v33
    v_sub_f32 v197, v197, v33
    v_sub_f32 v198, v198, v33
    v_sub_f32 v199, v199, v33
    v_sub_f32 v200, v200, v33
    v_sub_f32 v201, v201, v33
    v_sub_f32 v202, v202, v33
    v_sub_f32 v203, v203, v33
    v_sub_f32 v204, v204, v33
    v_sub_f32 v205, v205, v33
    v_sub_f32 v206, v206, v33
    v_sub_f32 v207, v207, v33
    v_accvgpr_read_b32 v40, a0
    v_accvgpr_read_b32 v41, a1
    v_accvgpr_read_b32 v42, a2
    v_accvgpr_read_b32 v43, a3
    v_accvgpr_read_b32 v44, a4
    v_accvgpr_read_b32 v45, a5
    v_accvgpr_read_b32 v46, a6
    v_accvgpr_read_b32 v47, a7
    v_mul_f32 v40, v40, v34
    v_mul_f32 v41, v41, v34
    v_mul_f32 v42, v42, v34
    v_mul_f32 v43, v43, v34
    v_mul_f32 v44, v44, v34
    v_mul_f32 v45, v45, v34
    v_mul_f32 v46, v46, v34
    v_mul_f32 v47, v47, v34
    v_accvgpr_write_b32 a0, v40
    v_accvgpr_write_b32 a1, v41
    v_accvgpr_write_b32 a2, v42
    v_accvgpr_write_b32 a3, v43
    v_accvgpr_write_b32 a4, v44
    v_accvgpr_write_b32 a5, v45
    v_accvgpr_write_b32 a6, v46
    v_accvgpr_write_b32 a7, v47
    v_accvgpr_read_b32 v40, a8
    v_accvgpr_read_b32 v41, a9
    v_accvgpr_read_b32 v42, a10
    v_accvgpr_read_b32 v43, a11
    v_accvgpr_read_b32 v44, a12
    v_accvgpr_read_b32 v45, a13
    v_accvgpr_read_b32 v46, a14
    v_accvgpr_read_b32 v47, a15
    v_mul_f32 v40, v40, v34
    v_mul_f32 v41, v41, v34
    v_mul_f32 v42, v42, v34
    v_mul_f32 v43, v43, v34
    v_mul_f32 v44, v44, v34
    v_mul_f32 v45, v45, v34
    v_mul_f32 v46, v46, v34
    v_mul_f32 v47, v47, v34
    v_accvgpr_write_b32 a8, v40
    v_accvgpr_write_b32 a9, v41
    v_accvgpr_write_b32 a10, v42
    v_accvgpr_write_b32 a11, v43
    v_accvgpr_write_b32 a12, v44
    v_accvgpr_write_b32 a13, v45
    v_accvgpr_write_b32 a14, v46
    v_accvgpr_write_b32 a15, v47
    v_accvgpr_read_b32 v40, a16
    v_accvgpr_read_b32 v41, a17
    v_accvgpr_read_b32 v42, a18
    v_accvgpr_read_b32 v43, a19
    v_accvgpr_read_b32 v44, a20
    v_accvgpr_read_b32 v45, a21
    v_accvgpr_read_b32 v46, a22
    v_accvgpr_read_b32 v47, a23
    v_mul_f32 v40, v40, v34
    v_mul_f32 v41, v41, v34
    v_mul_f32 v42, v42, v34
    v_mul_f32 v43, v43, v34
    v_mul_f32 v44, v44, v34
    v_mul_f32 v45, v45, v34
    v_mul_f32 v46, v46, v34
    v_mul_f32 v47, v47, v34
    v_accvgpr_write_b32 a16, v40
    v_accvgpr_write_b32 a17, v41
    v_accvgpr_write_b32 a18, v42
    v_accvgpr_write_b32 a19, v43
    v_accvgpr_write_b32 a20, v44
    v_accvgpr_write_b32 a21, v45
    v_accvgpr_write_b32 a22, v46
    v_accvgpr_write_b32 a23, v47
    v_accvgpr_read_b32 v40, a24
    v_accvgpr_read_b32 v41, a25
    v_accvgpr_read_b32 v42, a26
    v_accvgpr_read_b32 v43, a27
    v_accvgpr_read_b32 v44, a28
    v_accvgpr_read_b32 v45, a29
    v_accvgpr_read_b32 v46, a30
    v_accvgpr_read_b32 v47, a31
    v_mul_f32 v40, v40, v34
    v_mul_f32 v41, v41, v34
    v_mul_f32 v42, v42, v34
    v_mul_f32 v43, v43, v34
    v_mul_f32 v44, v44, v34
    v_mul_f32 v45, v45, v34
    v_mul_f32 v46, v46, v34
    v_mul_f32 v47, v47, v34
    v_accvgpr_write_b32 a24, v40
    v_accvgpr_write_b32 a25, v41
    v_accvgpr_write_b32 a26, v42
    v_accvgpr_write_b32 a27, v43
    v_accvgpr_write_b32 a28, v44
    v_accvgpr_write_b32 a29, v45
    v_accvgpr_write_b32 a30, v46
    v_accvgpr_write_b32 a31, v47
    v_accvgpr_read_b32 v40, a32
    v_accvgpr_read_b32 v41, a33
    v_accvgpr_read_b32 v42, a34
    v_accvgpr_read_b32 v43, a35
    v_accvgpr_read_b32 v44, a36
    v_accvgpr_read_b32 v45, a37
    v_accvgpr_read_b32 v46, a38
    v_accvgpr_read_b32 v47, a39
    v_mul_f32 v40, v40, v34
    v_mul_f32 v41, v41, v34
    v_mul_f32 v42, v42, v34
    v_mul_f32 v43, v43, v34
    v_mul_f32 v44, v44, v34
    v_mul_f32 v45, v45, v34
    v_mul_f32 v46, v46, v34
    v_mul_f32 v47, v47, v34
    v_accvgpr_write_b32 a32, v40
    v_accvgpr_write_b32 a33, v41
    v_accvgpr_write_b32 a34, v42
    v_accvgpr_write_b32 a35, v43
    v_accvgpr_write_b32 a36, v44
    v_accvgpr_write_b32 a37, v45
    v_accvgpr_write_b32 a38, v46
    v_accvgpr_write_b32 a39, v47
    v_accvgpr_read_b32 v40, a40
    v_accvgpr_read_b32 v41, a41
    v_accvgpr_read_b32 v42, a42
    v_accvgpr_read_b32 v43, a43
    v_accvgpr_read_b32 v44, a44
    v_accvgpr_read_b32 v45, a45
    v_accvgpr_read_b32 v46, a46
    v_accvgpr_read_b32 v47, a47
    v_mul_f32 v40, v40, v34
    v_mul_f32 v41, v41, v34
    v_mul_f32 v42, v42, v34
    v_mul_f32 v43, v43, v34
    v_mul_f32 v44, v44, v34
    v_mul_f32 v45, v45, v34
    v_mul_f32 v46, v46, v34
    v_mul_f32 v47, v47, v34
    v_accvgpr_write_b32 a40, v40
    v_accvgpr_write_b32 a41, v41
    v_accvgpr_write_b32 a42, v42
    v_accvgpr_write_b32 a43, v43
    v_accvgpr_write_b32 a44, v44
    v_accvgpr_write_b32 a45, v45
    v_accvgpr_write_b32 a46, v46
    v_accvgpr_write_b32 a47, v47
    v_accvgpr_read_b32 v40, a48
    v_accvgpr_read_b32 v41, a49
    v_accvgpr_read_b32 v42, a50
    v_accvgpr_read_b32 v43, a51
    v_accvgpr_read_b32 v44, a52
    v_accvgpr_read_b32 v45, a53
    v_accvgpr_read_b32 v46, a54
    v_accvgpr_read_b32 v47, a55
    v_mul_f32 v40, v40, v34
    v_mul_f32 v41, v41, v34
    v_mul_f32 v42, v42, v34
    v_mul_f32 v43, v43, v34
    v_mul_f32 v44, v44, v34
    v_mul_f32 v45, v45, v34
    v_mul_f32 v46, v46, v34
    v_mul_f32 v47, v47, v34
    v_accvgpr_write_b32 a48, v40
    v_accvgpr_write_b32 a49, v41
    v_accvgpr_write_b32 a50, v42
    v_accvgpr_write_b32 a51, v43
    v_accvgpr_write_b32 a52, v44
    v_accvgpr_write_b32 a53, v45
    v_accvgpr_write_b32 a54, v46
    v_accvgpr_write_b32 a55, v47
    v_accvgpr_read_b32 v40, a56
    v_accvgpr_read_b32 v41, a57
    v_accvgpr_read_b32 v42, a58
    v_accvgpr_read_b32 v43, a59
    v_accvgpr_read_b32 v44, a60
    v_accvgpr_read_b32 v45, a61
    v_accvgpr_read_b32 v46, a62
    v_accvgpr_read_b32 v47, a63
    v_mul_f32 v40, v40, v34
    v_mul_f32 v41, v41, v34
    v_mul_f32 v42, v42, v34
    v_mul_f32 v43, v43, v34
    v_mul_f32 v44, v44, v34
    v_mul_f32 v45, v45, v34
    v_mul_f32 v46, v46, v34
    v_mul_f32 v47, v47, v34
    v_accvgpr_write_b32 a56, v40
    v_accvgpr_write_b32 a57, v41
    v_accvgpr_write_b32 a58, v42
    v_accvgpr_write_b32 a59, v43
    v_accvgpr_write_b32 a60, v44
    v_accvgpr_write_b32 a61, v45
    v_accvgpr_write_b32 a62, v46
    v_accvgpr_write_b32 a63, v47
    v_subrev_u32 v32, s75, v9
    v_cmp_ge_i32 s[40:41], v32, 0
    v_cmp_ge_i32 s[42:43], v32, 1
    v_cmp_ge_i32 s[44:45], v32, 2
    v_cmp_ge_i32 s[46:47], v32, 3
    v_cndmask_b32 v144, v17, v144, s[40:41]
    v_cndmask_b32 v145, v17, v145, s[42:43]
    v_cndmask_b32 v146, v17, v146, s[44:45]
    v_cndmask_b32 v147, v17, v147, s[46:47]
    v_cmp_ge_i32 s[40:41], v32, 8
    v_cmp_ge_i32 s[42:43], v32, 9
    v_cmp_ge_i32 s[44:45], v32, 10
    v_cmp_ge_i32 s[46:47], v32, 11
    v_cndmask_b32 v148, v17, v148, s[40:41]
    v_cndmask_b32 v149, v17, v149, s[42:43]
    v_cndmask_b32 v150, v17, v150, s[44:45]
    v_cndmask_b32 v151, v17, v151, s[46:47]
    v_cmp_ge_i32 s[40:41], v32, 16
    v_cmp_ge_i32 s[42:43], v32, 17
    v_cmp_ge_i32 s[44:45], v32, 18
    v_cmp_ge_i32 s[46:47], v32, 19
    v_cndmask_b32 v152, v17, v152, s[40:41]
    v_cndmask_b32 v153, v17, v153, s[42:43]
    v_cndmask_b32 v154, v17, v154, s[44:45]
    v_cndmask_b32 v155, v17, v155, s[46:47]
    v_cmp_ge_i32 s[40:41], v32, 24
    v_cmp_ge_i32 s[42:43], v32, 25
    v_cmp_ge_i32 s[44:45], v32, 26
    v_cmp_ge_i32 s[46:47], v32, 27
    v_cndmask_b32 v156, v17, v156, s[40:41]
    v_cndmask_b32 v157, v17, v157, s[42:43]
    v_cndmask_b32 v158, v17, v158, s[44:45]
    v_cndmask_b32 v159, v17, v159, s[46:47]
    v_max3_f32 v33, v144, v145, v146
    v_max3_f32 v33, v33, v147, v148
    v_max3_f32 v33, v33, v149, v150
    v_max3_f32 v33, v33, v151, v152
    v_max3_f32 v33, v33, v153, v154
    v_max3_f32 v33, v33, v155, v156
    v_max3_f32 v33, v33, v157, v158
    v_max_f32 v33, v33, v159
    v_mov_b32 v35, v33
    s_nop 1
    v_permlane32_swap_b32 v33, v35
    v_max_f32 v33, v33, v35
    v_max_f32 v33, 0, v33
    v_sub_f32 v34, 0, v33
    v_exp_f32 v34, v34
    v_sub_f32 v144, v144, v33
    v_sub_f32 v145, v145, v33
    v_sub_f32 v146, v146, v33
    v_sub_f32 v147, v147, v33
    v_sub_f32 v148, v148, v33
    v_sub_f32 v149, v149, v33
    v_sub_f32 v150, v150, v33
    v_sub_f32 v151, v151, v33
    v_sub_f32 v152, v152, v33
    v_sub_f32 v153, v153, v33
    v_sub_f32 v154, v154, v33
    v_sub_f32 v155, v155, v33
    v_sub_f32 v156, v156, v33
    v_sub_f32 v157, v157, v33
    v_sub_f32 v158, v158, v33
    v_sub_f32 v159, v159, v33
    v_mul_f32 v25, v11, v34
    v_exp_f32 v40, v144
    v_exp_f32 v41, v145
    v_exp_f32 v42, v146
    v_exp_f32 v43, v147
    v_exp_f32 v44, v148
    v_exp_f32 v45, v149
    v_exp_f32 v46, v150
    v_exp_f32 v47, v151
    v_exp_f32 v48, v152
    v_exp_f32 v49, v153
    v_exp_f32 v50, v154
    v_exp_f32 v51, v155
    v_exp_f32 v52, v156
    v_exp_f32 v53, v157
    v_exp_f32 v54, v158
    v_exp_f32 v55, v159
    v_sub_f32 v176, v176, v33
    v_sub_f32 v177, v177, v33
    v_sub_f32 v178, v178, v33
    v_sub_f32 v179, v179, v33
    v_sub_f32 v180, v180, v33
    v_sub_f32 v181, v181, v33
    v_sub_f32 v182, v182, v33
    v_sub_f32 v183, v183, v33
    v_sub_f32 v184, v184, v33
    v_sub_f32 v185, v185, v33
    v_sub_f32 v186, v186, v33
    v_sub_f32 v187, v187, v33
    v_sub_f32 v188, v188, v33
    v_sub_f32 v189, v189, v33
    v_sub_f32 v190, v190, v33
    v_sub_f32 v191, v191, v33
    v_add_f32 v25, v25, v40
    v_add_f32 v25, v25, v41
    v_add_f32 v25, v25, v42
    v_add_f32 v25, v25, v43
    v_add_f32 v25, v25, v44
    v_add_f32 v25, v25, v45
    v_add_f32 v25, v25, v46
    v_add_f32 v25, v25, v47
    v_add_f32 v25, v25, v48
    v_add_f32 v25, v25, v49
    v_add_f32 v25, v25, v50
    v_add_f32 v25, v25, v51
    v_add_f32 v25, v25, v52
    v_add_f32 v25, v25, v53
    v_add_f32 v25, v25, v54
    v_add_f32 v25, v25, v55
    v_cvt_pk_bf16_f32 v232, v40, v41
    v_cvt_pk_bf16_f32 v233, v42, v43
    v_cvt_pk_bf16_f32 v234, v44, v45
    v_cvt_pk_bf16_f32 v235, v46, v47
    v_cvt_pk_bf16_f32 v236, v48, v49
    v_cvt_pk_bf16_f32 v237, v50, v51
    v_cvt_pk_bf16_f32 v238, v52, v53
    v_cvt_pk_bf16_f32 v239, v54, v55
    v_sub_f32 v208, v208, v33
    v_sub_f32 v209, v209, v33
    v_sub_f32 v210, v210, v33
    v_sub_f32 v211, v211, v33
    v_sub_f32 v212, v212, v33
    v_sub_f32 v213, v213, v33
    v_sub_f32 v214, v214, v33
    v_sub_f32 v215, v215, v33
    v_sub_f32 v216, v216, v33
    v_sub_f32 v217, v217, v33
    v_sub_f32 v218, v218, v33
    v_sub_f32 v219, v219, v33
    v_sub_f32 v220, v220, v33
    v_sub_f32 v221, v221, v33
    v_sub_f32 v222, v222, v33
    v_sub_f32 v223, v223, v33
    v_accvgpr_read_b32 v40, a64
    v_accvgpr_read_b32 v41, a65
    v_accvgpr_read_b32 v42, a66
    v_accvgpr_read_b32 v43, a67
    v_accvgpr_read_b32 v44, a68
    v_accvgpr_read_b32 v45, a69
    v_accvgpr_read_b32 v46, a70
    v_accvgpr_read_b32 v47, a71
    v_mul_f32 v40, v40, v34
    v_mul_f32 v41, v41, v34
    v_mul_f32 v42, v42, v34
    v_mul_f32 v43, v43, v34
    v_mul_f32 v44, v44, v34
    v_mul_f32 v45, v45, v34
    v_mul_f32 v46, v46, v34
    v_mul_f32 v47, v47, v34
    v_accvgpr_write_b32 a64, v40
    v_accvgpr_write_b32 a65, v41
    v_accvgpr_write_b32 a66, v42
    v_accvgpr_write_b32 a67, v43
    v_accvgpr_write_b32 a68, v44
    v_accvgpr_write_b32 a69, v45
    v_accvgpr_write_b32 a70, v46
    v_accvgpr_write_b32 a71, v47
    v_accvgpr_read_b32 v40, a72
    v_accvgpr_read_b32 v41, a73
    v_accvgpr_read_b32 v42, a74
    v_accvgpr_read_b32 v43, a75
    v_accvgpr_read_b32 v44, a76
    v_accvgpr_read_b32 v45, a77
    v_accvgpr_read_b32 v46, a78
    v_accvgpr_read_b32 v47, a79
    v_mul_f32 v40, v40, v34
    v_mul_f32 v41, v41, v34
    v_mul_f32 v42, v42, v34
    v_mul_f32 v43, v43, v34
    v_mul_f32 v44, v44, v34
    v_mul_f32 v45, v45, v34
    v_mul_f32 v46, v46, v34
    v_mul_f32 v47, v47, v34
    v_accvgpr_write_b32 a72, v40
    v_accvgpr_write_b32 a73, v41
    v_accvgpr_write_b32 a74, v42
    v_accvgpr_write_b32 a75, v43
    v_accvgpr_write_b32 a76, v44
    v_accvgpr_write_b32 a77, v45
    v_accvgpr_write_b32 a78, v46
    v_accvgpr_write_b32 a79, v47
    v_accvgpr_read_b32 v40, a80
    v_accvgpr_read_b32 v41, a81
    v_accvgpr_read_b32 v42, a82
    v_accvgpr_read_b32 v43, a83
    v_accvgpr_read_b32 v44, a84
    v_accvgpr_read_b32 v45, a85
    v_accvgpr_read_b32 v46, a86
    v_accvgpr_read_b32 v47, a87
    v_mul_f32 v40, v40, v34
    v_mul_f32 v41, v41, v34
    v_mul_f32 v42, v42, v34
    v_mul_f32 v43, v43, v34
    v_mul_f32 v44, v44, v34
    v_mul_f32 v45, v45, v34
    v_mul_f32 v46, v46, v34
    v_mul_f32 v47, v47, v34
    v_accvgpr_write_b32 a80, v40
    v_accvgpr_write_b32 a81, v41
    v_accvgpr_write_b32 a82, v42
    v_accvgpr_write_b32 a83, v43
    v_accvgpr_write_b32 a84, v44
    v_accvgpr_write_b32 a85, v45
    v_accvgpr_write_b32 a86, v46
    v_accvgpr_write_b32 a87, v47
    v_accvgpr_read_b32 v40, a88
    v_accvgpr_read_b32 v41, a89
    v_accvgpr_read_b32 v42, a90
    v_accvgpr_read_b32 v43, a91
    v_accvgpr_read_b32 v44, a92
    v_accvgpr_read_b32 v45, a93
    v_accvgpr_read_b32 v46, a94
    v_accvgpr_read_b32 v47, a95
    v_mul_f32 v40, v40, v34
    v_mul_f32 v41, v41, v34
    v_mul_f32 v42, v42, v34
    v_mul_f32 v43, v43, v34
    v_mul_f32 v44, v44, v34
    v_mul_f32 v45, v45, v34
    v_mul_f32 v46, v46, v34
    v_mul_f32 v47, v47, v34
    v_accvgpr_write_b32 a88, v40
    v_accvgpr_write_b32 a89, v41
    v_accvgpr_write_b32 a90, v42
    v_accvgpr_write_b32 a91, v43
    v_accvgpr_write_b32 a92, v44
    v_accvgpr_write_b32 a93, v45
    v_accvgpr_write_b32 a94, v46
    v_accvgpr_write_b32 a95, v47
    v_accvgpr_read_b32 v40, a96
    v_accvgpr_read_b32 v41, a97
    v_accvgpr_read_b32 v42, a98
    v_accvgpr_read_b32 v43, a99
    v_accvgpr_read_b32 v44, a100
    v_accvgpr_read_b32 v45, a101
    v_accvgpr_read_b32 v46, a102
    v_accvgpr_read_b32 v47, a103
    v_mul_f32 v40, v40, v34
    v_mul_f32 v41, v41, v34
    v_mul_f32 v42, v42, v34
    v_mul_f32 v43, v43, v34
    v_mul_f32 v44, v44, v34
    v_mul_f32 v45, v45, v34
    v_mul_f32 v46, v46, v34
    v_mul_f32 v47, v47, v34
    v_accvgpr_write_b32 a96, v40
    v_accvgpr_write_b32 a97, v41
    v_accvgpr_write_b32 a98, v42
    v_accvgpr_write_b32 a99, v43
    v_accvgpr_write_b32 a100, v44
    v_accvgpr_write_b32 a101, v45
    v_accvgpr_write_b32 a102, v46
    v_accvgpr_write_b32 a103, v47
    v_accvgpr_read_b32 v40, a104
    v_accvgpr_read_b32 v41, a105
    v_accvgpr_read_b32 v42, a106
    v_accvgpr_read_b32 v43, a107
    v_accvgpr_read_b32 v44, a108
    v_accvgpr_read_b32 v45, a109
    v_accvgpr_read_b32 v46, a110
    v_accvgpr_read_b32 v47, a111
    v_mul_f32 v40, v40, v34
    v_mul_f32 v41, v41, v34
    v_mul_f32 v42, v42, v34
    v_mul_f32 v43, v43, v34
    v_mul_f32 v44, v44, v34
    v_mul_f32 v45, v45, v34
    v_mul_f32 v46, v46, v34
    v_mul_f32 v47, v47, v34
    v_accvgpr_write_b32 a104, v40
    v_accvgpr_write_b32 a105, v41
    v_accvgpr_write_b32 a106, v42
    v_accvgpr_write_b32 a107, v43
    v_accvgpr_write_b32 a108, v44
    v_accvgpr_write_b32 a109, v45
    v_accvgpr_write_b32 a110, v46
    v_accvgpr_write_b32 a111, v47
    v_accvgpr_read_b32 v40, a112
    v_accvgpr_read_b32 v41, a113
    v_accvgpr_read_b32 v42, a114
    v_accvgpr_read_b32 v43, a115
    v_accvgpr_read_b32 v44, a116
    v_accvgpr_read_b32 v45, a117
    v_accvgpr_read_b32 v46, a118
    v_accvgpr_read_b32 v47, a119
    v_mul_f32 v40, v40, v34
    v_mul_f32 v41, v41, v34
    v_mul_f32 v42, v42, v34
    v_mul_f32 v43, v43, v34
    v_mul_f32 v44, v44, v34
    v_mul_f32 v45, v45, v34
    v_mul_f32 v46, v46, v34
    v_mul_f32 v47, v47, v34
    v_accvgpr_write_b32 a112, v40
    v_accvgpr_write_b32 a113, v41
    v_accvgpr_write_b32 a114, v42
    v_accvgpr_write_b32 a115, v43
    v_accvgpr_write_b32 a116, v44
    v_accvgpr_write_b32 a117, v45
    v_accvgpr_write_b32 a118, v46
    v_accvgpr_write_b32 a119, v47
    v_accvgpr_read_b32 v40, a120
    v_accvgpr_read_b32 v41, a121
    v_accvgpr_read_b32 v42, a122
    v_accvgpr_read_b32 v43, a123
    v_accvgpr_read_b32 v44, a124
    v_accvgpr_read_b32 v45, a125
    v_accvgpr_read_b32 v46, a126
    v_accvgpr_read_b32 v47, a127
    v_mul_f32 v40, v40, v34
    v_mul_f32 v41, v41, v34
    v_mul_f32 v42, v42, v34
    v_mul_f32 v43, v43, v34
    v_mul_f32 v44, v44, v34
    v_mul_f32 v45, v45, v34
    v_mul_f32 v46, v46, v34
    v_mul_f32 v47, v47, v34
    v_accvgpr_write_b32 a120, v40
    v_accvgpr_write_b32 a121, v41
    v_accvgpr_write_b32 a122, v42
    v_accvgpr_write_b32 a123, v43
    v_accvgpr_write_b32 a124, v44
    v_accvgpr_write_b32 a125, v45
    v_accvgpr_write_b32 a126, v46
    v_accvgpr_write_b32 a127, v47
    s_nop 3
    s_cmp_eq_u32 s76, 0
    s_cbranch_scc1 K2_RET_V0a
    s_cmp_eq_u32 s76, 2
    s_cbranch_scc1 K2_RET_V1a
    s_cmp_eq_u32 s76, 4
    s_cbranch_scc1 K2_RET_V2a
    s_cmp_eq_u32 s76, 6
    s_cbranch_scc1 K2_RET_V2La
    s_cmp_eq_u32 s76, 9
    s_cbranch_scc1 K2_RET_P1
    s_cmp_eq_u32 s76, 11
    s_cbranch_scc1 K2_RET_P2b
    s_branch K2_RET_P4
K2_RARE1:
    s_nop 15
    s_nop 7
    v_subrev_u32 v32, s75, v8
    v_cmp_ge_i32 s[40:41], v32, 0
    v_cmp_ge_i32 s[42:43], v32, 1
    v_cmp_ge_i32 s[44:45], v32, 2
    v_cmp_ge_i32 s[46:47], v32, 3
    v_cndmask_b32 v160, v17, v160, s[40:41]
    v_cndmask_b32 v161, v17, v161, s[42:43]
    v_cndmask_b32 v162, v17, v162, s[44:45]
    v_cndmask_b32 v163, v17, v163, s[46:47]
    v_cmp_ge_i32 s[40:41], v32, 8
    v_cmp_ge_i32 s[42:43], v32, 9
    v_cmp_ge_i32 s[44:45], v32, 10
    v_cmp_ge_i32 s[46:47], v32, 11
    v_cndmask_b32 v164, v17, v164, s[40:41]
    v_cndmask_b32 v165, v17, v165, s[42:43]
    v_cndmask_b32 v166, v17, v166, s[44:45]
    v_cndmask_b32 v167, v17, v167, s[46:47]
    v_cmp_ge_i32 s[40:41], v32, 16
    v_cmp_ge_i32 s[42:43], v32, 17
    v_cmp_ge_i32 s[44:45], v32, 18
    v_cmp_ge_i32 s[46:47], v32, 19
    v_cndmask_b32 v168, v17, v168, s[40:41]
    v_cndmask_b32 v169, v17, v169, s[42:43]
    v_cndmask_b32 v170, v17, v170, s[44:45]
    v_cndmask_b32 v171, v17, v171, s[46:47]
    v_cmp_ge_i32 s[40:41], v32, 24
    v_cmp_ge_i32 s[42:43], v32, 25
    v_cmp_ge_i32 s[44:45], v32, 26
    v_cmp_ge_i32 s[46:47], v32, 27
    v_cndmask_b32 v172, v17, v172, s[40:41]
    v_cndmask_b32 v173, v17, v173, s[42:43]
    v_cndmask_b32 v174, v17, v174, s[44:45]
    v_cndmask_b32 v175, v17, v175, s[46:47]
    v_max3_f32 v33, v160, v161, v162
    v_max3_f32 v33, v33, v163, v164
    v_max3_f32 v33, v33, v165, v166
    v_max3_f32 v33, v33, v167, v168
    v_max3_f32 v33, v33, v169, v170
    v_max3_f32 v33, v33, v171, v172
    v_max3_f32 v33, v33, v173, v174
    v_max_f32 v33, v33, v175
    v_mov_b32 v35, v33
    s_nop 1
    v_permlane32_swap_b32 v33, v35
    v_max_f32 v33, v33, v35
    v_max_f32 v33, 0, v33
    v_sub_f32 v34, 0, v33
    v_exp_f32 v34, v34
    v_sub_f32 v160, v160, v33
    v_sub_f32 v161, v161, v33
    v_sub_f32 v162, v162, v33
    v_sub_f32 v163, v163, v33
    v_sub_f32 v164, v164, v33
    v_sub_f32 v165, v165, v33
    v_sub_f32 v166, v166, v33
    v_sub_f32 v167, v167, v33
    v_sub_f32 v168, v168, v33
    v_sub_f32 v169, v169, v33
    v_sub_f32 v170, v170, v33
    v_sub_f32 v171, v171, v33
    v_sub_f32 v172, v172, v33
    v_sub_f32 v173, v173, v33
    v_sub_f32 v174, v174, v33
    v_sub_f32 v175, v175, v33
    v_mul_f32 v10, v24, v34
    v_exp_f32 v40, v160
    v_exp_f32 v41, v161
    v_exp_f32 v42, v162
    v_exp_f32 v43, v163
    v_exp_f32 v44, v164
    v_exp_f32 v45, v165
    v_exp_f32 v46, v166
    v_exp_f32 v47, v167
    v_exp_f32 v48, v168
    v_exp_f32 v49, v169
    v_exp_f32 v50, v170
    v_exp_f32 v51, v171
    v_exp_f32 v52, v172
    v_exp_f32 v53, v173
    v_exp_f32 v54, v174
    v_exp_f32 v55, v175
    v_sub_f32 v128, v128, v33
    v_sub_f32 v129, v129, v33
    v_sub_f32 v130, v130, v33
    v_sub_f32 v131, v131, v33
    v_sub_f32 v132, v132, v33
    v_sub_f32 v133, v133, v33
    v_sub_f32 v134, v134, v33
    v_sub_f32 v135, v135, v33
    v_sub_f32 v136, v136, v33
    v_sub_f32 v137, v137, v33
    v_sub_f32 v138, v138, v33
    v_sub_f32 v139, v139, v33
    v_sub_f32 v140, v140, v33
    v_sub_f32 v141, v141, v33
    v_sub_f32 v142, v142, v33
    v_sub_f32 v143, v143, v33
    v_add_f32 v10, v10, v40
    v_add_f32 v10, v10, v41
    v_add_f32 v10, v10, v42
    v_add_f32 v10, v10, v43
    v_add_f32 v10, v10, v44
    v_add_f32 v10, v10, v45
    v_add_f32 v10, v10, v46
    v_add_f32 v10, v10, v47
    v_add_f32 v10, v10, v48
    v_add_f32 v10, v10, v49
    v_add_f32 v10, v10, v50
    v_add_f32 v10, v10, v51
    v_add_f32 v10, v10, v52
    v_add_f32 v10, v10, v53
    v_add_f32 v10, v10, v54
    v_add_f32 v10, v10, v55
    v_cvt_pk_bf16_f32 v240, v40, v41
    v_cvt_pk_bf16_f32 v241, v42, v43
    v_cvt_pk_bf16_f32 v242, v44, v45
    v_cvt_pk_bf16_f32 v243, v46, v47
    v_cvt_pk_bf16_f32 v244, v48, v49
    v_cvt_pk_bf16_f32 v245, v50, v51
    v_cvt_pk_bf16_f32 v246, v52, v53
    v_cvt_pk_bf16_f32 v247, v54, v55
    v_sub_f32 v192, v192, v33
    v_sub_f32 v193, v193, v33
    v_sub_f32 v194, v194, v33
    v_sub_f32 v195, v195, v33
    v_sub_f32 v196, v196, v33
    v_sub_f32 v197, v197, v33
    v_sub_f32 v198, v198, v33
    v_sub_f32 v199, v199, v33
    v_sub_f32 v200, v200, v33
    v_sub_f32 v201, v201, v33
    v_sub_f32 v202, v202, v33
    v_sub_f32 v203, v203, v33
    v_sub_f32 v204, v204, v33
    v_sub_f32 v205, v205, v33
    v_sub_f32 v206, v206, v33
    v_sub_f32 v207, v207, v33
    v_accvgpr_read_b32 v40, a0
    v_accvgpr_read_b32 v41, a1
    v_accvgpr_read_b32 v42, a2
    v_accvgpr_read_b32 v43, a3
    v_accvgpr_read_b32 v44, a4
    v_accvgpr_read_b32 v45, a5
    v_accvgpr_read_b32 v46, a6
    v_accvgpr_read_b32 v47, a7
    v_mul_f32 v40, v40, v34
    v_mul_f32 v41, v41, v34
    v_mul_f32 v42, v42, v34
    v_mul_f32 v43, v43, v34
    v_mul_f32 v44, v44, v34
    v_mul_f32 v45, v45, v34
    v_mul_f32 v46, v46, v34
    v_mul_f32 v47, v47, v34
    v_accvgpr_write_b32 a0, v40
    v_accvgpr_write_b32 a1, v41
    v_accvgpr_write_b32 a2, v42
    v_accvgpr_write_b32 a3, v43
    v_accvgpr_write_b32 a4, v44
    v_accvgpr_write_b32 a5, v45
    v_accvgpr_write_b32 a6, v46
    v_accvgpr_write_b32 a7, v47
    v_accvgpr_read_b32 v40, a8
    v_accvgpr_read_b32 v41, a9
    v_accvgpr_read_b32 v42, a10
    v_accvgpr_read_b32 v43, a11
    v_accvgpr_read_b32 v44, a12
    v_accvgpr_read_b32 v45, a13
    v_accvgpr_read_b32 v46, a14
    v_accvgpr_read_b32 v47, a15
    v_mul_f32 v40, v40, v34
    v_mul_f32 v41, v41, v34
    v_mul_f32 v42, v42, v34
    v_mul_f32 v43, v43, v34
    v_mul_f32 v44, v44, v34
    v_mul_f32 v45, v45, v34
    v_mul_f32 v46, v46, v34
    v_mul_f32 v47, v47, v34
    v_accvgpr_write_b32 a8, v40
    v_accvgpr_write_b32 a9, v41
    v_accvgpr_write_b32 a10, v42
    v_accvgpr_write_b32 a11, v43
    v_accvgpr_write_b32 a12, v44
    v_accvgpr_write_b32 a13, v45
    v_accvgpr_write_b32 a14, v46
    v_accvgpr_write_b32 a15, v47
    v_accvgpr_read_b32 v40, a16
    v_accvgpr_read_b32 v41, a17
    v_accvgpr_read_b32 v42, a18
    v_accvgpr_read_b32 v43, a19
    v_accvgpr_read_b32 v44, a20
    v_accvgpr_read_b32 v45, a21
    v_accvgpr_read_b32 v46, a22
    v_accvgpr_read_b32 v47, a23
    v_mul_f32 v40, v40, v34
    v_mul_f32 v41, v41, v34
    v_mul_f32 v42, v42, v34
    v_mul_f32 v43, v43, v34
    v_mul_f32 v44, v44, v34
    v_mul_f32 v45, v45, v34
    v_mul_f32 v46, v46, v34
    v_mul_f32 v47, v47, v34
    v_accvgpr_write_b32 a16, v40
    v_accvgpr_write_b32 a17, v41
    v_accvgpr_write_b32 a18, v42
    v_accvgpr_write_b32 a19, v43
    v_accvgpr_write_b32 a20, v44
    v_accvgpr_write_b32 a21, v45
    v_accvgpr_write_b32 a22, v46
    v_accvgpr_write_b32 a23, v47
    v_accvgpr_read_b32 v40, a24
    v_accvgpr_read_b32 v41, a25
    v_accvgpr_read_b32 v42, a26
    v_accvgpr_read_b32 v43, a27
    v_accvgpr_read_b32 v44, a28
    v_accvgpr_read_b32 v45, a29
    v_accvgpr_read_b32 v46, a30
    v_accvgpr_read_b32 v47, a31
    v_mul_f32 v40, v40, v34
    v_mul_f32 v41, v41, v34
    v_mul_f32 v42, v42, v34
    v_mul_f32 v43, v43, v34
    v_mul_f32 v44, v44, v34
    v_mul_f32 v45, v45, v34
    v_mul_f32 v46, v46, v34
    v_mul_f32 v47, v47, v34
    v_accvgpr_write_b32 a24, v40
    v_accvgpr_write_b32 a25, v41
    v_accvgpr_write_b32 a26, v42
    v_accvgpr_write_b32 a27, v43
    v_accvgpr_write_b32 a28, v44
    v_accvgpr_write_b32 a29, v45
    v_accvgpr_write_b32 a30, v46
    v_accvgpr_write_b32 a31, v47
    v_accvgpr_read_b32 v40, a32
    v_accvgpr_read_b32 v41, a33
    v_accvgpr_read_b32 v42, a34
    v_accvgpr_read_b32 v43, a35
    v_accvgpr_read_b32 v44, a36
    v_accvgpr_read_b32 v45, a37
    v_accvgpr_read_b32 v46, a38
    v_accvgpr_read_b32 v47, a39
    v_mul_f32 v40, v40, v34
    v_mul_f32 v41, v41, v34
    v_mul_f32 v42, v42, v34
    v_mul_f32 v43, v43, v34
    v_mul_f32 v44, v44, v34
    v_mul_f32 v45, v45, v34
    v_mul_f32 v46, v46, v34
    v_mul_f32 v47, v47, v34
    v_accvgpr_write_b32 a32, v40
    v_accvgpr_write_b32 a33, v41
    v_accvgpr_write_b32 a34, v42
    v_accvgpr_write_b32 a35, v43
    v_accvgpr_write_b32 a36, v44
    v_accvgpr_write_b32 a37, v45
    v_accvgpr_write_b32 a38, v46
    v_accvgpr_write_b32 a39, v47
    v_accvgpr_read_b32 v40, a40
    v_accvgpr_read_b32 v41, a41
    v_accvgpr_read_b32 v42, a42
    v_accvgpr_read_b32 v43, a43
    v_accvgpr_read_b32 v44, a44
    v_accvgpr_read_b32 v45, a45
    v_accvgpr_read_b32 v46, a46
    v_accvgpr_read_b32 v47, a47
    v_mul_f32 v40, v40, v34
    v_mul_f32 v41, v41, v34
    v_mul_f32 v42, v42, v34
    v_mul_f32 v43, v43, v34
    v_mul_f32 v44, v44, v34
    v_mul_f32 v45, v45, v34
    v_mul_f32 v46, v46, v34
    v_mul_f32 v47, v47, v34
    v_accvgpr_write_b32 a40, v40
    v_accvgpr_write_b32 a41, v41
    v_accvgpr_write_b32 a42, v42
    v_accvgpr_write_b32 a43, v43
    v_accvgpr_write_b32 a44, v44
    v_accvgpr_write_b32 a45, v45
    v_accvgpr_write_b32 a46, v46
    v_accvgpr_write_b32 a47, v47
    v_accvgpr_read_b32 v40, a48
    v_accvgpr_read_b32 v41, a49
    v_accvgpr_read_b32 v42, a50
    v_accvgpr_read_b32 v43, a51
    v_accvgpr_read_b32 v44, a52
    v_accvgpr_read_b32 v45, a53
    v_accvgpr_read_b32 v46, a54
    v_accvgpr_read_b32 v47, a55
    v_mul_f32 v40, v40, v34
    v_mul_f32 v41, v41, v34
    v_mul_f32 v42, v42, v34
    v_mul_f32 v43, v43, v34
    v_mul_f32 v44, v44, v34
    v_mul_f32 v45, v45, v34
    v_mul_f32 v46, v46, v34
    v_mul_f32 v47, v47, v34
    v_accvgpr_write_b32 a48, v40
    v_accvgpr_write_b32 a49, v41
    v_accvgpr_write_b32 a50, v42
    v_accvgpr_write_b32 a51, v43
    v_accvgpr_write_b32 a52, v44
    v_accvgpr_write_b32 a53, v45
    v_accvgpr_write_b32 a54, v46
    v_accvgpr_write_b32 a55, v47
    v_accvgpr_read_b32 v40, a56
    v_accvgpr_read_b32 v41, a57
    v_accvgpr_read_b32 v42, a58
    v_accvgpr_read_b32 v43, a59
    v_accvgpr_read_b32 v44, a60
    v_accvgpr_read_b32 v45, a61
    v_accvgpr_read_b32 v46, a62
    v_accvgpr_read_b32 v47, a63
    v_mul_f32 v40, v40, v34
    v_mul_f32 v41, v41, v34
    v_mul_f32 v42, v42, v34
    v_mul_f32 v43, v43, v34
    v_mul_f32 v44, v44, v34
    v_mul_f32 v45, v45, v34
    v_mul_f32 v46, v46, v34
    v_mul_f32 v47, v47, v34
    v_accvgpr_write_b32 a56, v40
    v_accvgpr_write_b32 a57, v41
    v_accvgpr_write_b32 a58, v42
    v_accvgpr_write_b32 a59, v43
    v_accvgpr_write_b32 a60, v44
    v_accvgpr_write_b32 a61, v45
    v_accvgpr_write_b32 a62, v46
    v_accvgpr_write_b32 a63, v47
    v_subrev_u32 v32, s75, v9
    v_cmp_ge_i32 s[40:41], v32, 0
    v_cmp_ge_i32 s[42:43], v32, 1
    v_cmp_ge_i32 s[44:45], v32, 2
    v_cmp_ge_i32 s[46:47], v32, 3
    v_cndmask_b32 v176, v17, v176, s[40:41]
    v_cndmask_b32 v177, v17, v177, s[42:43]
    v_cndmask_b32 v178, v17, v178, s[44:45]
    v_cndmask_b32 v179, v17, v179, s[46:47]
    v_cmp_ge_i32 s[40:41], v32, 8
    v_cmp_ge_i32 s[42:43], v32, 9
    v_cmp_ge_i32 s[44:45], v32, 10
    v_cmp_ge_i32 s[46:47], v32, 11
    v_cndmask_b32 v180, v17, v180, s[40:41]
    v_cndmask_b32 v181, v17, v181, s[42:43]
    v_cndmask_b32 v182, v17, v182, s[44:45]
    v_cndmask_b32 v183, v17, v183, s[46:47]
    v_cmp_ge_i32 s[40:41], v32, 16
    v_cmp_ge_i32 s[42:43], v32, 17
    v_cmp_ge_i32 s[44:45], v32, 18
    v_cmp_ge_i32 s[46:47], v32, 19
    v_cndmask_b32 v184, v17, v184, s[40:41]
    v_cndmask_b32 v185, v17, v185, s[42:43]
    v_cndmask_b32 v186, v17, v186, s[44:45]
    v_cndmask_b32 v187, v17, v187, s[46:47]
    v_cmp_ge_i32 s[40:41], v32, 24
    v_cmp_ge_i32 s[42:43], v32, 25
    v_cmp_ge_i32 s[44:45], v32, 26
    v_cmp_ge_i32 s[46:47], v32, 27
    v_cndmask_b32 v188, v17, v188, s[40:41]
    v_cndmask_b32 v189, v17, v189, s[42:43]
    v_cndmask_b32 v190, v17, v190, s[44:45]
    v_cndmask_b32 v191, v17, v191, s[46:47]
    v_max3_f32 v33, v176, v177, v178
    v_max3_f32 v33, v33, v179, v180
    v_max3_f32 v33, v33, v181, v182
    v_max3_f32 v33, v33, v183, v184
    v_max3_f32 v33, v33, v185, v186
    v_max3_f32 v33, v33, v187, v188
    v_max3_f32 v33, v33, v189, v190
    v_max_f32 v33, v33, v191
    v_mov_b32 v35, v33
    s_nop 1
    v_permlane32_swap_b32 v33, v35
    v_max_f32 v33, v33, v35
    v_max_f32 v33, 0, v33
    v_sub_f32 v34, 0, v33
    v_exp_f32 v34, v34
    v_sub_f32 v176, v176, v33
    v_sub_f32 v177, v177, v33
    v_sub_f32 v178, v178, v33
    v_sub_f32 v179, v179, v33
    v_sub_f32 v180, v180, v33
    v_sub_f32 v181, v181, v33
    v_sub_f32 v182, v182, v33
    v_sub_f32 v183, v183, v33
    v_sub_f32 v184, v184, v33
    v_sub_f32 v185, v185, v33
    v_sub_f32 v186, v186, v33
    v_sub_f32 v187, v187, v33
    v_sub_f32 v188, v188, v33
    v_sub_f32 v189, v189, v33
    v_sub_f32 v190, v190, v33
    v_sub_f32 v191, v191, v33
    v_mul_f32 v11, v25, v34
    v_exp_f32 v40, v176
    v_exp_f32 v41, v177
    v_exp_f32 v42, v178
    v_exp_f32 v43, v179
    v_exp_f32 v44, v180
    v_exp_f32 v45, v181
    v_exp_f32 v46, v182
    v_exp_f32 v47, v183
    v_exp_f32 v48, v184
    v_exp_f32 v49, v185
    v_exp_f32 v50, v186
    v_exp_f32 v51, v187
    v_exp_f32 v52, v188
    v_exp_f32 v53, v189
    v_exp_f32 v54, v190
    v_exp_f32 v55, v191
    v_sub_f32 v144, v144, v33
    v_sub_f32 v145, v145, v33
    v_sub_f32 v146, v146, v33
    v_sub_f32 v147, v147, v33
    v_sub_f32 v148, v148, v33
    v_sub_f32 v149, v149, v33
    v_sub_f32 v150, v150, v33
    v_sub_f32 v151, v151, v33
    v_sub_f32 v152, v152, v33
    v_sub_f32 v153, v153, v33
    v_sub_f32 v154, v154, v33
    v_sub_f32 v155, v155, v33
    v_sub_f32 v156, v156, v33
    v_sub_f32 v157, v157, v33
    v_sub_f32 v158, v158, v33
    v_sub_f32 v159, v159, v33
    v_add_f32 v11, v11, v40
    v_add_f32 v11, v11, v41
    v_add_f32 v11, v11, v42
    v_add_f32 v11, v11, v43
    v_add_f32 v11, v11, v44
    v_add_f32 v11, v11, v45
    v_add_f32 v11, v11, v46
    v_add_f32 v11, v11, v47
    v_add_f32 v11, v11, v48
    v_add_f32 v11, v11, v49
    v_add_f32 v11, v11, v50
    v_add_f32 v11, v11, v51
    v_add_f32 v11, v11, v52
    v_add_f32 v11, v11, v53
    v_add_f32 v11, v11, v54
    v_add_f32 v11, v11, v55
    v_cvt_pk_bf16_f32 v248, v40, v41
    v_cvt_pk_bf16_f32 v249, v42, v43
    v_cvt_pk_bf16_f32 v250, v44, v45
    v_cvt_pk_bf16_f32 v251, v46, v47
    v_cvt_pk_bf16_f32 v252, v48, v49
    v_cvt_pk_bf16_f32 v253, v50, v51
    v_cvt_pk_bf16_f32 v254, v52, v53
    v_cvt_pk_bf16_f32 v255, v54, v55
    v_sub_f32 v208, v208, v33
    v_sub_f32 v209, v209, v33
    v_sub_f32 v210, v210, v33
    v_sub_f32 v211, v211, v33
    v_sub_f32 v212, v212, v33
    v_sub_f32 v213, v213, v33
    v_sub_f32 v214, v214, v33
    v_sub_f32 v215, v215, v33
    v_sub_f32 v216, v216, v33
    v_sub_f32 v217, v217, v33
    v_sub_f32 v218, v218, v33
    v_sub_f32 v219, v219, v33
    v_sub_f32 v220, v220, v33
    v_sub_f32 v221, v221, v33
    v_sub_f32 v222, v222, v33
    v_sub_f32 v223, v223, v33
    v_accvgpr_read_b32 v40, a64
    v_accvgpr_read_b32 v41, a65
    v_accvgpr_read_b32 v42, a66
    v_accvgpr_read_b32 v43, a67
    v_accvgpr_read_b32 v44, a68
    v_accvgpr_read_b32 v45, a69
    v_accvgpr_read_b32 v46, a70
    v_accvgpr_read_b32 v47, a71
    v_mul_f32 v40, v40, v34
    v_mul_f32 v41, v41, v34
    v_mul_f32 v42, v42, v34
    v_mul_f32 v43, v43, v34
    v_mul_f32 v44, v44, v34
    v_mul_f32 v45, v45, v34
    v_mul_f32 v46, v46, v34
    v_mul_f32 v47, v47, v34
    v_accvgpr_write_b32 a64, v40
    v_accvgpr_write_b32 a65, v41
    v_accvgpr_write_b32 a66, v42
    v_accvgpr_write_b32 a67, v43
    v_accvgpr_write_b32 a68, v44
    v_accvgpr_write_b32 a69, v45
    v_accvgpr_write_b32 a70, v46
    v_accvgpr_write_b32 a71, v47
    v_accvgpr_read_b32 v40, a72
    v_accvgpr_read_b32 v41, a73
    v_accvgpr_read_b32 v42, a74
    v_accvgpr_read_b32 v43, a75
    v_accvgpr_read_b32 v44, a76
    v_accvgpr_read_b32 v45, a77
    v_accvgpr_read_b32 v46, a78
    v_accvgpr_read_b32 v47, a79
    v_mul_f32 v40, v40, v34
    v_mul_f32 v41, v41, v34
    v_mul_f32 v42, v42, v34
    v_mul_f32 v43, v43, v34
    v_mul_f32 v44, v44, v34
    v_mul_f32 v45, v45, v34
    v_mul_f32 v46, v46, v34
    v_mul_f32 v47, v47, v34
    v_accvgpr_write_b32 a72, v40
    v_accvgpr_write_b32 a73, v41
    v_accvgpr_write_b32 a74, v42
    v_accvgpr_write_b32 a75, v43
    v_accvgpr_write_b32 a76, v44
    v_accvgpr_write_b32 a77, v45
    v_accvgpr_write_b32 a78, v46
    v_accvgpr_write_b32 a79, v47
    v_accvgpr_read_b32 v40, a80
    v_accvgpr_read_b32 v41, a81
    v_accvgpr_read_b32 v42, a82
    v_accvgpr_read_b32 v43, a83
    v_accvgpr_read_b32 v44, a84
    v_accvgpr_read_b32 v45, a85
    v_accvgpr_read_b32 v46, a86
    v_accvgpr_read_b32 v47, a87
    v_mul_f32 v40, v40, v34
    v_mul_f32 v41, v41, v34
    v_mul_f32 v42, v42, v34
    v_mul_f32 v43, v43, v34
    v_mul_f32 v44, v44, v34
    v_mul_f32 v45, v45, v34
    v_mul_f32 v46, v46, v34
    v_mul_f32 v47, v47, v34
    v_accvgpr_write_b32 a80, v40
    v_accvgpr_write_b32 a81, v41
    v_accvgpr_write_b32 a82, v42
    v_accvgpr_write_b32 a83, v43
    v_accvgpr_write_b32 a84, v44
    v_accvgpr_write_b32 a85, v45
    v_accvgpr_write_b32 a86, v46
    v_accvgpr_write_b32 a87, v47
    v_accvgpr_read_b32 v40, a88
    v_accvgpr_read_b32 v41, a89
    v_accvgpr_read_b32 v42, a90
    v_accvgpr_read_b32 v43, a91
    v_accvgpr_read_b32 v44, a92
    v_accvgpr_read_b32 v45, a93
    v_accvgpr_read_b32 v46, a94
    v_accvgpr_read_b32 v47, a95
    v_mul_f32 v40, v40, v34
    v_mul_f32 v41, v41, v34
    v_mul_f32 v42, v42, v34
    v_mul_f32 v43, v43, v34
    v_mul_f32 v44, v44, v34
    v_mul_f32 v45, v45, v34
    v_mul_f32 v46, v46, v34
    v_mul_f32 v47, v47, v34
    v_accvgpr_write_b32 a88, v40
    v_accvgpr_write_b32 a89, v41
    v_accvgpr_write_b32 a90, v42
    v_accvgpr_write_b32 a91, v43
    v_accvgpr_write_b32 a92, v44
    v_accvgpr_write_b32 a93, v45
    v_accvgpr_write_b32 a94, v46
    v_accvgpr_write_b32 a95, v47
    v_accvgpr_read_b32 v40, a96
    v_accvgpr_read_b32 v41, a97
    v_accvgpr_read_b32 v42, a98
    v_accvgpr_read_b32 v43, a99
    v_accvgpr_read_b32 v44, a100
    v_accvgpr_read_b32 v45, a101
    v_accvgpr_read_b32 v46, a102
    v_accvgpr_read_b32 v47, a103
    v_mul_f32 v40, v40, v34
    v_mul_f32 v41, v41, v34
    v_mul_f32 v42, v42, v34
    v_mul_f32 v43, v43, v34
    v_mul_f32 v44, v44, v34
    v_mul_f32 v45, v45, v34
    v_mul_f32 v46, v46, v34
    v_mul_f32 v47, v47, v34
    v_accvgpr_write_b32 a96, v40
    v_accvgpr_write_b32 a97, v41
    v_accvgpr_write_b32 a98, v42
    v_accvgpr_write_b32 a99, v43
    v_accvgpr_write_b32 a100, v44
    v_accvgpr_write_b32 a101, v45
    v_accvgpr_write_b32 a102, v46
    v_accvgpr_write_b32 a103, v47
    v_accvgpr_read_b32 v40, a104
    v_accvgpr_read_b32 v41, a105
    v_accvgpr_read_b32 v42, a106
    v_accvgpr_read_b32 v43, a107
    v_accvgpr_read_b32 v44, a108
    v_accvgpr_read_b32 v45, a109
    v_accvgpr_read_b32 v46, a110
    v_accvgpr_read_b32 v47, a111
    v_mul_f32 v40, v40, v34
    v_mul_f32 v41, v41, v34
    v_mul_f32 v42, v42, v34
    v_mul_f32 v43, v43, v34
    v_mul_f32 v44, v44, v34
    v_mul_f32 v45, v45, v34
    v_mul_f32 v46, v46, v34
    v_mul_f32 v47, v47, v34
    v_accvgpr_write_b32 a104, v40
    v_accvgpr_write_b32 a105, v41
    v_accvgpr_write_b32 a106, v42
    v_accvgpr_write_b32 a107, v43
    v_accvgpr_write_b32 a108, v44
    v_accvgpr_write_b32 a109, v45
    v_accvgpr_write_b32 a110, v46
    v_accvgpr_write_b32 a111, v47
    v_accvgpr_read_b32 v40, a112
    v_accvgpr_read_b32 v41, a113
    v_accvgpr_read_b32 v42, a114
    v_accvgpr_read_b32 v43, a115
    v_accvgpr_read_b32 v44, a116
    v_accvgpr_read_b32 v45, a117
    v_accvgpr_read_b32 v46, a118
    v_accvgpr_read_b32 v47, a119
    v_mul_f32 v40, v40, v34
    v_mul_f32 v41, v41, v34
    v_mul_f32 v42, v42, v34
    v_mul_f32 v43, v43, v34
    v_mul_f32 v44, v44, v34
    v_mul_f32 v45, v45, v34
    v_mul_f32 v46, v46, v34
    v_mul_f32 v47, v47, v34
    v_accvgpr_write_b32 a112, v40
    v_accvgpr_write_b32 a113, v41
    v_accvgpr_write_b32 a114, v42
    v_accvgpr_write_b32 a115, v43
    v_accvgpr_write_b32 a116, v44
    v_accvgpr_write_b32 a117, v45
    v_accvgpr_write_b32 a118, v46
    v_accvgpr_write_b32 a119, v47
    v_accvgpr_read_b32 v40, a120
    v_accvgpr_read_b32 v41, a121
    v_accvgpr_read_b32 v42, a122
    v_accvgpr_read_b32 v43, a123
    v_accvgpr_read_b32 v44, a124
    v_accvgpr_read_b32 v45, a125
    v_accvgpr_read_b32 v46, a126
    v_accvgpr_read_b32 v47, a127
    v_mul_f32 v40, v40, v34
    v_mul_f32 v41, v41, v34
    v_mul_f32 v42, v42, v34
    v_mul_f32 v43, v43, v34
    v_mul_f32 v44, v44, v34
    v_mul_f32 v45, v45, v34
    v_mul_f32 v46, v46, v34
    v_mul_f32 v47, v47, v34
    v_accvgpr_write_b32 a120, v40
    v_accvgpr_write_b32 a121, v41
    v_accvgpr_write_b32 a122, v42
    v_accvgpr_write_b32 a123, v43
    v_accvgpr_write_b32 a124, v44
    v_accvgpr_write_b32 a125, v45
    v_accvgpr_write_b32 a126, v46
    v_accvgpr_write_b32 a127, v47
    s_nop 3
    s_cmp_eq_u32 s76, 1
    s_cbranch_scc1 K2_RET_V0b
    s_cmp_eq_u32 s76, 3
    s_cbranch_scc1 K2_RET_V1b
    s_cmp_eq_u32 s76, 5
    s_cbranch_scc1 K2_RET_V2b
    s_cmp_eq_u32 s76, 7
    s_cbranch_scc1 K2_RET_V2Lb
    s_cmp_eq_u32 s76, 8
    s_cbranch_scc1 K2_RET_P0
    s_cmp_eq_u32 s76, 10
    s_cbranch_scc1 K2_RET_P2a
    s_branch K2_RET_P3
K2_END:
    s_endpgm
TEXT_END:
.section .rodata,"a"
.p2align 6
.amdhsa_kernel recurrent_scan__compressed_kv_cla__geglu_ffn__prompt_kernel
  .amdhsa_next_free_vgpr 512
  .amdhsa_next_free_sgpr 102
  .amdhsa_accum_offset 256
  .amdhsa_group_segment_fixed_size 0
  .amdhsa_kernarg_size 104
  .amdhsa_user_sgpr_count 2
  .amdhsa_user_sgpr_kernarg_segment_ptr 1
  .amdhsa_system_sgpr_workgroup_id_x 1
.end_amdhsa_kernel
```
